```python
import torch

def _softmax(x, axis=-1):
    return torch.softmax(x, dim=axis)
def _gelu(x):
    return torch.nn.functional.gelu(x, approximate="tanh")
def _silu(x):
    return torch.nn.functional.silu(x)
def _sigmoid(x):
    return torch.sigmoid(x)
def _layernorm(x, axis=-1, eps=1e-5):
    m = x.mean(dim=axis, keepdim=True)
    v = x.var(dim=axis, keepdim=True, unbiased=False)
    return (x - m) / torch.sqrt(v + eps)
def _scatter_add(tgt, idx, src, axis=0):
    return tgt.clone().index_add_(axis, idx, src)
def _segment_sum(src, seg, n):
    out = torch.zeros((n,) + src.shape[1:], dtype=src.dtype)
    return out.index_add_(0, seg, src)
def _pad(x, pw):
    flat = tuple(v for pair in reversed(pw) for v in pair)
    return torch.nn.functional.pad(x, flat)

kernel_name = 'recurrent_scan__ssm_conv_s5__mixer_channel_mlp__prompt'

def setup_inputs():

    _w = (lambda a: (lambda t: t.to(torch.bfloat16) if t.is_floating_point() else t)(torch.as_tensor(a)))
    def _A_setup():
        B, S, D = 1, 2048, 576
        P = D
        Lambda_re = -0.5 * (lambda _x: torch.exp(torch.as_tensor(_x)))((lambda *s: torch.randn(*s, dtype=torch.bfloat16) * 0.2)(P))
        Lambda_im = (lambda *s: torch.randn(*s, dtype=torch.bfloat16) * 0.8)(P) * 1.0
        B_re = (lambda *s: torch.randn(*s, dtype=torch.bfloat16) * 0.2)(P, D) * (D ** -0.5)
        B_im = (lambda *s: torch.randn(*s, dtype=torch.bfloat16) * 0.2)(P, D) * (D ** -0.5)
        C_re = (lambda *s: torch.randn(*s, dtype=torch.bfloat16) * 0.2)(D, P) * (P ** -0.5)
        C_im = (lambda *s: torch.randn(*s, dtype=torch.bfloat16) * 0.2)(D, P) * (P ** -0.5)
        log_dt = (lambda *s: torch.randn(*s, dtype=torch.bfloat16) * 0.2)(P) * 0.3 - 2.0
        Dskip = (lambda *s: torch.randn(*s, dtype=torch.bfloat16) * 0.05)(D)
        return {
            "x": _w((lambda *s: torch.randn(*s, dtype=torch.bfloat16) * 0.05)(B, S, D)),
            "Lambda_re": _w(Lambda_re),
            "Lambda_im": _w(Lambda_im),
            "B_re": _w(B_re),
            "B_im": _w(B_im),
            "C_re": _w(C_re),
            "C_im": _w(C_im),
            "log_dt": _w(log_dt),
            "Dskip": _w(Dskip),
        }
    _A_in = _A_setup()

    def _B_setup():
        B, S, D, F = 1, 2048, 576, 4608
        return {
            "x": _w((lambda *s: torch.randn(*s, dtype=torch.bfloat16) * 0.05)(B, S, D)),
            "w1": _w((lambda *s: torch.randn(*s, dtype=torch.bfloat16) * 3.2)(D, F) * (D ** -0.5)),
            "b1": _w((lambda *s: torch.randn(*s, dtype=torch.bfloat16) * 1.6)(F)),
            "w2": _w((lambda *s: torch.randn(*s, dtype=torch.bfloat16) * 0.1)(F, D) * (F ** -0.5)),
            "b2": _w((lambda *s: torch.randn(*s, dtype=torch.bfloat16) * 0.1)(D)),
        }
    _B_in = _B_setup()

    return {
        "A_x": _A_in["x"],
        "A_Lambda_re": _A_in["Lambda_re"],
        "A_Lambda_im": _A_in["Lambda_im"],
        "A_B_re": _A_in["B_re"],
        "A_B_im": _A_in["B_im"],
        "A_C_re": _A_in["C_re"],
        "A_C_im": _A_in["C_im"],
        "A_log_dt": _A_in["log_dt"],
        "A_Dskip": _A_in["Dskip"],
        "B_x": _B_in["x"],
        "B_w1": _B_in["w1"],
        "B_b1": _B_in["b1"],
        "B_w2": _B_in["w2"],
        "B_b2": _B_in["b2"],
    }

def reference(A_x, A_Lambda_re, A_Lambda_im, A_B_re, A_B_im, A_C_re, A_C_im, A_log_dt, A_Dskip, B_x, B_w1, B_b1, B_w2, B_b2):
    def _A_ref(x, Lambda_re, Lambda_im, B_re, B_im, C_re, C_im, log_dt, Dskip):
        Bsz, L, H = x.shape
        Lam = Lambda_re + 1j * Lambda_im
        Bmat = B_re + 1j * B_im
        Cmat = C_re + 1j * C_im
        dt = torch.exp(log_dt)
        Lam_bar = torch.exp(dt * Lam)
        B_bar = ((Lam_bar - 1.0) / Lam)[:, None] * Bmat
        Bu = torch.einsum("bld,pd->blp", x + 0j, B_bar)
        h = torch.zeros_like(Bu[:, 0, :])
        hs = []
        for t in range(L):
            h = Lam_bar[None, :] * h + Bu[:, t, :]
            hs.append(h)
        hseq = torch.stack(hs, 1)
        y = 2.0 * torch.einsum("blp,dp->bld", hseq, Cmat).real + x * Dskip[None, None, :]
        return y

    def _B_ref(x, w1, b1, w2, b2):
        y = _layernorm(x, axis=-1)
        h = _gelu(torch.einsum("bsd,df->bsf", y, w1) + b1)
        return torch.einsum("bsf,fd->bsd", h, w2) + b2

    x = A_x
    xn = _layernorm(x, axis=-1)
    s = _A_ref(xn, A_Lambda_re, A_Lambda_im, A_B_re, A_B_im, A_C_re, A_C_im, A_log_dt, A_Dskip)
    g = _silu(_B_ref(xn, B_w1, B_b1, B_w2, B_b2))
    return x + s * g
```

```asm
; @launch grid=(256,1,1) block=(256,1,1) lds=163840
.amdgcn_target "amdgcn-amd-amdhsa--gfx950"
.text
.globl recurrent_scan__ssm_conv_s5__mixer_channel_mlp__prompt_kernel
.p2align 8
.type recurrent_scan__ssm_conv_s5__mixer_channel_mlp__prompt_kernel,@function
recurrent_scan__ssm_conv_s5__mixer_channel_mlp__prompt_kernel:
 s_cmp_ge_u32 s2, 256
 s_cbranch_scc1 L_end
 s_load_dwordx2 s[4:5], s[0:1], 0
 s_load_dwordx2 s[16:17], s[0:1], 128
 s_load_dwordx2 s[24:25], s[0:1], 120
 s_load_dwordx2 s[8:9], s[0:1], 80
 s_load_dwordx2 s[12:13], s[0:1], 96
 s_load_dwordx2 s[20:21], s[0:1], 88
 s_load_dwordx2 s[92:93], s[0:1], 24
 s_load_dwordx2 s[94:95], s[0:1], 32
 v_lshrrev_b32 v1, 6, v0
 v_and_b32 v2, 7, v0
 v_readfirstlane_b32 s31, v1
 s_getpc_b64 s[52:53]
L_pc0:
 s_and_b32 s53, s53, 0xffff
 s_mov_b32 s54, L_code_end-L_pc0
 s_mov_b32 s55, 0x20000
 s_lshr_b32 s38, s2, 3
 s_lshl_b32 s38, s38, 2
 s_add_u32 s38, s38, s31
 s_lshl_b32 s38, s38, 7
 v_lshlrev_b32 v2, 14, v2
 buffer_load_dword v255, v2, s[52:55], s38 offen
 s_cmp_lt_u32 s2, 16
 s_cbranch_scc1 L_help0
 s_sub_u32 s2, s2, 16
L_main:
 s_and_b32 s38, s2, 7
 s_lshr_b32 s39, s2, 3
 s_mul_i32 s40, s39, 43
 s_lshr_b32 s40, s40, 7
 s_mul_i32 s41, s40, 3
 s_sub_u32 s30, s39, s41
 s_lshr_b32 s29, s38, 1
 s_and_b32 s41, s38, 6
 s_add_u32 s41, s41, s40
 s_sub_u32 s41, s41, 8
 s_cmp_ge_u32 s40, 8
 s_cselect_b32 s29, 4, s29
 s_cselect_b32 s40, s41, s40
 s_and_b32 s38, s38, 1
 s_lshl_b32 s38, s38, 3
 s_add_u32 s28, s38, s40
 v_and_b32 v0, 63, v0
 v_lshrrev_b32 v1, 3, v0
 v_lshrrev_b32 v2, 4, v0
 v_xor_b32 v2, v0, v2
 v_and_b32 v2, 7, v2
 v_mul_u32_u24 v1, 1152, v1
 v_lshl_add_u32 v1, v2, 4, v1
 v_xor_b32 v2, 64, v1
 v_add_u32 v3, 4096, v1
 v_add_u32 v4, 12288, v2
 v_add_u32 v5, 2176, v1
 v_add_u32 v6, 10368, v2
 s_mul_i32 s36, s31, 6144
 s_lshl_b32 s51, s28, 2
 s_add_u32 s51, s51, s31
 s_mul_i32 s37, s51, 36864
 s_mul_i32 s38, s30, 384
 s_add_u32 s37, s37, s38
 s_waitcnt lgkmcnt(0)
 s_sub_u32 s4, s4, 4096
 s_subb_u32 s5, s5, 0
 s_and_b32 s5, s5, 0xffff
 s_mov_b32 s6, 0x241000
 s_mov_b32 s7, 0x20000
 s_add_u32 m0, s36, 98304
 s_add_u32 s38, s37, 0
 buffer_load_dwordx4 v3, s[4:7], s38 offen offset:0 lds
 buffer_load_dwordx4 v4, s[4:7], s38 offen offset:1024 lds
 buffer_load_dwordx4 v5, s[4:7], s38 offen offset:2048 lds
 buffer_load_dwordx4 v6, s[4:7], s38 offen offset:3072 lds
 s_add_u32 m0, s36, 102400
 s_add_u32 s38, s37, 256
 buffer_load_dwordx4 v3, s[4:7], s38 offen offset:0 lds
 buffer_load_dwordx4 v4, s[4:7], s38 offen offset:1024 lds
 s_add_u32 m0, s36, 122880
 s_add_u32 s38, s37, 18432
 buffer_load_dwordx4 v3, s[4:7], s38 offen offset:0 lds
 buffer_load_dwordx4 v4, s[4:7], s38 offen offset:1024 lds
 buffer_load_dwordx4 v5, s[4:7], s38 offen offset:2048 lds
 buffer_load_dwordx4 v6, s[4:7], s38 offen offset:3072 lds
 s_add_u32 m0, s36, 126976
 s_add_u32 s38, s37, 18688
 buffer_load_dwordx4 v3, s[4:7], s38 offen offset:0 lds
 buffer_load_dwordx4 v4, s[4:7], s38 offen offset:1024 lds
 s_cmp_eq_u32 s29, 4
 s_waitcnt lgkmcnt(0)
 s_cbranch_scc1 L_ssm
L_mlp:
 s_load_dwordx2 s[92:93], s[0:1], 64
 s_load_dwordx2 s[94:95], s[0:1], 104
 s_load_dwordx2 s[96:97], s[0:1], 40
 s_load_dwordx2 s[98:99], s[0:1], 48
 s_and_b32 s9, s9, 0xffff
 s_mov_b32 s10, 0x510000
 s_mov_b32 s11, 0x20000
 s_mul_i32 s39, s29, 2304
 s_mul_i32 s40, s30, 768
 s_add_u32 s32, s39, s40
 s_and_b32 s17, s17, 0xffff
 s_mov_b32 s18, 0x2700000
 s_mov_b32 s19, 0x20000
 s_and_b32 s25, s25, 0xffff
 s_mov_b32 s26, 0x100
 s_mov_b32 s27, 0x20000
 s_sub_u32 s12, s12, 4096
 s_subb_u32 s13, s13, 0
 s_and_b32 s13, s13, 0xffff
 s_mov_b32 s14, 0x511000
 s_mov_b32 s15, 0x20000
 v_lshlrev_b32 v1, 2, v0
 s_cmp_lt_u32 s31, 2
 s_waitcnt lgkmcnt(0)
 s_cselect_b32 s52, s92, s94
 s_cselect_b32 s53, s93, s95
 s_and_b32 s53, s53, 0xffff
 s_mov_b32 s54, 0x480
 s_mov_b32 s55, 0x20000
 s_and_b32 s41, s31, 1
 s_lshl_b32 s41, s41, 8
 s_mul_i32 s40, s30, 384
 s_add_u32 s41, s41, s40
 buffer_load_dword v72, v1, s[52:55], s41 offen
 s_bitcmp0_b32 s29, 0
 s_cselect_b32 s52, s96, s98
 s_cselect_b32 s53, s97, s99
 s_sub_u32 s52, s52, 4096
 s_subb_u32 s53, s53, 0
 s_and_b32 s53, s53, 0xffff
 s_mov_b32 s54, 0xa3000
 s_mov_b32 s55, 0x20000
 s_mul_i32 s92, s51, 9
 s_lshr_b32 s92, s92, 1
 s_lshr_b32 s93, s29, 1
 s_mul_i32 s93, s93, 288
 s_add_u32 s92, s92, s93
 s_min_u32 s92, s92, 570
 s_mul_i32 s92, s92, 1152
 s_add_u32 s92, s92, s40
 s_lshl_b32 s90, s32, 3
 s_add_u32 s90, s90, 0x60000
 s_lshl_b32 s23, s31, 10
 s_add_u32 s23, s23, 151552
 s_mul_i32 s38, s31, 442368
 s_add_u32 s32, s32, s38
 s_mul_i32 s38, s30, 1769472
 s_add_u32 s20, s32, s38
 s_mov_b32 s40, 1769472
 s_cmp_eq_u32 s30, 2
 s_cselect_b32 s38, -3538944, s40
 s_add_u32 s21, s20, s38
 s_cmp_eq_u32 s30, 1
 s_cselect_b32 s38, -3538944, s40
 s_add_u32 s22, s21, s38
 s_mul_i32 s38, s29, 1327104
 s_mul_i32 s39, s30, 384
 s_add_u32 s38, s38, s39
 s_mul_i32 s91, s51, 20736
 s_add_u32 s91, s91, s38
 s_mul_i32 s39, s31, 18432
 s_add_u32 s49, s38, s39
 s_lshl_b32 s39, s28, 2
 s_add_u32 s39, s39, s29
 s_mul_i32 s39, s39, 3
 s_add_u32 s40, s30, 0
 s_cmp_ge_u32 s40, 3
 s_cselect_b32 s41, 3, 0
 s_sub_u32 s40, s40, s41
 s_mul_i32 s41, s40, 442368
 s_add_u32 s33, s49, s41
 s_add_u32 s40, s40, s39
 s_lshl_b32 s41, s40, 2
 s_add_u32 s41, s41, s31
 s_lshl_b32 s47, s41, 5
 s_mul_i32 s40, s40, 98304
 s_lshl_b32 s41, s31, 12
 s_add_u32 s40, s40, s41
 s_add_u32 s42, s40, 0x1500000
 s_add_u32 s40, s30, 1
 s_cmp_ge_u32 s40, 3
 s_cselect_b32 s41, 3, 0
 s_sub_u32 s40, s40, s41
 s_mul_i32 s41, s40, 442368
 s_add_u32 s34, s49, s41
 s_add_u32 s40, s40, s39
 s_lshl_b32 s41, s40, 2
 s_add_u32 s41, s41, s31
 s_lshl_b32 s41, s41, 5
 v_mov_b32 v57, s41
 s_mul_i32 s40, s40, 98304
 s_lshl_b32 s41, s31, 12
 s_add_u32 s40, s40, s41
 s_add_u32 s43, s40, 0x1500000
 s_add_u32 s40, s30, 2
 s_cmp_ge_u32 s40, 3
 s_cselect_b32 s41, 3, 0
 s_sub_u32 s40, s40, s41
 s_mul_i32 s41, s40, 442368
 s_add_u32 s35, s49, s41
 s_add_u32 s40, s40, s39
 s_lshl_b32 s41, s40, 2
 s_add_u32 s41, s41, s31
 s_lshl_b32 s41, s41, 5
 v_mov_b32 v58, s41
 s_mul_i32 s40, s40, 98304
 s_lshl_b32 s41, s31, 12
 s_add_u32 s40, s40, s41
 s_add_u32 s44, s40, 0x1500000
 v_cmp_gt_u32 vcc, 32, v0
 s_nop 1
 v_cndmask_b32 v17, v58, v57, vcc
 v_lshrrev_b32 v58, 3, v0
 v_and_b32 v59, 7, v0
 v_lshrrev_b32 v60, 2, v0
 v_and_b32 v60, 4, v60
 v_xor_b32 v59, v59, v60
 v_lshlrev_b32 v59, 4, v59
 v_mul_u32_u24 v60, 1152, v58
 v_add_u32 v60, v60, v59
 v_mov_b32 v69, v60
 v_and_b32 v60, 3, v58
 v_lshrrev_b32 v58, 2, v58
 v_lshl_add_u32 v58, v58, 3, v60
 v_mul_u32_u24 v58, 9216, v58
 v_add_u32 v7, v58, v59
 v_add_u32 v8, 35840, v7
 v_add_u32 v9, 145408, v7
 v_add_u32 v10, 181248, v7
 v_lshrrev_b32 v58, 5, v0
 v_lshlrev_b32 v58, 2, v58
 v_bfe_u32 v59, v0, 2, 2
 v_add_u32 v58, v58, v59
 v_lshlrev_b32 v58, 7, v58
 v_and_b32 v59, 3, v0
 v_lshl_add_u32 v58, v59, 3, v58
 v_bfe_u32 v59, v0, 4, 1
 v_lshl_add_u32 v58, v59, 5, v58
 v_bfe_u32 v59, v0, 3, 1
 v_lshl_add_u32 v1, v59, 6, v58
 v_xor_b32 v2, 64, v1
 v_lshlrev_b32 v11, 4, v0
 s_mov_b32 s50, 0xffff0000
 s_mul_i32 s39, s28, 3
 s_add_u32 s39, s39, s30
 s_lshl_b32 s39, s39, 2
 s_add_u32 s39, s39, s31
 s_mul_i32 s39, s39, 104704
 s_add_u32 s48, s39, 0x100000
 v_min_u32 v58, 17, v0
 v_mul_u32_u24 v59, 43, v58
 v_lshrrev_b32 v59, 7, v59
 v_mul_u32_u24 v59, 768, v59
 v_lshl_add_u32 v119, v58, 7, v59
 v_add_u32 v119, 4096, v119
 v_and_b32 v68, 31, v0
 v_lshl_add_u32 v12, v68, 4, s23
 v_lshrrev_b32 v58, 4, v68
 v_mul_u32_u24 v58, 24576, v58
 v_and_b32 v59, 15, v68
 v_lshl_add_u32 v58, v59, 7, v58
 v_add_u32 v58, s36, v58
 v_add_u32 v58, 49152, v58
 v_lshrrev_b32 v59, 1, v59
 v_lshrrev_b32 v117, 5, v0
 v_xor_b32 v59, v59, v117
 v_lshl_add_u32 v114, v59, 4, v58
 v_xor_b32 v115, 32, v114
 v_xor_b32 v116, 64, v114
 v_xor_b32 v117, 96, v114
 s_add_u32 m0, s36, 0
 s_add_u32 s38, s20, 0
 buffer_load_dwordx4 v7, s[8:11], s38 offen offset:0 lds
 buffer_load_dwordx4 v8, s[8:11], s38 offen offset:1024 lds
 buffer_load_dwordx4 v9, s[8:11], s38 offen offset:2048 lds
 buffer_load_dwordx4 v10, s[8:11], s38 offen offset:3072 lds
 s_add_u32 m0, s36, 4096
 s_add_u32 s38, s20, 294912
 buffer_load_dwordx4 v7, s[8:11], s38 offen offset:0 lds
 buffer_load_dwordx4 v8, s[8:11], s38 offen offset:1024 lds
 s_cmp_eq_u32 s30, 2
 s_mov_b32 s38, 384
 s_cselect_b32 s38, -768, s38
 s_add_u32 s37, s37, s38
 s_add_u32 m0, s36, 49152
 s_add_u32 s38, s37, 0
 buffer_load_dwordx4 v3, s[4:7], s38 offen offset:0 lds
 buffer_load_dwordx4 v4, s[4:7], s38 offen offset:1024 lds
 buffer_load_dwordx4 v5, s[4:7], s38 offen offset:2048 lds
 buffer_load_dwordx4 v6, s[4:7], s38 offen offset:3072 lds
 s_add_u32 m0, s36, 53248
 s_add_u32 s38, s37, 256
 buffer_load_dwordx4 v3, s[4:7], s38 offen offset:0 lds
 buffer_load_dwordx4 v4, s[4:7], s38 offen offset:1024 lds
 s_add_u32 m0, s36, 73728
 s_add_u32 s38, s37, 18432
 buffer_load_dwordx4 v3, s[4:7], s38 offen offset:0 lds
 buffer_load_dwordx4 v4, s[4:7], s38 offen offset:1024 lds
 buffer_load_dwordx4 v5, s[4:7], s38 offen offset:2048 lds
 buffer_load_dwordx4 v6, s[4:7], s38 offen offset:3072 lds
 s_add_u32 m0, s36, 77824
 s_add_u32 s38, s37, 18688
 buffer_load_dwordx4 v3, s[4:7], s38 offen offset:0 lds
 buffer_load_dwordx4 v4, s[4:7], s38 offen offset:1024 lds
 s_add_u32 m0, s36, 24576
 s_add_u32 s38, s21, 0
 buffer_load_dwordx4 v7, s[8:11], s38 offen offset:0 lds
 buffer_load_dwordx4 v8, s[8:11], s38 offen offset:1024 lds
 buffer_load_dwordx4 v9, s[8:11], s38 offen offset:2048 lds
 buffer_load_dwordx4 v10, s[8:11], s38 offen offset:3072 lds
 s_add_u32 m0, s36, 28672
 s_add_u32 s38, s21, 294912
 buffer_load_dwordx4 v7, s[8:11], s38 offen offset:0 lds
 buffer_load_dwordx4 v8, s[8:11], s38 offen offset:1024 lds
 s_lshl_b32 s40, s31, 9
 s_add_u32 s40, s40, 147456
 v_lshl_add_u32 v61, v0, 3, s40
 s_waitcnt vmcnt(24)
 v_lshlrev_b32 v74, 16, v72
 v_and_b32 v75, s50, v72
 ds_write_b64 v61, v[74:75] offset:2048
 v_mov_b32 v108, 0x3f803f80
 ds_read_b128 v[120:123], v114 offset:49152
 ds_read_b128 v[124:127], v115 offset:49152
 ds_read_b128 v[128:131], v116 offset:49152
 ds_read_b128 v[132:135], v117 offset:49152
 ds_read_b128 v[136:139], v114 offset:51200
 ds_read_b128 v[140:143], v115 offset:51200
 ds_read_b128 v[144:147], v116 offset:51200
 ds_read_b128 v[148:151], v117 offset:51200
 ds_read_b128 v[152:155], v114 offset:53248
 ds_read_b128 v[156:159], v115 offset:53248
 ds_read_b128 v[160:163], v116 offset:53248
 ds_read_b128 v[164:167], v117 offset:53248
 s_waitcnt lgkmcnt(0)
 s_cmp_eq_u32 s30, 1
 s_mov_b32 s38, 384
 s_cselect_b32 s38, -768, s38
 s_add_u32 s37, s37, s38
 s_add_u32 m0, s36, 98304
 s_add_u32 s38, s37, 0
 buffer_load_dwordx4 v3, s[4:7], s38 offen offset:0 lds
 v_dot2_f32_bf16 v104, v120, v108, 0
 v_dot2_f32_bf16 v105, v120, v120, 0
 v_dot2_f32_bf16 v106, v121, v108, 0
 v_dot2_f32_bf16 v107, v121, v121, 0
 v_dot2_f32_bf16 v104, v122, v108, v104
 v_dot2_f32_bf16 v105, v122, v122, v105
 v_dot2_f32_bf16 v106, v123, v108, v106
 v_dot2_f32_bf16 v107, v123, v123, v107
 buffer_load_dwordx4 v4, s[4:7], s38 offen offset:1024 lds
 v_dot2_f32_bf16 v104, v124, v108, v104
 v_dot2_f32_bf16 v105, v124, v124, v105
 v_dot2_f32_bf16 v106, v125, v108, v106
 v_dot2_f32_bf16 v107, v125, v125, v107
 v_dot2_f32_bf16 v104, v126, v108, v104
 v_dot2_f32_bf16 v105, v126, v126, v105
 v_dot2_f32_bf16 v106, v127, v108, v106
 v_dot2_f32_bf16 v107, v127, v127, v107
 buffer_load_dwordx4 v5, s[4:7], s38 offen offset:2048 lds
 v_dot2_f32_bf16 v104, v128, v108, v104
 v_dot2_f32_bf16 v105, v128, v128, v105
 v_dot2_f32_bf16 v106, v129, v108, v106
 v_dot2_f32_bf16 v107, v129, v129, v107
 v_dot2_f32_bf16 v104, v130, v108, v104
 v_dot2_f32_bf16 v105, v130, v130, v105
 v_dot2_f32_bf16 v106, v131, v108, v106
 v_dot2_f32_bf16 v107, v131, v131, v107
 buffer_load_dwordx4 v6, s[4:7], s38 offen offset:3072 lds
 v_dot2_f32_bf16 v104, v132, v108, v104
 v_dot2_f32_bf16 v105, v132, v132, v105
 v_dot2_f32_bf16 v106, v133, v108, v106
 v_dot2_f32_bf16 v107, v133, v133, v107
 v_dot2_f32_bf16 v104, v134, v108, v104
 v_dot2_f32_bf16 v105, v134, v134, v105
 v_dot2_f32_bf16 v106, v135, v108, v106
 v_dot2_f32_bf16 v107, v135, v135, v107
 s_add_u32 m0, s36, 102400
 s_add_u32 s38, s37, 256
 buffer_load_dwordx4 v3, s[4:7], s38 offen offset:0 lds
 v_dot2_f32_bf16 v104, v136, v108, v104
 v_dot2_f32_bf16 v105, v136, v136, v105
 v_dot2_f32_bf16 v106, v137, v108, v106
 v_dot2_f32_bf16 v107, v137, v137, v107
 v_dot2_f32_bf16 v104, v138, v108, v104
 v_dot2_f32_bf16 v105, v138, v138, v105
 v_dot2_f32_bf16 v106, v139, v108, v106
 v_dot2_f32_bf16 v107, v139, v139, v107
 buffer_load_dwordx4 v4, s[4:7], s38 offen offset:1024 lds
 v_dot2_f32_bf16 v104, v140, v108, v104
 v_dot2_f32_bf16 v105, v140, v140, v105
 v_dot2_f32_bf16 v106, v141, v108, v106
 v_dot2_f32_bf16 v107, v141, v141, v107
 v_dot2_f32_bf16 v104, v142, v108, v104
 v_dot2_f32_bf16 v105, v142, v142, v105
 v_dot2_f32_bf16 v106, v143, v108, v106
 v_dot2_f32_bf16 v107, v143, v143, v107
 s_add_u32 m0, s36, 122880
 s_add_u32 s38, s37, 18432
 buffer_load_dwordx4 v3, s[4:7], s38 offen offset:0 lds
 v_dot2_f32_bf16 v104, v144, v108, v104
 v_dot2_f32_bf16 v105, v144, v144, v105
 v_dot2_f32_bf16 v106, v145, v108, v106
 v_dot2_f32_bf16 v107, v145, v145, v107
 v_dot2_f32_bf16 v104, v146, v108, v104
 v_dot2_f32_bf16 v105, v146, v146, v105
 v_dot2_f32_bf16 v106, v147, v108, v106
 v_dot2_f32_bf16 v107, v147, v147, v107
 buffer_load_dwordx4 v4, s[4:7], s38 offen offset:1024 lds
 v_dot2_f32_bf16 v104, v148, v108, v104
 v_dot2_f32_bf16 v105, v148, v148, v105
 v_dot2_f32_bf16 v106, v149, v108, v106
 v_dot2_f32_bf16 v107, v149, v149, v107
 v_dot2_f32_bf16 v104, v150, v108, v104
 v_dot2_f32_bf16 v105, v150, v150, v105
 v_dot2_f32_bf16 v106, v151, v108, v106
 v_dot2_f32_bf16 v107, v151, v151, v107
 buffer_load_dwordx4 v5, s[4:7], s38 offen offset:2048 lds
 v_dot2_f32_bf16 v104, v152, v108, v104
 v_dot2_f32_bf16 v105, v152, v152, v105
 v_dot2_f32_bf16 v106, v153, v108, v106
 v_dot2_f32_bf16 v107, v153, v153, v107
 v_dot2_f32_bf16 v104, v154, v108, v104
 v_dot2_f32_bf16 v105, v154, v154, v105
 v_dot2_f32_bf16 v106, v155, v108, v106
 v_dot2_f32_bf16 v107, v155, v155, v107
 buffer_load_dwordx4 v6, s[4:7], s38 offen offset:3072 lds
 v_dot2_f32_bf16 v104, v156, v108, v104
 v_dot2_f32_bf16 v105, v156, v156, v105
 v_dot2_f32_bf16 v106, v157, v108, v106
 v_dot2_f32_bf16 v107, v157, v157, v107
 v_dot2_f32_bf16 v104, v158, v108, v104
 v_dot2_f32_bf16 v105, v158, v158, v105
 v_dot2_f32_bf16 v106, v159, v108, v106
 v_dot2_f32_bf16 v107, v159, v159, v107
 s_add_u32 m0, s36, 126976
 s_add_u32 s38, s37, 18688
 buffer_load_dwordx4 v3, s[4:7], s38 offen offset:0 lds
 v_dot2_f32_bf16 v104, v160, v108, v104
 v_dot2_f32_bf16 v105, v160, v160, v105
 v_dot2_f32_bf16 v106, v161, v108, v106
 v_dot2_f32_bf16 v107, v161, v161, v107
 v_dot2_f32_bf16 v104, v162, v108, v104
 v_dot2_f32_bf16 v105, v162, v162, v105
 v_dot2_f32_bf16 v106, v163, v108, v106
 v_dot2_f32_bf16 v107, v163, v163, v107
 buffer_load_dwordx4 v4, s[4:7], s38 offen offset:1024 lds
 v_dot2_f32_bf16 v104, v164, v108, v104
 v_dot2_f32_bf16 v105, v164, v164, v105
 v_dot2_f32_bf16 v106, v165, v108, v106
 v_dot2_f32_bf16 v107, v165, v165, v107
 v_dot2_f32_bf16 v104, v166, v108, v104
 v_dot2_f32_bf16 v105, v166, v166, v105
 v_dot2_f32_bf16 v106, v167, v108, v106
 v_dot2_f32_bf16 v107, v167, v167, v107
 s_cmp_eq_u32 s30, 0
 s_mov_b32 s38, 384
 s_cselect_b32 s38, -768, s38
 s_add_u32 s37, s37, s38
 v_add_u32 v3, 4096, v69
 v_add_u32 v4, 12288, v69
 v_add_u32 v5, 2176, v69
 v_add_u32 v6, 10368, v69
 s_waitcnt vmcnt(30)
 s_waitcnt lgkmcnt(0)
 s_barrier
 ds_read_b64_tr_b16 a[96:97], v1 offset:0
 ds_read_b64_tr_b16 a[98:99], v1 offset:1024
 ds_read_b64_tr_b16 a[100:101], v2 offset:0
 ds_read_b64_tr_b16 a[102:103], v2 offset:1024
 ds_read_b64_tr_b16 a[104:105], v1 offset:2048
 ds_read_b64_tr_b16 a[106:107], v1 offset:3072
 ds_read_b64_tr_b16 a[108:109], v2 offset:2048
 ds_read_b64_tr_b16 a[110:111], v2 offset:3072
 ds_read_b64_tr_b16 a[112:113], v1 offset:4096
 ds_read_b64_tr_b16 a[114:115], v1 offset:5120
 s_waitcnt lgkmcnt(8)
 v_mfma_f32_32x32x16_bf16 v[24:39], a[96:99], v[120:123], 0
 ds_read_b64_tr_b16 a[116:117], v2 offset:4096
 ds_read_b64_tr_b16 a[118:119], v2 offset:5120
 s_waitcnt lgkmcnt(8)
 v_mfma_f32_32x32x16_bf16 v[40:55], a[100:103], v[120:123], 0
 ds_read_b64_tr_b16 a[120:121], v1 offset:6144
 ds_read_b64_tr_b16 a[122:123], v1 offset:7168
 s_waitcnt lgkmcnt(6)
 v_mfma_f32_32x32x16_bf16 v[24:39], a[104:107], v[124:127], v[24:39]
 ds_read_b64_tr_b16 a[124:125], v2 offset:6144
 ds_read_b64_tr_b16 a[126:127], v2 offset:7168
 v_mfma_f32_32x32x16_bf16 v[40:55], a[108:111], v[124:127], v[40:55]
 ds_read_b64_tr_b16 a[96:97], v1 offset:8192
 ds_read_b64_tr_b16 a[98:99], v1 offset:9216
 s_waitcnt lgkmcnt(6)
 v_mfma_f32_32x32x16_bf16 v[24:39], a[112:115], v[128:131], v[24:39]
 ds_read_b64_tr_b16 a[100:101], v2 offset:8192
 ds_read_b64_tr_b16 a[102:103], v2 offset:9216
 v_mfma_f32_32x32x16_bf16 v[40:55], a[116:119], v[128:131], v[40:55]
 ds_read_b64_tr_b16 a[104:105], v1 offset:10240
 ds_read_b64_tr_b16 a[106:107], v1 offset:11264
 s_waitcnt lgkmcnt(6)
 v_mfma_f32_32x32x16_bf16 v[24:39], a[120:123], v[132:135], v[24:39]
 ds_read_b64_tr_b16 a[108:109], v2 offset:10240
 ds_read_b64_tr_b16 a[110:111], v2 offset:11264
 s_waitcnt vmcnt(18)
 ds_read_b128 v[168:171], v114 offset:0
 ds_read_b128 v[172:175], v115 offset:0
 ds_read_b128 v[176:179], v116 offset:0
 ds_read_b128 v[180:183], v117 offset:0
 v_mfma_f32_32x32x16_bf16 v[40:55], a[124:127], v[132:135], v[40:55]
 ds_read_b64_tr_b16 a[112:113], v1 offset:12288
 ds_read_b64_tr_b16 a[114:115], v1 offset:13312
 ds_read_b128 v[184:187], v114 offset:2048
 ds_read_b128 v[188:191], v115 offset:2048
 ds_read_b128 v[192:195], v116 offset:2048
 ds_read_b128 v[196:199], v117 offset:2048
 s_waitcnt lgkmcnt(14)
 v_mfma_f32_32x32x16_bf16 v[24:39], a[96:99], v[136:139], v[24:39]
 ds_read_b64_tr_b16 a[116:117], v2 offset:12288
 ds_read_b64_tr_b16 a[118:119], v2 offset:13312
 ds_read_b128 v[200:203], v114 offset:4096
 ds_read_b128 v[204:207], v115 offset:4096
 ds_read_b128 v[208:211], v116 offset:4096
 ds_read_b128 v[212:215], v117 offset:4096
 v_mfma_f32_32x32x16_bf16 v[40:55], a[100:103], v[136:139], v[40:55]
 ds_read_b64_tr_b16 a[120:121], v1 offset:14336
 ds_read_b64_tr_b16 a[122:123], v1 offset:15360
 s_waitcnt lgkmcnt(15)
 v_mfma_f32_32x32x16_bf16 v[24:39], a[104:107], v[140:143], v[24:39]
 ds_read_b64_tr_b16 a[124:125], v2 offset:14336
 ds_read_b64_tr_b16 a[126:127], v2 offset:15360
 s_waitcnt lgkmcnt(4)
 s_add_u32 m0, s36, 49152
 s_add_u32 s38, s22, 0
 buffer_load_dwordx4 v7, s[8:11], s38 offen offset:0 lds
 v_dot2_f32_bf16 v104, v168, v108, v104
 v_dot2_f32_bf16 v105, v168, v168, v105
 v_mfma_f32_32x32x16_bf16 v[40:55], a[108:111], v[140:143], v[40:55]
 ds_read_b64_tr_b16 a[96:97], v1 offset:16384
 ds_read_b64_tr_b16 a[98:99], v1 offset:17408
 buffer_load_dwordx4 v8, s[8:11], s38 offen offset:1024 lds
 v_dot2_f32_bf16 v106, v169, v108, v106
 v_dot2_f32_bf16 v107, v169, v169, v107
 v_dot2_f32_bf16 v104, v170, v108, v104
 v_mfma_f32_32x32x16_bf16 v[24:39], a[112:115], v[144:147], v[24:39]
 ds_read_b64_tr_b16 a[100:101], v2 offset:16384
 ds_read_b64_tr_b16 a[102:103], v2 offset:17408
 buffer_load_dwordx4 v9, s[8:11], s38 offen offset:2048 lds
 v_dot2_f32_bf16 v105, v170, v170, v105
 v_dot2_f32_bf16 v106, v171, v108, v106
 v_dot2_f32_bf16 v107, v171, v171, v107
 v_dot2_f32_bf16 v104, v172, v108, v104
 v_mfma_f32_32x32x16_bf16 v[40:55], a[116:119], v[144:147], v[40:55]
 ds_read_b64_tr_b16 a[104:105], v1 offset:18432
 ds_read_b64_tr_b16 a[106:107], v1 offset:19456
 buffer_load_dwordx4 v10, s[8:11], s38 offen offset:3072 lds
 s_waitcnt lgkmcnt(6)
 v_dot2_f32_bf16 v105, v172, v172, v105
 v_dot2_f32_bf16 v106, v173, v108, v106
 v_dot2_f32_bf16 v107, v173, v173, v107
 v_mfma_f32_32x32x16_bf16 v[24:39], a[120:123], v[148:151], v[24:39]
 ds_read_b64_tr_b16 a[108:109], v2 offset:18432
 ds_read_b64_tr_b16 a[110:111], v2 offset:19456
 s_add_u32 m0, s36, 53248
 s_add_u32 s38, s22, 294912
 buffer_load_dwordx4 v7, s[8:11], s38 offen offset:0 lds
 v_dot2_f32_bf16 v104, v174, v108, v104
 v_dot2_f32_bf16 v105, v174, v174, v105
 v_mfma_f32_32x32x16_bf16 v[40:55], a[124:127], v[148:151], v[40:55]
 ds_read_b64_tr_b16 a[112:113], v1 offset:20480
 ds_read_b64_tr_b16 a[114:115], v1 offset:21504
 buffer_load_dwordx4 v8, s[8:11], s38 offen offset:1024 lds
 s_waitcnt lgkmcnt(6)
 v_dot2_f32_bf16 v106, v175, v108, v106
 v_dot2_f32_bf16 v107, v175, v175, v107
 v_dot2_f32_bf16 v104, v176, v108, v104
 v_mfma_f32_32x32x16_bf16 v[24:39], a[96:99], v[152:155], v[24:39]
 ds_read_b64_tr_b16 a[116:117], v2 offset:20480
 ds_read_b64_tr_b16 a[118:119], v2 offset:21504
 s_add_u32 m0, s36, 73728
 s_add_u32 s38, s20, 128
 buffer_load_dwordx4 v7, s[8:11], s38 offen offset:0 lds
 v_dot2_f32_bf16 v105, v176, v176, v105
 v_dot2_f32_bf16 v106, v177, v108, v106
 v_mfma_f32_32x32x16_bf16 v[40:55], a[100:103], v[152:155], v[40:55]
 ds_read_b64_tr_b16 a[120:121], v1 offset:22528
 ds_read_b64_tr_b16 a[122:123], v1 offset:23552
 buffer_load_dwordx4 v8, s[8:11], s38 offen offset:1024 lds
 s_waitcnt lgkmcnt(6)
 v_dot2_f32_bf16 v107, v177, v177, v107
 v_dot2_f32_bf16 v104, v178, v108, v104
 v_dot2_f32_bf16 v105, v178, v178, v105
 v_mfma_f32_32x32x16_bf16 v[24:39], a[104:107], v[156:159], v[24:39]
 ds_read_b64_tr_b16 a[124:125], v2 offset:22528
 ds_read_b64_tr_b16 a[126:127], v2 offset:23552
 buffer_load_dwordx4 v9, s[8:11], s38 offen offset:2048 lds
 v_dot2_f32_bf16 v106, v179, v108, v106
 v_dot2_f32_bf16 v107, v179, v179, v107
 v_dot2_f32_bf16 v104, v180, v108, v104
 v_dot2_f32_bf16 v105, v180, v180, v105
 v_mfma_f32_32x32x16_bf16 v[40:55], a[108:111], v[156:159], v[40:55]
 s_waitcnt vmcnt(21)
 s_barrier
 ds_read_b64_tr_b16 a[96:97], v1 offset:24576
 ds_read_b64_tr_b16 a[98:99], v1 offset:25600
 buffer_load_dwordx4 v10, s[8:11], s38 offen offset:3072 lds
 s_waitcnt lgkmcnt(6)
 v_dot2_f32_bf16 v106, v181, v108, v106
 v_mfma_f32_32x32x16_bf16 v[24:39], a[112:115], v[160:163], v[24:39]
 ds_read_b64_tr_b16 a[100:101], v2 offset:24576
 ds_read_b64_tr_b16 a[102:103], v2 offset:25600
 s_add_u32 m0, s36, 77824
 s_add_u32 s38, s20, 295040
 buffer_load_dwordx4 v7, s[8:11], s38 offen offset:0 lds
 v_dot2_f32_bf16 v107, v181, v181, v107
 v_dot2_f32_bf16 v104, v182, v108, v104
 v_mfma_f32_32x32x16_bf16 v[40:55], a[116:119], v[160:163], v[40:55]
 ds_read_b64_tr_b16 a[104:105], v1 offset:26624
 ds_read_b64_tr_b16 a[106:107], v1 offset:27648
 buffer_load_dwordx4 v8, s[8:11], s38 offen offset:1024 lds
 s_waitcnt lgkmcnt(6)
 v_dot2_f32_bf16 v105, v182, v182, v105
 v_dot2_f32_bf16 v106, v183, v108, v106
 v_dot2_f32_bf16 v107, v183, v183, v107
 v_mfma_f32_32x32x16_bf16 v[24:39], a[120:123], v[164:167], v[24:39]
 ds_read_b64_tr_b16 a[108:109], v2 offset:26624
 ds_read_b64_tr_b16 a[110:111], v2 offset:27648
 v_dot2_f32_bf16 v104, v184, v108, v104
 v_dot2_f32_bf16 v105, v184, v184, v105
 v_dot2_f32_bf16 v106, v185, v108, v106
 v_dot2_f32_bf16 v107, v185, v185, v107
 v_dot2_f32_bf16 v104, v186, v108, v104
 v_dot2_f32_bf16 v105, v186, v186, v105
 v_dot2_f32_bf16 v106, v187, v108, v106
 v_dot2_f32_bf16 v107, v187, v187, v107
 v_mfma_f32_32x32x16_bf16 v[40:55], a[124:127], v[164:167], v[40:55]
 ds_read_b64_tr_b16 a[112:113], v1 offset:28672
 ds_read_b64_tr_b16 a[114:115], v1 offset:29696
 s_waitcnt lgkmcnt(6)
 v_dot2_f32_bf16 v104, v188, v108, v104
 v_dot2_f32_bf16 v105, v188, v188, v105
 v_dot2_f32_bf16 v106, v189, v108, v106
 v_dot2_f32_bf16 v107, v189, v189, v107
 v_dot2_f32_bf16 v104, v190, v108, v104
 v_dot2_f32_bf16 v105, v190, v190, v105
 v_dot2_f32_bf16 v106, v191, v108, v106
 v_mfma_f32_32x32x16_bf16 v[24:39], a[96:99], v[168:171], v[24:39]
 ds_read_b64_tr_b16 a[116:117], v2 offset:28672
 ds_read_b64_tr_b16 a[118:119], v2 offset:29696
 v_dot2_f32_bf16 v107, v191, v191, v107
 v_dot2_f32_bf16 v104, v192, v108, v104
 v_dot2_f32_bf16 v105, v192, v192, v105
 v_dot2_f32_bf16 v106, v193, v108, v106
 v_dot2_f32_bf16 v107, v193, v193, v107
 v_dot2_f32_bf16 v104, v194, v108, v104
 v_dot2_f32_bf16 v105, v194, v194, v105
 v_dot2_f32_bf16 v106, v195, v108, v106
 v_mfma_f32_32x32x16_bf16 v[40:55], a[100:103], v[168:171], v[40:55]
 ds_read_b64_tr_b16 a[120:121], v1 offset:30720
 ds_read_b64_tr_b16 a[122:123], v1 offset:31744
 s_waitcnt lgkmcnt(6)
 v_dot2_f32_bf16 v107, v195, v195, v107
 v_dot2_f32_bf16 v104, v196, v108, v104
 v_dot2_f32_bf16 v105, v196, v196, v105
 v_dot2_f32_bf16 v106, v197, v108, v106
 v_dot2_f32_bf16 v107, v197, v197, v107
 v_dot2_f32_bf16 v104, v198, v108, v104
 v_dot2_f32_bf16 v105, v198, v198, v105
 v_mfma_f32_32x32x16_bf16 v[24:39], a[104:107], v[172:175], v[24:39]
 ds_read_b64_tr_b16 a[124:125], v2 offset:30720
 ds_read_b64_tr_b16 a[126:127], v2 offset:31744
 s_waitcnt vmcnt(12)
 ds_read_b128 a[128:131], v116 offset:53248
 ds_read_b128 a[132:135], v117 offset:53248
 ds_read_b128 v[216:219], v114 offset:49152
 ds_read_b128 v[220:223], v115 offset:49152
 v_dot2_f32_bf16 v106, v199, v108, v106
 v_dot2_f32_bf16 v107, v199, v199, v107
 v_dot2_f32_bf16 v104, v200, v108, v104
 v_dot2_f32_bf16 v105, v200, v200, v105
 v_mfma_f32_32x32x16_bf16 v[40:55], a[108:111], v[172:175], v[40:55]
 ds_read_b64_tr_b16 a[96:97], v1 offset:32768
 ds_read_b64_tr_b16 a[98:99], v1 offset:33792
 ds_read_b128 v[224:227], v116 offset:49152
 ds_read_b128 v[228:231], v117 offset:49152
 ds_read_b128 v[232:235], v114 offset:51200
 ds_read_b128 v[236:239], v115 offset:51200
 s_waitcnt lgkmcnt(14)
 v_dot2_f32_bf16 v106, v201, v108, v106
 v_dot2_f32_bf16 v107, v201, v201, v107
 v_dot2_f32_bf16 v104, v202, v108, v104
 v_mfma_f32_32x32x16_bf16 v[24:39], a[112:115], v[176:179], v[24:39]
 ds_read_b64_tr_b16 a[100:101], v2 offset:32768
 ds_read_b64_tr_b16 a[102:103], v2 offset:33792
 ds_read_b128 v[240:243], v116 offset:51200
 ds_read_b128 v[244:247], v117 offset:51200
 ds_read_b128 v[248:251], v114 offset:53248
 ds_read_b128 v[252:255], v115 offset:53248
 v_dot2_f32_bf16 v105, v202, v202, v105
 v_dot2_f32_bf16 v106, v203, v108, v106
 v_dot2_f32_bf16 v107, v203, v203, v107
 v_dot2_f32_bf16 v104, v204, v108, v104
 v_mfma_f32_32x32x16_bf16 v[40:55], a[116:119], v[176:179], v[40:55]
 ds_read_b64_tr_b16 a[104:105], v1 offset:34816
 ds_read_b64_tr_b16 a[106:107], v1 offset:35840
 ds_read_b128 v[88:91], v116 offset:53248
 ds_read_b128 v[92:95], v117 offset:53248
 s_waitcnt lgkmcnt(15)
 v_dot2_f32_bf16 v105, v204, v204, v105
 v_dot2_f32_bf16 v106, v205, v108, v106
 v_dot2_f32_bf16 v107, v205, v205, v107
 v_mfma_f32_32x32x16_bf16 v[24:39], a[120:123], v[180:183], v[24:39]
 ds_read_b64_tr_b16 a[108:109], v2 offset:34816
 ds_read_b64_tr_b16 a[110:111], v2 offset:35840
 buffer_load_dword v16, off, s[24:27], 0 sc1
 v_dot2_f32_bf16 v104, v206, v108, v104
 v_dot2_f32_bf16 v105, v206, v206, v105
 v_dot2_f32_bf16 v106, v207, v108, v106
 v_dot2_f32_bf16 v107, v207, v207, v107
 v_dot2_f32_bf16 v104, v208, v108, v104
 v_dot2_f32_bf16 v105, v208, v208, v105
 v_mfma_f32_32x32x16_bf16 v[40:55], a[124:127], v[180:183], v[40:55]
 ds_read_b64_tr_b16 a[112:113], v1 offset:36864
 ds_read_b64_tr_b16 a[114:115], v1 offset:37888
 s_waitcnt lgkmcnt(4)
 s_add_u32 m0, s36, 98304
 s_add_u32 s38, s21, 128
 buffer_load_dwordx4 v7, s[8:11], s38 offen offset:0 lds
 v_dot2_f32_bf16 v106, v209, v108, v106
 v_mfma_f32_32x32x16_bf16 v[24:39], a[96:99], v[184:187], v[24:39]
 ds_read_b64_tr_b16 a[116:117], v2 offset:36864
 ds_read_b64_tr_b16 a[118:119], v2 offset:37888
 buffer_load_dwordx4 v8, s[8:11], s38 offen offset:1024 lds
 v_dot2_f32_bf16 v107, v209, v209, v107
 v_dot2_f32_bf16 v104, v210, v108, v104
 v_dot2_f32_bf16 v105, v210, v210, v105
 v_dot2_f32_bf16 v106, v211, v108, v106
 v_mfma_f32_32x32x16_bf16 v[40:55], a[100:103], v[184:187], v[40:55]
 ds_read_b64_tr_b16 a[120:121], v1 offset:38912
 ds_read_b64_tr_b16 a[122:123], v1 offset:39936
 buffer_load_dwordx4 v9, s[8:11], s38 offen offset:2048 lds
 s_waitcnt lgkmcnt(6)
 v_dot2_f32_bf16 v107, v211, v211, v107
 v_dot2_f32_bf16 v104, v212, v108, v104
 v_dot2_f32_bf16 v105, v212, v212, v105
 v_mfma_f32_32x32x16_bf16 v[24:39], a[104:107], v[188:191], v[24:39]
 ds_read_b64_tr_b16 a[124:125], v2 offset:38912
 ds_read_b64_tr_b16 a[126:127], v2 offset:39936
 buffer_load_dwordx4 v10, s[8:11], s38 offen offset:3072 lds
 v_dot2_f32_bf16 v106, v213, v108, v106
 v_dot2_f32_bf16 v107, v213, v213, v107
 v_dot2_f32_bf16 v104, v214, v108, v104
 v_dot2_f32_bf16 v105, v214, v214, v105
 v_mfma_f32_32x32x16_bf16 v[40:55], a[108:111], v[188:191], v[40:55]
 ds_read_b64_tr_b16 a[96:97], v1 offset:40960
 ds_read_b64_tr_b16 a[98:99], v1 offset:41984
 s_add_u32 m0, s36, 102400
 s_add_u32 s38, s21, 295040
 buffer_load_dwordx4 v7, s[8:11], s38 offen offset:0 lds
 s_waitcnt lgkmcnt(6)
 v_dot2_f32_bf16 v106, v215, v108, v106
 v_mfma_f32_32x32x16_bf16 v[24:39], a[112:115], v[192:195], v[24:39]
 ds_read_b64_tr_b16 a[100:101], v2 offset:40960
 ds_read_b64_tr_b16 a[102:103], v2 offset:41984
 buffer_load_dwordx4 v8, s[8:11], s38 offen offset:1024 lds
 v_dot2_f32_bf16 v107, v215, v215, v107
 v_dot2_f32_bf16 v104, v216, v108, v104
 v_dot2_f32_bf16 v105, v216, v216, v105
 v_dot2_f32_bf16 v106, v217, v108, v106
 v_mfma_f32_32x32x16_bf16 v[40:55], a[116:119], v[192:195], v[40:55]
 ds_read_b64_tr_b16 a[104:105], v1 offset:43008
 ds_read_b64_tr_b16 a[106:107], v1 offset:44032
 s_add_u32 m0, s36, 122880
 s_add_u32 s38, s22, 128
 buffer_load_dwordx4 v7, s[8:11], s38 offen offset:0 lds
 s_waitcnt lgkmcnt(6)
 v_dot2_f32_bf16 v107, v217, v217, v107
 v_mfma_f32_32x32x16_bf16 v[24:39], a[120:123], v[196:199], v[24:39]
 ds_read_b64_tr_b16 a[108:109], v2 offset:43008
 ds_read_b64_tr_b16 a[110:111], v2 offset:44032
 buffer_load_dwordx4 v8, s[8:11], s38 offen offset:1024 lds
 v_dot2_f32_bf16 v104, v218, v108, v104
 v_dot2_f32_bf16 v105, v218, v218, v105
 v_dot2_f32_bf16 v106, v219, v108, v106
 v_dot2_f32_bf16 v107, v219, v219, v107
 v_mfma_f32_32x32x16_bf16 v[40:55], a[124:127], v[196:199], v[40:55]
 ds_read_b64_tr_b16 a[112:113], v1 offset:45056
 ds_read_b64_tr_b16 a[114:115], v1 offset:46080
 buffer_load_dwordx4 v9, s[8:11], s38 offen offset:2048 lds
 s_waitcnt lgkmcnt(6)
 v_dot2_f32_bf16 v104, v220, v108, v104
 v_dot2_f32_bf16 v105, v220, v220, v105
 v_dot2_f32_bf16 v106, v221, v108, v106
 v_mfma_f32_32x32x16_bf16 v[24:39], a[96:99], v[200:203], v[24:39]
 ds_read_b64_tr_b16 a[116:117], v2 offset:45056
 ds_read_b64_tr_b16 a[118:119], v2 offset:46080
 buffer_load_dwordx4 v10, s[8:11], s38 offen offset:3072 lds
 v_dot2_f32_bf16 v107, v221, v221, v107
 v_dot2_f32_bf16 v104, v222, v108, v104
 v_dot2_f32_bf16 v105, v222, v222, v105
 v_dot2_f32_bf16 v106, v223, v108, v106
 v_mfma_f32_32x32x16_bf16 v[40:55], a[100:103], v[200:203], v[40:55]
 ds_read_b64_tr_b16 a[120:121], v1 offset:47104
 ds_read_b64_tr_b16 a[122:123], v1 offset:48128
 s_add_u32 m0, s36, 126976
 s_add_u32 s38, s22, 295040
 buffer_load_dwordx4 v7, s[8:11], s38 offen offset:0 lds
 s_waitcnt lgkmcnt(6)
 v_dot2_f32_bf16 v107, v223, v223, v107
 v_mfma_f32_32x32x16_bf16 v[24:39], a[104:107], v[204:207], v[24:39]
 ds_read_b64_tr_b16 a[124:125], v2 offset:47104
 ds_read_b64_tr_b16 a[126:127], v2 offset:48128
 buffer_load_dwordx4 v8, s[8:11], s38 offen offset:1024 lds
 v_dot2_f32_bf16 v104, v224, v108, v104
 v_dot2_f32_bf16 v105, v224, v224, v105
 v_dot2_f32_bf16 v106, v225, v108, v106
 v_dot2_f32_bf16 v107, v225, v225, v107
 v_mfma_f32_32x32x16_bf16 v[40:55], a[108:111], v[204:207], v[40:55]
 s_waitcnt vmcnt(19)
 s_barrier
 v_add_u32 v1, 49152, v1
 v_add_u32 v2, 49152, v2
 ds_read_b64_tr_b16 a[96:97], v1 offset:0
 ds_read_b64_tr_b16 a[98:99], v1 offset:1024
 s_waitcnt lgkmcnt(6)
 v_dot2_f32_bf16 v104, v226, v108, v104
 v_dot2_f32_bf16 v105, v226, v226, v105
 v_dot2_f32_bf16 v106, v227, v108, v106
 v_mfma_f32_32x32x16_bf16 v[24:39], a[112:115], v[208:211], v[24:39]
 ds_read_b64_tr_b16 a[100:101], v2 offset:0
 ds_read_b64_tr_b16 a[102:103], v2 offset:1024
 s_add_u32 m0, s36, 0
 s_add_u32 s38, s33, 0
 buffer_load_dwordx4 v3, s[12:15], s38 offen offset:0 lds
 v_dot2_f32_bf16 v107, v227, v227, v107
 v_dot2_f32_bf16 v104, v228, v108, v104
 v_mfma_f32_32x32x16_bf16 v[40:55], a[116:119], v[208:211], v[40:55]
 ds_read_b64_tr_b16 a[104:105], v1 offset:2048
 ds_read_b64_tr_b16 a[106:107], v1 offset:3072
 s_waitcnt lgkmcnt(6)
 v_dot2_f32_bf16 v105, v228, v228, v105
 v_dot2_f32_bf16 v106, v229, v108, v106
 v_dot2_f32_bf16 v107, v229, v229, v107
 v_dot2_f32_bf16 v104, v230, v108, v104
 v_dot2_f32_bf16 v105, v230, v230, v105
 v_dot2_f32_bf16 v106, v231, v108, v106
 v_dot2_f32_bf16 v107, v231, v231, v107
 v_mfma_f32_32x32x16_bf16 v[24:39], a[120:123], v[212:215], v[24:39]
 ds_read_b64_tr_b16 a[108:109], v2 offset:2048
 ds_read_b64_tr_b16 a[110:111], v2 offset:3072
 v_dot2_f32_bf16 v104, v232, v108, v104
 v_dot2_f32_bf16 v105, v232, v232, v105
 v_dot2_f32_bf16 v106, v233, v108, v106
 v_dot2_f32_bf16 v107, v233, v233, v107
 v_dot2_f32_bf16 v104, v234, v108, v104
 v_dot2_f32_bf16 v105, v234, v234, v105
 v_dot2_f32_bf16 v106, v235, v108, v106
 v_dot2_f32_bf16 v107, v235, v235, v107
 v_mfma_f32_32x32x16_bf16 v[40:55], a[124:127], v[212:215], v[40:55]
 ds_read_b64_tr_b16 a[112:113], v1 offset:4096
 ds_read_b64_tr_b16 a[114:115], v1 offset:5120
 buffer_load_dwordx4 v4, s[12:15], s38 offen offset:1024 lds
 s_mov_b32 m0, s23
 s_nop 0
 buffer_load_dwordx4 v11, s[16:19], s90 offen sc1 lds
 s_waitcnt lgkmcnt(6)
 v_mfma_f32_32x32x16_bf16 v[24:39], a[96:99], v[216:219], v[24:39]
 ds_read_b64_tr_b16 a[116:117], v2 offset:4096
 ds_read_b64_tr_b16 a[118:119], v2 offset:5120
 v_dot2_f32_bf16 v104, v236, v108, v104
 v_dot2_f32_bf16 v105, v236, v236, v105
 v_dot2_f32_bf16 v106, v237, v108, v106
 v_dot2_f32_bf16 v107, v237, v237, v107
 v_dot2_f32_bf16 v104, v238, v108, v104
 v_dot2_f32_bf16 v105, v238, v238, v105
 v_mfma_f32_32x32x16_bf16 v[40:55], a[100:103], v[216:219], v[40:55]
 ds_read_b64_tr_b16 a[120:121], v1 offset:6144
 ds_read_b64_tr_b16 a[122:123], v1 offset:7168
 s_waitcnt lgkmcnt(6)
 v_dot2_f32_bf16 v106, v239, v108, v106
 v_dot2_f32_bf16 v107, v239, v239, v107
 v_dot2_f32_bf16 v104, v240, v108, v104
 v_dot2_f32_bf16 v105, v240, v240, v105
 v_dot2_f32_bf16 v106, v241, v108, v106
 v_dot2_f32_bf16 v107, v241, v241, v107
 v_dot2_f32_bf16 v104, v242, v108, v104
 v_mfma_f32_32x32x16_bf16 v[24:39], a[104:107], v[220:223], v[24:39]
 ds_read_b64_tr_b16 a[124:125], v2 offset:6144
 ds_read_b64_tr_b16 a[126:127], v2 offset:7168
 s_add_u32 m0, s36, 0
 s_nop 0
 buffer_load_dwordx4 v5, s[12:15], s38 offen offset:2048 lds
 s_waitcnt vmcnt(16)
 v_cmp_eq_u32 vcc, 0, v16
 s_cbranch_vccnz L_mn
L_mn_b:
 v_readfirstlane_b32 s45, v16
 s_and_b32 s46, s45, 0xbfffbfff
 v_mfma_f32_32x32x16_bf16 v[40:55], a[108:111], v[220:223], v[40:55]
 ds_read_b64_tr_b16 a[96:97], v1 offset:8192
 ds_read_b64_tr_b16 a[98:99], v1 offset:9216
 s_waitcnt lgkmcnt(6)
 v_dot2_f32_bf16 v105, v242, v242, v105
 v_dot2_f32_bf16 v106, v243, v108, v106
 v_dot2_f32_bf16 v107, v243, v243, v107
 v_dot2_f32_bf16 v104, v244, v108, v104
 v_dot2_f32_bf16 v105, v244, v244, v105
 v_dot2_f32_bf16 v106, v245, v108, v106
 v_dot2_f32_bf16 v107, v245, v245, v107
 v_mfma_f32_32x32x16_bf16 v[24:39], a[112:115], v[224:227], v[24:39]
 ds_read_b64_tr_b16 a[100:101], v2 offset:8192
 ds_read_b64_tr_b16 a[102:103], v2 offset:9216
 v_dot2_f32_bf16 v104, v246, v108, v104
 v_dot2_f32_bf16 v105, v246, v246, v105
 v_dot2_f32_bf16 v106, v247, v108, v106
 v_dot2_f32_bf16 v107, v247, v247, v107
 v_dot2_f32_bf16 v104, v248, v108, v104
 v_dot2_f32_bf16 v105, v248, v248, v105
 v_dot2_f32_bf16 v106, v249, v108, v106
 v_dot2_f32_bf16 v107, v249, v249, v107
 v_mfma_f32_32x32x16_bf16 v[40:55], a[116:119], v[224:227], v[40:55]
 ds_read_b64_tr_b16 a[104:105], v1 offset:10240
 ds_read_b64_tr_b16 a[106:107], v1 offset:11264
 buffer_load_dwordx4 v6, s[12:15], s38 offen offset:3072 lds
 s_waitcnt lgkmcnt(6)
 v_dot2_f32_bf16 v104, v250, v108, v104
 v_dot2_f32_bf16 v105, v250, v250, v105
 v_dot2_f32_bf16 v106, v251, v108, v106
 v_mfma_f32_32x32x16_bf16 v[24:39], a[120:123], v[228:231], v[24:39]
 ds_read_b64_tr_b16 a[108:109], v2 offset:10240
 ds_read_b64_tr_b16 a[110:111], v2 offset:11264
 v_dot2_f32_bf16 v107, v251, v251, v107
 v_dot2_f32_bf16 v104, v252, v108, v104
 v_dot2_f32_bf16 v105, v252, v252, v105
 v_dot2_f32_bf16 v106, v253, v108, v106
 v_dot2_f32_bf16 v107, v253, v253, v107
 v_dot2_f32_bf16 v104, v254, v108, v104
 v_dot2_f32_bf16 v105, v254, v254, v105
 v_dot2_f32_bf16 v106, v255, v108, v106
 v_mfma_f32_32x32x16_bf16 v[40:55], a[124:127], v[228:231], v[40:55]
 ds_read_b64_tr_b16 a[112:113], v1 offset:12288
 ds_read_b64_tr_b16 a[114:115], v1 offset:13312
 s_waitcnt lgkmcnt(6)
 v_dot2_f32_bf16 v107, v255, v255, v107
 v_dot2_f32_bf16 v104, v88, v108, v104
 v_dot2_f32_bf16 v105, v88, v88, v105
 v_dot2_f32_bf16 v106, v89, v108, v106
 v_dot2_f32_bf16 v107, v89, v89, v107
 v_dot2_f32_bf16 v104, v90, v108, v104
 v_dot2_f32_bf16 v105, v90, v90, v105
 v_mfma_f32_32x32x16_bf16 v[24:39], a[96:99], v[232:235], v[24:39]
 ds_read_b64_tr_b16 a[116:117], v2 offset:12288
 ds_read_b64_tr_b16 a[118:119], v2 offset:13312
 s_add_u32 m0, s36, 4096
 s_add_u32 s38, s33, 256
 buffer_load_dwordx4 v3, s[12:15], s38 offen offset:0 lds
 v_dot2_f32_bf16 v106, v91, v108, v106
 v_dot2_f32_bf16 v107, v91, v91, v107
 v_mfma_f32_32x32x16_bf16 v[40:55], a[100:103], v[232:235], v[40:55]
 ds_read_b64_tr_b16 a[120:121], v1 offset:14336
 ds_read_b64_tr_b16 a[122:123], v1 offset:15360
 s_waitcnt lgkmcnt(6)
 v_dot2_f32_bf16 v104, v92, v108, v104
 v_dot2_f32_bf16 v105, v92, v92, v105
 v_dot2_f32_bf16 v106, v93, v108, v106
 v_dot2_f32_bf16 v107, v93, v93, v107
 v_dot2_f32_bf16 v104, v94, v108, v104
 v_dot2_f32_bf16 v105, v94, v94, v105
 v_dot2_f32_bf16 v106, v95, v108, v106
 v_mfma_f32_32x32x16_bf16 v[24:39], a[104:107], v[236:239], v[24:39]
 ds_read_b64_tr_b16 a[124:125], v2 offset:14336
 ds_read_b64_tr_b16 a[126:127], v2 offset:15360
 buffer_load_dword a232, v119, s[12:15], s91 offen
 s_add_u32 s91, s91, 6912
 v_dot2_f32_bf16 v107, v95, v95, v107
 v_add_f32 v104, v104, v106
 s_nop 1
 v_add_f32 v105, v105, v107
 v_mov_b32 v106, v104
 v_mfma_f32_32x32x16_bf16 v[40:55], a[108:111], v[236:239], v[40:55]
 ds_read_b64_tr_b16 a[96:97], v1 offset:16384
 ds_read_b64_tr_b16 a[98:99], v1 offset:17408
 buffer_load_dwordx4 v4, s[12:15], s38 offen offset:1024 lds
 s_waitcnt lgkmcnt(6)
 v_mov_b32 v107, v105
 v_permlane32_swap_b32 v104, v106
 s_nop 0
 v_permlane32_swap_b32 v105, v107
 v_mfma_f32_32x32x16_bf16 v[24:39], a[112:115], v[240:243], v[24:39]
 ds_read_b64_tr_b16 a[100:101], v2 offset:16384
 ds_read_b64_tr_b16 a[102:103], v2 offset:17408
 buffer_load_dword a233, v119, s[12:15], s91 offen
 s_add_u32 s91, s91, 6912
 v_add_f32 v104, v104, v106
 v_add_f32 v105, v105, v107
 v_mul_f32 v104, 0x3ae38e39, v104
 v_mul_f32 v105, 0x3ae38e39, v105
 v_mfma_f32_32x32x16_bf16 v[40:55], a[116:119], v[240:243], v[40:55]
 ds_read_b64_tr_b16 a[104:105], v1 offset:18432
 ds_read_b64_tr_b16 a[106:107], v1 offset:19456
 s_waitcnt lgkmcnt(6)
 v_fma_f32 v105, -v104, v104, v105
 v_max_f32 v105, 0, v105
 v_add_f32 v106, 0x3727c5ac, v105
 v_rsq_f32 v106, v106
 v_accvgpr_write_b32 a248, v104
 v_mov_b32 v108, 0x3727c5ac
 v_mfma_f32_32x32x16_bf16 v[24:39], a[120:123], v[244:247], v[24:39]
 ds_read_b64_tr_b16 a[108:109], v2 offset:18432
 ds_read_b64_tr_b16 a[110:111], v2 offset:19456
 v_mul_f32 v107, v106, v106
 v_accvgpr_write_b32 a249, v106
 v_fma_f32 v107, v107, v105, v108
 v_rsq_f32 v107, v107
 v_cvt_pk_bf16_f32 v109, -v104, -v104
 v_lshlrev_b32 v110, 16, v109
 v_mul_f32 v14, v106, v107
 v_mfma_f32_32x32x16_bf16 v[40:55], a[124:127], v[244:247], v[40:55]
 ds_read_b64_tr_b16 a[112:113], v1 offset:20480
 ds_read_b64_tr_b16 a[114:115], v1 offset:21504
 s_waitcnt vmcnt(6)
 ds_read2_b32 v[18:19], v12 offset0:3 offset1:131
 s_waitcnt lgkmcnt(7)
 v_rcp_f32 v15, v14
 v_add_f32 v110, v110, v104
 v_mul_f32 v13, v14, v14
 v_cvt_pk_bf16_f32 v110, -v110, v15
 v_mfma_f32_32x32x16_bf16 v[24:39], a[96:99], v[248:251], v[24:39]
 ds_read_b64_tr_b16 a[116:117], v2 offset:20480
 ds_read_b64_tr_b16 a[118:119], v2 offset:21504
 v_mul_f32 v14, 0xc0135761, v14
 v_and_b32 v111, s50, v110
 v_mul_f32 v13, 0x3d372713, v13
 v_sub_f32 v111, v15, v111
 v_mul_f32 v13, v13, v14
 v_cvt_pk_bf16_f32 v111, v111, 0
 v_lshrrev_b32 v112, 5, v0
 v_add_u32 v112, -1, v112
 v_mfma_f32_32x32x16_bf16 v[40:55], a[100:103], v[248:251], v[40:55]
 ds_read_b64_tr_b16 a[120:121], v1 offset:22528
 ds_read_b64_tr_b16 a[122:123], v1 offset:23552
 s_waitcnt lgkmcnt(7)
 v_and_b32 v109, v109, v112
 v_and_b32 v110, v110, v112
 v_and_b32 v111, v111, v112
 v_accvgpr_write_b32 a253, 0
 v_accvgpr_write_b32 a250, v109
 v_accvgpr_write_b32 a251, v110
 v_accvgpr_write_b32 a252, v111
 v_mfma_f32_32x32x16_bf16 v[24:39], a[104:107], v[252:255], v[24:39]
 ds_read_b64_tr_b16 a[124:125], v2 offset:22528
 ds_read_b64_tr_b16 a[126:127], v2 offset:23552
 s_waitcnt lgkmcnt(6)
 v_bitop3_b32 v19, v18, v19, s46 bitop3:0x7e
 v_cmp_ne_u32 vcc, 0, v19
 s_cbranch_vccnz L_fx0
L_fx0_b:
 v_mfma_f32_32x32x16_bf16 v[40:55], a[108:111], v[252:255], v[40:55]
 ds_read_b128 a[96:99], v12 offset:0
 s_waitcnt lgkmcnt(5)
 v_mfma_f32_32x32x16_bf16 v[24:39], a[112:115], a[128:131], v[24:39]
 ds_read_b128 a[100:103], v12 offset:512
 v_mfma_f32_32x32x16_bf16 v[40:55], a[116:119], a[128:131], v[40:55]
 s_barrier
 ds_read_b64_tr_b16 a[104:105], v1 offset:24576
 ds_read_b64_tr_b16 a[106:107], v1 offset:25600
 s_waitcnt lgkmcnt(4)
 v_mfma_f32_32x32x16_bf16 v[24:39], a[120:123], a[132:135], v[24:39]
 ds_read_b64_tr_b16 a[108:109], v2 offset:24576
 ds_read_b64_tr_b16 a[110:111], v2 offset:25600
 s_add_u32 m0, s36, 24576
 s_add_u32 s38, s20, 256
 buffer_load_dwordx4 v7, s[8:11], s38 offen offset:0 lds
 v_mfma_f32_32x32x16_bf16 v[40:55], a[124:127], a[132:135], v[40:55]
 ds_read_b64_tr_b16 a[112:113], v1 offset:26624
 ds_read_b64_tr_b16 a[114:115], v1 offset:27648
 s_waitcnt lgkmcnt(6)
 v_mfma_f32_32x32x16_bf16 v[24:39], a[96:99], a[250:253], v[24:39]
 ds_read_b64_tr_b16 a[116:117], v2 offset:26624
 ds_read_b64_tr_b16 a[118:119], v2 offset:27648
 v_mfma_f32_32x32x16_bf16 v[40:55], a[100:103], a[250:253], v[40:55]
 ds_read_b64_tr_b16 a[120:121], v1 offset:28672
 ds_read_b64_tr_b16 a[122:123], v1 offset:29696
 buffer_load_dwordx4 v8, s[8:11], s38 offen offset:1024 lds
 s_waitcnt lgkmcnt(6)
 v_mfma_f32_32x32x16_bf16 v[56:71], a[104:107], v[120:123], 0
 ds_read_b64_tr_b16 a[124:125], v2 offset:28672
 ds_read_b64_tr_b16 a[126:127], v2 offset:29696
 v_mfma_f32_32x32x16_bf16 v[72:87], a[108:111], v[120:123], 0
 ds_read_b64_tr_b16 a[96:97], v1 offset:30720
 ds_read_b64_tr_b16 a[98:99], v1 offset:31744
 s_waitcnt lgkmcnt(6)
 s_add_u32 s39, s42, 0
 v_mul_f32 v20, v24, v24
 v_mul_f32 v21, v25, v25
 v_fma_f32 v20, v20, v13, v14
 v_mfma_f32_32x32x16_bf16 v[56:71], a[112:115], v[124:127], v[56:71]
 ds_read_b64_tr_b16 a[100:101], v2 offset:30720
 ds_read_b64_tr_b16 a[102:103], v2 offset:31744
 buffer_load_dwordx4 v9, s[8:11], s38 offen offset:2048 lds
 v_fma_f32 v21, v21, v13, v14
 v_mfma_f32_32x32x16_bf16 v[72:87], a[116:119], v[124:127], v[72:87]
 ds_read_b64_tr_b16 a[104:105], v1 offset:32768
 ds_read_b64_tr_b16 a[106:107], v1 offset:33792
 s_waitcnt lgkmcnt(6)
 v_mul_f32 v20, v20, v24
 v_mul_f32 v21, v21, v25
 v_exp_f32 v20, v20
 v_mfma_f32_32x32x16_bf16 v[56:71], a[120:123], v[128:131], v[56:71]
 ds_read_b64_tr_b16 a[108:109], v2 offset:32768
 ds_read_b64_tr_b16 a[110:111], v2 offset:33792
 v_exp_f32 v21, v21
 v_fma_f32 v20, v20, v15, v15
 v_fma_f32 v21, v21, v15, v15
 v_mfma_f32_32x32x16_bf16 v[72:87], a[124:127], v[128:131], v[72:87]
 ds_read_b64_tr_b16 a[112:113], v1 offset:34816
 ds_read_b64_tr_b16 a[114:115], v1 offset:35840
 buffer_load_dwordx4 v10, s[8:11], s38 offen offset:3072 lds
 s_waitcnt lgkmcnt(6)
 v_mfma_f32_32x32x16_bf16 v[56:71], a[96:99], v[132:135], v[56:71]
 ds_read_b64_tr_b16 a[116:117], v2 offset:34816
 ds_read_b64_tr_b16 a[118:119], v2 offset:35840
 v_rcp_f32 v20, v20
 v_rcp_f32 v21, v21
 v_mul_f32 v20, v20, v24
 v_mul_f32 v21, v21, v25
 v_mfma_f32_32x32x16_bf16 v[72:87], a[100:103], v[132:135], v[72:87]
 ds_read_b64_tr_b16 a[120:121], v1 offset:36864
 ds_read_b64_tr_b16 a[122:123], v1 offset:37888
 s_waitcnt lgkmcnt(6)
 v_cvt_pk_bf16_f32 v88, v20, v21
 v_mul_f32 v22, v26, v26
 v_mul_f32 v23, v27, v27
 v_fma_f32 v22, v22, v13, v14
 v_mfma_f32_32x32x16_bf16 v[56:71], a[104:107], v[136:139], v[56:71]
 ds_read_b64_tr_b16 a[124:125], v2 offset:36864
 ds_read_b64_tr_b16 a[126:127], v2 offset:37888
 s_add_u32 m0, s36, 28672
 s_add_u32 s38, s20, 295168
 buffer_load_dwordx4 v7, s[8:11], s38 offen offset:0 lds
 v_mfma_f32_32x32x16_bf16 v[72:87], a[108:111], v[136:139], v[72:87]
 ds_read_b64_tr_b16 a[96:97], v1 offset:38912
 ds_read_b64_tr_b16 a[98:99], v1 offset:39936
 s_waitcnt lgkmcnt(6)
 v_fma_f32 v23, v23, v13, v14
 v_mul_f32 v22, v22, v26
 v_mul_f32 v23, v23, v27
 v_mfma_f32_32x32x16_bf16 v[56:71], a[112:115], v[140:143], v[56:71]
 ds_read_b64_tr_b16 a[100:101], v2 offset:38912
 ds_read_b64_tr_b16 a[102:103], v2 offset:39936
 v_exp_f32 v22, v22
 v_exp_f32 v23, v23
 v_fma_f32 v22, v22, v15, v15
 v_mfma_f32_32x32x16_bf16 v[72:87], a[116:119], v[140:143], v[72:87]
 ds_read_b64_tr_b16 a[104:105], v1 offset:40960
 ds_read_b64_tr_b16 a[106:107], v1 offset:41984
 buffer_load_dwordx4 v8, s[8:11], s38 offen offset:1024 lds
 s_waitcnt lgkmcnt(6)
 v_mfma_f32_32x32x16_bf16 v[56:71], a[120:123], v[144:147], v[56:71]
 ds_read_b64_tr_b16 a[108:109], v2 offset:40960
 ds_read_b64_tr_b16 a[110:111], v2 offset:41984
 v_fma_f32 v23, v23, v15, v15
 v_rcp_f32 v22, v22
 v_rcp_f32 v23, v23
 v_mfma_f32_32x32x16_bf16 v[72:87], a[124:127], v[144:147], v[72:87]
 ds_read_b64_tr_b16 a[112:113], v1 offset:43008
 ds_read_b64_tr_b16 a[114:115], v1 offset:44032
 s_waitcnt lgkmcnt(6)
 v_mul_f32 v22, v22, v26
 v_mul_f32 v23, v23, v27
 v_cvt_pk_bf16_f32 v89, v22, v23
 v_mul_f32 v20, v28, v28
 v_mfma_f32_32x32x16_bf16 v[56:71], a[96:99], v[148:151], v[56:71]
 ds_read_b64_tr_b16 a[116:117], v2 offset:43008
 ds_read_b64_tr_b16 a[118:119], v2 offset:44032
 v_mul_f32 v21, v29, v29
 v_fma_f32 v20, v20, v13, v14
 v_fma_f32 v21, v21, v13, v14
 v_mul_f32 v20, v20, v28
 v_mul_f32 v21, v21, v29
 v_mfma_f32_32x32x16_bf16 v[72:87], a[100:103], v[148:151], v[72:87]
 ds_read_b64_tr_b16 a[120:121], v1 offset:45056
 ds_read_b64_tr_b16 a[122:123], v1 offset:46080
 s_waitcnt lgkmcnt(6)
 v_exp_f32 v20, v20
 v_exp_f32 v21, v21
 v_mfma_f32_32x32x16_bf16 v[56:71], a[104:107], v[152:155], v[56:71]
 ds_read_b64_tr_b16 a[124:125], v2 offset:45056
 ds_read_b64_tr_b16 a[126:127], v2 offset:46080
 s_mul_i32 s49, s29, 26112
 s_add_u32 s49, s49, s48
 s_add_u32 s49, s49, 25856
 buffer_load_dword a254, off, s[16:19], s49 sc1
 v_mfma_f32_32x32x16_bf16 v[72:87], a[108:111], v[152:155], v[72:87]
 ds_read_b64_tr_b16 a[96:97], v1 offset:47104
 ds_read_b64_tr_b16 a[98:99], v1 offset:48128
 s_waitcnt lgkmcnt(6)
 v_fma_f32 v20, v20, v15, v15
 v_fma_f32 v21, v21, v15, v15
 v_mfma_f32_32x32x16_bf16 v[56:71], a[112:115], v[156:159], v[56:71]
 ds_read_b64_tr_b16 a[100:101], v2 offset:47104
 ds_read_b64_tr_b16 a[102:103], v2 offset:48128
 v_rcp_f32 v20, v20
 v_rcp_f32 v21, v21
 v_mul_f32 v20, v20, v28
 v_mul_f32 v21, v21, v29
 v_mfma_f32_32x32x16_bf16 v[72:87], a[116:119], v[156:159], v[72:87]
 s_barrier
 v_add_u32 v1, 49152, v1
 v_add_u32 v2, 49152, v2
 ds_read_b64_tr_b16 a[104:105], v1 offset:0
 ds_read_b64_tr_b16 a[106:107], v1 offset:1024
 s_waitcnt lgkmcnt(6)
 v_mfma_f32_32x32x16_bf16 v[56:71], a[120:123], v[160:163], v[56:71]
 ds_read_b64_tr_b16 a[108:109], v2 offset:0
 ds_read_b64_tr_b16 a[110:111], v2 offset:1024
 s_add_u32 m0, s36, 49152
 s_add_u32 s38, s21, 256
 buffer_load_dwordx4 v7, s[8:11], s38 offen offset:0 lds
 v_mfma_f32_32x32x16_bf16 v[72:87], a[124:127], v[160:163], v[72:87]
 ds_read_b64_tr_b16 a[112:113], v1 offset:2048
 ds_read_b64_tr_b16 a[114:115], v1 offset:3072
 s_waitcnt lgkmcnt(6)
 v_cvt_pk_bf16_f32 v90, v20, v21
 v_mul_f32 v22, v30, v30
 v_mul_f32 v23, v31, v31
 v_mfma_f32_32x32x16_bf16 v[56:71], a[96:99], v[164:167], v[56:71]
 ds_read_b64_tr_b16 a[116:117], v2 offset:2048
 ds_read_b64_tr_b16 a[118:119], v2 offset:3072
 v_fma_f32 v22, v22, v13, v14
 v_fma_f32 v23, v23, v13, v14
 v_mul_f32 v22, v22, v30
 v_mul_f32 v23, v23, v31
 v_mfma_f32_32x32x16_bf16 v[72:87], a[100:103], v[164:167], v[72:87]
 ds_read_b64_tr_b16 a[120:121], v1 offset:4096
 ds_read_b64_tr_b16 a[122:123], v1 offset:5120
 buffer_load_dwordx4 v8, s[8:11], s38 offen offset:1024 lds
 s_waitcnt lgkmcnt(6)
 v_mfma_f32_32x32x16_bf16 v[56:71], a[104:107], v[168:171], v[56:71]
 ds_read_b64_tr_b16 a[124:125], v2 offset:4096
 ds_read_b64_tr_b16 a[126:127], v2 offset:5120
 v_exp_f32 v22, v22
 v_exp_f32 v23, v23
 v_fma_f32 v22, v22, v15, v15
 v_fma_f32 v23, v23, v15, v15
 v_mfma_f32_32x32x16_bf16 v[72:87], a[108:111], v[168:171], v[72:87]
 ds_read_b64_tr_b16 a[96:97], v1 offset:6144
 ds_read_b64_tr_b16 a[98:99], v1 offset:7168
 s_waitcnt lgkmcnt(6)
 v_rcp_f32 v22, v22
 v_rcp_f32 v23, v23
 v_mfma_f32_32x32x16_bf16 v[56:71], a[112:115], v[172:175], v[56:71]
 ds_read_b64_tr_b16 a[100:101], v2 offset:6144
 ds_read_b64_tr_b16 a[102:103], v2 offset:7168
 buffer_load_dwordx4 v9, s[8:11], s38 offen offset:2048 lds
 s_load_dwordx2 s[24:25], s[0:1], 112
 v_mfma_f32_32x32x16_bf16 v[72:87], a[116:119], v[172:175], v[72:87]
 ds_read_b64_tr_b16 a[104:105], v1 offset:8192
 ds_read_b64_tr_b16 a[106:107], v1 offset:9216
 s_waitcnt lgkmcnt(6)
 v_mul_f32 v22, v22, v30
 v_mul_f32 v23, v23, v31
 v_cvt_pk_bf16_f32 v91, v22, v23
 v_mfma_f32_32x32x16_bf16 v[56:71], a[120:123], v[176:179], v[56:71]
 ds_read_b64_tr_b16 a[108:109], v2 offset:8192
 ds_read_b64_tr_b16 a[110:111], v2 offset:9216
 buffer_store_dwordx4 v[88:91], v11, s[16:19], s39 offen offset:0 sc1
 v_mul_f32 v20, v32, v32
 v_mul_f32 v21, v33, v33
 v_fma_f32 v20, v20, v13, v14
 v_mfma_f32_32x32x16_bf16 v[72:87], a[124:127], v[176:179], v[72:87]
 ds_read_b64_tr_b16 a[112:113], v1 offset:10240
 ds_read_b64_tr_b16 a[114:115], v1 offset:11264
 buffer_load_dwordx4 v10, s[8:11], s38 offen offset:3072 lds
 s_waitcnt lgkmcnt(6)
 v_mfma_f32_32x32x16_bf16 v[56:71], a[96:99], v[180:183], v[56:71]
 ds_read_b64_tr_b16 a[116:117], v2 offset:10240
 ds_read_b64_tr_b16 a[118:119], v2 offset:11264
 v_fma_f32 v21, v21, v13, v14
 v_mul_f32 v20, v20, v32
 v_mul_f32 v21, v21, v33
 v_exp_f32 v20, v20
 v_mfma_f32_32x32x16_bf16 v[72:87], a[100:103], v[180:183], v[72:87]
 ds_read_b64_tr_b16 a[120:121], v1 offset:12288
 ds_read_b64_tr_b16 a[122:123], v1 offset:13312
 s_waitcnt lgkmcnt(6)
 v_exp_f32 v21, v21
 v_fma_f32 v20, v20, v15, v15
 v_fma_f32 v21, v21, v15, v15
 v_mfma_f32_32x32x16_bf16 v[56:71], a[104:107], v[184:187], v[56:71]
 ds_read_b64_tr_b16 a[124:125], v2 offset:12288
 ds_read_b64_tr_b16 a[126:127], v2 offset:13312
 s_add_u32 m0, s36, 53248
 s_add_u32 s38, s21, 295168
 buffer_load_dwordx4 v7, s[8:11], s38 offen offset:0 lds
 v_mfma_f32_32x32x16_bf16 v[72:87], a[108:111], v[184:187], v[72:87]
 ds_read_b64_tr_b16 a[96:97], v1 offset:14336
 ds_read_b64_tr_b16 a[98:99], v1 offset:15360
 s_add_u32 s90, s90, 1024
 s_mov_b32 m0, s23
 s_nop 0
 buffer_load_dwordx4 v11, s[16:19], s90 offen sc1 lds
 s_waitcnt lgkmcnt(6)
 v_mfma_f32_32x32x16_bf16 v[56:71], a[112:115], v[188:191], v[56:71]
 ds_read_b64_tr_b16 a[100:101], v2 offset:14336
 ds_read_b64_tr_b16 a[102:103], v2 offset:15360
 v_rcp_f32 v20, v20
 v_mfma_f32_32x32x16_bf16 v[72:87], a[116:119], v[188:191], v[72:87]
 ds_read_b64_tr_b16 a[104:105], v1 offset:16384
 ds_read_b64_tr_b16 a[106:107], v1 offset:17408
 s_add_u32 m0, s36, 53248
 s_nop 0
 buffer_load_dwordx4 v8, s[8:11], s38 offen offset:1024 lds
 s_waitcnt lgkmcnt(6)
 v_mfma_f32_32x32x16_bf16 v[56:71], a[120:123], v[192:195], v[56:71]
 ds_read_b64_tr_b16 a[108:109], v2 offset:16384
 ds_read_b64_tr_b16 a[110:111], v2 offset:17408
 v_rcp_f32 v21, v21
 v_mul_f32 v20, v20, v32
 v_mul_f32 v21, v21, v33
 v_cvt_pk_bf16_f32 v92, v20, v21
 v_mfma_f32_32x32x16_bf16 v[72:87], a[124:127], v[192:195], v[72:87]
 ds_read_b64_tr_b16 a[112:113], v1 offset:18432
 ds_read_b64_tr_b16 a[114:115], v1 offset:19456
 s_waitcnt lgkmcnt(6)
 v_mul_f32 v22, v34, v34
 v_mul_f32 v23, v35, v35
 v_fma_f32 v22, v22, v13, v14
 v_fma_f32 v23, v23, v13, v14
 v_mfma_f32_32x32x16_bf16 v[56:71], a[96:99], v[196:199], v[56:71]
 ds_read_b64_tr_b16 a[116:117], v2 offset:18432
 ds_read_b64_tr_b16 a[118:119], v2 offset:19456
 v_mul_f32 v22, v22, v34
 v_mul_f32 v23, v23, v35
 v_exp_f32 v22, v22
 v_mfma_f32_32x32x16_bf16 v[72:87], a[100:103], v[196:199], v[72:87]
 ds_read_b64_tr_b16 a[120:121], v1 offset:20480
 ds_read_b64_tr_b16 a[122:123], v1 offset:21504
 s_waitcnt lgkmcnt(6)
 v_exp_f32 v23, v23
 v_fma_f32 v22, v22, v15, v15
 v_fma_f32 v23, v23, v15, v15
 v_mfma_f32_32x32x16_bf16 v[56:71], a[104:107], v[200:203], v[56:71]
 ds_read_b64_tr_b16 a[124:125], v2 offset:20480
 ds_read_b64_tr_b16 a[126:127], v2 offset:21504
 v_rcp_f32 v22, v22
 v_rcp_f32 v23, v23
 v_mul_f32 v22, v22, v34
 v_mul_f32 v23, v23, v35
 v_mfma_f32_32x32x16_bf16 v[72:87], a[108:111], v[200:203], v[72:87]
 ds_read_b64_tr_b16 a[96:97], v1 offset:22528
 ds_read_b64_tr_b16 a[98:99], v1 offset:23552
 s_waitcnt lgkmcnt(6)
 v_cvt_pk_bf16_f32 v93, v22, v23
 v_mul_f32 v20, v36, v36
 v_mul_f32 v21, v37, v37
 v_fma_f32 v20, v20, v13, v14
 v_mfma_f32_32x32x16_bf16 v[56:71], a[112:115], v[204:207], v[56:71]
 ds_read_b64_tr_b16 a[100:101], v2 offset:22528
 ds_read_b64_tr_b16 a[102:103], v2 offset:23552
 buffer_load_dword a234, v119, s[12:15], s91 offen
 s_add_u32 s91, s91, 6912
 v_fma_f32 v21, v21, v13, v14
 v_mfma_f32_32x32x16_bf16 v[72:87], a[116:119], v[204:207], v[72:87]
 s_barrier
 ds_read_b64_tr_b16 a[104:105], v1 offset:24576
 ds_read_b64_tr_b16 a[106:107], v1 offset:25600
 buffer_load_dword a235, v119, s[52:55], s92 offen
 s_waitcnt lgkmcnt(6)
 v_mfma_f32_32x32x16_bf16 v[56:71], a[120:123], v[208:211], v[56:71]
 ds_read_b64_tr_b16 a[108:109], v2 offset:24576
 ds_read_b64_tr_b16 a[110:111], v2 offset:25600
 s_add_u32 m0, s36, 73728
 s_add_u32 s38, s22, 256
 buffer_load_dwordx4 v7, s[8:11], s38 offen offset:0 lds
 v_mfma_f32_32x32x16_bf16 v[72:87], a[124:127], v[208:211], v[72:87]
 ds_read_b64_tr_b16 a[112:113], v1 offset:26624
 ds_read_b64_tr_b16 a[114:115], v1 offset:27648
 s_waitcnt lgkmcnt(6)
 v_mul_f32 v20, v20, v36
 v_mul_f32 v21, v21, v37
 v_mfma_f32_32x32x16_bf16 v[56:71], a[96:99], v[212:215], v[56:71]
 ds_read_b64_tr_b16 a[116:117], v2 offset:26624
 ds_read_b64_tr_b16 a[118:119], v2 offset:27648
 v_exp_f32 v20, v20
 v_exp_f32 v21, v21
 v_fma_f32 v20, v20, v15, v15
 v_mfma_f32_32x32x16_bf16 v[72:87], a[100:103], v[212:215], v[72:87]
 ds_read_b64_tr_b16 a[120:121], v1 offset:28672
 ds_read_b64_tr_b16 a[122:123], v1 offset:29696
 buffer_load_dwordx4 v8, s[8:11], s38 offen offset:1024 lds
 s_waitcnt lgkmcnt(6)
 v_mfma_f32_32x32x16_bf16 v[56:71], a[104:107], v[216:219], v[56:71]
 ds_read_b64_tr_b16 a[124:125], v2 offset:28672
 ds_read_b64_tr_b16 a[126:127], v2 offset:29696
 v_fma_f32 v21, v21, v15, v15
 v_rcp_f32 v20, v20
 v_rcp_f32 v21, v21
 v_mfma_f32_32x32x16_bf16 v[72:87], a[108:111], v[216:219], v[72:87]
 ds_read_b64_tr_b16 a[96:97], v1 offset:30720
 ds_read_b64_tr_b16 a[98:99], v1 offset:31744
 s_waitcnt lgkmcnt(6)
 v_mul_f32 v20, v20, v36
 v_mul_f32 v21, v21, v37
 v_cvt_pk_bf16_f32 v94, v20, v21
 v_mul_f32 v22, v38, v38
 v_mfma_f32_32x32x16_bf16 v[56:71], a[112:115], v[220:223], v[56:71]
 ds_read_b64_tr_b16 a[100:101], v2 offset:30720
 ds_read_b64_tr_b16 a[102:103], v2 offset:31744
 buffer_load_dwordx4 v9, s[8:11], s38 offen offset:2048 lds
 v_mul_f32 v23, v39, v39
 v_mfma_f32_32x32x16_bf16 v[72:87], a[116:119], v[220:223], v[72:87]
 ds_read_b64_tr_b16 a[104:105], v1 offset:32768
 ds_read_b64_tr_b16 a[106:107], v1 offset:33792
 s_waitcnt lgkmcnt(6)
 v_fma_f32 v22, v22, v13, v14
 v_fma_f32 v23, v23, v13, v14
 v_mul_f32 v22, v22, v38
 v_mul_f32 v23, v23, v39
 v_mfma_f32_32x32x16_bf16 v[56:71], a[120:123], v[224:227], v[56:71]
 ds_read_b64_tr_b16 a[108:109], v2 offset:32768
 ds_read_b64_tr_b16 a[110:111], v2 offset:33792
 v_exp_f32 v22, v22
 v_exp_f32 v23, v23
 v_fma_f32 v22, v22, v15, v15
 v_mfma_f32_32x32x16_bf16 v[72:87], a[124:127], v[224:227], v[72:87]
 ds_read_b64_tr_b16 a[112:113], v1 offset:34816
 ds_read_b64_tr_b16 a[114:115], v1 offset:35840
 buffer_load_dwordx4 v10, s[8:11], s38 offen offset:3072 lds
 s_waitcnt lgkmcnt(6)
 v_mfma_f32_32x32x16_bf16 v[56:71], a[96:99], v[228:231], v[56:71]
 ds_read_b64_tr_b16 a[116:117], v2 offset:34816
 ds_read_b64_tr_b16 a[118:119], v2 offset:35840
 v_fma_f32 v23, v23, v15, v15
 v_rcp_f32 v22, v22
 v_rcp_f32 v23, v23
 v_mfma_f32_32x32x16_bf16 v[72:87], a[100:103], v[228:231], v[72:87]
 ds_read_b64_tr_b16 a[120:121], v1 offset:36864
 ds_read_b64_tr_b16 a[122:123], v1 offset:37888
 s_waitcnt lgkmcnt(6)
 v_mul_f32 v22, v22, v38
 v_mul_f32 v23, v23, v39
 v_cvt_pk_bf16_f32 v95, v22, v23
 v_mfma_f32_32x32x16_bf16 v[56:71], a[104:107], v[232:235], v[56:71]
 ds_read_b64_tr_b16 a[124:125], v2 offset:36864
 ds_read_b64_tr_b16 a[126:127], v2 offset:37888
 s_add_u32 m0, s36, 77824
 s_add_u32 s38, s22, 295168
 buffer_load_dwordx4 v7, s[8:11], s38 offen offset:0 lds
 v_mfma_f32_32x32x16_bf16 v[72:87], a[108:111], v[232:235], v[72:87]
 ds_read_b64_tr_b16 a[96:97], v1 offset:38912
 ds_read_b64_tr_b16 a[98:99], v1 offset:39936
 s_waitcnt lgkmcnt(6)
 buffer_store_dwordx4 v[92:95], v11, s[16:19], s39 offen offset:1024 sc1
 v_mul_f32 v20, v40, v40
 v_mfma_f32_32x32x16_bf16 v[56:71], a[112:115], v[236:239], v[56:71]
 ds_read_b64_tr_b16 a[100:101], v2 offset:38912
 ds_read_b64_tr_b16 a[102:103], v2 offset:39936
 v_mul_f32 v21, v41, v41
 v_fma_f32 v20, v20, v13, v14
 v_fma_f32 v21, v21, v13, v14
 v_mul_f32 v20, v20, v40
 v_mul_f32 v21, v21, v41
 v_mfma_f32_32x32x16_bf16 v[72:87], a[116:119], v[236:239], v[72:87]
 ds_read_b64_tr_b16 a[104:105], v1 offset:40960
 ds_read_b64_tr_b16 a[106:107], v1 offset:41984
 buffer_load_dwordx4 v8, s[8:11], s38 offen offset:1024 lds
 s_waitcnt lgkmcnt(6)
 v_mfma_f32_32x32x16_bf16 v[56:71], a[120:123], v[240:243], v[56:71]
 ds_read_b64_tr_b16 a[108:109], v2 offset:40960
 ds_read_b64_tr_b16 a[110:111], v2 offset:41984
 v_exp_f32 v20, v20
 v_exp_f32 v21, v21
 v_fma_f32 v20, v20, v15, v15
 v_mfma_f32_32x32x16_bf16 v[72:87], a[124:127], v[240:243], v[72:87]
 ds_read_b64_tr_b16 a[112:113], v1 offset:43008
 ds_read_b64_tr_b16 a[114:115], v1 offset:44032
 s_waitcnt lgkmcnt(6)
 v_fma_f32 v21, v21, v15, v15
 v_rcp_f32 v20, v20
 v_mfma_f32_32x32x16_bf16 v[56:71], a[96:99], v[244:247], v[56:71]
 ds_read_b64_tr_b16 a[116:117], v2 offset:43008
 ds_read_b64_tr_b16 a[118:119], v2 offset:44032
 v_rcp_f32 v21, v21
 v_mul_f32 v20, v20, v40
 v_mul_f32 v21, v21, v41
 v_cvt_pk_bf16_f32 v96, v20, v21
 v_mul_f32 v22, v42, v42
 v_mfma_f32_32x32x16_bf16 v[72:87], a[100:103], v[244:247], v[72:87]
 ds_read_b64_tr_b16 a[120:121], v1 offset:45056
 ds_read_b64_tr_b16 a[122:123], v1 offset:46080
 s_waitcnt vmcnt(10)
 ds_read2_b32 v[18:19], v12 offset0:3 offset1:131
 s_waitcnt lgkmcnt(7)
 v_mul_f32 v23, v43, v43
 v_fma_f32 v22, v22, v13, v14
 v_mfma_f32_32x32x16_bf16 v[56:71], a[104:107], v[248:251], v[56:71]
 ds_read_b64_tr_b16 a[124:125], v2 offset:45056
 ds_read_b64_tr_b16 a[126:127], v2 offset:46080
 v_fma_f32 v23, v23, v13, v14
 v_mul_f32 v22, v22, v42
 v_mul_f32 v23, v23, v43
 v_exp_f32 v22, v22
 v_mfma_f32_32x32x16_bf16 v[72:87], a[108:111], v[248:251], v[72:87]
 ds_read_b64_tr_b16 a[96:97], v1 offset:47104
 ds_read_b64_tr_b16 a[98:99], v1 offset:48128
 s_waitcnt lgkmcnt(7)
 v_exp_f32 v23, v23
 v_fma_f32 v22, v22, v15, v15
 v_fma_f32 v23, v23, v15, v15
 v_mfma_f32_32x32x16_bf16 v[56:71], a[112:115], v[252:255], v[56:71]
 ds_read_b64_tr_b16 a[100:101], v2 offset:47104
 ds_read_b64_tr_b16 a[102:103], v2 offset:48128
 s_waitcnt lgkmcnt(6)
 v_bitop3_b32 v19, v18, v19, s46 bitop3:0x7e
 v_cmp_ne_u32 vcc, 0, v19
 s_cbranch_vccnz L_fx1
L_fx1_b:
 v_mfma_f32_32x32x16_bf16 v[72:87], a[116:119], v[252:255], v[72:87]
 ds_read_b128 a[104:107], v12 offset:0
 s_waitcnt lgkmcnt(5)
 v_rcp_f32 v22, v22
 v_rcp_f32 v23, v23
 v_mul_f32 v22, v22, v42
 v_mfma_f32_32x32x16_bf16 v[56:71], a[120:123], a[128:131], v[56:71]
 ds_read_b128 a[108:111], v12 offset:512
 v_mul_f32 v23, v23, v43
 v_cvt_pk_bf16_f32 v97, v22, v23
 v_mul_f32 v20, v44, v44
 v_mul_f32 v21, v45, v45
 v_fma_f32 v20, v20, v13, v14
 v_mfma_f32_32x32x16_bf16 v[72:87], a[124:127], a[128:131], v[72:87]
 s_barrier
 v_add_u32 v1, -98304, v1
 v_add_u32 v2, -98304, v2
 ds_read_b64_tr_b16 a[112:113], v1 offset:0
 ds_read_b64_tr_b16 a[114:115], v1 offset:1024
 s_waitcnt lgkmcnt(4)
 v_mfma_f32_32x32x16_bf16 v[56:71], a[96:99], a[132:135], v[56:71]
 ds_read_b64_tr_b16 a[116:117], v2 offset:0
 ds_read_b64_tr_b16 a[118:119], v2 offset:1024
 s_add_u32 m0, s36, 98304
 s_add_u32 s38, s33, 73728
 buffer_load_dwordx4 v3, s[12:15], s38 offen offset:0 lds
 v_mfma_f32_32x32x16_bf16 v[72:87], a[100:103], a[132:135], v[72:87]
 ds_read_b64_tr_b16 a[120:121], v1 offset:2048
 ds_read_b64_tr_b16 a[122:123], v1 offset:3072
 s_waitcnt lgkmcnt(6)
 v_fma_f32 v21, v21, v13, v14
 v_mul_f32 v20, v20, v44
 v_mul_f32 v21, v21, v45
 v_mfma_f32_32x32x16_bf16 v[56:71], a[104:107], a[250:253], v[56:71]
 ds_read_b64_tr_b16 a[124:125], v2 offset:2048
 ds_read_b64_tr_b16 a[126:127], v2 offset:3072
 v_exp_f32 v20, v20
 v_exp_f32 v21, v21
 v_fma_f32 v20, v20, v15, v15
 v_mfma_f32_32x32x16_bf16 v[72:87], a[108:111], a[250:253], v[72:87]
 ds_read_b64_tr_b16 a[96:97], v1 offset:4096
 ds_read_b64_tr_b16 a[98:99], v1 offset:5120
 buffer_load_dwordx4 v4, s[12:15], s38 offen offset:1024 lds
 s_waitcnt lgkmcnt(6)
 v_mfma_f32_32x32x16_bf16 a[0:15], a[112:115], v[88:91], 0
 ds_read_b64_tr_b16 a[100:101], v2 offset:4096
 ds_read_b64_tr_b16 a[102:103], v2 offset:5120
 v_fma_f32 v21, v21, v15, v15
 v_rcp_f32 v20, v20
 v_rcp_f32 v21, v21
 v_mfma_f32_32x32x16_bf16 a[16:31], a[116:119], v[88:91], 0
 ds_read_b64_tr_b16 a[104:105], v1 offset:6144
 ds_read_b64_tr_b16 a[106:107], v1 offset:7168
 s_waitcnt lgkmcnt(6)
 v_mul_f32 v20, v20, v44
 v_mul_f32 v21, v21, v45
 v_cvt_pk_bf16_f32 v98, v20, v21
 v_mul_f32 v22, v46, v46
 v_mfma_f32_32x32x16_bf16 a[32:47], a[120:123], v[88:91], 0
 ds_read_b64_tr_b16 a[108:109], v2 offset:6144
 ds_read_b64_tr_b16 a[110:111], v2 offset:7168
 buffer_load_dwordx4 v5, s[12:15], s38 offen offset:2048 lds
 v_mul_f32 v23, v47, v47
 v_mfma_f32_32x32x16_bf16 a[48:63], a[124:127], v[88:91], 0
 ds_read_b64_tr_b16 a[112:113], v1 offset:8192
 ds_read_b64_tr_b16 a[114:115], v1 offset:9216
 s_waitcnt lgkmcnt(6)
 v_fma_f32 v22, v22, v13, v14
 v_fma_f32 v23, v23, v13, v14
 v_mul_f32 v22, v22, v46
 v_mul_f32 v23, v23, v47
 v_mfma_f32_32x32x16_bf16 a[64:79], a[96:99], v[88:91], 0
 ds_read_b64_tr_b16 a[116:117], v2 offset:8192
 ds_read_b64_tr_b16 a[118:119], v2 offset:9216
 v_exp_f32 v22, v22
 v_exp_f32 v23, v23
 v_fma_f32 v22, v22, v15, v15
 v_mfma_f32_32x32x16_bf16 a[80:95], a[100:103], v[88:91], 0
 ds_read_b64_tr_b16 a[120:121], v1 offset:10240
 ds_read_b64_tr_b16 a[122:123], v1 offset:11264
 buffer_load_dwordx4 v6, s[12:15], s38 offen offset:3072 lds
 s_waitcnt lgkmcnt(6)
 v_mfma_f32_32x32x16_bf16 a[0:15], a[104:107], v[92:95], a[0:15]
 ds_read_b64_tr_b16 a[124:125], v2 offset:10240
 ds_read_b64_tr_b16 a[126:127], v2 offset:11264
 v_fma_f32 v23, v23, v15, v15
 v_rcp_f32 v22, v22
 v_rcp_f32 v23, v23
 v_mfma_f32_32x32x16_bf16 a[16:31], a[108:111], v[92:95], a[16:31]
 ds_read_b64_tr_b16 a[96:97], v1 offset:12288
 ds_read_b64_tr_b16 a[98:99], v1 offset:13312
 s_waitcnt lgkmcnt(6)
 v_mul_f32 v22, v22, v46
 v_mul_f32 v23, v23, v47
 v_cvt_pk_bf16_f32 v99, v22, v23
 v_mfma_f32_32x32x16_bf16 a[32:47], a[112:115], v[92:95], a[32:47]
 ds_read_b64_tr_b16 a[100:101], v2 offset:12288
 ds_read_b64_tr_b16 a[102:103], v2 offset:13312
 s_add_u32 m0, s36, 102400
 s_add_u32 s38, s33, 73984
 buffer_load_dwordx4 v3, s[12:15], s38 offen offset:0 lds
 v_mfma_f32_32x32x16_bf16 a[48:63], a[116:119], v[92:95], a[48:63]
 ds_read_b64_tr_b16 a[104:105], v1 offset:14336
 ds_read_b64_tr_b16 a[106:107], v1 offset:15360
 s_waitcnt lgkmcnt(6)
 buffer_store_dwordx4 v[96:99], v11, s[16:19], s39 offen offset:2048 sc1
 v_mul_f32 v20, v48, v48
 v_mfma_f32_32x32x16_bf16 a[64:79], a[120:123], v[92:95], a[64:79]
 ds_read_b64_tr_b16 a[108:109], v2 offset:14336
 ds_read_b64_tr_b16 a[110:111], v2 offset:15360
 v_mul_f32 v21, v49, v49
 v_fma_f32 v20, v20, v13, v14
 v_fma_f32 v21, v21, v13, v14
 v_mul_f32 v20, v20, v48
 v_mul_f32 v21, v21, v49
 v_mfma_f32_32x32x16_bf16 a[80:95], a[124:127], v[92:95], a[80:95]
 ds_read_b64_tr_b16 a[112:113], v1 offset:16384
 ds_read_b64_tr_b16 a[114:115], v1 offset:17408
 buffer_load_dwordx4 v4, s[12:15], s38 offen offset:1024 lds
 s_waitcnt lgkmcnt(6)
 v_mfma_f32_32x32x16_bf16 a[0:15], a[96:99], v[96:99], a[0:15]
 ds_read_b64_tr_b16 a[116:117], v2 offset:16384
 ds_read_b64_tr_b16 a[118:119], v2 offset:17408
 v_exp_f32 v20, v20
 v_exp_f32 v21, v21
 v_fma_f32 v20, v20, v15, v15
 v_mfma_f32_32x32x16_bf16 a[16:31], a[100:103], v[96:99], a[16:31]
 ds_read_b64_tr_b16 a[120:121], v1 offset:18432
 ds_read_b64_tr_b16 a[122:123], v1 offset:19456
 s_waitcnt lgkmcnt(6)
 v_fma_f32 v21, v21, v15, v15
 v_rcp_f32 v20, v20
 v_mfma_f32_32x32x16_bf16 a[32:47], a[104:107], v[96:99], a[32:47]
 ds_read_b64_tr_b16 a[124:125], v2 offset:18432
 ds_read_b64_tr_b16 a[126:127], v2 offset:19456
 v_rcp_f32 v21, v21
 v_mul_f32 v20, v20, v48
 v_mul_f32 v21, v21, v49
 v_cvt_pk_bf16_f32 v100, v20, v21
 v_mul_f32 v22, v50, v50
 v_mfma_f32_32x32x16_bf16 a[48:63], a[108:111], v[96:99], a[48:63]
 ds_read_b64_tr_b16 a[96:97], v1 offset:20480
 ds_read_b64_tr_b16 a[98:99], v1 offset:21504
 s_waitcnt lgkmcnt(6)
 v_mul_f32 v23, v51, v51
 v_fma_f32 v22, v22, v13, v14
 v_fma_f32 v23, v23, v13, v14
 v_mul_f32 v22, v22, v50
 v_mfma_f32_32x32x16_bf16 a[64:79], a[112:115], v[96:99], a[64:79]
 ds_read_b64_tr_b16 a[100:101], v2 offset:20480
 ds_read_b64_tr_b16 a[102:103], v2 offset:21504
 v_mul_f32 v23, v23, v51
 v_exp_f32 v22, v22
 v_exp_f32 v23, v23
 v_mfma_f32_32x32x16_bf16 a[80:95], a[116:119], v[96:99], a[80:95]
 ds_read_b64_tr_b16 a[104:105], v1 offset:22528
 ds_read_b64_tr_b16 a[106:107], v1 offset:23552
 s_waitcnt lgkmcnt(6)
 v_fma_f32 v22, v22, v15, v15
 v_fma_f32 v23, v23, v15, v15
 v_rcp_f32 v22, v22
 v_rcp_f32 v23, v23
 v_mul_f32 v22, v22, v50
 v_mul_f32 v23, v23, v51
 v_cvt_pk_bf16_f32 v101, v22, v23
 v_mul_f32 v20, v52, v52
 v_mul_f32 v21, v53, v53
 v_fma_f32 v20, v20, v13, v14
 v_fma_f32 v21, v21, v13, v14
 v_mul_f32 v20, v20, v52
 v_mul_f32 v21, v21, v53
 v_exp_f32 v20, v20
 v_exp_f32 v21, v21
 v_fma_f32 v20, v20, v15, v15
 v_fma_f32 v21, v21, v15, v15
 v_rcp_f32 v20, v20
 v_rcp_f32 v21, v21
 v_mul_f32 v20, v20, v52
 v_mul_f32 v21, v21, v53
 v_cvt_pk_bf16_f32 v102, v20, v21
 v_mul_f32 v22, v54, v54
 v_mul_f32 v23, v55, v55
 v_fma_f32 v22, v22, v13, v14
 v_fma_f32 v23, v23, v13, v14
 v_mul_f32 v22, v22, v54
 v_mul_f32 v23, v23, v55
 v_exp_f32 v22, v22
 v_exp_f32 v23, v23
 v_fma_f32 v22, v22, v15, v15
 v_fma_f32 v23, v23, v15, v15
 v_rcp_f32 v22, v22
 v_rcp_f32 v23, v23
 v_mul_f32 v22, v22, v54
 v_mul_f32 v23, v23, v55
 v_cvt_pk_bf16_f32 v103, v22, v23
 s_nop 1
 v_mfma_f32_32x32x16_bf16 a[0:15], a[120:123], v[100:103], a[0:15]
 ds_read_b64_tr_b16 a[108:109], v2 offset:22528
 ds_read_b64_tr_b16 a[110:111], v2 offset:23552
 buffer_store_dwordx4 v[100:103], v11, s[16:19], s39 offen offset:3072 sc1
 s_add_u32 s39, s42, 16384
 v_mul_f32 v20, v56, v56
 v_mfma_f32_32x32x16_bf16 a[16:31], a[124:127], v[100:103], a[16:31]
 s_barrier
 ds_read_b64_tr_b16 a[112:113], v1 offset:24576
 ds_read_b64_tr_b16 a[114:115], v1 offset:25600
 s_waitcnt lgkmcnt(6)
 v_mul_f32 v21, v57, v57
 v_fma_f32 v20, v20, v13, v14
 v_mfma_f32_32x32x16_bf16 a[32:47], a[96:99], v[100:103], a[32:47]
 ds_read_b64_tr_b16 a[116:117], v2 offset:24576
 ds_read_b64_tr_b16 a[118:119], v2 offset:25600
 s_add_u32 m0, s36, 122880
 s_add_u32 s38, s20, 384
 buffer_load_dwordx4 v7, s[8:11], s38 offen offset:0 lds
 v_mfma_f32_32x32x16_bf16 a[48:63], a[100:103], v[100:103], a[48:63]
 ds_read_b64_tr_b16 a[120:121], v1 offset:26624
 ds_read_b64_tr_b16 a[122:123], v1 offset:27648
 s_waitcnt lgkmcnt(6)
 v_fma_f32 v21, v21, v13, v14
 v_mul_f32 v20, v20, v56
 v_mul_f32 v21, v21, v57
 v_mfma_f32_32x32x16_bf16 a[64:79], a[104:107], v[100:103], a[64:79]
 ds_read_b64_tr_b16 a[124:125], v2 offset:26624
 ds_read_b64_tr_b16 a[126:127], v2 offset:27648
 v_exp_f32 v20, v20
 v_exp_f32 v21, v21
 v_fma_f32 v20, v20, v15, v15
 v_mfma_f32_32x32x16_bf16 a[80:95], a[108:111], v[100:103], a[80:95]
 ds_read_b64_tr_b16 a[96:97], v1 offset:28672
 ds_read_b64_tr_b16 a[98:99], v1 offset:29696
 buffer_load_dwordx4 v8, s[8:11], s38 offen offset:1024 lds
 s_waitcnt lgkmcnt(6)
 v_mfma_f32_32x32x16_bf16 v[24:39], a[112:115], v[120:123], 0
 ds_read_b64_tr_b16 a[100:101], v2 offset:28672
 ds_read_b64_tr_b16 a[102:103], v2 offset:29696
 v_fma_f32 v21, v21, v15, v15
 v_rcp_f32 v20, v20
 v_rcp_f32 v21, v21
 v_mfma_f32_32x32x16_bf16 v[40:55], a[116:119], v[120:123], 0
 ds_read_b64_tr_b16 a[104:105], v1 offset:30720
 ds_read_b64_tr_b16 a[106:107], v1 offset:31744
 s_waitcnt lgkmcnt(6)
 v_mul_f32 v20, v20, v56
 v_mul_f32 v21, v21, v57
 v_cvt_pk_bf16_f32 v104, v20, v21
 v_mul_f32 v22, v58, v58
 v_mfma_f32_32x32x16_bf16 v[24:39], a[120:123], v[124:127], v[24:39]
 ds_read_b64_tr_b16 a[108:109], v2 offset:30720
 ds_read_b64_tr_b16 a[110:111], v2 offset:31744
 buffer_load_dwordx4 v9, s[8:11], s38 offen offset:2048 lds
 v_mul_f32 v23, v59, v59
 v_mfma_f32_32x32x16_bf16 v[40:55], a[124:127], v[124:127], v[40:55]
 ds_read_b64_tr_b16 a[112:113], v1 offset:32768
 ds_read_b64_tr_b16 a[114:115], v1 offset:33792
 s_waitcnt lgkmcnt(6)
 v_fma_f32 v22, v22, v13, v14
 v_fma_f32 v23, v23, v13, v14
 v_mul_f32 v22, v22, v58
 v_mul_f32 v23, v23, v59
 v_mfma_f32_32x32x16_bf16 v[24:39], a[96:99], v[128:131], v[24:39]
 ds_read_b64_tr_b16 a[116:117], v2 offset:32768
 ds_read_b64_tr_b16 a[118:119], v2 offset:33792
 v_exp_f32 v22, v22
 v_exp_f32 v23, v23
 v_fma_f32 v22, v22, v15, v15
 v_mfma_f32_32x32x16_bf16 v[40:55], a[100:103], v[128:131], v[40:55]
 ds_read_b64_tr_b16 a[120:121], v1 offset:34816
 ds_read_b64_tr_b16 a[122:123], v1 offset:35840
 buffer_load_dwordx4 v10, s[8:11], s38 offen offset:3072 lds
 s_waitcnt lgkmcnt(6)
 v_mfma_f32_32x32x16_bf16 v[24:39], a[104:107], v[132:135], v[24:39]
 ds_read_b64_tr_b16 a[124:125], v2 offset:34816
 ds_read_b64_tr_b16 a[126:127], v2 offset:35840
 v_fma_f32 v23, v23, v15, v15
 v_rcp_f32 v22, v22
 v_rcp_f32 v23, v23
 v_mfma_f32_32x32x16_bf16 v[40:55], a[108:111], v[132:135], v[40:55]
 ds_read_b64_tr_b16 a[96:97], v1 offset:36864
 ds_read_b64_tr_b16 a[98:99], v1 offset:37888
 s_waitcnt lgkmcnt(6)
 v_mul_f32 v22, v22, v58
 v_mul_f32 v23, v23, v59
 v_cvt_pk_bf16_f32 v105, v22, v23
 v_mul_f32 v20, v60, v60
 v_mfma_f32_32x32x16_bf16 v[24:39], a[112:115], v[136:139], v[24:39]
 ds_read_b64_tr_b16 a[100:101], v2 offset:36864
 ds_read_b64_tr_b16 a[102:103], v2 offset:37888
 s_add_u32 m0, s36, 126976
 s_add_u32 s38, s20, 295296
 buffer_load_dwordx4 v7, s[8:11], s38 offen offset:0 lds
 v_mfma_f32_32x32x16_bf16 v[40:55], a[116:119], v[136:139], v[40:55]
 ds_read_b64_tr_b16 a[104:105], v1 offset:38912
 ds_read_b64_tr_b16 a[106:107], v1 offset:39936
 s_waitcnt lgkmcnt(6)
 v_mul_f32 v21, v61, v61
 v_fma_f32 v20, v20, v13, v14
 v_fma_f32 v21, v21, v13, v14
 v_mfma_f32_32x32x16_bf16 v[24:39], a[120:123], v[140:143], v[24:39]
 ds_read_b64_tr_b16 a[108:109], v2 offset:38912
 ds_read_b64_tr_b16 a[110:111], v2 offset:39936
 v_mul_f32 v20, v20, v60
 v_mul_f32 v21, v21, v61
 v_exp_f32 v20, v20
 v_mfma_f32_32x32x16_bf16 v[40:55], a[124:127], v[140:143], v[40:55]
 ds_read_b64_tr_b16 a[112:113], v1 offset:40960
 ds_read_b64_tr_b16 a[114:115], v1 offset:41984
 buffer_load_dwordx4 v8, s[8:11], s38 offen offset:1024 lds
 s_waitcnt lgkmcnt(6)
 v_mfma_f32_32x32x16_bf16 v[24:39], a[96:99], v[144:147], v[24:39]
 ds_read_b64_tr_b16 a[116:117], v2 offset:40960
 ds_read_b64_tr_b16 a[118:119], v2 offset:41984
 v_exp_f32 v21, v21
 v_fma_f32 v20, v20, v15, v15
 v_fma_f32 v21, v21, v15, v15
 v_rcp_f32 v20, v20
 v_mfma_f32_32x32x16_bf16 v[40:55], a[100:103], v[144:147], v[40:55]
 ds_read_b64_tr_b16 a[120:121], v1 offset:43008
 ds_read_b64_tr_b16 a[122:123], v1 offset:44032
 s_waitcnt lgkmcnt(6)
 v_rcp_f32 v21, v21
 v_mul_f32 v20, v20, v60
 v_mul_f32 v21, v21, v61
 v_mfma_f32_32x32x16_bf16 v[24:39], a[104:107], v[148:151], v[24:39]
 ds_read_b64_tr_b16 a[124:125], v2 offset:43008
 ds_read_b64_tr_b16 a[126:127], v2 offset:44032
 v_cvt_pk_bf16_f32 v106, v20, v21
 v_mul_f32 v22, v62, v62
 v_mul_f32 v23, v63, v63
 v_fma_f32 v22, v22, v13, v14
 v_fma_f32 v23, v23, v13, v14
 v_mfma_f32_32x32x16_bf16 v[40:55], a[108:111], v[148:151], v[40:55]
 ds_read_b64_tr_b16 a[96:97], v1 offset:45056
 ds_read_b64_tr_b16 a[98:99], v1 offset:46080
 s_waitcnt lgkmcnt(6)
 v_mul_f32 v22, v22, v62
 v_mul_f32 v23, v23, v63
 v_exp_f32 v22, v22
 v_mfma_f32_32x32x16_bf16 v[24:39], a[112:115], v[152:155], v[24:39]
 ds_read_b64_tr_b16 a[100:101], v2 offset:45056
 ds_read_b64_tr_b16 a[102:103], v2 offset:46080
 v_exp_f32 v23, v23
 v_fma_f32 v22, v22, v15, v15
 v_fma_f32 v23, v23, v15, v15
 v_mfma_f32_32x32x16_bf16 v[40:55], a[116:119], v[152:155], v[40:55]
 ds_read_b64_tr_b16 a[104:105], v1 offset:47104
 ds_read_b64_tr_b16 a[106:107], v1 offset:48128
 s_waitcnt lgkmcnt(6)
 v_rcp_f32 v22, v22
 v_rcp_f32 v23, v23
 v_mul_f32 v22, v22, v62
 v_mfma_f32_32x32x16_bf16 v[24:39], a[120:123], v[156:159], v[24:39]
 ds_read_b64_tr_b16 a[108:109], v2 offset:47104
 ds_read_b64_tr_b16 a[110:111], v2 offset:48128
 v_mul_f32 v23, v23, v63
 v_cvt_pk_bf16_f32 v107, v22, v23
 buffer_store_dwordx4 v[104:107], v11, s[16:19], s39 offen offset:0 sc1
 v_mfma_f32_32x32x16_bf16 v[40:55], a[124:127], v[156:159], v[40:55]
 s_waitcnt vmcnt(24)
 s_barrier
 v_add_u32 v1, 49152, v1
 v_add_u32 v2, 49152, v2
 ds_read_b64_tr_b16 a[112:113], v1 offset:0
 ds_read_b64_tr_b16 a[114:115], v1 offset:1024
 s_waitcnt lgkmcnt(6)
 v_mfma_f32_32x32x16_bf16 v[24:39], a[96:99], v[160:163], v[24:39]
 ds_read_b64_tr_b16 a[116:117], v2 offset:0
 ds_read_b64_tr_b16 a[118:119], v2 offset:1024
 s_add_u32 m0, s36, 0
 s_add_u32 s38, s21, 384
 buffer_load_dwordx4 v7, s[8:11], s38 offen offset:0 lds
 v_mfma_f32_32x32x16_bf16 v[40:55], a[100:103], v[160:163], v[40:55]
 ds_read_b64_tr_b16 a[120:121], v1 offset:2048
 ds_read_b64_tr_b16 a[122:123], v1 offset:3072
 s_waitcnt lgkmcnt(6)
 v_mul_f32 v20, v64, v64
 v_mul_f32 v21, v65, v65
 v_fma_f32 v20, v20, v13, v14
 v_mfma_f32_32x32x16_bf16 v[24:39], a[104:107], v[164:167], v[24:39]
 ds_read_b64_tr_b16 a[124:125], v2 offset:2048
 ds_read_b64_tr_b16 a[126:127], v2 offset:3072
 v_fma_f32 v21, v21, v13, v14
 v_mul_f32 v20, v20, v64
 v_mul_f32 v21, v21, v65
 v_exp_f32 v20, v20
 v_mfma_f32_32x32x16_bf16 v[40:55], a[108:111], v[164:167], v[40:55]
 ds_read_b64_tr_b16 a[96:97], v1 offset:4096
 ds_read_b64_tr_b16 a[98:99], v1 offset:5120
 buffer_load_dwordx4 v8, s[8:11], s38 offen offset:1024 lds
 s_waitcnt lgkmcnt(6)
 v_mfma_f32_32x32x16_bf16 v[24:39], a[112:115], v[168:171], v[24:39]
 ds_read_b64_tr_b16 a[100:101], v2 offset:4096
 ds_read_b64_tr_b16 a[102:103], v2 offset:5120
 v_exp_f32 v21, v21
 v_fma_f32 v20, v20, v15, v15
 v_fma_f32 v21, v21, v15, v15
 v_mfma_f32_32x32x16_bf16 v[40:55], a[116:119], v[168:171], v[40:55]
 ds_read_b64_tr_b16 a[104:105], v1 offset:6144
 ds_read_b64_tr_b16 a[106:107], v1 offset:7168
 s_waitcnt lgkmcnt(6)
 v_rcp_f32 v20, v20
 v_rcp_f32 v21, v21
 v_mul_f32 v20, v20, v64
 v_mfma_f32_32x32x16_bf16 v[24:39], a[120:123], v[172:175], v[24:39]
 ds_read_b64_tr_b16 a[108:109], v2 offset:6144
 ds_read_b64_tr_b16 a[110:111], v2 offset:7168
 buffer_load_dwordx4 v9, s[8:11], s38 offen offset:2048 lds
 v_mul_f32 v21, v21, v65
 v_mfma_f32_32x32x16_bf16 v[40:55], a[124:127], v[172:175], v[40:55]
 ds_read_b64_tr_b16 a[112:113], v1 offset:8192
 ds_read_b64_tr_b16 a[114:115], v1 offset:9216
 s_waitcnt lgkmcnt(6)
 v_cvt_pk_bf16_f32 v108, v20, v21
 v_mul_f32 v22, v66, v66
 v_mul_f32 v23, v67, v67
 v_fma_f32 v22, v22, v13, v14
 v_mfma_f32_32x32x16_bf16 v[24:39], a[96:99], v[176:179], v[24:39]
 ds_read_b64_tr_b16 a[116:117], v2 offset:8192
 ds_read_b64_tr_b16 a[118:119], v2 offset:9216
 v_fma_f32 v23, v23, v13, v14
 v_mul_f32 v22, v22, v66
 v_mul_f32 v23, v23, v67
 v_exp_f32 v22, v22
 v_mfma_f32_32x32x16_bf16 v[40:55], a[100:103], v[176:179], v[40:55]
 ds_read_b64_tr_b16 a[120:121], v1 offset:10240
 ds_read_b64_tr_b16 a[122:123], v1 offset:11264
 buffer_load_dwordx4 v10, s[8:11], s38 offen offset:3072 lds
 s_waitcnt lgkmcnt(6)
 v_mfma_f32_32x32x16_bf16 v[24:39], a[104:107], v[180:183], v[24:39]
 ds_read_b64_tr_b16 a[124:125], v2 offset:10240
 ds_read_b64_tr_b16 a[126:127], v2 offset:11264
 s_add_u32 s40, s45, 1
 v_mov_b32 v18, s40
 s_waitcnt vmcnt(11)
 s_mov_b64 exec, 1
 buffer_store_dword v18, off, s[16:19], s47 sc1
 s_mov_b64 exec, -1
 v_mfma_f32_32x32x16_bf16 v[40:55], a[108:111], v[180:183], v[40:55]
 ds_read_b64_tr_b16 a[96:97], v1 offset:12288
 ds_read_b64_tr_b16 a[98:99], v1 offset:13312
 s_waitcnt lgkmcnt(6)
 v_exp_f32 v23, v23
 v_mfma_f32_32x32x16_bf16 v[24:39], a[112:115], v[184:187], v[24:39]
 ds_read_b64_tr_b16 a[100:101], v2 offset:12288
 ds_read_b64_tr_b16 a[102:103], v2 offset:13312
 s_add_u32 m0, s36, 4096
 s_add_u32 s38, s21, 295296
 buffer_load_dwordx4 v7, s[8:11], s38 offen offset:0 lds
 v_mfma_f32_32x32x16_bf16 v[40:55], a[116:119], v[184:187], v[40:55]
 ds_read_b64_tr_b16 a[104:105], v1 offset:14336
 ds_read_b64_tr_b16 a[106:107], v1 offset:15360
 s_add_u32 s90, s90, 1024
 s_mov_b32 m0, s23
 s_nop 0
 buffer_load_dwordx4 v11, s[16:19], s90 offen sc1 lds
 s_waitcnt lgkmcnt(6)
 v_mfma_f32_32x32x16_bf16 v[24:39], a[120:123], v[188:191], v[24:39]
 ds_read_b64_tr_b16 a[108:109], v2 offset:14336
 ds_read_b64_tr_b16 a[110:111], v2 offset:15360
 v_fma_f32 v22, v22, v15, v15
 v_fma_f32 v23, v23, v15, v15
 v_mfma_f32_32x32x16_bf16 v[40:55], a[124:127], v[188:191], v[40:55]
 ds_read_b64_tr_b16 a[112:113], v1 offset:16384
 ds_read_b64_tr_b16 a[114:115], v1 offset:17408
 s_add_u32 m0, s36, 4096
 s_nop 0
 buffer_load_dwordx4 v8, s[8:11], s38 offen offset:1024 lds
 s_waitcnt lgkmcnt(6)
 v_mfma_f32_32x32x16_bf16 v[24:39], a[96:99], v[192:195], v[24:39]
 ds_read_b64_tr_b16 a[116:117], v2 offset:16384
 ds_read_b64_tr_b16 a[118:119], v2 offset:17408
 v_rcp_f32 v22, v22
 v_rcp_f32 v23, v23
 v_mul_f32 v22, v22, v66
 v_mfma_f32_32x32x16_bf16 v[40:55], a[100:103], v[192:195], v[40:55]
 ds_read_b64_tr_b16 a[120:121], v1 offset:18432
 ds_read_b64_tr_b16 a[122:123], v1 offset:19456
 s_waitcnt lgkmcnt(6)
 v_mul_f32 v23, v23, v67
 v_cvt_pk_bf16_f32 v109, v22, v23
 v_mul_f32 v20, v68, v68
 v_mul_f32 v21, v69, v69
 v_mfma_f32_32x32x16_bf16 v[24:39], a[104:107], v[196:199], v[24:39]
 ds_read_b64_tr_b16 a[124:125], v2 offset:18432
 ds_read_b64_tr_b16 a[126:127], v2 offset:19456
 v_fma_f32 v20, v20, v13, v14
 v_fma_f32 v21, v21, v13, v14
 v_mul_f32 v20, v20, v68
 v_mul_f32 v21, v21, v69
 v_mfma_f32_32x32x16_bf16 v[40:55], a[108:111], v[196:199], v[40:55]
 ds_read_b64_tr_b16 a[96:97], v1 offset:20480
 ds_read_b64_tr_b16 a[98:99], v1 offset:21504
 s_waitcnt lgkmcnt(6)
 v_exp_f32 v20, v20
 v_exp_f32 v21, v21
 v_fma_f32 v20, v20, v15, v15
 v_mfma_f32_32x32x16_bf16 v[24:39], a[112:115], v[200:203], v[24:39]
 ds_read_b64_tr_b16 a[100:101], v2 offset:20480
 ds_read_b64_tr_b16 a[102:103], v2 offset:21504
 v_fma_f32 v21, v21, v15, v15
 v_rcp_f32 v20, v20
 v_rcp_f32 v21, v21
 v_mfma_f32_32x32x16_bf16 v[40:55], a[116:119], v[200:203], v[40:55]
 ds_read_b64_tr_b16 a[104:105], v1 offset:22528
 ds_read_b64_tr_b16 a[106:107], v1 offset:23552
 s_waitcnt lgkmcnt(6)
 v_mul_f32 v20, v20, v68
 v_mul_f32 v21, v21, v69
 v_cvt_pk_bf16_f32 v110, v20, v21
 v_mul_f32 v22, v70, v70
 v_mfma_f32_32x32x16_bf16 v[24:39], a[120:123], v[204:207], v[24:39]
 ds_read_b64_tr_b16 a[108:109], v2 offset:22528
 ds_read_b64_tr_b16 a[110:111], v2 offset:23552
 v_mul_f32 v23, v71, v71
 v_fma_f32 v22, v22, v13, v14
 v_fma_f32 v23, v23, v13, v14
 v_mul_f32 v22, v22, v70
 v_mul_f32 v23, v23, v71
 v_mfma_f32_32x32x16_bf16 v[40:55], a[124:127], v[204:207], v[40:55]
 s_barrier
 ds_read_b64_tr_b16 a[112:113], v1 offset:24576
 ds_read_b64_tr_b16 a[114:115], v1 offset:25600
 s_waitcnt lgkmcnt(6)
 v_exp_f32 v22, v22
 v_mfma_f32_32x32x16_bf16 v[24:39], a[96:99], v[208:211], v[24:39]
 ds_read_b64_tr_b16 a[116:117], v2 offset:24576
 ds_read_b64_tr_b16 a[118:119], v2 offset:25600
 s_add_u32 m0, s36, 24576
 s_add_u32 s38, s22, 384
 buffer_load_dwordx4 v7, s[8:11], s38 offen offset:0 lds
 v_mfma_f32_32x32x16_bf16 v[40:55], a[100:103], v[208:211], v[40:55]
 ds_read_b64_tr_b16 a[120:121], v1 offset:26624
 ds_read_b64_tr_b16 a[122:123], v1 offset:27648
 s_waitcnt lgkmcnt(6)
 v_exp_f32 v23, v23
 v_fma_f32 v22, v22, v15, v15
 v_mfma_f32_32x32x16_bf16 v[24:39], a[104:107], v[212:215], v[24:39]
 ds_read_b64_tr_b16 a[124:125], v2 offset:26624
 ds_read_b64_tr_b16 a[126:127], v2 offset:27648
 v_fma_f32 v23, v23, v15, v15
 v_rcp_f32 v22, v22
 v_rcp_f32 v23, v23
 v_mfma_f32_32x32x16_bf16 v[40:55], a[108:111], v[212:215], v[40:55]
 ds_read_b64_tr_b16 a[96:97], v1 offset:28672
 ds_read_b64_tr_b16 a[98:99], v1 offset:29696
 buffer_load_dwordx4 v8, s[8:11], s38 offen offset:1024 lds
 s_waitcnt lgkmcnt(6)
 v_mfma_f32_32x32x16_bf16 v[24:39], a[112:115], v[216:219], v[24:39]
 ds_read_b64_tr_b16 a[100:101], v2 offset:28672
 ds_read_b64_tr_b16 a[102:103], v2 offset:29696
 v_mul_f32 v22, v22, v70
 v_mul_f32 v23, v23, v71
 v_cvt_pk_bf16_f32 v111, v22, v23
 v_mfma_f32_32x32x16_bf16 v[40:55], a[116:119], v[216:219], v[40:55]
 ds_read_b64_tr_b16 a[104:105], v1 offset:30720
 ds_read_b64_tr_b16 a[106:107], v1 offset:31744
 s_waitcnt lgkmcnt(6)
 buffer_store_dwordx4 v[108:111], v11, s[16:19], s39 offen offset:1024 sc1
 v_mul_f32 v20, v72, v72
 v_mul_f32 v21, v73, v73
 v_mfma_f32_32x32x16_bf16 v[24:39], a[120:123], v[220:223], v[24:39]
 ds_read_b64_tr_b16 a[108:109], v2 offset:30720
 ds_read_b64_tr_b16 a[110:111], v2 offset:31744
 buffer_load_dwordx4 v9, s[8:11], s38 offen offset:2048 lds
 v_fma_f32 v20, v20, v13, v14
 v_mfma_f32_32x32x16_bf16 v[40:55], a[124:127], v[220:223], v[40:55]
 ds_read_b64_tr_b16 a[112:113], v1 offset:32768
 ds_read_b64_tr_b16 a[114:115], v1 offset:33792
 s_waitcnt lgkmcnt(6)
 v_fma_f32 v21, v21, v13, v14
 v_mul_f32 v20, v20, v72
 v_mul_f32 v21, v21, v73
 v_mfma_f32_32x32x16_bf16 v[24:39], a[96:99], v[224:227], v[24:39]
 ds_read_b64_tr_b16 a[116:117], v2 offset:32768
 ds_read_b64_tr_b16 a[118:119], v2 offset:33792
 v_exp_f32 v20, v20
 v_exp_f32 v21, v21
 v_fma_f32 v20, v20, v15, v15
 v_fma_f32 v21, v21, v15, v15
 v_mfma_f32_32x32x16_bf16 v[40:55], a[100:103], v[224:227], v[40:55]
 ds_read_b64_tr_b16 a[120:121], v1 offset:34816
 ds_read_b64_tr_b16 a[122:123], v1 offset:35840
 buffer_load_dwordx4 v10, s[8:11], s38 offen offset:3072 lds
 s_waitcnt lgkmcnt(6)
 v_mfma_f32_32x32x16_bf16 v[24:39], a[104:107], v[228:231], v[24:39]
 ds_read_b64_tr_b16 a[124:125], v2 offset:34816
 ds_read_b64_tr_b16 a[126:127], v2 offset:35840
 v_rcp_f32 v20, v20
 v_rcp_f32 v21, v21
 v_mul_f32 v20, v20, v72
 v_mfma_f32_32x32x16_bf16 v[40:55], a[108:111], v[228:231], v[40:55]
 ds_read_b64_tr_b16 a[96:97], v1 offset:36864
 ds_read_b64_tr_b16 a[98:99], v1 offset:37888
 s_waitcnt lgkmcnt(6)
 v_mul_f32 v21, v21, v73
 v_cvt_pk_bf16_f32 v112, v20, v21
 v_mul_f32 v22, v74, v74
 v_mul_f32 v23, v75, v75
 v_mfma_f32_32x32x16_bf16 v[24:39], a[112:115], v[232:235], v[24:39]
 ds_read_b64_tr_b16 a[100:101], v2 offset:36864
 ds_read_b64_tr_b16 a[102:103], v2 offset:37888
 s_add_u32 m0, s36, 28672
 s_add_u32 s38, s22, 295296
 buffer_load_dwordx4 v7, s[8:11], s38 offen offset:0 lds
 v_mfma_f32_32x32x16_bf16 v[40:55], a[116:119], v[232:235], v[40:55]
 ds_read_b64_tr_b16 a[104:105], v1 offset:38912
 ds_read_b64_tr_b16 a[106:107], v1 offset:39936
 s_waitcnt lgkmcnt(6)
 v_fma_f32 v22, v22, v13, v14
 v_fma_f32 v23, v23, v13, v14
 v_mul_f32 v22, v22, v74
 v_mfma_f32_32x32x16_bf16 v[24:39], a[120:123], v[236:239], v[24:39]
 ds_read_b64_tr_b16 a[108:109], v2 offset:38912
 ds_read_b64_tr_b16 a[110:111], v2 offset:39936
 v_mul_f32 v23, v23, v75
 v_exp_f32 v22, v22
 v_exp_f32 v23, v23
 v_mfma_f32_32x32x16_bf16 v[40:55], a[124:127], v[236:239], v[40:55]
 ds_read_b64_tr_b16 a[112:113], v1 offset:40960
 ds_read_b64_tr_b16 a[114:115], v1 offset:41984
 buffer_load_dwordx4 v8, s[8:11], s38 offen offset:1024 lds
 s_waitcnt lgkmcnt(6)
 v_mfma_f32_32x32x16_bf16 v[24:39], a[96:99], v[240:243], v[24:39]
 ds_read_b64_tr_b16 a[116:117], v2 offset:40960
 ds_read_b64_tr_b16 a[118:119], v2 offset:41984
 v_fma_f32 v22, v22, v15, v15
 v_fma_f32 v23, v23, v15, v15
 v_rcp_f32 v22, v22
 v_mfma_f32_32x32x16_bf16 v[40:55], a[100:103], v[240:243], v[40:55]
 ds_read_b64_tr_b16 a[120:121], v1 offset:43008
 ds_read_b64_tr_b16 a[122:123], v1 offset:44032
 s_waitcnt lgkmcnt(6)
 v_rcp_f32 v23, v23
 v_mul_f32 v22, v22, v74
 v_mul_f32 v23, v23, v75
 v_cvt_pk_bf16_f32 v113, v22, v23
 v_mfma_f32_32x32x16_bf16 v[24:39], a[104:107], v[244:247], v[24:39]
 ds_read_b64_tr_b16 a[124:125], v2 offset:43008
 ds_read_b64_tr_b16 a[126:127], v2 offset:44032
 v_mul_f32 v20, v76, v76
 v_mul_f32 v21, v77, v77
 v_fma_f32 v20, v20, v13, v14
 v_fma_f32 v21, v21, v13, v14
 v_mul_f32 v20, v20, v76
 v_mfma_f32_32x32x16_bf16 v[40:55], a[108:111], v[244:247], v[40:55]
 ds_read_b64_tr_b16 a[96:97], v1 offset:45056
 ds_read_b64_tr_b16 a[98:99], v1 offset:46080
 s_waitcnt vmcnt(8)
 ds_read2_b32 v[18:19], v12 offset0:3 offset1:131
 s_waitcnt lgkmcnt(7)
 v_mul_f32 v21, v21, v77
 v_mfma_f32_32x32x16_bf16 v[24:39], a[112:115], v[248:251], v[24:39]
 ds_read_b64_tr_b16 a[100:101], v2 offset:45056
 ds_read_b64_tr_b16 a[102:103], v2 offset:46080
 v_exp_f32 v20, v20
 v_exp_f32 v21, v21
 v_fma_f32 v20, v20, v15, v15
 v_fma_f32 v21, v21, v15, v15
 v_mfma_f32_32x32x16_bf16 v[40:55], a[116:119], v[248:251], v[40:55]
 ds_read_b64_tr_b16 a[104:105], v1 offset:47104
 ds_read_b64_tr_b16 a[106:107], v1 offset:48128
 s_waitcnt lgkmcnt(7)
 v_rcp_f32 v20, v20
 v_rcp_f32 v21, v21
 v_mfma_f32_32x32x16_bf16 v[24:39], a[120:123], v[252:255], v[24:39]
 ds_read_b64_tr_b16 a[108:109], v2 offset:47104
 ds_read_b64_tr_b16 a[110:111], v2 offset:48128
 s_waitcnt lgkmcnt(6)
 v_bitop3_b32 v19, v18, v19, s46 bitop3:0x7e
 v_cmp_ne_u32 vcc, 0, v19
 s_cbranch_vccnz L_fx2
L_fx2_b:
 v_mul_f32 v20, v20, v76
 v_mfma_f32_32x32x16_bf16 v[40:55], a[124:127], v[252:255], v[40:55]
 ds_read_b128 a[112:115], v12 offset:0
 s_waitcnt lgkmcnt(5)
 v_mul_f32 v21, v21, v77
 v_cvt_pk_bf16_f32 v114, v20, v21
 v_mul_f32 v22, v78, v78
 v_mul_f32 v23, v79, v79
 v_mfma_f32_32x32x16_bf16 v[24:39], a[96:99], a[128:131], v[24:39]
 ds_read_b128 a[116:119], v12 offset:512
 v_fma_f32 v22, v22, v13, v14
 v_fma_f32 v23, v23, v13, v14
 v_mul_f32 v22, v22, v78
 v_mul_f32 v23, v23, v79
 v_mfma_f32_32x32x16_bf16 v[40:55], a[100:103], a[128:131], v[40:55]
 s_barrier
 v_add_u32 v1, 49152, v1
 v_add_u32 v2, 49152, v2
 ds_read_b64_tr_b16 a[120:121], v1 offset:0
 ds_read_b64_tr_b16 a[122:123], v1 offset:1024
 s_waitcnt lgkmcnt(4)
 v_mfma_f32_32x32x16_bf16 v[24:39], a[104:107], a[132:135], v[24:39]
 ds_read_b64_tr_b16 a[124:125], v2 offset:0
 ds_read_b64_tr_b16 a[126:127], v2 offset:1024
 s_add_u32 m0, s36, 49152
 s_add_u32 s38, s33, 147456
 buffer_load_dwordx4 v3, s[12:15], s38 offen offset:0 lds
 v_mfma_f32_32x32x16_bf16 v[40:55], a[108:111], a[132:135], v[40:55]
 ds_read_b64_tr_b16 a[96:97], v1 offset:2048
 ds_read_b64_tr_b16 a[98:99], v1 offset:3072
 s_waitcnt lgkmcnt(6)
 buffer_load_dword v16, v17, s[16:19], 0 offen sc1
 v_mfma_f32_32x32x16_bf16 v[24:39], a[112:115], a[250:253], v[24:39]
 ds_read_b64_tr_b16 a[100:101], v2 offset:2048
 ds_read_b64_tr_b16 a[102:103], v2 offset:3072
 v_exp_f32 v22, v22
 v_exp_f32 v23, v23
 v_fma_f32 v22, v22, v15, v15
 v_fma_f32 v23, v23, v15, v15
 v_mfma_f32_32x32x16_bf16 v[40:55], a[116:119], a[250:253], v[40:55]
 ds_read_b64_tr_b16 a[104:105], v1 offset:4096
 ds_read_b64_tr_b16 a[106:107], v1 offset:5120
 buffer_load_dwordx4 v4, s[12:15], s38 offen offset:1024 lds
 s_waitcnt lgkmcnt(6)
 v_mfma_f32_32x32x16_bf16 a[0:15], a[120:123], v[104:107], a[0:15]
 ds_read_b64_tr_b16 a[108:109], v2 offset:4096
 ds_read_b64_tr_b16 a[110:111], v2 offset:5120
 v_rcp_f32 v22, v22
 v_rcp_f32 v23, v23
 v_mul_f32 v22, v22, v78
 v_mfma_f32_32x32x16_bf16 a[16:31], a[124:127], v[104:107], a[16:31]
 ds_read_b64_tr_b16 a[112:113], v1 offset:6144
 ds_read_b64_tr_b16 a[114:115], v1 offset:7168
 s_waitcnt lgkmcnt(6)
 v_mul_f32 v23, v23, v79
 v_cvt_pk_bf16_f32 v115, v22, v23
 v_mfma_f32_32x32x16_bf16 a[32:47], a[96:99], v[104:107], a[32:47]
 ds_read_b64_tr_b16 a[116:117], v2 offset:6144
 ds_read_b64_tr_b16 a[118:119], v2 offset:7168
 buffer_load_dwordx4 v5, s[12:15], s38 offen offset:2048 lds
 v_mfma_f32_32x32x16_bf16 a[48:63], a[100:103], v[104:107], a[48:63]
 ds_read_b64_tr_b16 a[120:121], v1 offset:8192
 ds_read_b64_tr_b16 a[122:123], v1 offset:9216
 s_waitcnt lgkmcnt(6)
 buffer_store_dwordx4 v[112:115], v11, s[16:19], s39 offen offset:2048 sc1
 v_mul_f32 v20, v80, v80
 v_mul_f32 v21, v81, v81
 v_mfma_f32_32x32x16_bf16 a[64:79], a[104:107], v[104:107], a[64:79]
 ds_read_b64_tr_b16 a[124:125], v2 offset:8192
 ds_read_b64_tr_b16 a[126:127], v2 offset:9216
 v_fma_f32 v20, v20, v13, v14
 v_fma_f32 v21, v21, v13, v14
 v_mul_f32 v20, v20, v80
 v_mul_f32 v21, v21, v81
 v_mfma_f32_32x32x16_bf16 a[80:95], a[108:111], v[104:107], a[80:95]
 ds_read_b64_tr_b16 a[96:97], v1 offset:10240
 ds_read_b64_tr_b16 a[98:99], v1 offset:11264
 buffer_load_dwordx4 v6, s[12:15], s38 offen offset:3072 lds
 s_waitcnt lgkmcnt(6)
 v_mfma_f32_32x32x16_bf16 a[0:15], a[112:115], v[108:111], a[0:15]
 ds_read_b64_tr_b16 a[100:101], v2 offset:10240
 ds_read_b64_tr_b16 a[102:103], v2 offset:11264
 v_exp_f32 v20, v20
 v_exp_f32 v21, v21
 v_fma_f32 v20, v20, v15, v15
 v_fma_f32 v21, v21, v15, v15
 v_mfma_f32_32x32x16_bf16 a[16:31], a[116:119], v[108:111], a[16:31]
 ds_read_b64_tr_b16 a[104:105], v1 offset:12288
 ds_read_b64_tr_b16 a[106:107], v1 offset:13312
 s_waitcnt lgkmcnt(6)
 v_rcp_f32 v20, v20
 v_rcp_f32 v21, v21
 v_mfma_f32_32x32x16_bf16 a[32:47], a[120:123], v[108:111], a[32:47]
 ds_read_b64_tr_b16 a[108:109], v2 offset:12288
 ds_read_b64_tr_b16 a[110:111], v2 offset:13312
 s_add_u32 m0, s36, 53248
 s_add_u32 s38, s33, 147712
 buffer_load_dwordx4 v3, s[12:15], s38 offen offset:0 lds
 v_mfma_f32_32x32x16_bf16 a[48:63], a[124:127], v[108:111], a[48:63]
 ds_read_b64_tr_b16 a[112:113], v1 offset:14336
 ds_read_b64_tr_b16 a[114:115], v1 offset:15360
 s_waitcnt lgkmcnt(6)
 v_mul_f32 v20, v20, v80
 v_mul_f32 v21, v21, v81
 v_cvt_pk_bf16_f32 v116, v20, v21
 v_mfma_f32_32x32x16_bf16 a[64:79], a[96:99], v[108:111], a[64:79]
 ds_read_b64_tr_b16 a[116:117], v2 offset:14336
 ds_read_b64_tr_b16 a[118:119], v2 offset:15360
 v_mul_f32 v22, v82, v82
 v_mul_f32 v23, v83, v83
 v_fma_f32 v22, v22, v13, v14
 v_fma_f32 v23, v23, v13, v14
 v_mul_f32 v22, v22, v82
 v_mfma_f32_32x32x16_bf16 a[80:95], a[100:103], v[108:111], a[80:95]
 ds_read_b64_tr_b16 a[120:121], v1 offset:16384
 ds_read_b64_tr_b16 a[122:123], v1 offset:17408
 buffer_load_dwordx4 v4, s[12:15], s38 offen offset:1024 lds
 s_waitcnt lgkmcnt(6)
 v_mfma_f32_32x32x16_bf16 a[0:15], a[104:107], v[112:115], a[0:15]
 ds_read_b64_tr_b16 a[124:125], v2 offset:16384
 ds_read_b64_tr_b16 a[126:127], v2 offset:17408
 v_mul_f32 v23, v23, v83
 v_exp_f32 v22, v22
 v_exp_f32 v23, v23
 v_mfma_f32_32x32x16_bf16 a[16:31], a[108:111], v[112:115], a[16:31]
 ds_read_b64_tr_b16 a[96:97], v1 offset:18432
 ds_read_b64_tr_b16 a[98:99], v1 offset:19456
 s_waitcnt lgkmcnt(6)
 v_fma_f32 v22, v22, v15, v15
 v_fma_f32 v23, v23, v15, v15
 v_rcp_f32 v22, v22
 v_mfma_f32_32x32x16_bf16 a[32:47], a[112:115], v[112:115], a[32:47]
 ds_read_b64_tr_b16 a[100:101], v2 offset:18432
 ds_read_b64_tr_b16 a[102:103], v2 offset:19456
 v_rcp_f32 v23, v23
 v_mul_f32 v22, v22, v82
 v_mul_f32 v23, v23, v83
 v_cvt_pk_bf16_f32 v117, v22, v23
 v_mfma_f32_32x32x16_bf16 a[48:63], a[116:119], v[112:115], a[48:63]
 ds_read_b64_tr_b16 a[104:105], v1 offset:20480
 ds_read_b64_tr_b16 a[106:107], v1 offset:21504
 s_waitcnt lgkmcnt(6)
 v_mul_f32 v20, v84, v84
 v_mul_f32 v21, v85, v85
 v_fma_f32 v20, v20, v13, v14
 v_fma_f32 v21, v21, v13, v14
 v_mfma_f32_32x32x16_bf16 a[64:79], a[120:123], v[112:115], a[64:79]
 ds_read_b64_tr_b16 a[108:109], v2 offset:20480
 ds_read_b64_tr_b16 a[110:111], v2 offset:21504
 v_mul_f32 v20, v20, v84
 v_mul_f32 v21, v21, v85
 v_exp_f32 v20, v20
 v_mfma_f32_32x32x16_bf16 a[80:95], a[124:127], v[112:115], a[80:95]
 ds_read_b64_tr_b16 a[112:113], v1 offset:22528
 ds_read_b64_tr_b16 a[114:115], v1 offset:23552
 s_waitcnt lgkmcnt(6)
 v_exp_f32 v21, v21
 v_fma_f32 v20, v20, v15, v15
 v_fma_f32 v21, v21, v15, v15
 v_rcp_f32 v20, v20
 v_rcp_f32 v21, v21
 v_mul_f32 v20, v20, v84
 v_mul_f32 v21, v21, v85
 v_cvt_pk_bf16_f32 v118, v20, v21
 v_mul_f32 v22, v86, v86
 v_mul_f32 v23, v87, v87
 v_fma_f32 v22, v22, v13, v14
 v_fma_f32 v23, v23, v13, v14
 v_mul_f32 v22, v22, v86
 v_mul_f32 v23, v23, v87
 v_exp_f32 v22, v22
 v_exp_f32 v23, v23
 v_fma_f32 v22, v22, v15, v15
 v_fma_f32 v23, v23, v15, v15
 v_rcp_f32 v22, v22
 v_rcp_f32 v23, v23
 v_mul_f32 v22, v22, v86
 v_mul_f32 v23, v23, v87
 v_cvt_pk_bf16_f32 v119, v22, v23
 s_nop 1
 v_mfma_f32_32x32x16_bf16 a[0:15], a[96:99], v[116:119], a[0:15]
 ds_read_b64_tr_b16 a[116:117], v2 offset:22528
 ds_read_b64_tr_b16 a[118:119], v2 offset:23552
 buffer_store_dwordx4 v[116:119], v11, s[16:19], s39 offen offset:3072 sc1
 s_add_u32 s39, s42, 32768
 v_mul_f32 v20, v24, v24
 v_mul_f32 v21, v25, v25
 v_mfma_f32_32x32x16_bf16 a[16:31], a[100:103], v[116:119], a[16:31]
 s_barrier
 ds_read_b64_tr_b16 a[120:121], v1 offset:24576
 ds_read_b64_tr_b16 a[122:123], v1 offset:25600
 s_waitcnt lgkmcnt(6)
 v_fma_f32 v20, v20, v13, v14
 v_fma_f32 v21, v21, v13, v14
 v_mfma_f32_32x32x16_bf16 a[32:47], a[104:107], v[116:119], a[32:47]
 ds_read_b64_tr_b16 a[124:125], v2 offset:24576
 ds_read_b64_tr_b16 a[126:127], v2 offset:25600
 s_add_u32 m0, s36, 73728
 s_add_u32 s38, s34, 0
 buffer_load_dwordx4 v3, s[12:15], s38 offen offset:0 lds
 v_mfma_f32_32x32x16_bf16 a[48:63], a[108:111], v[116:119], a[48:63]
 ds_read_b64_tr_b16 a[96:97], v1 offset:26624
 ds_read_b64_tr_b16 a[98:99], v1 offset:27648
 s_waitcnt lgkmcnt(6)
 s_add_u32 s40, s45, 1
 s_waitcnt vmcnt(8)
 v_subrev_u32 v16, s40, v16
 v_cmp_lt_u32 vcc, 5, v16
 s_cbranch_vccnz L_fp0
L_fp0_b:
 v_mfma_f32_32x32x16_bf16 a[64:79], a[112:115], v[116:119], a[64:79]
 ds_read_b64_tr_b16 a[100:101], v2 offset:26624
 ds_read_b64_tr_b16 a[102:103], v2 offset:27648
 v_mul_f32 v20, v20, v24
 v_mul_f32 v21, v21, v25
 v_mfma_f32_32x32x16_bf16 a[80:95], a[116:119], v[116:119], a[80:95]
 ds_read_b64_tr_b16 a[104:105], v1 offset:28672
 ds_read_b64_tr_b16 a[106:107], v1 offset:29696
 buffer_load_dwordx4 v4, s[12:15], s38 offen offset:1024 lds
 s_waitcnt lgkmcnt(6)
 v_mfma_f32_32x32x16_bf16 v[56:71], a[120:123], v[120:123], 0
 ds_read_b64_tr_b16 a[108:109], v2 offset:28672
 ds_read_b64_tr_b16 a[110:111], v2 offset:29696
 s_add_u32 s41, s43, 0
 buffer_load_dwordx4 a[136:139], v11, s[16:19], s41 offen offset:0 sc1
 v_exp_f32 v20, v20
 v_mfma_f32_32x32x16_bf16 v[72:87], a[124:127], v[120:123], 0
 ds_read_b64_tr_b16 a[112:113], v1 offset:30720
 ds_read_b64_tr_b16 a[114:115], v1 offset:31744
 s_waitcnt lgkmcnt(6)
 v_exp_f32 v21, v21
 v_fma_f32 v20, v20, v15, v15
 v_fma_f32 v21, v21, v15, v15
 v_mfma_f32_32x32x16_bf16 v[56:71], a[96:99], v[124:127], v[56:71]
 ds_read_b64_tr_b16 a[116:117], v2 offset:30720
 ds_read_b64_tr_b16 a[118:119], v2 offset:31744
 buffer_load_dwordx4 v5, s[12:15], s38 offen offset:2048 lds
 v_mfma_f32_32x32x16_bf16 v[72:87], a[100:103], v[124:127], v[72:87]
 ds_read_b64_tr_b16 a[120:121], v1 offset:32768
 ds_read_b64_tr_b16 a[122:123], v1 offset:33792
 s_waitcnt lgkmcnt(6)
 buffer_load_dwordx4 a[140:143], v11, s[16:19], s41 offen offset:1024 sc1
 v_mfma_f32_32x32x16_bf16 v[56:71], a[104:107], v[128:131], v[56:71]
 ds_read_b64_tr_b16 a[124:125], v2 offset:32768
 ds_read_b64_tr_b16 a[126:127], v2 offset:33792
 v_rcp_f32 v20, v20
 v_rcp_f32 v21, v21
 v_mul_f32 v20, v20, v24
 v_mul_f32 v21, v21, v25
 v_mfma_f32_32x32x16_bf16 v[72:87], a[108:111], v[128:131], v[72:87]
 ds_read_b64_tr_b16 a[96:97], v1 offset:34816
 ds_read_b64_tr_b16 a[98:99], v1 offset:35840
 buffer_load_dwordx4 v6, s[12:15], s38 offen offset:3072 lds
 s_waitcnt lgkmcnt(6)
 v_mfma_f32_32x32x16_bf16 v[56:71], a[112:115], v[132:135], v[56:71]
 ds_read_b64_tr_b16 a[100:101], v2 offset:34816
 ds_read_b64_tr_b16 a[102:103], v2 offset:35840
 buffer_load_dwordx4 a[144:147], v11, s[16:19], s41 offen offset:2048 sc1
 v_cvt_pk_bf16_f32 v88, v20, v21
 v_mfma_f32_32x32x16_bf16 v[72:87], a[116:119], v[132:135], v[72:87]
 ds_read_b64_tr_b16 a[104:105], v1 offset:36864
 ds_read_b64_tr_b16 a[106:107], v1 offset:37888
 s_waitcnt lgkmcnt(6)
 v_mul_f32 v22, v26, v26
 v_mul_f32 v23, v27, v27
 v_fma_f32 v22, v22, v13, v14
 v_fma_f32 v23, v23, v13, v14
 v_mfma_f32_32x32x16_bf16 v[56:71], a[120:123], v[136:139], v[56:71]
 ds_read_b64_tr_b16 a[108:109], v2 offset:36864
 ds_read_b64_tr_b16 a[110:111], v2 offset:37888
 s_add_u32 m0, s36, 77824
 s_add_u32 s38, s34, 256
 buffer_load_dwordx4 v3, s[12:15], s38 offen offset:0 lds
 v_mfma_f32_32x32x16_bf16 v[72:87], a[124:127], v[136:139], v[72:87]
 ds_read_b64_tr_b16 a[112:113], v1 offset:38912
 ds_read_b64_tr_b16 a[114:115], v1 offset:39936
 s_waitcnt lgkmcnt(6)
 buffer_load_dwordx4 a[148:151], v11, s[16:19], s41 offen offset:3072 sc1
 v_mfma_f32_32x32x16_bf16 v[56:71], a[96:99], v[140:143], v[56:71]
 ds_read_b64_tr_b16 a[116:117], v2 offset:38912
 ds_read_b64_tr_b16 a[118:119], v2 offset:39936
 v_mul_f32 v22, v22, v26
 v_mul_f32 v23, v23, v27
 v_exp_f32 v22, v22
 v_mfma_f32_32x32x16_bf16 v[72:87], a[100:103], v[140:143], v[72:87]
 ds_read_b64_tr_b16 a[120:121], v1 offset:40960
 ds_read_b64_tr_b16 a[122:123], v1 offset:41984
 buffer_load_dwordx4 v4, s[12:15], s38 offen offset:1024 lds
 s_waitcnt lgkmcnt(6)
 v_mfma_f32_32x32x16_bf16 v[56:71], a[104:107], v[144:147], v[56:71]
 ds_read_b64_tr_b16 a[124:125], v2 offset:40960
 ds_read_b64_tr_b16 a[126:127], v2 offset:41984
 s_add_u32 s41, s44, 0
 buffer_load_dwordx4 a[152:155], v11, s[16:19], s41 offen offset:0 sc1
 v_mfma_f32_32x32x16_bf16 v[72:87], a[108:111], v[144:147], v[72:87]
 ds_read_b64_tr_b16 a[96:97], v1 offset:43008
 ds_read_b64_tr_b16 a[98:99], v1 offset:44032
 s_waitcnt lgkmcnt(6)
 v_exp_f32 v23, v23
 v_fma_f32 v22, v22, v15, v15
 v_fma_f32 v23, v23, v15, v15
 v_mfma_f32_32x32x16_bf16 v[56:71], a[112:115], v[148:151], v[56:71]
 ds_read_b64_tr_b16 a[100:101], v2 offset:43008
 ds_read_b64_tr_b16 a[102:103], v2 offset:44032
 buffer_load_dwordx4 a[156:159], v11, s[16:19], s41 offen offset:1024 sc1
 v_rcp_f32 v22, v22
 v_mfma_f32_32x32x16_bf16 v[72:87], a[116:119], v[148:151], v[72:87]
 ds_read_b64_tr_b16 a[104:105], v1 offset:45056
 ds_read_b64_tr_b16 a[106:107], v1 offset:46080
 s_waitcnt lgkmcnt(6)
 v_rcp_f32 v23, v23
 v_mul_f32 v22, v22, v26
 v_mul_f32 v23, v23, v27
 v_mfma_f32_32x32x16_bf16 v[56:71], a[120:123], v[152:155], v[56:71]
 ds_read_b64_tr_b16 a[108:109], v2 offset:45056
 ds_read_b64_tr_b16 a[110:111], v2 offset:46080
 buffer_load_dwordx4 a[160:163], v11, s[16:19], s41 offen offset:2048 sc1
 v_cvt_pk_bf16_f32 v89, v22, v23
 v_mfma_f32_32x32x16_bf16 v[72:87], a[124:127], v[152:155], v[72:87]
 ds_read_b64_tr_b16 a[112:113], v1 offset:47104
 ds_read_b64_tr_b16 a[114:115], v1 offset:48128
 s_waitcnt lgkmcnt(6)
 v_mul_f32 v20, v28, v28
 v_mul_f32 v21, v29, v29
 v_fma_f32 v20, v20, v13, v14
 v_fma_f32 v21, v21, v13, v14
 v_mfma_f32_32x32x16_bf16 v[56:71], a[96:99], v[156:159], v[56:71]
 ds_read_b64_tr_b16 a[116:117], v2 offset:47104
 ds_read_b64_tr_b16 a[118:119], v2 offset:48128
 buffer_load_dwordx4 a[164:167], v11, s[16:19], s41 offen offset:3072 sc1
 v_mul_f32 v20, v20, v28
 v_mfma_f32_32x32x16_bf16 v[72:87], a[100:103], v[156:159], v[72:87]
 s_barrier
 v_add_u32 v1, -98304, v1
 v_add_u32 v2, -98304, v2
 ds_read_b64_tr_b16 a[120:121], v1 offset:0
 ds_read_b64_tr_b16 a[122:123], v1 offset:1024
 s_waitcnt lgkmcnt(6)
 v_mfma_f32_32x32x16_bf16 v[56:71], a[104:107], v[160:163], v[56:71]
 ds_read_b64_tr_b16 a[124:125], v2 offset:0
 ds_read_b64_tr_b16 a[126:127], v2 offset:1024
 s_add_u32 m0, s36, 98304
 s_add_u32 s38, s35, 0
 buffer_load_dwordx4 v3, s[12:15], s38 offen offset:0 lds
 v_mfma_f32_32x32x16_bf16 v[72:87], a[108:111], v[160:163], v[72:87]
 ds_read_b64_tr_b16 a[96:97], v1 offset:2048
 ds_read_b64_tr_b16 a[98:99], v1 offset:3072
 s_waitcnt lgkmcnt(6)
 v_mul_f32 v21, v21, v29
 v_exp_f32 v20, v20
 v_mfma_f32_32x32x16_bf16 v[56:71], a[112:115], v[164:167], v[56:71]
 ds_read_b64_tr_b16 a[100:101], v2 offset:2048
 ds_read_b64_tr_b16 a[102:103], v2 offset:3072
 v_exp_f32 v21, v21
 v_fma_f32 v20, v20, v15, v15
 v_fma_f32 v21, v21, v15, v15
 v_mfma_f32_32x32x16_bf16 v[72:87], a[116:119], v[164:167], v[72:87]
 ds_read_b64_tr_b16 a[104:105], v1 offset:4096
 ds_read_b64_tr_b16 a[106:107], v1 offset:5120
 buffer_load_dwordx4 v4, s[12:15], s38 offen offset:1024 lds
 s_waitcnt lgkmcnt(6)
 v_mfma_f32_32x32x16_bf16 v[56:71], a[120:123], v[168:171], v[56:71]
 ds_read_b64_tr_b16 a[108:109], v2 offset:4096
 ds_read_b64_tr_b16 a[110:111], v2 offset:5120
 v_rcp_f32 v20, v20
 v_rcp_f32 v21, v21
 v_mul_f32 v20, v20, v28
 v_mul_f32 v21, v21, v29
 v_mfma_f32_32x32x16_bf16 v[72:87], a[124:127], v[168:171], v[72:87]
 ds_read_b64_tr_b16 a[112:113], v1 offset:6144
 ds_read_b64_tr_b16 a[114:115], v1 offset:7168
 s_waitcnt lgkmcnt(6)
 v_cvt_pk_bf16_f32 v90, v20, v21
 v_mul_f32 v22, v30, v30
 v_mul_f32 v23, v31, v31
 v_fma_f32 v22, v22, v13, v14
 v_mfma_f32_32x32x16_bf16 v[56:71], a[96:99], v[172:175], v[56:71]
 ds_read_b64_tr_b16 a[116:117], v2 offset:6144
 ds_read_b64_tr_b16 a[118:119], v2 offset:7168
 buffer_load_dwordx4 v5, s[12:15], s38 offen offset:2048 lds
 v_fma_f32 v23, v23, v13, v14
 v_mfma_f32_32x32x16_bf16 v[72:87], a[100:103], v[172:175], v[72:87]
 ds_read_b64_tr_b16 a[120:121], v1 offset:8192
 ds_read_b64_tr_b16 a[122:123], v1 offset:9216
 s_waitcnt lgkmcnt(6)
 v_mul_f32 v22, v22, v30
 v_mul_f32 v23, v23, v31
 v_exp_f32 v22, v22
 v_mfma_f32_32x32x16_bf16 v[56:71], a[104:107], v[176:179], v[56:71]
 ds_read_b64_tr_b16 a[124:125], v2 offset:8192
 ds_read_b64_tr_b16 a[126:127], v2 offset:9216
 v_exp_f32 v23, v23
 v_fma_f32 v22, v22, v15, v15
 v_fma_f32 v23, v23, v15, v15
 v_mfma_f32_32x32x16_bf16 v[72:87], a[108:111], v[176:179], v[72:87]
 ds_read_b64_tr_b16 a[96:97], v1 offset:10240
 ds_read_b64_tr_b16 a[98:99], v1 offset:11264
 buffer_load_dwordx4 v6, s[12:15], s38 offen offset:3072 lds
 s_waitcnt lgkmcnt(6)
 v_mfma_f32_32x32x16_bf16 v[56:71], a[112:115], v[180:183], v[56:71]
 ds_read_b64_tr_b16 a[100:101], v2 offset:10240
 ds_read_b64_tr_b16 a[102:103], v2 offset:11264
 s_add_u32 s40, s45, 2
 v_mov_b32 v18, s40
 s_waitcnt vmcnt(18)
 s_mov_b64 exec, 1
 buffer_store_dword v18, off, s[16:19], s47 sc1
 s_mov_b64 exec, -1
 v_mfma_f32_32x32x16_bf16 v[72:87], a[116:119], v[180:183], v[72:87]
 ds_read_b64_tr_b16 a[104:105], v1 offset:12288
 ds_read_b64_tr_b16 a[106:107], v1 offset:13312
 s_waitcnt lgkmcnt(6)
 v_rcp_f32 v22, v22
 v_mfma_f32_32x32x16_bf16 v[56:71], a[120:123], v[184:187], v[56:71]
 ds_read_b64_tr_b16 a[108:109], v2 offset:12288
 ds_read_b64_tr_b16 a[110:111], v2 offset:13312
 s_add_u32 m0, s36, 102400
 s_add_u32 s38, s35, 256
 buffer_load_dwordx4 v3, s[12:15], s38 offen offset:0 lds
 v_mfma_f32_32x32x16_bf16 v[72:87], a[124:127], v[184:187], v[72:87]
 ds_read_b64_tr_b16 a[112:113], v1 offset:14336
 ds_read_b64_tr_b16 a[114:115], v1 offset:15360
 s_add_u32 s90, s90, 1024
 s_mov_b32 m0, s23
 s_nop 0
 buffer_load_dwordx4 v11, s[16:19], s90 offen sc1 lds
 s_waitcnt lgkmcnt(6)
 v_mfma_f32_32x32x16_bf16 v[56:71], a[96:99], v[188:191], v[56:71]
 ds_read_b64_tr_b16 a[116:117], v2 offset:14336
 ds_read_b64_tr_b16 a[118:119], v2 offset:15360
 v_rcp_f32 v23, v23
 v_mul_f32 v22, v22, v30
 v_mfma_f32_32x32x16_bf16 v[72:87], a[100:103], v[188:191], v[72:87]
 ds_read_b64_tr_b16 a[120:121], v1 offset:16384
 ds_read_b64_tr_b16 a[122:123], v1 offset:17408
 s_add_u32 m0, s36, 102400
 s_nop 0
 buffer_load_dwordx4 v4, s[12:15], s38 offen offset:1024 lds
 s_waitcnt lgkmcnt(6)
 v_mfma_f32_32x32x16_bf16 v[56:71], a[104:107], v[192:195], v[56:71]
 ds_read_b64_tr_b16 a[124:125], v2 offset:16384
 ds_read_b64_tr_b16 a[126:127], v2 offset:17408
 v_mul_f32 v23, v23, v31
 v_cvt_pk_bf16_f32 v91, v22, v23
 v_mfma_f32_32x32x16_bf16 v[72:87], a[108:111], v[192:195], v[72:87]
 ds_read_b64_tr_b16 a[96:97], v1 offset:18432
 ds_read_b64_tr_b16 a[98:99], v1 offset:19456
 s_waitcnt lgkmcnt(6)
 buffer_store_dwordx4 v[88:91], v11, s[16:19], s39 offen offset:0 sc1
 v_mul_f32 v20, v32, v32
 v_mul_f32 v21, v33, v33
 v_mfma_f32_32x32x16_bf16 v[56:71], a[112:115], v[196:199], v[56:71]
 ds_read_b64_tr_b16 a[100:101], v2 offset:18432
 ds_read_b64_tr_b16 a[102:103], v2 offset:19456
 v_fma_f32 v20, v20, v13, v14
 v_fma_f32 v21, v21, v13, v14
 v_mul_f32 v20, v20, v32
 v_mul_f32 v21, v21, v33
 v_mfma_f32_32x32x16_bf16 v[72:87], a[116:119], v[196:199], v[72:87]
 ds_read_b64_tr_b16 a[104:105], v1 offset:20480
 ds_read_b64_tr_b16 a[106:107], v1 offset:21504
 s_waitcnt lgkmcnt(6)
 v_exp_f32 v20, v20
 v_exp_f32 v21, v21
 v_fma_f32 v20, v20, v15, v15
 v_mfma_f32_32x32x16_bf16 v[56:71], a[120:123], v[200:203], v[56:71]
 ds_read_b64_tr_b16 a[108:109], v2 offset:20480
 ds_read_b64_tr_b16 a[110:111], v2 offset:21504
 v_fma_f32 v21, v21, v15, v15
 v_rcp_f32 v20, v20
 v_rcp_f32 v21, v21
 v_mfma_f32_32x32x16_bf16 v[72:87], a[124:127], v[200:203], v[72:87]
 ds_read_b64_tr_b16 a[112:113], v1 offset:22528
 ds_read_b64_tr_b16 a[114:115], v1 offset:23552
 s_waitcnt lgkmcnt(6)
 v_mul_f32 v20, v20, v32
 v_mul_f32 v21, v21, v33
 v_cvt_pk_bf16_f32 v92, v20, v21
 v_mul_f32 v22, v34, v34
 v_mfma_f32_32x32x16_bf16 v[56:71], a[96:99], v[204:207], v[56:71]
 ds_read_b64_tr_b16 a[116:117], v2 offset:22528
 ds_read_b64_tr_b16 a[118:119], v2 offset:23552
 v_mul_f32 v23, v35, v35
 v_fma_f32 v22, v22, v13, v14
 v_fma_f32 v23, v23, v13, v14
 v_mul_f32 v22, v22, v34
 v_mul_f32 v23, v23, v35
 v_mfma_f32_32x32x16_bf16 v[72:87], a[100:103], v[204:207], v[72:87]
 s_barrier
 ds_read_b64_tr_b16 a[120:121], v1 offset:24576
 ds_read_b64_tr_b16 a[122:123], v1 offset:25600
 s_waitcnt lgkmcnt(6)
 v_exp_f32 v22, v22
 v_mfma_f32_32x32x16_bf16 v[56:71], a[104:107], v[208:211], v[56:71]
 ds_read_b64_tr_b16 a[124:125], v2 offset:24576
 ds_read_b64_tr_b16 a[126:127], v2 offset:25600
 s_add_u32 m0, s36, 122880
 s_add_u32 s38, s20, 512
 buffer_load_dwordx4 v7, s[8:11], s38 offen offset:0 lds
 v_mfma_f32_32x32x16_bf16 v[72:87], a[108:111], v[208:211], v[72:87]
 ds_read_b64_tr_b16 a[96:97], v1 offset:26624
 ds_read_b64_tr_b16 a[98:99], v1 offset:27648
 s_waitcnt lgkmcnt(6)
 v_exp_f32 v23, v23
 v_fma_f32 v22, v22, v15, v15
 v_mfma_f32_32x32x16_bf16 v[56:71], a[112:115], v[212:215], v[56:71]
 ds_read_b64_tr_b16 a[100:101], v2 offset:26624
 ds_read_b64_tr_b16 a[102:103], v2 offset:27648
 v_fma_f32 v23, v23, v15, v15
 v_rcp_f32 v22, v22
 v_rcp_f32 v23, v23
 v_mfma_f32_32x32x16_bf16 v[72:87], a[116:119], v[212:215], v[72:87]
 ds_read_b64_tr_b16 a[104:105], v1 offset:28672
 ds_read_b64_tr_b16 a[106:107], v1 offset:29696
 buffer_load_dwordx4 v8, s[8:11], s38 offen offset:1024 lds
 s_waitcnt lgkmcnt(6)
 v_mfma_f32_32x32x16_bf16 v[56:71], a[120:123], v[216:219], v[56:71]
 ds_read_b64_tr_b16 a[108:109], v2 offset:28672
 ds_read_b64_tr_b16 a[110:111], v2 offset:29696
 v_mul_f32 v22, v22, v34
 v_mul_f32 v23, v23, v35
 v_cvt_pk_bf16_f32 v93, v22, v23
 v_mul_f32 v20, v36, v36
 v_mul_f32 v21, v37, v37
 v_mfma_f32_32x32x16_bf16 v[72:87], a[124:127], v[216:219], v[72:87]
 ds_read_b64_tr_b16 a[112:113], v1 offset:30720
 ds_read_b64_tr_b16 a[114:115], v1 offset:31744
 s_waitcnt lgkmcnt(6)
 v_fma_f32 v20, v20, v13, v14
 v_fma_f32 v21, v21, v13, v14
 v_mul_f32 v20, v20, v36
 v_mul_f32 v21, v21, v37
 v_mfma_f32_32x32x16_bf16 v[56:71], a[96:99], v[220:223], v[56:71]
 ds_read_b64_tr_b16 a[116:117], v2 offset:30720
 ds_read_b64_tr_b16 a[118:119], v2 offset:31744
 buffer_load_dwordx4 v9, s[8:11], s38 offen offset:2048 lds
 v_mfma_f32_32x32x16_bf16 v[72:87], a[100:103], v[220:223], v[72:87]
 ds_read_b64_tr_b16 a[120:121], v1 offset:32768
 ds_read_b64_tr_b16 a[122:123], v1 offset:33792
 s_waitcnt lgkmcnt(6)
 v_exp_f32 v20, v20
 v_exp_f32 v21, v21
 v_fma_f32 v20, v20, v15, v15
 v_mfma_f32_32x32x16_bf16 v[56:71], a[104:107], v[224:227], v[56:71]
 ds_read_b64_tr_b16 a[124:125], v2 offset:32768
 ds_read_b64_tr_b16 a[126:127], v2 offset:33792
 v_fma_f32 v21, v21, v15, v15
 v_rcp_f32 v20, v20
 v_rcp_f32 v21, v21
 v_mfma_f32_32x32x16_bf16 v[72:87], a[108:111], v[224:227], v[72:87]
 ds_read_b64_tr_b16 a[96:97], v1 offset:34816
 ds_read_b64_tr_b16 a[98:99], v1 offset:35840
 buffer_load_dwordx4 v10, s[8:11], s38 offen offset:3072 lds
 s_waitcnt lgkmcnt(6)
 v_mfma_f32_32x32x16_bf16 v[56:71], a[112:115], v[228:231], v[56:71]
 ds_read_b64_tr_b16 a[100:101], v2 offset:34816
 ds_read_b64_tr_b16 a[102:103], v2 offset:35840
 v_mul_f32 v20, v20, v36
 v_mul_f32 v21, v21, v37
 v_cvt_pk_bf16_f32 v94, v20, v21
 v_mul_f32 v22, v38, v38
 v_mul_f32 v23, v39, v39
 v_mfma_f32_32x32x16_bf16 v[72:87], a[116:119], v[228:231], v[72:87]
 ds_read_b64_tr_b16 a[104:105], v1 offset:36864
 ds_read_b64_tr_b16 a[106:107], v1 offset:37888
 s_waitcnt lgkmcnt(6)
 v_fma_f32 v22, v22, v13, v14
 v_fma_f32 v23, v23, v13, v14
 v_mul_f32 v22, v22, v38
 v_mul_f32 v23, v23, v39
 v_mfma_f32_32x32x16_bf16 v[56:71], a[120:123], v[232:235], v[56:71]
 ds_read_b64_tr_b16 a[108:109], v2 offset:36864
 ds_read_b64_tr_b16 a[110:111], v2 offset:37888
 s_add_u32 m0, s36, 126976
 s_add_u32 s38, s20, 295424
 buffer_load_dwordx4 v7, s[8:11], s38 offen offset:0 lds
 v_mfma_f32_32x32x16_bf16 v[72:87], a[124:127], v[232:235], v[72:87]
 ds_read_b64_tr_b16 a[112:113], v1 offset:38912
 ds_read_b64_tr_b16 a[114:115], v1 offset:39936
 s_waitcnt lgkmcnt(6)
 v_exp_f32 v22, v22
 v_mfma_f32_32x32x16_bf16 v[56:71], a[96:99], v[236:239], v[56:71]
 ds_read_b64_tr_b16 a[116:117], v2 offset:38912
 ds_read_b64_tr_b16 a[118:119], v2 offset:39936
 v_exp_f32 v23, v23
 v_fma_f32 v22, v22, v15, v15
 v_fma_f32 v23, v23, v15, v15
 v_rcp_f32 v22, v22
 v_mfma_f32_32x32x16_bf16 v[72:87], a[100:103], v[236:239], v[72:87]
 ds_read_b64_tr_b16 a[120:121], v1 offset:40960
 ds_read_b64_tr_b16 a[122:123], v1 offset:41984
 buffer_load_dwordx4 v8, s[8:11], s38 offen offset:1024 lds
 s_waitcnt lgkmcnt(6)
 v_mfma_f32_32x32x16_bf16 v[56:71], a[104:107], v[240:243], v[56:71]
 ds_read_b64_tr_b16 a[124:125], v2 offset:40960
 ds_read_b64_tr_b16 a[126:127], v2 offset:41984
 v_rcp_f32 v23, v23
 v_mul_f32 v22, v22, v38
 v_mul_f32 v23, v23, v39
 v_cvt_pk_bf16_f32 v95, v22, v23
 v_mfma_f32_32x32x16_bf16 v[72:87], a[108:111], v[240:243], v[72:87]
 ds_read_b64_tr_b16 a[96:97], v1 offset:43008
 ds_read_b64_tr_b16 a[98:99], v1 offset:44032
 s_waitcnt lgkmcnt(6)
 buffer_store_dwordx4 v[92:95], v11, s[16:19], s39 offen offset:1024 sc1
 v_mul_f32 v20, v40, v40
 v_mfma_f32_32x32x16_bf16 v[56:71], a[112:115], v[244:247], v[56:71]
 ds_read_b64_tr_b16 a[100:101], v2 offset:43008
 ds_read_b64_tr_b16 a[102:103], v2 offset:44032
 v_mul_f32 v21, v41, v41
 v_fma_f32 v20, v20, v13, v14
 v_fma_f32 v21, v21, v13, v14
 v_mul_f32 v20, v20, v40
 v_mul_f32 v21, v21, v41
 v_mfma_f32_32x32x16_bf16 v[72:87], a[116:119], v[244:247], v[72:87]
 ds_read_b64_tr_b16 a[104:105], v1 offset:45056
 ds_read_b64_tr_b16 a[106:107], v1 offset:46080
 s_waitcnt vmcnt(9)
 ds_read2_b32 v[18:19], v12 offset0:3 offset1:131
 s_waitcnt lgkmcnt(7)
 v_exp_f32 v20, v20
 v_mfma_f32_32x32x16_bf16 v[56:71], a[120:123], v[248:251], v[56:71]
 ds_read_b64_tr_b16 a[108:109], v2 offset:45056
 ds_read_b64_tr_b16 a[110:111], v2 offset:46080
 v_exp_f32 v21, v21
 v_fma_f32 v20, v20, v15, v15
 v_fma_f32 v21, v21, v15, v15
 v_mfma_f32_32x32x16_bf16 v[72:87], a[124:127], v[248:251], v[72:87]
 ds_read_b64_tr_b16 a[112:113], v1 offset:47104
 ds_read_b64_tr_b16 a[114:115], v1 offset:48128
 s_waitcnt lgkmcnt(7)
 v_rcp_f32 v20, v20
 v_rcp_f32 v21, v21
 v_mul_f32 v20, v20, v40
 v_mfma_f32_32x32x16_bf16 v[56:71], a[96:99], v[252:255], v[56:71]
 ds_read_b64_tr_b16 a[116:117], v2 offset:47104
 ds_read_b64_tr_b16 a[118:119], v2 offset:48128
 s_waitcnt lgkmcnt(6)
 v_bitop3_b32 v19, v18, v19, s46 bitop3:0x7e
 v_cmp_ne_u32 vcc, 0, v19
 s_cbranch_vccnz L_fx3
L_fx3_b:
 v_mul_f32 v21, v21, v41
 v_mfma_f32_32x32x16_bf16 v[72:87], a[100:103], v[252:255], v[72:87]
 ds_read_b128 a[120:123], v12 offset:0
 s_waitcnt lgkmcnt(5)
 v_cvt_pk_bf16_f32 v96, v20, v21
 v_mul_f32 v22, v42, v42
 v_mul_f32 v23, v43, v43
 v_fma_f32 v22, v22, v13, v14
 v_mfma_f32_32x32x16_bf16 v[56:71], a[104:107], a[128:131], v[56:71]
 ds_read_b128 a[124:127], v12 offset:512
 v_fma_f32 v23, v23, v13, v14
 v_mul_f32 v22, v22, v42
 v_mul_f32 v23, v23, v43
 v_exp_f32 v22, v22
 v_mfma_f32_32x32x16_bf16 v[72:87], a[108:111], a[128:131], v[72:87]
 s_barrier
 v_add_u32 v1, 49152, v1
 v_add_u32 v2, 49152, v2
 ds_read_b64_tr_b16 a[96:97], v1 offset:0
 ds_read_b64_tr_b16 a[98:99], v1 offset:1024
 s_waitcnt lgkmcnt(4)
 v_mfma_f32_32x32x16_bf16 v[56:71], a[112:115], a[132:135], v[56:71]
 ds_read_b64_tr_b16 a[100:101], v2 offset:0
 ds_read_b64_tr_b16 a[102:103], v2 offset:1024
 s_add_u32 m0, s36, 0
 s_add_u32 s38, s21, 512
 buffer_load_dwordx4 v7, s[8:11], s38 offen offset:0 lds
 v_mfma_f32_32x32x16_bf16 v[72:87], a[116:119], a[132:135], v[72:87]
 ds_read_b64_tr_b16 a[104:105], v1 offset:2048
 ds_read_b64_tr_b16 a[106:107], v1 offset:3072
 s_waitcnt lgkmcnt(6)
 buffer_load_dword v16, v17, s[16:19], 0 offen sc1
 v_mfma_f32_32x32x16_bf16 v[56:71], a[120:123], a[250:253], v[56:71]
 ds_read_b64_tr_b16 a[108:109], v2 offset:2048
 ds_read_b64_tr_b16 a[110:111], v2 offset:3072
 v_exp_f32 v23, v23
 v_fma_f32 v22, v22, v15, v15
 v_fma_f32 v23, v23, v15, v15
 v_mfma_f32_32x32x16_bf16 v[72:87], a[124:127], a[250:253], v[72:87]
 ds_read_b64_tr_b16 a[112:113], v1 offset:4096
 ds_read_b64_tr_b16 a[114:115], v1 offset:5120
 buffer_load_dwordx4 v8, s[8:11], s38 offen offset:1024 lds
 s_waitcnt lgkmcnt(6)
 v_mfma_f32_32x32x16_bf16 a[0:15], a[96:99], v[88:91], a[0:15]
 ds_read_b64_tr_b16 a[116:117], v2 offset:4096
 ds_read_b64_tr_b16 a[118:119], v2 offset:5120
 v_rcp_f32 v22, v22
 v_rcp_f32 v23, v23
 v_mul_f32 v22, v22, v42
 v_mul_f32 v23, v23, v43
 v_mfma_f32_32x32x16_bf16 a[16:31], a[100:103], v[88:91], a[16:31]
 ds_read_b64_tr_b16 a[120:121], v1 offset:6144
 ds_read_b64_tr_b16 a[122:123], v1 offset:7168
 s_waitcnt lgkmcnt(6)
 v_cvt_pk_bf16_f32 v97, v22, v23
 v_mul_f32 v20, v44, v44
 v_mul_f32 v21, v45, v45
 v_fma_f32 v20, v20, v13, v14
 v_mfma_f32_32x32x16_bf16 a[32:47], a[104:107], v[88:91], a[32:47]
 ds_read_b64_tr_b16 a[124:125], v2 offset:6144
 ds_read_b64_tr_b16 a[126:127], v2 offset:7168
 buffer_load_dwordx4 v9, s[8:11], s38 offen offset:2048 lds
 v_fma_f32 v21, v21, v13, v14
 v_mfma_f32_32x32x16_bf16 a[48:63], a[108:111], v[88:91], a[48:63]
 ds_read_b64_tr_b16 a[96:97], v1 offset:8192
 ds_read_b64_tr_b16 a[98:99], v1 offset:9216
 s_waitcnt lgkmcnt(6)
 v_mul_f32 v20, v20, v44
 v_mul_f32 v21, v21, v45
 v_exp_f32 v20, v20
 v_mfma_f32_32x32x16_bf16 a[64:79], a[112:115], v[88:91], a[64:79]
 ds_read_b64_tr_b16 a[100:101], v2 offset:8192
 ds_read_b64_tr_b16 a[102:103], v2 offset:9216
 v_exp_f32 v21, v21
 v_fma_f32 v20, v20, v15, v15
 v_fma_f32 v21, v21, v15, v15
 v_mfma_f32_32x32x16_bf16 a[80:95], a[116:119], v[88:91], a[80:95]
 ds_read_b64_tr_b16 a[104:105], v1 offset:10240
 ds_read_b64_tr_b16 a[106:107], v1 offset:11264
 buffer_load_dwordx4 v10, s[8:11], s38 offen offset:3072 lds
 s_waitcnt lgkmcnt(6)
 v_mfma_f32_32x32x16_bf16 a[0:15], a[120:123], v[92:95], a[0:15]
 ds_read_b64_tr_b16 a[108:109], v2 offset:10240
 ds_read_b64_tr_b16 a[110:111], v2 offset:11264
 v_rcp_f32 v20, v20
 v_rcp_f32 v21, v21
 v_mul_f32 v20, v20, v44
 v_mul_f32 v21, v21, v45
 v_mfma_f32_32x32x16_bf16 a[16:31], a[124:127], v[92:95], a[16:31]
 ds_read_b64_tr_b16 a[112:113], v1 offset:12288
 ds_read_b64_tr_b16 a[114:115], v1 offset:13312
 s_waitcnt lgkmcnt(6)
 v_cvt_pk_bf16_f32 v98, v20, v21
 v_mul_f32 v22, v46, v46
 v_mul_f32 v23, v47, v47
 v_fma_f32 v22, v22, v13, v14
 v_mfma_f32_32x32x16_bf16 a[32:47], a[96:99], v[92:95], a[32:47]
 ds_read_b64_tr_b16 a[116:117], v2 offset:12288
 ds_read_b64_tr_b16 a[118:119], v2 offset:13312
 s_add_u32 m0, s36, 4096
 s_add_u32 s38, s21, 295424
 buffer_load_dwordx4 v7, s[8:11], s38 offen offset:0 lds
 v_mfma_f32_32x32x16_bf16 a[48:63], a[100:103], v[92:95], a[48:63]
 ds_read_b64_tr_b16 a[120:121], v1 offset:14336
 ds_read_b64_tr_b16 a[122:123], v1 offset:15360
 s_waitcnt lgkmcnt(6)
 v_fma_f32 v23, v23, v13, v14
 v_mul_f32 v22, v22, v46
 v_mul_f32 v23, v23, v47
 v_mfma_f32_32x32x16_bf16 a[64:79], a[104:107], v[92:95], a[64:79]
 ds_read_b64_tr_b16 a[124:125], v2 offset:14336
 ds_read_b64_tr_b16 a[126:127], v2 offset:15360
 v_exp_f32 v22, v22
 v_exp_f32 v23, v23
 v_fma_f32 v22, v22, v15, v15
 v_mfma_f32_32x32x16_bf16 a[80:95], a[108:111], v[92:95], a[80:95]
 ds_read_b64_tr_b16 a[96:97], v1 offset:16384
 ds_read_b64_tr_b16 a[98:99], v1 offset:17408
 buffer_load_dwordx4 v8, s[8:11], s38 offen offset:1024 lds
 s_waitcnt lgkmcnt(6)
 v_fma_f32 v23, v23, v15, v15
 v_rcp_f32 v22, v22
 v_rcp_f32 v23, v23
 v_mul_f32 v22, v22, v46
 v_mul_f32 v23, v23, v47
 v_cvt_pk_bf16_f32 v99, v22, v23
 s_nop 1
 v_mfma_f32_32x32x16_bf16 a[0:15], a[112:115], v[96:99], a[0:15]
 ds_read_b64_tr_b16 a[100:101], v2 offset:16384
 ds_read_b64_tr_b16 a[102:103], v2 offset:17408
 buffer_store_dwordx4 v[96:99], v11, s[16:19], s39 offen offset:2048 sc1
 v_mul_f32 v20, v48, v48
 v_mul_f32 v21, v49, v49
 v_mfma_f32_32x32x16_bf16 a[16:31], a[116:119], v[96:99], a[16:31]
 ds_read_b64_tr_b16 a[104:105], v1 offset:18432
 ds_read_b64_tr_b16 a[106:107], v1 offset:19456
 s_waitcnt lgkmcnt(6)
 v_fma_f32 v20, v20, v13, v14
 v_fma_f32 v21, v21, v13, v14
 v_mul_f32 v20, v20, v48
 v_mul_f32 v21, v21, v49
 v_mfma_f32_32x32x16_bf16 a[32:47], a[120:123], v[96:99], a[32:47]
 ds_read_b64_tr_b16 a[108:109], v2 offset:18432
 ds_read_b64_tr_b16 a[110:111], v2 offset:19456
 v_exp_f32 v20, v20
 v_exp_f32 v21, v21
 v_fma_f32 v20, v20, v15, v15
 v_mfma_f32_32x32x16_bf16 a[48:63], a[124:127], v[96:99], a[48:63]
 ds_read_b64_tr_b16 a[112:113], v1 offset:20480
 ds_read_b64_tr_b16 a[114:115], v1 offset:21504
 s_waitcnt lgkmcnt(6)
 v_fma_f32 v21, v21, v15, v15
 v_rcp_f32 v20, v20
 v_mfma_f32_32x32x16_bf16 a[64:79], a[96:99], v[96:99], a[64:79]
 ds_read_b64_tr_b16 a[116:117], v2 offset:20480
 ds_read_b64_tr_b16 a[118:119], v2 offset:21504
 v_rcp_f32 v21, v21
 v_mul_f32 v20, v20, v48
 v_mul_f32 v21, v21, v49
 v_cvt_pk_bf16_f32 v100, v20, v21
 v_mul_f32 v22, v50, v50
 v_mfma_f32_32x32x16_bf16 a[80:95], a[100:103], v[96:99], a[80:95]
 ds_read_b64_tr_b16 a[120:121], v1 offset:22528
 ds_read_b64_tr_b16 a[122:123], v1 offset:23552
 s_waitcnt lgkmcnt(6)
 v_mul_f32 v23, v51, v51
 v_fma_f32 v22, v22, v13, v14
 v_fma_f32 v23, v23, v13, v14
 v_mul_f32 v22, v22, v50
 v_mul_f32 v23, v23, v51
 v_exp_f32 v22, v22
 v_exp_f32 v23, v23
 v_fma_f32 v22, v22, v15, v15
 v_fma_f32 v23, v23, v15, v15
 v_rcp_f32 v22, v22
 v_rcp_f32 v23, v23
 v_mul_f32 v22, v22, v50
 v_mul_f32 v23, v23, v51
 v_cvt_pk_bf16_f32 v101, v22, v23
 v_mul_f32 v20, v52, v52
 v_mul_f32 v21, v53, v53
 v_fma_f32 v20, v20, v13, v14
 v_fma_f32 v21, v21, v13, v14
 v_mul_f32 v20, v20, v52
 v_mul_f32 v21, v21, v53
 v_exp_f32 v20, v20
 v_exp_f32 v21, v21
 v_fma_f32 v20, v20, v15, v15
 v_fma_f32 v21, v21, v15, v15
 v_rcp_f32 v20, v20
 v_rcp_f32 v21, v21
 v_mul_f32 v20, v20, v52
 v_mul_f32 v21, v21, v53
 v_cvt_pk_bf16_f32 v102, v20, v21
 v_mul_f32 v22, v54, v54
 v_mul_f32 v23, v55, v55
 v_fma_f32 v22, v22, v13, v14
 v_fma_f32 v23, v23, v13, v14
 v_mul_f32 v22, v22, v54
 v_mul_f32 v23, v23, v55
 v_exp_f32 v22, v22
 v_exp_f32 v23, v23
 v_fma_f32 v22, v22, v15, v15
 v_fma_f32 v23, v23, v15, v15
 v_rcp_f32 v22, v22
 v_rcp_f32 v23, v23
 v_mul_f32 v22, v22, v54
 v_mul_f32 v23, v23, v55
 v_cvt_pk_bf16_f32 v103, v22, v23
 s_nop 1
 v_mfma_f32_32x32x16_bf16 a[0:15], a[104:107], v[100:103], a[0:15]
 ds_read_b64_tr_b16 a[124:125], v2 offset:22528
 ds_read_b64_tr_b16 a[126:127], v2 offset:23552
 buffer_store_dwordx4 v[100:103], v11, s[16:19], s39 offen offset:3072 sc1
 s_add_u32 s39, s42, 49152
 v_mul_f32 v20, v56, v56
 v_mfma_f32_32x32x16_bf16 a[16:31], a[108:111], v[100:103], a[16:31]
 s_barrier
 ds_read_b64_tr_b16 a[96:97], v1 offset:24576
 ds_read_b64_tr_b16 a[98:99], v1 offset:25600
 s_waitcnt lgkmcnt(6)
 v_mul_f32 v21, v57, v57
 v_fma_f32 v20, v20, v13, v14
 v_mfma_f32_32x32x16_bf16 a[32:47], a[112:115], v[100:103], a[32:47]
 ds_read_b64_tr_b16 a[100:101], v2 offset:24576
 ds_read_b64_tr_b16 a[102:103], v2 offset:25600
 s_add_u32 m0, s36, 24576
 s_add_u32 s38, s22, 512
 buffer_load_dwordx4 v7, s[8:11], s38 offen offset:0 lds
 v_mfma_f32_32x32x16_bf16 a[48:63], a[116:119], v[100:103], a[48:63]
 ds_read_b64_tr_b16 a[104:105], v1 offset:26624
 ds_read_b64_tr_b16 a[106:107], v1 offset:27648
 s_waitcnt lgkmcnt(6)
 s_add_u32 s40, s45, 2
 s_waitcnt vmcnt(8)
 v_subrev_u32 v16, s40, v16
 v_cmp_lt_u32 vcc, 4, v16
 s_cbranch_vccnz L_fp1
L_fp1_b:
 v_mfma_f32_32x32x16_bf16 a[64:79], a[120:123], v[100:103], a[64:79]
 ds_read_b64_tr_b16 a[108:109], v2 offset:26624
 ds_read_b64_tr_b16 a[110:111], v2 offset:27648
 v_fma_f32 v21, v21, v13, v14
 v_mul_f32 v20, v20, v56
 v_mul_f32 v21, v21, v57
 v_mfma_f32_32x32x16_bf16 a[80:95], a[124:127], v[100:103], a[80:95]
 ds_read_b64_tr_b16 a[112:113], v1 offset:28672
 ds_read_b64_tr_b16 a[114:115], v1 offset:29696
 buffer_load_dwordx4 v8, s[8:11], s38 offen offset:1024 lds
 s_waitcnt lgkmcnt(6)
 v_mfma_f32_32x32x16_bf16 a[0:15], a[96:99], a[136:139], a[0:15]
 ds_read_b64_tr_b16 a[116:117], v2 offset:28672
 ds_read_b64_tr_b16 a[118:119], v2 offset:29696
 s_add_u32 s41, s43, 16384
 buffer_load_dwordx4 a[168:171], v11, s[16:19], s41 offen offset:0 sc1
 v_mfma_f32_32x32x16_bf16 a[16:31], a[100:103], a[136:139], a[16:31]
 ds_read_b64_tr_b16 a[120:121], v1 offset:30720
 ds_read_b64_tr_b16 a[122:123], v1 offset:31744
 s_waitcnt lgkmcnt(6)
 v_exp_f32 v20, v20
 v_exp_f32 v21, v21
 v_fma_f32 v20, v20, v15, v15
 v_mfma_f32_32x32x16_bf16 a[32:47], a[104:107], a[136:139], a[32:47]
 ds_read_b64_tr_b16 a[124:125], v2 offset:30720
 ds_read_b64_tr_b16 a[126:127], v2 offset:31744
 buffer_load_dwordx4 v9, s[8:11], s38 offen offset:2048 lds
 v_mfma_f32_32x32x16_bf16 a[48:63], a[108:111], a[136:139], a[48:63]
 ds_read_b64_tr_b16 a[96:97], v1 offset:32768
 ds_read_b64_tr_b16 a[98:99], v1 offset:33792
 s_waitcnt lgkmcnt(6)
 buffer_load_dwordx4 a[172:175], v11, s[16:19], s41 offen offset:1024 sc1
 v_fma_f32 v21, v21, v15, v15
 v_mfma_f32_32x32x16_bf16 a[64:79], a[112:115], a[136:139], a[64:79]
 ds_read_b64_tr_b16 a[100:101], v2 offset:32768
 ds_read_b64_tr_b16 a[102:103], v2 offset:33792
 v_rcp_f32 v20, v20
 v_rcp_f32 v21, v21
 v_mul_f32 v20, v20, v56
 v_mfma_f32_32x32x16_bf16 a[80:95], a[116:119], a[136:139], a[80:95]
 ds_read_b64_tr_b16 a[104:105], v1 offset:34816
 ds_read_b64_tr_b16 a[106:107], v1 offset:35840
 buffer_load_dwordx4 v10, s[8:11], s38 offen offset:3072 lds
 s_waitcnt lgkmcnt(6)
 v_mfma_f32_32x32x16_bf16 a[0:15], a[120:123], a[140:143], a[0:15]
 ds_read_b64_tr_b16 a[108:109], v2 offset:34816
 ds_read_b64_tr_b16 a[110:111], v2 offset:35840
 buffer_load_dwordx4 a[176:179], v11, s[16:19], s41 offen offset:2048 sc1
 v_mul_f32 v21, v21, v57
 v_mfma_f32_32x32x16_bf16 a[16:31], a[124:127], a[140:143], a[16:31]
 ds_read_b64_tr_b16 a[112:113], v1 offset:36864
 ds_read_b64_tr_b16 a[114:115], v1 offset:37888
 s_waitcnt lgkmcnt(6)
 v_cvt_pk_bf16_f32 v104, v20, v21
 v_mul_f32 v22, v58, v58
 v_mul_f32 v23, v59, v59
 v_fma_f32 v22, v22, v13, v14
 v_mfma_f32_32x32x16_bf16 a[32:47], a[96:99], a[140:143], a[32:47]
 ds_read_b64_tr_b16 a[116:117], v2 offset:36864
 ds_read_b64_tr_b16 a[118:119], v2 offset:37888
 s_add_u32 m0, s36, 28672
 s_add_u32 s38, s22, 295424
 buffer_load_dwordx4 v7, s[8:11], s38 offen offset:0 lds
 v_mfma_f32_32x32x16_bf16 a[48:63], a[100:103], a[140:143], a[48:63]
 ds_read_b64_tr_b16 a[120:121], v1 offset:38912
 ds_read_b64_tr_b16 a[122:123], v1 offset:39936
 s_waitcnt lgkmcnt(6)
 buffer_load_dwordx4 a[180:183], v11, s[16:19], s41 offen offset:3072 sc1
 v_mfma_f32_32x32x16_bf16 a[64:79], a[104:107], a[140:143], a[64:79]
 ds_read_b64_tr_b16 a[124:125], v2 offset:38912
 ds_read_b64_tr_b16 a[126:127], v2 offset:39936
 v_fma_f32 v23, v23, v13, v14
 v_mul_f32 v22, v22, v58
 v_mul_f32 v23, v23, v59
 v_mfma_f32_32x32x16_bf16 a[80:95], a[108:111], a[140:143], a[80:95]
 ds_read_b64_tr_b16 a[96:97], v1 offset:40960
 ds_read_b64_tr_b16 a[98:99], v1 offset:41984
 buffer_load_dwordx4 v8, s[8:11], s38 offen offset:1024 lds
 s_waitcnt lgkmcnt(6)
 v_mfma_f32_32x32x16_bf16 a[0:15], a[112:115], a[144:147], a[0:15]
 ds_read_b64_tr_b16 a[100:101], v2 offset:40960
 ds_read_b64_tr_b16 a[102:103], v2 offset:41984
 s_add_u32 s41, s44, 16384
 buffer_load_dwordx4 a[184:187], v11, s[16:19], s41 offen offset:0 sc1
 v_exp_f32 v22, v22
 v_mfma_f32_32x32x16_bf16 a[16:31], a[116:119], a[144:147], a[16:31]
 ds_read_b64_tr_b16 a[104:105], v1 offset:43008
 ds_read_b64_tr_b16 a[106:107], v1 offset:44032
 s_waitcnt lgkmcnt(6)
 v_exp_f32 v23, v23
 v_fma_f32 v22, v22, v15, v15
 v_fma_f32 v23, v23, v15, v15
 v_mfma_f32_32x32x16_bf16 a[32:47], a[120:123], a[144:147], a[32:47]
 ds_read_b64_tr_b16 a[108:109], v2 offset:43008
 ds_read_b64_tr_b16 a[110:111], v2 offset:44032
 buffer_load_dwordx4 a[188:191], v11, s[16:19], s41 offen offset:1024 sc1
 v_mfma_f32_32x32x16_bf16 a[48:63], a[124:127], a[144:147], a[48:63]
 ds_read_b64_tr_b16 a[112:113], v1 offset:45056
 ds_read_b64_tr_b16 a[114:115], v1 offset:46080
 s_waitcnt lgkmcnt(6)
 v_rcp_f32 v22, v22
 v_rcp_f32 v23, v23
 v_mul_f32 v22, v22, v58
 v_mfma_f32_32x32x16_bf16 a[64:79], a[96:99], a[144:147], a[64:79]
 ds_read_b64_tr_b16 a[116:117], v2 offset:45056
 ds_read_b64_tr_b16 a[118:119], v2 offset:46080
 buffer_load_dwordx4 a[192:195], v11, s[16:19], s41 offen offset:2048 sc1
 v_mul_f32 v23, v23, v59
 v_mfma_f32_32x32x16_bf16 a[80:95], a[100:103], a[144:147], a[80:95]
 ds_read_b64_tr_b16 a[120:121], v1 offset:47104
 ds_read_b64_tr_b16 a[122:123], v1 offset:48128
 s_waitcnt lgkmcnt(6)
 v_cvt_pk_bf16_f32 v105, v22, v23
 v_mul_f32 v20, v60, v60
 v_mul_f32 v21, v61, v61
 v_fma_f32 v20, v20, v13, v14
 v_mfma_f32_32x32x16_bf16 a[0:15], a[104:107], a[148:151], a[0:15]
 ds_read_b64_tr_b16 a[124:125], v2 offset:47104
 ds_read_b64_tr_b16 a[126:127], v2 offset:48128
 buffer_load_dwordx4 a[196:199], v11, s[16:19], s41 offen offset:3072 sc1
 v_fma_f32 v21, v21, v13, v14
 v_mfma_f32_32x32x16_bf16 a[16:31], a[108:111], a[148:151], a[16:31]
 s_barrier
 v_add_u32 v1, 49152, v1
 v_add_u32 v2, 49152, v2
 ds_read_b64_tr_b16 a[96:97], v1 offset:0
 ds_read_b64_tr_b16 a[98:99], v1 offset:1024
 s_waitcnt lgkmcnt(6)
 v_mfma_f32_32x32x16_bf16 a[32:47], a[112:115], a[148:151], a[32:47]
 ds_read_b64_tr_b16 a[100:101], v2 offset:0
 ds_read_b64_tr_b16 a[102:103], v2 offset:1024
 s_add_u32 m0, s36, 49152
 s_add_u32 s38, s33, 221184
 buffer_load_dwordx4 v3, s[12:15], s38 offen offset:0 lds
 v_mfma_f32_32x32x16_bf16 a[48:63], a[116:119], a[148:151], a[48:63]
 ds_read_b64_tr_b16 a[104:105], v1 offset:2048
 ds_read_b64_tr_b16 a[106:107], v1 offset:3072
 s_waitcnt lgkmcnt(6)
 v_mul_f32 v20, v20, v60
 v_mul_f32 v21, v21, v61
 v_mfma_f32_32x32x16_bf16 a[64:79], a[120:123], a[148:151], a[64:79]
 ds_read_b64_tr_b16 a[108:109], v2 offset:2048
 ds_read_b64_tr_b16 a[110:111], v2 offset:3072
 v_exp_f32 v20, v20
 v_exp_f32 v21, v21
 v_fma_f32 v20, v20, v15, v15
 v_fma_f32 v21, v21, v15, v15
 v_mfma_f32_32x32x16_bf16 a[80:95], a[124:127], a[148:151], a[80:95]
 ds_read_b64_tr_b16 a[112:113], v1 offset:4096
 ds_read_b64_tr_b16 a[114:115], v1 offset:5120
 buffer_load_dwordx4 v4, s[12:15], s38 offen offset:1024 lds
 s_waitcnt lgkmcnt(6)
 v_mfma_f32_32x32x16_bf16 a[0:15], a[96:99], a[152:155], a[0:15]
 ds_read_b64_tr_b16 a[116:117], v2 offset:4096
 ds_read_b64_tr_b16 a[118:119], v2 offset:5120
 v_rcp_f32 v20, v20
 v_rcp_f32 v21, v21
 v_mul_f32 v20, v20, v60
 v_mfma_f32_32x32x16_bf16 a[16:31], a[100:103], a[152:155], a[16:31]
 ds_read_b64_tr_b16 a[120:121], v1 offset:6144
 ds_read_b64_tr_b16 a[122:123], v1 offset:7168
 s_waitcnt lgkmcnt(6)
 v_mul_f32 v21, v21, v61
 v_cvt_pk_bf16_f32 v106, v20, v21
 v_mul_f32 v22, v62, v62
 v_mul_f32 v23, v63, v63
 v_mfma_f32_32x32x16_bf16 a[32:47], a[104:107], a[152:155], a[32:47]
 ds_read_b64_tr_b16 a[124:125], v2 offset:6144
 ds_read_b64_tr_b16 a[126:127], v2 offset:7168
 buffer_load_dwordx4 v5, s[12:15], s38 offen offset:2048 lds
 v_fma_f32 v22, v22, v13, v14
 v_mfma_f32_32x32x16_bf16 a[48:63], a[108:111], a[152:155], a[48:63]
 ds_read_b64_tr_b16 a[96:97], v1 offset:8192
 ds_read_b64_tr_b16 a[98:99], v1 offset:9216
 s_waitcnt lgkmcnt(6)
 v_fma_f32 v23, v23, v13, v14
 v_mul_f32 v22, v22, v62
 v_mul_f32 v23, v23, v63
 v_mfma_f32_32x32x16_bf16 a[64:79], a[112:115], a[152:155], a[64:79]
 ds_read_b64_tr_b16 a[100:101], v2 offset:8192
 ds_read_b64_tr_b16 a[102:103], v2 offset:9216
 v_exp_f32 v22, v22
 v_exp_f32 v23, v23
 v_fma_f32 v22, v22, v15, v15
 v_fma_f32 v23, v23, v15, v15
 v_mfma_f32_32x32x16_bf16 a[80:95], a[116:119], a[152:155], a[80:95]
 ds_read_b64_tr_b16 a[104:105], v1 offset:10240
 ds_read_b64_tr_b16 a[106:107], v1 offset:11264
 buffer_load_dwordx4 v6, s[12:15], s38 offen offset:3072 lds
 s_waitcnt lgkmcnt(6)
 v_mfma_f32_32x32x16_bf16 a[0:15], a[120:123], a[156:159], a[0:15]
 ds_read_b64_tr_b16 a[108:109], v2 offset:10240
 ds_read_b64_tr_b16 a[110:111], v2 offset:11264
 s_add_u32 s40, s45, 3
 v_mov_b32 v18, s40
 s_waitcnt vmcnt(18)
 s_mov_b64 exec, 1
 buffer_store_dword v18, off, s[16:19], s47 sc1
 s_mov_b64 exec, -1
 v_mfma_f32_32x32x16_bf16 a[16:31], a[124:127], a[156:159], a[16:31]
 ds_read_b64_tr_b16 a[112:113], v1 offset:12288
 ds_read_b64_tr_b16 a[114:115], v1 offset:13312
 s_waitcnt lgkmcnt(6)
 v_rcp_f32 v22, v22
 v_mfma_f32_32x32x16_bf16 a[32:47], a[96:99], a[156:159], a[32:47]
 ds_read_b64_tr_b16 a[116:117], v2 offset:12288
 ds_read_b64_tr_b16 a[118:119], v2 offset:13312
 s_add_u32 m0, s36, 53248
 s_add_u32 s38, s33, 221440
 buffer_load_dwordx4 v3, s[12:15], s38 offen offset:0 lds
 v_mfma_f32_32x32x16_bf16 a[48:63], a[100:103], a[156:159], a[48:63]
 ds_read_b64_tr_b16 a[120:121], v1 offset:14336
 ds_read_b64_tr_b16 a[122:123], v1 offset:15360
 s_waitcnt lgkmcnt(6)
 v_rcp_f32 v23, v23
 v_mul_f32 v22, v22, v62
 v_mfma_f32_32x32x16_bf16 a[64:79], a[104:107], a[156:159], a[64:79]
 ds_read_b64_tr_b16 a[124:125], v2 offset:14336
 ds_read_b64_tr_b16 a[126:127], v2 offset:15360
 v_mul_f32 v23, v23, v63
 v_cvt_pk_bf16_f32 v107, v22, v23
 buffer_store_dwordx4 v[104:107], v11, s[16:19], s39 offen offset:0 sc1
 v_mfma_f32_32x32x16_bf16 a[80:95], a[108:111], a[156:159], a[80:95]
 ds_read_b64_tr_b16 a[96:97], v1 offset:16384
 ds_read_b64_tr_b16 a[98:99], v1 offset:17408
 buffer_load_dwordx4 v4, s[12:15], s38 offen offset:1024 lds
 s_waitcnt lgkmcnt(6)
 v_mfma_f32_32x32x16_bf16 a[0:15], a[112:115], a[160:163], a[0:15]
 ds_read_b64_tr_b16 a[100:101], v2 offset:16384
 ds_read_b64_tr_b16 a[102:103], v2 offset:17408
 v_mul_f32 v20, v64, v64
 v_mul_f32 v21, v65, v65
 v_fma_f32 v20, v20, v13, v14
 v_fma_f32 v21, v21, v13, v14
 v_mul_f32 v20, v20, v64
 v_mfma_f32_32x32x16_bf16 a[16:31], a[116:119], a[160:163], a[16:31]
 ds_read_b64_tr_b16 a[104:105], v1 offset:18432
 ds_read_b64_tr_b16 a[106:107], v1 offset:19456
 s_waitcnt lgkmcnt(6)
 v_mul_f32 v21, v21, v65
 v_exp_f32 v20, v20
 v_mfma_f32_32x32x16_bf16 a[32:47], a[120:123], a[160:163], a[32:47]
 ds_read_b64_tr_b16 a[108:109], v2 offset:18432
 ds_read_b64_tr_b16 a[110:111], v2 offset:19456
 v_exp_f32 v21, v21
 v_fma_f32 v20, v20, v15, v15
 v_fma_f32 v21, v21, v15, v15
 v_rcp_f32 v20, v20
 v_mfma_f32_32x32x16_bf16 a[48:63], a[124:127], a[160:163], a[48:63]
 ds_read_b64_tr_b16 a[112:113], v1 offset:20480
 ds_read_b64_tr_b16 a[114:115], v1 offset:21504
 s_waitcnt lgkmcnt(6)
 v_rcp_f32 v21, v21
 v_mul_f32 v20, v20, v64
 v_mul_f32 v21, v21, v65
 v_mfma_f32_32x32x16_bf16 a[64:79], a[96:99], a[160:163], a[64:79]
 ds_read_b64_tr_b16 a[116:117], v2 offset:20480
 ds_read_b64_tr_b16 a[118:119], v2 offset:21504
 v_cvt_pk_bf16_f32 v108, v20, v21
 v_mul_f32 v22, v66, v66
 v_mul_f32 v23, v67, v67
 v_fma_f32 v22, v22, v13, v14
 v_fma_f32 v23, v23, v13, v14
 v_mfma_f32_32x32x16_bf16 a[80:95], a[100:103], a[160:163], a[80:95]
 ds_read_b64_tr_b16 a[120:121], v1 offset:22528
 ds_read_b64_tr_b16 a[122:123], v1 offset:23552
 s_waitcnt lgkmcnt(6)
 v_mul_f32 v22, v22, v66
 v_mul_f32 v23, v23, v67
 v_exp_f32 v22, v22
 v_mfma_f32_32x32x16_bf16 a[0:15], a[104:107], a[164:167], a[0:15]
 ds_read_b64_tr_b16 a[124:125], v2 offset:22528
 ds_read_b64_tr_b16 a[126:127], v2 offset:23552
 v_exp_f32 v23, v23
 v_fma_f32 v22, v22, v15, v15
 v_fma_f32 v23, v23, v15, v15
 v_mfma_f32_32x32x16_bf16 a[16:31], a[108:111], a[164:167], a[16:31]
 s_barrier
 ds_read_b64_tr_b16 a[96:97], v1 offset:24576
 ds_read_b64_tr_b16 a[98:99], v1 offset:25600
 s_waitcnt lgkmcnt(6)
 v_rcp_f32 v22, v22
 v_mfma_f32_32x32x16_bf16 a[32:47], a[112:115], a[164:167], a[32:47]
 ds_read_b64_tr_b16 a[100:101], v2 offset:24576
 ds_read_b64_tr_b16 a[102:103], v2 offset:25600
 s_add_u32 m0, s36, 73728
 s_add_u32 s38, s34, 73728
 buffer_load_dwordx4 v3, s[12:15], s38 offen offset:0 lds
 v_mfma_f32_32x32x16_bf16 a[48:63], a[116:119], a[164:167], a[48:63]
 ds_read_b64_tr_b16 a[104:105], v1 offset:26624
 ds_read_b64_tr_b16 a[106:107], v1 offset:27648
 s_waitcnt lgkmcnt(6)
 v_rcp_f32 v23, v23
 v_mul_f32 v22, v22, v66
 v_mul_f32 v23, v23, v67
 v_mfma_f32_32x32x16_bf16 a[64:79], a[120:123], a[164:167], a[64:79]
 ds_read_b64_tr_b16 a[108:109], v2 offset:26624
 ds_read_b64_tr_b16 a[110:111], v2 offset:27648
 v_cvt_pk_bf16_f32 v109, v22, v23
 v_mul_f32 v20, v68, v68
 v_mul_f32 v21, v69, v69
 v_fma_f32 v20, v20, v13, v14
 v_fma_f32 v21, v21, v13, v14
 v_mfma_f32_32x32x16_bf16 a[80:95], a[124:127], a[164:167], a[80:95]
 ds_read_b64_tr_b16 a[112:113], v1 offset:28672
 ds_read_b64_tr_b16 a[114:115], v1 offset:29696
 buffer_load_dwordx4 v4, s[12:15], s38 offen offset:1024 lds
 s_waitcnt lgkmcnt(6)
 v_mfma_f32_32x32x16_bf16 v[24:39], a[96:99], v[120:123], 0
 ds_read_b64_tr_b16 a[116:117], v2 offset:28672
 ds_read_b64_tr_b16 a[118:119], v2 offset:29696
 v_mul_f32 v20, v20, v68
 v_mul_f32 v21, v21, v69
 v_exp_f32 v20, v20
 v_mfma_f32_32x32x16_bf16 v[40:55], a[100:103], v[120:123], 0
 ds_read_b64_tr_b16 a[120:121], v1 offset:30720
 ds_read_b64_tr_b16 a[122:123], v1 offset:31744
 s_waitcnt lgkmcnt(6)
 v_exp_f32 v21, v21
 v_fma_f32 v20, v20, v15, v15
 v_fma_f32 v21, v21, v15, v15
 v_mfma_f32_32x32x16_bf16 v[24:39], a[104:107], v[124:127], v[24:39]
 ds_read_b64_tr_b16 a[124:125], v2 offset:30720
 ds_read_b64_tr_b16 a[126:127], v2 offset:31744
 buffer_load_dwordx4 v5, s[12:15], s38 offen offset:2048 lds
 v_rcp_f32 v20, v20
 v_mfma_f32_32x32x16_bf16 v[40:55], a[108:111], v[124:127], v[40:55]
 ds_read_b64_tr_b16 a[96:97], v1 offset:32768
 ds_read_b64_tr_b16 a[98:99], v1 offset:33792
 s_waitcnt lgkmcnt(6)
 v_rcp_f32 v21, v21
 v_mul_f32 v20, v20, v68
 v_mul_f32 v21, v21, v69
 v_mfma_f32_32x32x16_bf16 v[24:39], a[112:115], v[128:131], v[24:39]
 ds_read_b64_tr_b16 a[100:101], v2 offset:32768
 ds_read_b64_tr_b16 a[102:103], v2 offset:33792
 v_cvt_pk_bf16_f32 v110, v20, v21
 v_mul_f32 v22, v70, v70
 v_mul_f32 v23, v71, v71
 v_fma_f32 v22, v22, v13, v14
 v_fma_f32 v23, v23, v13, v14
 v_mfma_f32_32x32x16_bf16 v[40:55], a[116:119], v[128:131], v[40:55]
 ds_read_b64_tr_b16 a[104:105], v1 offset:34816
 ds_read_b64_tr_b16 a[106:107], v1 offset:35840
 buffer_load_dwordx4 v6, s[12:15], s38 offen offset:3072 lds
 s_waitcnt lgkmcnt(6)
 v_mfma_f32_32x32x16_bf16 v[24:39], a[120:123], v[132:135], v[24:39]
 ds_read_b64_tr_b16 a[108:109], v2 offset:34816
 ds_read_b64_tr_b16 a[110:111], v2 offset:35840
 v_mul_f32 v22, v22, v70
 v_mul_f32 v23, v23, v71
 v_exp_f32 v22, v22
 v_mfma_f32_32x32x16_bf16 v[40:55], a[124:127], v[132:135], v[40:55]
 ds_read_b64_tr_b16 a[112:113], v1 offset:36864
 ds_read_b64_tr_b16 a[114:115], v1 offset:37888
 s_waitcnt lgkmcnt(6)
 v_exp_f32 v23, v23
 v_fma_f32 v22, v22, v15, v15
 v_fma_f32 v23, v23, v15, v15
 v_mfma_f32_32x32x16_bf16 v[24:39], a[96:99], v[136:139], v[24:39]
 ds_read_b64_tr_b16 a[116:117], v2 offset:36864
 ds_read_b64_tr_b16 a[118:119], v2 offset:37888
 s_add_u32 m0, s36, 77824
 s_add_u32 s38, s34, 73984
 buffer_load_dwordx4 v3, s[12:15], s38 offen offset:0 lds
 v_mfma_f32_32x32x16_bf16 v[40:55], a[100:103], v[136:139], v[40:55]
 ds_read_b64_tr_b16 a[120:121], v1 offset:38912
 ds_read_b64_tr_b16 a[122:123], v1 offset:39936
 s_waitcnt lgkmcnt(6)
 v_rcp_f32 v22, v22
 v_rcp_f32 v23, v23
 v_mfma_f32_32x32x16_bf16 v[24:39], a[104:107], v[140:143], v[24:39]
 ds_read_b64_tr_b16 a[124:125], v2 offset:38912
 ds_read_b64_tr_b16 a[126:127], v2 offset:39936
 v_mul_f32 v22, v22, v70
 v_mul_f32 v23, v23, v71
 v_cvt_pk_bf16_f32 v111, v22, v23
 v_mfma_f32_32x32x16_bf16 v[40:55], a[108:111], v[140:143], v[40:55]
 ds_read_b64_tr_b16 a[96:97], v1 offset:40960
 ds_read_b64_tr_b16 a[98:99], v1 offset:41984
 buffer_load_dwordx4 v4, s[12:15], s38 offen offset:1024 lds
 s_waitcnt lgkmcnt(6)
 v_mfma_f32_32x32x16_bf16 v[24:39], a[112:115], v[144:147], v[24:39]
 ds_read_b64_tr_b16 a[100:101], v2 offset:40960
 ds_read_b64_tr_b16 a[102:103], v2 offset:41984
 buffer_store_dwordx4 v[108:111], v11, s[16:19], s39 offen offset:1024 sc1
 v_mul_f32 v20, v72, v72
 v_mul_f32 v21, v73, v73
 v_fma_f32 v20, v20, v13, v14
 v_mfma_f32_32x32x16_bf16 v[40:55], a[116:119], v[144:147], v[40:55]
 ds_read_b64_tr_b16 a[104:105], v1 offset:43008
 ds_read_b64_tr_b16 a[106:107], v1 offset:44032
 s_waitcnt lgkmcnt(6)
 v_fma_f32 v21, v21, v13, v14
 v_mul_f32 v20, v20, v72
 v_mul_f32 v21, v21, v73
 v_mfma_f32_32x32x16_bf16 v[24:39], a[120:123], v[148:151], v[24:39]
 ds_read_b64_tr_b16 a[108:109], v2 offset:43008
 ds_read_b64_tr_b16 a[110:111], v2 offset:44032
 v_exp_f32 v20, v20
 v_exp_f32 v21, v21
 v_fma_f32 v20, v20, v15, v15
 v_fma_f32 v21, v21, v15, v15
 v_mfma_f32_32x32x16_bf16 v[40:55], a[124:127], v[148:151], v[40:55]
 ds_read_b64_tr_b16 a[112:113], v1 offset:45056
 ds_read_b64_tr_b16 a[114:115], v1 offset:46080
 s_waitcnt lgkmcnt(6)
 v_rcp_f32 v20, v20
 v_rcp_f32 v21, v21
 v_mfma_f32_32x32x16_bf16 v[24:39], a[96:99], v[152:155], v[24:39]
 ds_read_b64_tr_b16 a[116:117], v2 offset:45056
 ds_read_b64_tr_b16 a[118:119], v2 offset:46080
 v_mul_f32 v20, v20, v72
 v_mul_f32 v21, v21, v73
 v_cvt_pk_bf16_f32 v112, v20, v21
 v_mul_f32 v22, v74, v74
 v_mul_f32 v23, v75, v75
 v_mfma_f32_32x32x16_bf16 v[40:55], a[100:103], v[152:155], v[40:55]
 ds_read_b64_tr_b16 a[120:121], v1 offset:47104
 ds_read_b64_tr_b16 a[122:123], v1 offset:48128
 s_waitcnt lgkmcnt(6)
 v_fma_f32 v22, v22, v13, v14
 v_fma_f32 v23, v23, v13, v14
 v_mul_f32 v22, v22, v74
 v_mul_f32 v23, v23, v75
 v_mfma_f32_32x32x16_bf16 v[24:39], a[104:107], v[156:159], v[24:39]
 ds_read_b64_tr_b16 a[124:125], v2 offset:47104
 ds_read_b64_tr_b16 a[126:127], v2 offset:48128
 v_exp_f32 v22, v22
 v_exp_f32 v23, v23
 v_fma_f32 v22, v22, v15, v15
 v_mfma_f32_32x32x16_bf16 v[40:55], a[108:111], v[156:159], v[40:55]
 s_barrier
 v_add_u32 v1, -98304, v1
 v_add_u32 v2, -98304, v2
 ds_read_b64_tr_b16 a[96:97], v1 offset:0
 ds_read_b64_tr_b16 a[98:99], v1 offset:1024
 s_waitcnt lgkmcnt(6)
 v_mfma_f32_32x32x16_bf16 v[24:39], a[112:115], v[160:163], v[24:39]
 ds_read_b64_tr_b16 a[100:101], v2 offset:0
 ds_read_b64_tr_b16 a[102:103], v2 offset:1024
 s_add_u32 m0, s36, 98304
 s_add_u32 s38, s20, 640
 buffer_load_dwordx4 v7, s[8:11], s38 offen offset:0 lds
 v_mfma_f32_32x32x16_bf16 v[40:55], a[116:119], v[160:163], v[40:55]
 ds_read_b64_tr_b16 a[104:105], v1 offset:2048
 ds_read_b64_tr_b16 a[106:107], v1 offset:3072
 s_waitcnt lgkmcnt(6)
 v_fma_f32 v23, v23, v15, v15
 v_rcp_f32 v22, v22
 v_mfma_f32_32x32x16_bf16 v[24:39], a[120:123], v[164:167], v[24:39]
 ds_read_b64_tr_b16 a[108:109], v2 offset:2048
 ds_read_b64_tr_b16 a[110:111], v2 offset:3072
 buffer_load_dword v16, v17, s[16:19], 0 offen sc1
 v_rcp_f32 v23, v23
 v_mfma_f32_32x32x16_bf16 v[40:55], a[124:127], v[164:167], v[40:55]
 ds_read_b64_tr_b16 a[112:113], v1 offset:4096
 ds_read_b64_tr_b16 a[114:115], v1 offset:5120
 buffer_load_dwordx4 v8, s[8:11], s38 offen offset:1024 lds
 s_waitcnt lgkmcnt(6)
 v_mfma_f32_32x32x16_bf16 v[24:39], a[96:99], v[168:171], v[24:39]
 ds_read_b64_tr_b16 a[116:117], v2 offset:4096
 ds_read_b64_tr_b16 a[118:119], v2 offset:5120
 v_mul_f32 v22, v22, v74
 v_mul_f32 v23, v23, v75
 v_cvt_pk_bf16_f32 v113, v22, v23
 v_mul_f32 v20, v76, v76
 v_mul_f32 v21, v77, v77
 v_mfma_f32_32x32x16_bf16 v[40:55], a[100:103], v[168:171], v[40:55]
 ds_read_b64_tr_b16 a[120:121], v1 offset:6144
 ds_read_b64_tr_b16 a[122:123], v1 offset:7168
 s_waitcnt lgkmcnt(6)
 v_fma_f32 v20, v20, v13, v14
 v_fma_f32 v21, v21, v13, v14
 v_mul_f32 v20, v20, v76
 v_mul_f32 v21, v21, v77
 v_mfma_f32_32x32x16_bf16 v[24:39], a[104:107], v[172:175], v[24:39]
 ds_read_b64_tr_b16 a[124:125], v2 offset:6144
 ds_read_b64_tr_b16 a[126:127], v2 offset:7168
 buffer_load_dwordx4 v9, s[8:11], s38 offen offset:2048 lds
 v_mfma_f32_32x32x16_bf16 v[40:55], a[108:111], v[172:175], v[40:55]
 ds_read_b64_tr_b16 a[96:97], v1 offset:8192
 ds_read_b64_tr_b16 a[98:99], v1 offset:9216
 s_waitcnt lgkmcnt(6)
 v_exp_f32 v20, v20
 v_exp_f32 v21, v21
 v_fma_f32 v20, v20, v15, v15
 v_mfma_f32_32x32x16_bf16 v[24:39], a[112:115], v[176:179], v[24:39]
 ds_read_b64_tr_b16 a[100:101], v2 offset:8192
 ds_read_b64_tr_b16 a[102:103], v2 offset:9216
 v_fma_f32 v21, v21, v15, v15
 v_rcp_f32 v20, v20
 v_rcp_f32 v21, v21
 v_mfma_f32_32x32x16_bf16 v[40:55], a[116:119], v[176:179], v[40:55]
 ds_read_b64_tr_b16 a[104:105], v1 offset:10240
 ds_read_b64_tr_b16 a[106:107], v1 offset:11264
 buffer_load_dwordx4 v10, s[8:11], s38 offen offset:3072 lds
 s_waitcnt lgkmcnt(6)
 v_mfma_f32_32x32x16_bf16 v[24:39], a[120:123], v[180:183], v[24:39]
 ds_read_b64_tr_b16 a[108:109], v2 offset:10240
 ds_read_b64_tr_b16 a[110:111], v2 offset:11264
 v_mul_f32 v20, v20, v76
 v_mul_f32 v21, v21, v77
 v_cvt_pk_bf16_f32 v114, v20, v21
 v_mul_f32 v22, v78, v78
 v_mul_f32 v23, v79, v79
 v_mfma_f32_32x32x16_bf16 v[40:55], a[124:127], v[180:183], v[40:55]
 ds_read_b64_tr_b16 a[112:113], v1 offset:12288
 ds_read_b64_tr_b16 a[114:115], v1 offset:13312
 s_waitcnt lgkmcnt(6)
 v_fma_f32 v22, v22, v13, v14
 v_fma_f32 v23, v23, v13, v14
 v_mul_f32 v22, v22, v78
 v_mul_f32 v23, v23, v79
 v_mfma_f32_32x32x16_bf16 v[24:39], a[96:99], v[184:187], v[24:39]
 ds_read_b64_tr_b16 a[116:117], v2 offset:12288
 ds_read_b64_tr_b16 a[118:119], v2 offset:13312
 s_add_u32 m0, s36, 102400
 s_add_u32 s38, s20, 295552
 buffer_load_dwordx4 v7, s[8:11], s38 offen offset:0 lds
 v_mfma_f32_32x32x16_bf16 v[40:55], a[100:103], v[184:187], v[40:55]
 ds_read_b64_tr_b16 a[120:121], v1 offset:14336
 ds_read_b64_tr_b16 a[122:123], v1 offset:15360
 s_add_u32 s90, s90, 1024
 s_mov_b32 m0, s23
 s_nop 0
 buffer_load_dwordx4 v11, s[16:19], s90 offen sc1 lds
 s_waitcnt lgkmcnt(6)
 v_mfma_f32_32x32x16_bf16 v[24:39], a[104:107], v[188:191], v[24:39]
 ds_read_b64_tr_b16 a[124:125], v2 offset:14336
 ds_read_b64_tr_b16 a[126:127], v2 offset:15360
 v_exp_f32 v22, v22
 v_mfma_f32_32x32x16_bf16 v[40:55], a[108:111], v[188:191], v[40:55]
 ds_read_b64_tr_b16 a[96:97], v1 offset:16384
 ds_read_b64_tr_b16 a[98:99], v1 offset:17408
 s_add_u32 m0, s36, 102400
 s_nop 0
 buffer_load_dwordx4 v8, s[8:11], s38 offen offset:1024 lds
 s_waitcnt lgkmcnt(6)
 v_mfma_f32_32x32x16_bf16 v[24:39], a[112:115], v[192:195], v[24:39]
 ds_read_b64_tr_b16 a[100:101], v2 offset:16384
 ds_read_b64_tr_b16 a[102:103], v2 offset:17408
 v_exp_f32 v23, v23
 v_fma_f32 v22, v22, v15, v15
 v_fma_f32 v23, v23, v15, v15
 v_mfma_f32_32x32x16_bf16 v[40:55], a[116:119], v[192:195], v[40:55]
 ds_read_b64_tr_b16 a[104:105], v1 offset:18432
 ds_read_b64_tr_b16 a[106:107], v1 offset:19456
 s_waitcnt lgkmcnt(6)
 v_rcp_f32 v22, v22
 v_rcp_f32 v23, v23
 v_mul_f32 v22, v22, v78
 v_mfma_f32_32x32x16_bf16 v[24:39], a[120:123], v[196:199], v[24:39]
 ds_read_b64_tr_b16 a[108:109], v2 offset:18432
 ds_read_b64_tr_b16 a[110:111], v2 offset:19456
 v_mul_f32 v23, v23, v79
 v_cvt_pk_bf16_f32 v115, v22, v23
 buffer_store_dwordx4 v[112:115], v11, s[16:19], s39 offen offset:2048 sc1
 v_mfma_f32_32x32x16_bf16 v[40:55], a[124:127], v[196:199], v[40:55]
 ds_read_b64_tr_b16 a[112:113], v1 offset:20480
 ds_read_b64_tr_b16 a[114:115], v1 offset:21504
 s_waitcnt lgkmcnt(6)
 v_mul_f32 v20, v80, v80
 v_mul_f32 v21, v81, v81
 v_fma_f32 v20, v20, v13, v14
 v_fma_f32 v21, v21, v13, v14
 v_mfma_f32_32x32x16_bf16 v[24:39], a[96:99], v[200:203], v[24:39]
 ds_read_b64_tr_b16 a[116:117], v2 offset:20480
 ds_read_b64_tr_b16 a[118:119], v2 offset:21504
 v_mul_f32 v20, v20, v80
 v_mul_f32 v21, v21, v81
 v_exp_f32 v20, v20
 v_mfma_f32_32x32x16_bf16 v[40:55], a[100:103], v[200:203], v[40:55]
 ds_read_b64_tr_b16 a[120:121], v1 offset:22528
 ds_read_b64_tr_b16 a[122:123], v1 offset:23552
 s_waitcnt lgkmcnt(6)
 v_exp_f32 v21, v21
 v_fma_f32 v20, v20, v15, v15
 v_fma_f32 v21, v21, v15, v15
 v_mfma_f32_32x32x16_bf16 v[24:39], a[104:107], v[204:207], v[24:39]
 ds_read_b64_tr_b16 a[124:125], v2 offset:22528
 ds_read_b64_tr_b16 a[126:127], v2 offset:23552
 v_rcp_f32 v20, v20
 v_rcp_f32 v21, v21
 v_mul_f32 v20, v20, v80
 v_mul_f32 v21, v21, v81
 v_mfma_f32_32x32x16_bf16 v[40:55], a[108:111], v[204:207], v[40:55]
 s_waitcnt vmcnt(28)
 s_barrier
 ds_read_b64_tr_b16 a[96:97], v1 offset:24576
 ds_read_b64_tr_b16 a[98:99], v1 offset:25600
 s_waitcnt lgkmcnt(6)
 v_cvt_pk_bf16_f32 v116, v20, v21
 v_mul_f32 v22, v82, v82
 v_mfma_f32_32x32x16_bf16 v[24:39], a[112:115], v[208:211], v[24:39]
 ds_read_b64_tr_b16 a[100:101], v2 offset:24576
 ds_read_b64_tr_b16 a[102:103], v2 offset:25600
 s_add_u32 m0, s36, 122880
 s_add_u32 s38, s21, 640
 buffer_load_dwordx4 v7, s[8:11], s38 offen offset:0 lds
 v_mfma_f32_32x32x16_bf16 v[40:55], a[116:119], v[208:211], v[40:55]
 ds_read_b64_tr_b16 a[104:105], v1 offset:26624
 ds_read_b64_tr_b16 a[106:107], v1 offset:27648
 s_waitcnt lgkmcnt(6)
 v_mul_f32 v23, v83, v83
 v_fma_f32 v22, v22, v13, v14
 v_fma_f32 v23, v23, v13, v14
 v_mfma_f32_32x32x16_bf16 v[24:39], a[120:123], v[212:215], v[24:39]
 ds_read_b64_tr_b16 a[108:109], v2 offset:26624
 ds_read_b64_tr_b16 a[110:111], v2 offset:27648
 s_add_u32 s40, s45, 3
 s_waitcnt vmcnt(8)
 v_subrev_u32 v16, s40, v16
 v_cmp_lt_u32 vcc, 3, v16
 s_cbranch_vccnz L_fp2
L_fp2_b:
 v_mfma_f32_32x32x16_bf16 v[40:55], a[124:127], v[212:215], v[40:55]
 ds_read_b64_tr_b16 a[112:113], v1 offset:28672
 ds_read_b64_tr_b16 a[114:115], v1 offset:29696
 buffer_load_dwordx4 v8, s[8:11], s38 offen offset:1024 lds
 s_waitcnt lgkmcnt(6)
 v_mfma_f32_32x32x16_bf16 v[24:39], a[96:99], v[216:219], v[24:39]
 ds_read_b64_tr_b16 a[116:117], v2 offset:28672
 ds_read_b64_tr_b16 a[118:119], v2 offset:29696
 s_add_u32 s41, s43, 32768
 buffer_load_dwordx4 a[200:203], v11, s[16:19], s41 offen offset:0 sc1
 v_mul_f32 v22, v22, v82
 v_mfma_f32_32x32x16_bf16 v[40:55], a[100:103], v[216:219], v[40:55]
 ds_read_b64_tr_b16 a[120:121], v1 offset:30720
 ds_read_b64_tr_b16 a[122:123], v1 offset:31744
 s_waitcnt lgkmcnt(6)
 v_mul_f32 v23, v23, v83
 v_exp_f32 v22, v22
 v_mfma_f32_32x32x16_bf16 v[24:39], a[104:107], v[220:223], v[24:39]
 ds_read_b64_tr_b16 a[124:125], v2 offset:30720
 ds_read_b64_tr_b16 a[126:127], v2 offset:31744
 buffer_load_dwordx4 v9, s[8:11], s38 offen offset:2048 lds
 v_mfma_f32_32x32x16_bf16 v[40:55], a[108:111], v[220:223], v[40:55]
 ds_read_b64_tr_b16 a[96:97], v1 offset:32768
 ds_read_b64_tr_b16 a[98:99], v1 offset:33792
 s_waitcnt lgkmcnt(6)
 buffer_load_dwordx4 a[204:207], v11, s[16:19], s41 offen offset:1024 sc1
 v_mfma_f32_32x32x16_bf16 v[24:39], a[112:115], v[224:227], v[24:39]
 ds_read_b64_tr_b16 a[100:101], v2 offset:32768
 ds_read_b64_tr_b16 a[102:103], v2 offset:33792
 v_exp_f32 v23, v23
 v_fma_f32 v22, v22, v15, v15
 v_fma_f32 v23, v23, v15, v15
 v_rcp_f32 v22, v22
 v_mfma_f32_32x32x16_bf16 v[40:55], a[116:119], v[224:227], v[40:55]
 ds_read_b64_tr_b16 a[104:105], v1 offset:34816
 ds_read_b64_tr_b16 a[106:107], v1 offset:35840
 buffer_load_dwordx4 v10, s[8:11], s38 offen offset:3072 lds
 s_waitcnt lgkmcnt(6)
 v_mfma_f32_32x32x16_bf16 v[24:39], a[120:123], v[228:231], v[24:39]
 ds_read_b64_tr_b16 a[108:109], v2 offset:34816
 ds_read_b64_tr_b16 a[110:111], v2 offset:35840
 buffer_load_dwordx4 a[208:211], v11, s[16:19], s41 offen offset:2048 sc1
 v_mfma_f32_32x32x16_bf16 v[40:55], a[124:127], v[228:231], v[40:55]
 ds_read_b64_tr_b16 a[112:113], v1 offset:36864
 ds_read_b64_tr_b16 a[114:115], v1 offset:37888
 s_waitcnt lgkmcnt(6)
 v_rcp_f32 v23, v23
 v_mul_f32 v22, v22, v82
 v_mul_f32 v23, v23, v83
 v_cvt_pk_bf16_f32 v117, v22, v23
 v_mfma_f32_32x32x16_bf16 v[24:39], a[96:99], v[232:235], v[24:39]
 ds_read_b64_tr_b16 a[116:117], v2 offset:36864
 ds_read_b64_tr_b16 a[118:119], v2 offset:37888
 s_add_u32 m0, s36, 126976
 s_add_u32 s38, s21, 295552
 buffer_load_dwordx4 v7, s[8:11], s38 offen offset:0 lds
 v_mfma_f32_32x32x16_bf16 v[40:55], a[100:103], v[232:235], v[40:55]
 ds_read_b64_tr_b16 a[120:121], v1 offset:38912
 ds_read_b64_tr_b16 a[122:123], v1 offset:39936
 s_waitcnt lgkmcnt(6)
 buffer_load_dwordx4 a[212:215], v11, s[16:19], s41 offen offset:3072 sc1
 v_mfma_f32_32x32x16_bf16 v[24:39], a[104:107], v[236:239], v[24:39]
 ds_read_b64_tr_b16 a[124:125], v2 offset:38912
 ds_read_b64_tr_b16 a[126:127], v2 offset:39936
 v_mul_f32 v20, v84, v84
 v_mul_f32 v21, v85, v85
 v_fma_f32 v20, v20, v13, v14
 v_fma_f32 v21, v21, v13, v14
 v_mfma_f32_32x32x16_bf16 v[40:55], a[108:111], v[236:239], v[40:55]
 ds_read_b64_tr_b16 a[96:97], v1 offset:40960
 ds_read_b64_tr_b16 a[98:99], v1 offset:41984
 buffer_load_dwordx4 v8, s[8:11], s38 offen offset:1024 lds
 s_waitcnt lgkmcnt(6)
 v_mfma_f32_32x32x16_bf16 v[24:39], a[112:115], v[240:243], v[24:39]
 ds_read_b64_tr_b16 a[100:101], v2 offset:40960
 ds_read_b64_tr_b16 a[102:103], v2 offset:41984
 s_add_u32 s41, s44, 32768
 buffer_load_dwordx4 a[216:219], v11, s[16:19], s41 offen offset:0 sc1
 v_mul_f32 v20, v20, v84
 v_mfma_f32_32x32x16_bf16 v[40:55], a[116:119], v[240:243], v[40:55]
 ds_read_b64_tr_b16 a[104:105], v1 offset:43008
 ds_read_b64_tr_b16 a[106:107], v1 offset:44032
 s_waitcnt lgkmcnt(6)
 v_mul_f32 v21, v21, v85
 v_exp_f32 v20, v20
 v_mfma_f32_32x32x16_bf16 v[24:39], a[120:123], v[244:247], v[24:39]
 ds_read_b64_tr_b16 a[108:109], v2 offset:43008
 ds_read_b64_tr_b16 a[110:111], v2 offset:44032
 buffer_load_dwordx4 a[220:223], v11, s[16:19], s41 offen offset:1024 sc1
 v_exp_f32 v21, v21
 v_mfma_f32_32x32x16_bf16 v[40:55], a[124:127], v[244:247], v[40:55]
 ds_read_b64_tr_b16 a[112:113], v1 offset:45056
 ds_read_b64_tr_b16 a[114:115], v1 offset:46080
 s_waitcnt vmcnt(14)
 ds_read2_b32 v[18:19], v12 offset0:3 offset1:131
 s_waitcnt lgkmcnt(7)
 v_fma_f32 v20, v20, v15, v15
 v_fma_f32 v21, v21, v15, v15
 v_mfma_f32_32x32x16_bf16 v[24:39], a[96:99], v[248:251], v[24:39]
 ds_read_b64_tr_b16 a[116:117], v2 offset:45056
 ds_read_b64_tr_b16 a[118:119], v2 offset:46080
 buffer_load_dwordx4 a[224:227], v11, s[16:19], s41 offen offset:2048 sc1
 v_mfma_f32_32x32x16_bf16 v[40:55], a[100:103], v[248:251], v[40:55]
 ds_read_b64_tr_b16 a[120:121], v1 offset:47104
 ds_read_b64_tr_b16 a[122:123], v1 offset:48128
 s_waitcnt lgkmcnt(7)
 v_rcp_f32 v20, v20
 v_rcp_f32 v21, v21
 v_mul_f32 v20, v20, v84
 v_mfma_f32_32x32x16_bf16 v[24:39], a[104:107], v[252:255], v[24:39]
 ds_read_b64_tr_b16 a[124:125], v2 offset:47104
 ds_read_b64_tr_b16 a[126:127], v2 offset:48128
 s_waitcnt lgkmcnt(6)
 v_bitop3_b32 v19, v18, v19, s46 bitop3:0x7e
 v_cmp_ne_u32 vcc, 0, v19
 s_cbranch_vccnz L_fx4
L_fx4_b:
 v_mfma_f32_32x32x16_bf16 v[40:55], a[108:111], v[252:255], v[40:55]
 ds_read_b128 a[96:99], v12 offset:0
 s_waitcnt lgkmcnt(5)
 buffer_load_dwordx4 a[228:231], v11, s[16:19], s41 offen offset:3072 sc1
 v_mul_f32 v21, v21, v85
 v_mfma_f32_32x32x16_bf16 v[24:39], a[112:115], a[128:131], v[24:39]
 ds_read_b128 a[100:103], v12 offset:512
 v_cvt_pk_bf16_f32 v118, v20, v21
 v_mul_f32 v22, v86, v86
 v_mul_f32 v23, v87, v87
 v_fma_f32 v22, v22, v13, v14
 v_fma_f32 v23, v23, v13, v14
 v_mfma_f32_32x32x16_bf16 v[40:55], a[116:119], a[128:131], v[40:55]
 s_barrier
 v_add_u32 v1, 49152, v1
 v_add_u32 v2, 49152, v2
 ds_read_b64_tr_b16 a[104:105], v1 offset:0
 ds_read_b64_tr_b16 a[106:107], v1 offset:1024
 s_waitcnt lgkmcnt(4)
 v_mfma_f32_32x32x16_bf16 v[24:39], a[120:123], a[132:135], v[24:39]
 ds_read_b64_tr_b16 a[108:109], v2 offset:0
 ds_read_b64_tr_b16 a[110:111], v2 offset:1024
 s_add_u32 m0, s36, 0
 s_add_u32 s38, s22, 640
 buffer_load_dwordx4 v7, s[8:11], s38 offen offset:0 lds
 v_mfma_f32_32x32x16_bf16 v[40:55], a[124:127], a[132:135], v[40:55]
 ds_read_b64_tr_b16 a[112:113], v1 offset:2048
 ds_read_b64_tr_b16 a[114:115], v1 offset:3072
 s_waitcnt lgkmcnt(6)
 v_mul_f32 v22, v22, v86
 v_mul_f32 v23, v23, v87
 v_mfma_f32_32x32x16_bf16 v[24:39], a[96:99], a[250:253], v[24:39]
 ds_read_b64_tr_b16 a[116:117], v2 offset:2048
 ds_read_b64_tr_b16 a[118:119], v2 offset:3072
 v_exp_f32 v22, v22
 v_exp_f32 v23, v23
 v_fma_f32 v22, v22, v15, v15
 v_fma_f32 v23, v23, v15, v15
 v_mfma_f32_32x32x16_bf16 v[40:55], a[100:103], a[250:253], v[40:55]
 ds_read_b64_tr_b16 a[120:121], v1 offset:4096
 ds_read_b64_tr_b16 a[122:123], v1 offset:5120
 buffer_load_dwordx4 v8, s[8:11], s38 offen offset:1024 lds
 s_waitcnt lgkmcnt(6)
 v_mfma_f32_32x32x16_bf16 a[0:15], a[104:107], v[104:107], a[0:15]
 ds_read_b64_tr_b16 a[124:125], v2 offset:4096
 ds_read_b64_tr_b16 a[126:127], v2 offset:5120
 v_rcp_f32 v22, v22
 v_rcp_f32 v23, v23
 v_mul_f32 v22, v22, v86
 v_mfma_f32_32x32x16_bf16 a[16:31], a[108:111], v[104:107], a[16:31]
 ds_read_b64_tr_b16 a[96:97], v1 offset:6144
 ds_read_b64_tr_b16 a[98:99], v1 offset:7168
 s_waitcnt lgkmcnt(6)
 v_mul_f32 v23, v23, v87
 v_cvt_pk_bf16_f32 v119, v22, v23
 v_mfma_f32_32x32x16_bf16 a[32:47], a[112:115], v[104:107], a[32:47]
 ds_read_b64_tr_b16 a[100:101], v2 offset:6144
 ds_read_b64_tr_b16 a[102:103], v2 offset:7168
 buffer_load_dwordx4 v9, s[8:11], s38 offen offset:2048 lds
 v_mfma_f32_32x32x16_bf16 a[48:63], a[116:119], v[104:107], a[48:63]
 ds_read_b64_tr_b16 a[104:105], v1 offset:8192
 ds_read_b64_tr_b16 a[106:107], v1 offset:9216
 s_waitcnt lgkmcnt(6)
 buffer_store_dwordx4 v[116:119], v11, s[16:19], s39 offen offset:3072 sc1
 s_add_u32 s39, s42, 65536
 v_mul_f32 v20, v24, v24
 v_mfma_f32_32x32x16_bf16 a[64:79], a[120:123], v[104:107], a[64:79]
 ds_read_b64_tr_b16 a[108:109], v2 offset:8192
 ds_read_b64_tr_b16 a[110:111], v2 offset:9216
 v_mul_f32 v21, v25, v25
 v_fma_f32 v20, v20, v13, v14
 v_fma_f32 v21, v21, v13, v14
 v_mul_f32 v20, v20, v24
 v_mul_f32 v21, v21, v25
 v_mfma_f32_32x32x16_bf16 a[80:95], a[124:127], v[104:107], a[80:95]
 ds_read_b64_tr_b16 a[112:113], v1 offset:10240
 ds_read_b64_tr_b16 a[114:115], v1 offset:11264
 buffer_load_dwordx4 v10, s[8:11], s38 offen offset:3072 lds
 s_waitcnt lgkmcnt(6)
 v_mfma_f32_32x32x16_bf16 a[0:15], a[96:99], v[108:111], a[0:15]
 ds_read_b64_tr_b16 a[116:117], v2 offset:10240
 ds_read_b64_tr_b16 a[118:119], v2 offset:11264
 v_exp_f32 v20, v20
 v_exp_f32 v21, v21
 v_fma_f32 v20, v20, v15, v15
 v_mfma_f32_32x32x16_bf16 a[16:31], a[100:103], v[108:111], a[16:31]
 ds_read_b64_tr_b16 a[120:121], v1 offset:12288
 ds_read_b64_tr_b16 a[122:123], v1 offset:13312
 s_waitcnt lgkmcnt(6)
 v_fma_f32 v21, v21, v15, v15
 v_rcp_f32 v20, v20
 v_mfma_f32_32x32x16_bf16 a[32:47], a[104:107], v[108:111], a[32:47]
 ds_read_b64_tr_b16 a[124:125], v2 offset:12288
 ds_read_b64_tr_b16 a[126:127], v2 offset:13312
 s_add_u32 m0, s36, 4096
 s_add_u32 s38, s22, 295552
 buffer_load_dwordx4 v7, s[8:11], s38 offen offset:0 lds
 v_mfma_f32_32x32x16_bf16 a[48:63], a[108:111], v[108:111], a[48:63]
 ds_read_b64_tr_b16 a[96:97], v1 offset:14336
 ds_read_b64_tr_b16 a[98:99], v1 offset:15360
 s_waitcnt lgkmcnt(6)
 v_rcp_f32 v21, v21
 v_mul_f32 v20, v20, v24
 v_mul_f32 v21, v21, v25
 v_mfma_f32_32x32x16_bf16 a[64:79], a[112:115], v[108:111], a[64:79]
 ds_read_b64_tr_b16 a[100:101], v2 offset:14336
 ds_read_b64_tr_b16 a[102:103], v2 offset:15360
 v_cvt_pk_bf16_f32 v88, v20, v21
 v_mul_f32 v22, v26, v26
 v_mul_f32 v23, v27, v27
 v_fma_f32 v22, v22, v13, v14
 v_fma_f32 v23, v23, v13, v14
 v_mfma_f32_32x32x16_bf16 a[80:95], a[116:119], v[108:111], a[80:95]
 ds_read_b64_tr_b16 a[104:105], v1 offset:16384
 ds_read_b64_tr_b16 a[106:107], v1 offset:17408
 buffer_load_dwordx4 v8, s[8:11], s38 offen offset:1024 lds
 s_waitcnt lgkmcnt(6)
 v_mfma_f32_32x32x16_bf16 a[0:15], a[120:123], v[112:115], a[0:15]
 ds_read_b64_tr_b16 a[108:109], v2 offset:16384
 ds_read_b64_tr_b16 a[110:111], v2 offset:17408
 v_mul_f32 v22, v22, v26
 v_mul_f32 v23, v23, v27
 v_exp_f32 v22, v22
 v_mfma_f32_32x32x16_bf16 a[16:31], a[124:127], v[112:115], a[16:31]
 ds_read_b64_tr_b16 a[112:113], v1 offset:18432
 ds_read_b64_tr_b16 a[114:115], v1 offset:19456
 s_waitcnt lgkmcnt(6)
 v_exp_f32 v23, v23
 v_fma_f32 v22, v22, v15, v15
 v_fma_f32 v23, v23, v15, v15
 v_mfma_f32_32x32x16_bf16 a[32:47], a[96:99], v[112:115], a[32:47]
 ds_read_b64_tr_b16 a[116:117], v2 offset:18432
 ds_read_b64_tr_b16 a[118:119], v2 offset:19456
 v_rcp_f32 v22, v22
 v_rcp_f32 v23, v23
 v_mul_f32 v22, v22, v26
 v_mul_f32 v23, v23, v27
 v_mfma_f32_32x32x16_bf16 a[48:63], a[100:103], v[112:115], a[48:63]
 ds_read_b64_tr_b16 a[120:121], v1 offset:20480
 ds_read_b64_tr_b16 a[122:123], v1 offset:21504
 s_waitcnt lgkmcnt(6)
 v_cvt_pk_bf16_f32 v89, v22, v23
 v_mul_f32 v20, v28, v28
 v_mul_f32 v21, v29, v29
 v_fma_f32 v20, v20, v13, v14
 v_mfma_f32_32x32x16_bf16 a[64:79], a[104:107], v[112:115], a[64:79]
 ds_read_b64_tr_b16 a[124:125], v2 offset:20480
 ds_read_b64_tr_b16 a[126:127], v2 offset:21504
 v_fma_f32 v21, v21, v13, v14
 v_mul_f32 v20, v20, v28
 v_mul_f32 v21, v21, v29
 v_exp_f32 v20, v20
 v_mfma_f32_32x32x16_bf16 a[80:95], a[108:111], v[112:115], a[80:95]
 ds_read_b64_tr_b16 a[96:97], v1 offset:22528
 ds_read_b64_tr_b16 a[98:99], v1 offset:23552
 s_waitcnt lgkmcnt(6)
 v_exp_f32 v21, v21
 v_fma_f32 v20, v20, v15, v15
 v_fma_f32 v21, v21, v15, v15
 v_mfma_f32_32x32x16_bf16 a[0:15], a[112:115], v[116:119], a[0:15]
 ds_read_b64_tr_b16 a[100:101], v2 offset:22528
 ds_read_b64_tr_b16 a[102:103], v2 offset:23552
 v_rcp_f32 v20, v20
 v_rcp_f32 v21, v21
 v_mul_f32 v20, v20, v28
 v_mfma_f32_32x32x16_bf16 a[16:31], a[116:119], v[116:119], a[16:31]
 s_barrier
 ds_read_b64_tr_b16 a[104:105], v1 offset:24576
 ds_read_b64_tr_b16 a[106:107], v1 offset:25600
 s_waitcnt lgkmcnt(6)
 v_mul_f32 v21, v21, v29
 v_cvt_pk_bf16_f32 v90, v20, v21
 v_mfma_f32_32x32x16_bf16 a[32:47], a[120:123], v[116:119], a[32:47]
 ds_read_b64_tr_b16 a[108:109], v2 offset:24576
 ds_read_b64_tr_b16 a[110:111], v2 offset:25600
 s_add_u32 m0, s36, 24576
 s_add_u32 s38, s35, 73728
 buffer_load_dwordx4 v3, s[12:15], s38 offen offset:0 lds
 v_mfma_f32_32x32x16_bf16 a[48:63], a[124:127], v[116:119], a[48:63]
 ds_read_b64_tr_b16 a[112:113], v1 offset:26624
 ds_read_b64_tr_b16 a[114:115], v1 offset:27648
 s_waitcnt lgkmcnt(6)
 v_mul_f32 v22, v30, v30
 v_mul_f32 v23, v31, v31
 v_fma_f32 v22, v22, v13, v14
 v_mfma_f32_32x32x16_bf16 a[64:79], a[96:99], v[116:119], a[64:79]
 ds_read_b64_tr_b16 a[116:117], v2 offset:26624
 ds_read_b64_tr_b16 a[118:119], v2 offset:27648
 v_fma_f32 v23, v23, v13, v14
 v_mul_f32 v22, v22, v30
 v_mul_f32 v23, v23, v31
 v_exp_f32 v22, v22
 v_mfma_f32_32x32x16_bf16 a[80:95], a[100:103], v[116:119], a[80:95]
 ds_read_b64_tr_b16 a[120:121], v1 offset:28672
 ds_read_b64_tr_b16 a[122:123], v1 offset:29696
 buffer_load_dwordx4 v4, s[12:15], s38 offen offset:1024 lds
 s_waitcnt lgkmcnt(6)
 v_mfma_f32_32x32x16_bf16 a[0:15], a[104:107], a[168:171], a[0:15]
 ds_read_b64_tr_b16 a[124:125], v2 offset:28672
 ds_read_b64_tr_b16 a[126:127], v2 offset:29696
 v_exp_f32 v23, v23
 v_fma_f32 v22, v22, v15, v15
 v_fma_f32 v23, v23, v15, v15
 v_mfma_f32_32x32x16_bf16 a[16:31], a[108:111], a[168:171], a[16:31]
 ds_read_b64_tr_b16 a[96:97], v1 offset:30720
 ds_read_b64_tr_b16 a[98:99], v1 offset:31744
 s_waitcnt lgkmcnt(6)
 v_rcp_f32 v22, v22
 v_rcp_f32 v23, v23
 v_mul_f32 v22, v22, v30
 v_mfma_f32_32x32x16_bf16 a[32:47], a[112:115], a[168:171], a[32:47]
 ds_read_b64_tr_b16 a[100:101], v2 offset:30720
 ds_read_b64_tr_b16 a[102:103], v2 offset:31744
 buffer_load_dwordx4 v5, s[12:15], s38 offen offset:2048 lds
 v_mul_f32 v23, v23, v31
 v_mfma_f32_32x32x16_bf16 a[48:63], a[116:119], a[168:171], a[48:63]
 ds_read_b64_tr_b16 a[104:105], v1 offset:32768
 ds_read_b64_tr_b16 a[106:107], v1 offset:33792
 s_waitcnt lgkmcnt(6)
 v_cvt_pk_bf16_f32 v91, v22, v23
 buffer_store_dwordx4 v[88:91], v11, s[16:19], s39 offen offset:0 sc1
 v_mfma_f32_32x32x16_bf16 a[64:79], a[120:123], a[168:171], a[64:79]
 ds_read_b64_tr_b16 a[108:109], v2 offset:32768
 ds_read_b64_tr_b16 a[110:111], v2 offset:33792
 v_mul_f32 v20, v32, v32
 v_mul_f32 v21, v33, v33
 v_fma_f32 v20, v20, v13, v14
 v_fma_f32 v21, v21, v13, v14
 v_mul_f32 v20, v20, v32
 v_mfma_f32_32x32x16_bf16 a[80:95], a[124:127], a[168:171], a[80:95]
 ds_read_b64_tr_b16 a[112:113], v1 offset:34816
 ds_read_b64_tr_b16 a[114:115], v1 offset:35840
 buffer_load_dwordx4 v6, s[12:15], s38 offen offset:3072 lds
 s_waitcnt lgkmcnt(6)
 v_mfma_f32_32x32x16_bf16 a[0:15], a[96:99], a[172:175], a[0:15]
 ds_read_b64_tr_b16 a[116:117], v2 offset:34816
 ds_read_b64_tr_b16 a[118:119], v2 offset:35840
 v_mul_f32 v21, v21, v33
 v_exp_f32 v20, v20
 v_exp_f32 v21, v21
 v_mfma_f32_32x32x16_bf16 a[16:31], a[100:103], a[172:175], a[16:31]
 ds_read_b64_tr_b16 a[120:121], v1 offset:36864
 ds_read_b64_tr_b16 a[122:123], v1 offset:37888
 s_waitcnt lgkmcnt(6)
 v_fma_f32 v20, v20, v15, v15
 v_fma_f32 v21, v21, v15, v15
 v_rcp_f32 v20, v20
 v_mfma_f32_32x32x16_bf16 a[32:47], a[104:107], a[172:175], a[32:47]
 ds_read_b64_tr_b16 a[124:125], v2 offset:36864
 ds_read_b64_tr_b16 a[126:127], v2 offset:37888
 s_add_u32 m0, s36, 28672
 s_add_u32 s38, s35, 73984
 buffer_load_dwordx4 v3, s[12:15], s38 offen offset:0 lds
 v_mfma_f32_32x32x16_bf16 a[48:63], a[108:111], a[172:175], a[48:63]
 ds_read_b64_tr_b16 a[96:97], v1 offset:38912
 ds_read_b64_tr_b16 a[98:99], v1 offset:39936
 s_waitcnt lgkmcnt(6)
 v_rcp_f32 v21, v21
 v_mul_f32 v20, v20, v32
 v_mfma_f32_32x32x16_bf16 a[64:79], a[112:115], a[172:175], a[64:79]
 ds_read_b64_tr_b16 a[100:101], v2 offset:38912
 ds_read_b64_tr_b16 a[102:103], v2 offset:39936
 v_mul_f32 v21, v21, v33
 v_cvt_pk_bf16_f32 v92, v20, v21
 v_mul_f32 v22, v34, v34
 v_mul_f32 v23, v35, v35
 v_fma_f32 v22, v22, v13, v14
 v_mfma_f32_32x32x16_bf16 a[80:95], a[116:119], a[172:175], a[80:95]
 ds_read_b64_tr_b16 a[104:105], v1 offset:40960
 ds_read_b64_tr_b16 a[106:107], v1 offset:41984
 buffer_load_dwordx4 v4, s[12:15], s38 offen offset:1024 lds
 s_waitcnt lgkmcnt(6)
 v_mfma_f32_32x32x16_bf16 a[0:15], a[120:123], a[176:179], a[0:15]
 ds_read_b64_tr_b16 a[108:109], v2 offset:40960
 ds_read_b64_tr_b16 a[110:111], v2 offset:41984
 v_fma_f32 v23, v23, v13, v14
 v_mul_f32 v22, v22, v34
 v_mul_f32 v23, v23, v35
 v_exp_f32 v22, v22
 v_mfma_f32_32x32x16_bf16 a[16:31], a[124:127], a[176:179], a[16:31]
 ds_read_b64_tr_b16 a[112:113], v1 offset:43008
 ds_read_b64_tr_b16 a[114:115], v1 offset:44032
 s_waitcnt lgkmcnt(6)
 v_exp_f32 v23, v23
 v_fma_f32 v22, v22, v15, v15
 v_fma_f32 v23, v23, v15, v15
 v_mfma_f32_32x32x16_bf16 a[32:47], a[96:99], a[176:179], a[32:47]
 ds_read_b64_tr_b16 a[116:117], v2 offset:43008
 ds_read_b64_tr_b16 a[118:119], v2 offset:44032
 v_rcp_f32 v22, v22
 v_rcp_f32 v23, v23
 v_mul_f32 v22, v22, v34
 v_mfma_f32_32x32x16_bf16 a[48:63], a[100:103], a[176:179], a[48:63]
 ds_read_b64_tr_b16 a[120:121], v1 offset:45056
 ds_read_b64_tr_b16 a[122:123], v1 offset:46080
 s_waitcnt lgkmcnt(6)
 s_add_u32 s40, s45, 4
 v_mov_b32 v18, s40
 s_waitcnt vmcnt(10)
 s_mov_b64 exec, 1
 buffer_store_dword v18, off, s[16:19], s47 sc1
 s_mov_b64 exec, -1
 v_mfma_f32_32x32x16_bf16 a[64:79], a[104:107], a[176:179], a[64:79]
 ds_read_b64_tr_b16 a[124:125], v2 offset:45056
 ds_read_b64_tr_b16 a[126:127], v2 offset:46080
 v_mul_f32 v23, v23, v35
 v_cvt_pk_bf16_f32 v93, v22, v23
 v_mul_f32 v20, v36, v36
 v_mfma_f32_32x32x16_bf16 a[80:95], a[108:111], a[176:179], a[80:95]
 ds_read_b64_tr_b16 a[96:97], v1 offset:47104
 ds_read_b64_tr_b16 a[98:99], v1 offset:48128
 s_waitcnt lgkmcnt(6)
 v_mul_f32 v21, v37, v37
 v_fma_f32 v20, v20, v13, v14
 v_fma_f32 v21, v21, v13, v14
 v_mul_f32 v20, v20, v36
 v_mfma_f32_32x32x16_bf16 a[0:15], a[112:115], a[180:183], a[0:15]
 ds_read_b64_tr_b16 a[100:101], v2 offset:47104
 ds_read_b64_tr_b16 a[102:103], v2 offset:48128
 v_mul_f32 v21, v21, v37
 v_exp_f32 v20, v20
 v_exp_f32 v21, v21
 v_mfma_f32_32x32x16_bf16 a[16:31], a[116:119], a[180:183], a[16:31]
 s_barrier
 v_add_u32 v1, 49152, v1
 v_add_u32 v2, 49152, v2
 ds_read_b64_tr_b16 a[104:105], v1 offset:0
 ds_read_b64_tr_b16 a[106:107], v1 offset:1024
 s_waitcnt lgkmcnt(6)
 v_mfma_f32_32x32x16_bf16 a[32:47], a[120:123], a[180:183], a[32:47]
 ds_read_b64_tr_b16 a[108:109], v2 offset:0
 ds_read_b64_tr_b16 a[110:111], v2 offset:1024
 s_add_u32 m0, s36, 49152
 s_add_u32 s38, s33, 294912
 buffer_load_dwordx4 v3, s[12:15], s38 offen offset:0 lds
 v_mfma_f32_32x32x16_bf16 a[48:63], a[124:127], a[180:183], a[48:63]
 ds_read_b64_tr_b16 a[112:113], v1 offset:2048
 ds_read_b64_tr_b16 a[114:115], v1 offset:3072
 s_waitcnt lgkmcnt(6)
 v_fma_f32 v20, v20, v15, v15
 v_fma_f32 v21, v21, v15, v15
 v_mfma_f32_32x32x16_bf16 a[64:79], a[96:99], a[180:183], a[64:79]
 ds_read_b64_tr_b16 a[116:117], v2 offset:2048
 ds_read_b64_tr_b16 a[118:119], v2 offset:3072
 v_rcp_f32 v20, v20
 v_rcp_f32 v21, v21
 v_mul_f32 v20, v20, v36
 v_mul_f32 v21, v21, v37
 v_mfma_f32_32x32x16_bf16 a[80:95], a[100:103], a[180:183], a[80:95]
 ds_read_b64_tr_b16 a[120:121], v1 offset:4096
 ds_read_b64_tr_b16 a[122:123], v1 offset:5120
 buffer_load_dwordx4 v4, s[12:15], s38 offen offset:1024 lds
 s_waitcnt lgkmcnt(6)
 v_mfma_f32_32x32x16_bf16 v[56:71], a[104:107], v[120:123], 0
 ds_read_b64_tr_b16 a[124:125], v2 offset:4096
 ds_read_b64_tr_b16 a[126:127], v2 offset:5120
 v_cvt_pk_bf16_f32 v94, v20, v21
 v_mul_f32 v22, v38, v38
 v_mul_f32 v23, v39, v39
 v_fma_f32 v22, v22, v13, v14
 v_fma_f32 v23, v23, v13, v14
 v_mfma_f32_32x32x16_bf16 v[72:87], a[108:111], v[120:123], 0
 ds_read_b64_tr_b16 a[96:97], v1 offset:6144
 ds_read_b64_tr_b16 a[98:99], v1 offset:7168
 s_waitcnt lgkmcnt(6)
 v_mul_f32 v22, v22, v38
 v_mul_f32 v23, v23, v39
 v_exp_f32 v22, v22
 v_mfma_f32_32x32x16_bf16 v[56:71], a[112:115], v[124:127], v[56:71]
 ds_read_b64_tr_b16 a[100:101], v2 offset:6144
 ds_read_b64_tr_b16 a[102:103], v2 offset:7168
 buffer_load_dwordx4 v5, s[12:15], s38 offen offset:2048 lds
 v_mfma_f32_32x32x16_bf16 v[72:87], a[116:119], v[124:127], v[72:87]
 ds_read_b64_tr_b16 a[104:105], v1 offset:8192
 ds_read_b64_tr_b16 a[106:107], v1 offset:9216
 s_waitcnt lgkmcnt(6)
 v_exp_f32 v23, v23
 v_fma_f32 v22, v22, v15, v15
 v_fma_f32 v23, v23, v15, v15
 v_mfma_f32_32x32x16_bf16 v[56:71], a[120:123], v[128:131], v[56:71]
 ds_read_b64_tr_b16 a[108:109], v2 offset:8192
 ds_read_b64_tr_b16 a[110:111], v2 offset:9216
 v_rcp_f32 v22, v22
 v_rcp_f32 v23, v23
 v_mul_f32 v22, v22, v38
 v_mul_f32 v23, v23, v39
 v_mfma_f32_32x32x16_bf16 v[72:87], a[124:127], v[128:131], v[72:87]
 ds_read_b64_tr_b16 a[112:113], v1 offset:10240
 ds_read_b64_tr_b16 a[114:115], v1 offset:11264
 buffer_load_dwordx4 v6, s[12:15], s38 offen offset:3072 lds
 s_waitcnt lgkmcnt(6)
 v_mfma_f32_32x32x16_bf16 v[56:71], a[96:99], v[132:135], v[56:71]
 ds_read_b64_tr_b16 a[116:117], v2 offset:10240
 ds_read_b64_tr_b16 a[118:119], v2 offset:11264
 v_cvt_pk_bf16_f32 v95, v22, v23
 buffer_store_dwordx4 v[92:95], v11, s[16:19], s39 offen offset:1024 sc1
 v_mul_f32 v20, v40, v40
 v_mfma_f32_32x32x16_bf16 v[72:87], a[100:103], v[132:135], v[72:87]
 ds_read_b64_tr_b16 a[120:121], v1 offset:12288
 ds_read_b64_tr_b16 a[122:123], v1 offset:13312
 s_waitcnt lgkmcnt(6)
 v_mul_f32 v21, v41, v41
 v_fma_f32 v20, v20, v13, v14
 v_fma_f32 v21, v21, v13, v14
 v_mul_f32 v20, v20, v40
 v_mfma_f32_32x32x16_bf16 v[56:71], a[104:107], v[136:139], v[56:71]
 ds_read_b64_tr_b16 a[124:125], v2 offset:12288
 ds_read_b64_tr_b16 a[126:127], v2 offset:13312
 s_add_u32 m0, s36, 53248
 s_add_u32 s38, s33, 295168
 buffer_load_dwordx4 v3, s[12:15], s38 offen offset:0 lds
 v_mfma_f32_32x32x16_bf16 v[72:87], a[108:111], v[136:139], v[72:87]
 ds_read_b64_tr_b16 a[96:97], v1 offset:14336
 ds_read_b64_tr_b16 a[98:99], v1 offset:15360
 s_waitcnt lgkmcnt(6)
 v_mul_f32 v21, v21, v41
 v_exp_f32 v20, v20
 v_mfma_f32_32x32x16_bf16 v[56:71], a[112:115], v[140:143], v[56:71]
 ds_read_b64_tr_b16 a[100:101], v2 offset:14336
 ds_read_b64_tr_b16 a[102:103], v2 offset:15360
 v_exp_f32 v21, v21
 v_fma_f32 v20, v20, v15, v15
 v_fma_f32 v21, v21, v15, v15
 v_mfma_f32_32x32x16_bf16 v[72:87], a[116:119], v[140:143], v[72:87]
 ds_read_b64_tr_b16 a[104:105], v1 offset:16384
 ds_read_b64_tr_b16 a[106:107], v1 offset:17408
 buffer_load_dwordx4 v4, s[12:15], s38 offen offset:1024 lds
 s_waitcnt lgkmcnt(6)
 v_mfma_f32_32x32x16_bf16 v[56:71], a[120:123], v[144:147], v[56:71]
 ds_read_b64_tr_b16 a[108:109], v2 offset:16384
 ds_read_b64_tr_b16 a[110:111], v2 offset:17408
 v_rcp_f32 v20, v20
 v_rcp_f32 v21, v21
 v_mul_f32 v20, v20, v40
 v_mul_f32 v21, v21, v41
 v_mfma_f32_32x32x16_bf16 v[72:87], a[124:127], v[144:147], v[72:87]
 ds_read_b64_tr_b16 a[112:113], v1 offset:18432
 ds_read_b64_tr_b16 a[114:115], v1 offset:19456
 s_waitcnt lgkmcnt(6)
 v_cvt_pk_bf16_f32 v96, v20, v21
 v_mul_f32 v22, v42, v42
 v_mul_f32 v23, v43, v43
 v_fma_f32 v22, v22, v13, v14
 v_mfma_f32_32x32x16_bf16 v[56:71], a[96:99], v[148:151], v[56:71]
 ds_read_b64_tr_b16 a[116:117], v2 offset:18432
 ds_read_b64_tr_b16 a[118:119], v2 offset:19456
 v_fma_f32 v23, v23, v13, v14
 v_mul_f32 v22, v22, v42
 v_mul_f32 v23, v23, v43
 v_exp_f32 v22, v22
 v_mfma_f32_32x32x16_bf16 v[72:87], a[100:103], v[148:151], v[72:87]
 ds_read_b64_tr_b16 a[120:121], v1 offset:20480
 ds_read_b64_tr_b16 a[122:123], v1 offset:21504
 s_waitcnt lgkmcnt(6)
 v_exp_f32 v23, v23
 v_fma_f32 v22, v22, v15, v15
 v_fma_f32 v23, v23, v15, v15
 v_mfma_f32_32x32x16_bf16 v[56:71], a[104:107], v[152:155], v[56:71]
 ds_read_b64_tr_b16 a[124:125], v2 offset:20480
 ds_read_b64_tr_b16 a[126:127], v2 offset:21504
 v_rcp_f32 v22, v22
 v_rcp_f32 v23, v23
 v_mul_f32 v22, v22, v42
 v_mfma_f32_32x32x16_bf16 v[72:87], a[108:111], v[152:155], v[72:87]
 ds_read_b64_tr_b16 a[96:97], v1 offset:22528
 ds_read_b64_tr_b16 a[98:99], v1 offset:23552
 s_waitcnt lgkmcnt(6)
 v_mul_f32 v23, v23, v43
 v_cvt_pk_bf16_f32 v97, v22, v23
 v_mul_f32 v20, v44, v44
 v_mul_f32 v21, v45, v45
 v_mfma_f32_32x32x16_bf16 v[56:71], a[112:115], v[156:159], v[56:71]
 ds_read_b64_tr_b16 a[100:101], v2 offset:22528
 ds_read_b64_tr_b16 a[102:103], v2 offset:23552
 v_fma_f32 v20, v20, v13, v14
 v_fma_f32 v21, v21, v13, v14
 v_mul_f32 v20, v20, v44
 v_mul_f32 v21, v21, v45
 v_mfma_f32_32x32x16_bf16 v[72:87], a[116:119], v[156:159], v[72:87]
 s_barrier
 ds_read_b64_tr_b16 a[104:105], v1 offset:24576
 ds_read_b64_tr_b16 a[106:107], v1 offset:25600
 s_waitcnt lgkmcnt(6)
 v_exp_f32 v20, v20
 v_mfma_f32_32x32x16_bf16 v[56:71], a[120:123], v[160:163], v[56:71]
 ds_read_b64_tr_b16 a[108:109], v2 offset:24576
 ds_read_b64_tr_b16 a[110:111], v2 offset:25600
 s_add_u32 m0, s36, 73728
 s_add_u32 s38, s34, 147456
 buffer_load_dwordx4 v3, s[12:15], s38 offen offset:0 lds
 v_mfma_f32_32x32x16_bf16 v[72:87], a[124:127], v[160:163], v[72:87]
 ds_read_b64_tr_b16 a[112:113], v1 offset:26624
 ds_read_b64_tr_b16 a[114:115], v1 offset:27648
 s_waitcnt lgkmcnt(6)
 v_exp_f32 v21, v21
 v_fma_f32 v20, v20, v15, v15
 v_fma_f32 v21, v21, v15, v15
 v_mfma_f32_32x32x16_bf16 v[56:71], a[96:99], v[164:167], v[56:71]
 ds_read_b64_tr_b16 a[116:117], v2 offset:26624
 ds_read_b64_tr_b16 a[118:119], v2 offset:27648
 v_rcp_f32 v20, v20
 v_rcp_f32 v21, v21
 v_mul_f32 v20, v20, v44
 v_mfma_f32_32x32x16_bf16 v[72:87], a[100:103], v[164:167], v[72:87]
 ds_read_b64_tr_b16 a[120:121], v1 offset:28672
 ds_read_b64_tr_b16 a[122:123], v1 offset:29696
 buffer_load_dwordx4 v4, s[12:15], s38 offen offset:1024 lds
 s_waitcnt lgkmcnt(6)
 v_mfma_f32_32x32x16_bf16 v[56:71], a[104:107], v[168:171], v[56:71]
 ds_read_b64_tr_b16 a[124:125], v2 offset:28672
 ds_read_b64_tr_b16 a[126:127], v2 offset:29696
 v_mul_f32 v21, v21, v45
 v_cvt_pk_bf16_f32 v98, v20, v21
 v_mul_f32 v22, v46, v46
 v_mul_f32 v23, v47, v47
 v_fma_f32 v22, v22, v13, v14
 v_mfma_f32_32x32x16_bf16 v[72:87], a[108:111], v[168:171], v[72:87]
 ds_read_b64_tr_b16 a[96:97], v1 offset:30720
 ds_read_b64_tr_b16 a[98:99], v1 offset:31744
 s_waitcnt lgkmcnt(6)
 v_fma_f32 v23, v23, v13, v14
 v_mul_f32 v22, v22, v46
 v_mul_f32 v23, v23, v47
 v_mfma_f32_32x32x16_bf16 v[56:71], a[112:115], v[172:175], v[56:71]
 ds_read_b64_tr_b16 a[100:101], v2 offset:30720
 ds_read_b64_tr_b16 a[102:103], v2 offset:31744
 buffer_load_dwordx4 v5, s[12:15], s38 offen offset:2048 lds
 v_exp_f32 v22, v22
 v_mfma_f32_32x32x16_bf16 v[72:87], a[116:119], v[172:175], v[72:87]
 ds_read_b64_tr_b16 a[104:105], v1 offset:32768
 ds_read_b64_tr_b16 a[106:107], v1 offset:33792
 s_waitcnt lgkmcnt(6)
 v_exp_f32 v23, v23
 v_fma_f32 v22, v22, v15, v15
 v_fma_f32 v23, v23, v15, v15
 v_mfma_f32_32x32x16_bf16 v[56:71], a[120:123], v[176:179], v[56:71]
 ds_read_b64_tr_b16 a[108:109], v2 offset:32768
 ds_read_b64_tr_b16 a[110:111], v2 offset:33792
 v_rcp_f32 v22, v22
 v_rcp_f32 v23, v23
 v_mul_f32 v22, v22, v46
 v_mfma_f32_32x32x16_bf16 v[72:87], a[124:127], v[176:179], v[72:87]
 ds_read_b64_tr_b16 a[112:113], v1 offset:34816
 ds_read_b64_tr_b16 a[114:115], v1 offset:35840
 buffer_load_dwordx4 v6, s[12:15], s38 offen offset:3072 lds
 s_waitcnt lgkmcnt(6)
 v_mfma_f32_32x32x16_bf16 v[56:71], a[96:99], v[180:183], v[56:71]
 ds_read_b64_tr_b16 a[116:117], v2 offset:34816
 ds_read_b64_tr_b16 a[118:119], v2 offset:35840
 v_mul_f32 v23, v23, v47
 v_cvt_pk_bf16_f32 v99, v22, v23
 buffer_store_dwordx4 v[96:99], v11, s[16:19], s39 offen offset:2048 sc1
 v_mfma_f32_32x32x16_bf16 v[72:87], a[100:103], v[180:183], v[72:87]
 ds_read_b64_tr_b16 a[120:121], v1 offset:36864
 ds_read_b64_tr_b16 a[122:123], v1 offset:37888
 s_waitcnt lgkmcnt(6)
 buffer_load_dword v16, v17, s[16:19], 0 offen sc1
 v_mul_f32 v20, v48, v48
 v_mfma_f32_32x32x16_bf16 v[56:71], a[104:107], v[184:187], v[56:71]
 ds_read_b64_tr_b16 a[124:125], v2 offset:36864
 ds_read_b64_tr_b16 a[126:127], v2 offset:37888
 s_add_u32 m0, s36, 77824
 s_add_u32 s38, s34, 147712
 buffer_load_dwordx4 v3, s[12:15], s38 offen offset:0 lds
 v_mfma_f32_32x32x16_bf16 v[72:87], a[108:111], v[184:187], v[72:87]
 ds_read_b64_tr_b16 a[96:97], v1 offset:38912
 ds_read_b64_tr_b16 a[98:99], v1 offset:39936
 s_add_u32 s90, s90, 1024
 s_mov_b32 m0, s23
 s_nop 0
 buffer_load_dwordx4 v11, s[16:19], s90 offen sc1 lds
 s_waitcnt lgkmcnt(6)
 v_mfma_f32_32x32x16_bf16 v[56:71], a[112:115], v[188:191], v[56:71]
 ds_read_b64_tr_b16 a[100:101], v2 offset:38912
 ds_read_b64_tr_b16 a[102:103], v2 offset:39936
 v_mul_f32 v21, v49, v49
 v_fma_f32 v20, v20, v13, v14
 v_fma_f32 v21, v21, v13, v14
 v_mfma_f32_32x32x16_bf16 v[72:87], a[116:119], v[188:191], v[72:87]
 ds_read_b64_tr_b16 a[104:105], v1 offset:40960
 ds_read_b64_tr_b16 a[106:107], v1 offset:41984
 s_add_u32 m0, s36, 77824
 s_nop 0
 buffer_load_dwordx4 v4, s[12:15], s38 offen offset:1024 lds
 s_waitcnt lgkmcnt(6)
 v_mfma_f32_32x32x16_bf16 v[56:71], a[120:123], v[192:195], v[56:71]
 ds_read_b64_tr_b16 a[108:109], v2 offset:40960
 ds_read_b64_tr_b16 a[110:111], v2 offset:41984
 v_mul_f32 v20, v20, v48
 v_mul_f32 v21, v21, v49
 v_exp_f32 v20, v20
 v_mfma_f32_32x32x16_bf16 v[72:87], a[124:127], v[192:195], v[72:87]
 ds_read_b64_tr_b16 a[112:113], v1 offset:43008
 ds_read_b64_tr_b16 a[114:115], v1 offset:44032
 s_waitcnt lgkmcnt(6)
 v_exp_f32 v21, v21
 v_fma_f32 v20, v20, v15, v15
 v_fma_f32 v21, v21, v15, v15
 v_mfma_f32_32x32x16_bf16 v[56:71], a[96:99], v[196:199], v[56:71]
 ds_read_b64_tr_b16 a[116:117], v2 offset:43008
 ds_read_b64_tr_b16 a[118:119], v2 offset:44032
 v_rcp_f32 v20, v20
 v_rcp_f32 v21, v21
 v_mul_f32 v20, v20, v48
 v_mfma_f32_32x32x16_bf16 v[72:87], a[100:103], v[196:199], v[72:87]
 ds_read_b64_tr_b16 a[120:121], v1 offset:45056
 ds_read_b64_tr_b16 a[122:123], v1 offset:46080
 s_waitcnt lgkmcnt(6)
 v_mul_f32 v21, v21, v49
 v_cvt_pk_bf16_f32 v100, v20, v21
 v_mul_f32 v22, v50, v50
 v_mul_f32 v23, v51, v51
 v_mfma_f32_32x32x16_bf16 v[56:71], a[104:107], v[200:203], v[56:71]
 ds_read_b64_tr_b16 a[124:125], v2 offset:45056
 ds_read_b64_tr_b16 a[126:127], v2 offset:46080
 v_fma_f32 v22, v22, v13, v14
 v_fma_f32 v23, v23, v13, v14
 v_mul_f32 v22, v22, v50
 v_mul_f32 v23, v23, v51
 v_mfma_f32_32x32x16_bf16 v[72:87], a[108:111], v[200:203], v[72:87]
 ds_read_b64_tr_b16 a[96:97], v1 offset:47104
 ds_read_b64_tr_b16 a[98:99], v1 offset:48128
 s_waitcnt lgkmcnt(6)
 v_exp_f32 v22, v22
 v_exp_f32 v23, v23
 v_fma_f32 v22, v22, v15, v15
 v_mfma_f32_32x32x16_bf16 v[56:71], a[112:115], v[204:207], v[56:71]
 ds_read_b64_tr_b16 a[100:101], v2 offset:47104
 ds_read_b64_tr_b16 a[102:103], v2 offset:48128
 v_fma_f32 v23, v23, v15, v15
 v_rcp_f32 v22, v22
 v_rcp_f32 v23, v23
 v_mfma_f32_32x32x16_bf16 v[72:87], a[116:119], v[204:207], v[72:87]
 s_waitcnt vmcnt(24)
 s_barrier
 v_add_u32 v1, -98304, v1
 v_add_u32 v2, -98304, v2
 ds_read_b64_tr_b16 a[104:105], v1 offset:0
 ds_read_b64_tr_b16 a[106:107], v1 offset:1024
 s_waitcnt lgkmcnt(6)
 v_mfma_f32_32x32x16_bf16 v[56:71], a[120:123], v[208:211], v[56:71]
 ds_read_b64_tr_b16 a[108:109], v2 offset:0
 ds_read_b64_tr_b16 a[110:111], v2 offset:1024
 s_add_u32 m0, s36, 98304
 s_add_u32 s38, s35, 147456
 buffer_load_dwordx4 v3, s[12:15], s38 offen offset:0 lds
 v_mfma_f32_32x32x16_bf16 v[72:87], a[124:127], v[208:211], v[72:87]
 ds_read_b64_tr_b16 a[112:113], v1 offset:2048
 ds_read_b64_tr_b16 a[114:115], v1 offset:3072
 s_waitcnt lgkmcnt(6)
 v_mul_f32 v22, v22, v50
 v_mul_f32 v23, v23, v51
 v_cvt_pk_bf16_f32 v101, v22, v23
 v_mfma_f32_32x32x16_bf16 v[56:71], a[96:99], v[212:215], v[56:71]
 ds_read_b64_tr_b16 a[116:117], v2 offset:2048
 ds_read_b64_tr_b16 a[118:119], v2 offset:3072
 v_mul_f32 v20, v52, v52
 v_mul_f32 v21, v53, v53
 v_fma_f32 v20, v20, v13, v14
 v_fma_f32 v21, v21, v13, v14
 v_mul_f32 v20, v20, v52
 v_mfma_f32_32x32x16_bf16 v[72:87], a[100:103], v[212:215], v[72:87]
 ds_read_b64_tr_b16 a[120:121], v1 offset:4096
 ds_read_b64_tr_b16 a[122:123], v1 offset:5120
 buffer_load_dwordx4 v4, s[12:15], s38 offen offset:1024 lds
 s_waitcnt lgkmcnt(6)
 v_mfma_f32_32x32x16_bf16 v[56:71], a[104:107], v[216:219], v[56:71]
 ds_read_b64_tr_b16 a[124:125], v2 offset:4096
 ds_read_b64_tr_b16 a[126:127], v2 offset:5120
 v_mul_f32 v21, v21, v53
 v_exp_f32 v20, v20
 v_exp_f32 v21, v21
 v_mfma_f32_32x32x16_bf16 v[72:87], a[108:111], v[216:219], v[72:87]
 ds_read_b64_tr_b16 a[96:97], v1 offset:6144
 ds_read_b64_tr_b16 a[98:99], v1 offset:7168
 s_waitcnt lgkmcnt(6)
 v_fma_f32 v20, v20, v15, v15
 v_fma_f32 v21, v21, v15, v15
 v_rcp_f32 v20, v20
 v_mfma_f32_32x32x16_bf16 v[56:71], a[112:115], v[220:223], v[56:71]
 ds_read_b64_tr_b16 a[100:101], v2 offset:6144
 ds_read_b64_tr_b16 a[102:103], v2 offset:7168
 buffer_load_dwordx4 v5, s[12:15], s38 offen offset:2048 lds
 v_mfma_f32_32x32x16_bf16 v[72:87], a[116:119], v[220:223], v[72:87]
 ds_read_b64_tr_b16 a[104:105], v1 offset:8192
 ds_read_b64_tr_b16 a[106:107], v1 offset:9216
 s_waitcnt lgkmcnt(6)
 v_rcp_f32 v21, v21
 v_mul_f32 v20, v20, v52
 v_mul_f32 v21, v21, v53
 v_cvt_pk_bf16_f32 v102, v20, v21
 v_mfma_f32_32x32x16_bf16 v[56:71], a[120:123], v[224:227], v[56:71]
 ds_read_b64_tr_b16 a[108:109], v2 offset:8192
 ds_read_b64_tr_b16 a[110:111], v2 offset:9216
 v_mul_f32 v22, v54, v54
 v_mul_f32 v23, v55, v55
 v_fma_f32 v22, v22, v13, v14
 v_fma_f32 v23, v23, v13, v14
 v_mul_f32 v22, v22, v54
 v_mfma_f32_32x32x16_bf16 v[72:87], a[124:127], v[224:227], v[72:87]
 ds_read_b64_tr_b16 a[112:113], v1 offset:10240
 ds_read_b64_tr_b16 a[114:115], v1 offset:11264
 buffer_load_dwordx4 v6, s[12:15], s38 offen offset:3072 lds
 s_waitcnt lgkmcnt(6)
 v_mfma_f32_32x32x16_bf16 v[56:71], a[96:99], v[228:231], v[56:71]
 ds_read_b64_tr_b16 a[116:117], v2 offset:10240
 ds_read_b64_tr_b16 a[118:119], v2 offset:11264
 v_mul_f32 v23, v23, v55
 v_exp_f32 v22, v22
 v_exp_f32 v23, v23
 v_mfma_f32_32x32x16_bf16 v[72:87], a[100:103], v[228:231], v[72:87]
 ds_read_b64_tr_b16 a[120:121], v1 offset:12288
 ds_read_b64_tr_b16 a[122:123], v1 offset:13312
 s_waitcnt lgkmcnt(6)
 s_add_u32 s40, s45, 4
 s_waitcnt vmcnt(7)
 v_subrev_u32 v16, s40, v16
 v_cmp_lt_u32 vcc, 2, v16
 s_cbranch_vccnz L_fp3
L_fp3_b:
 v_mfma_f32_32x32x16_bf16 v[56:71], a[104:107], v[232:235], v[56:71]
 ds_read_b64_tr_b16 a[124:125], v2 offset:12288
 ds_read_b64_tr_b16 a[126:127], v2 offset:13312
 s_add_u32 m0, s36, 102400
 s_add_u32 s38, s35, 147712
 buffer_load_dwordx4 v3, s[12:15], s38 offen offset:0 lds
 v_mfma_f32_32x32x16_bf16 v[72:87], a[108:111], v[232:235], v[72:87]
 ds_read_b64_tr_b16 a[96:97], v1 offset:14336
 ds_read_b64_tr_b16 a[98:99], v1 offset:15360
 s_waitcnt lgkmcnt(6)
 s_add_u32 s41, s43, 49152
 buffer_load_dwordx4 a[232:235], v11, s[16:19], s41 offen offset:0 sc1
 v_mfma_f32_32x32x16_bf16 v[56:71], a[112:115], v[236:239], v[56:71]
 ds_read_b64_tr_b16 a[100:101], v2 offset:14336
 ds_read_b64_tr_b16 a[102:103], v2 offset:15360
 v_fma_f32 v22, v22, v15, v15
 v_fma_f32 v23, v23, v15, v15
 v_mfma_f32_32x32x16_bf16 v[72:87], a[116:119], v[236:239], v[72:87]
 ds_read_b64_tr_b16 a[104:105], v1 offset:16384
 ds_read_b64_tr_b16 a[106:107], v1 offset:17408
 buffer_load_dwordx4 v4, s[12:15], s38 offen offset:1024 lds
 s_waitcnt lgkmcnt(6)
 v_mfma_f32_32x32x16_bf16 v[56:71], a[120:123], v[240:243], v[56:71]
 ds_read_b64_tr_b16 a[108:109], v2 offset:16384
 ds_read_b64_tr_b16 a[110:111], v2 offset:17408
 buffer_load_dwordx4 a[236:239], v11, s[16:19], s41 offen offset:1024 sc1
 v_rcp_f32 v22, v22
 v_mfma_f32_32x32x16_bf16 v[72:87], a[124:127], v[240:243], v[72:87]
 ds_read_b64_tr_b16 a[112:113], v1 offset:18432
 ds_read_b64_tr_b16 a[114:115], v1 offset:19456
 s_waitcnt lgkmcnt(6)
 v_rcp_f32 v23, v23
 v_mul_f32 v22, v22, v54
 v_mul_f32 v23, v23, v55
 v_mfma_f32_32x32x16_bf16 v[56:71], a[96:99], v[244:247], v[56:71]
 ds_read_b64_tr_b16 a[116:117], v2 offset:18432
 ds_read_b64_tr_b16 a[118:119], v2 offset:19456
 buffer_load_dwordx4 a[240:243], v11, s[16:19], s41 offen offset:2048 sc1
 v_cvt_pk_bf16_f32 v103, v22, v23
 v_mfma_f32_32x32x16_bf16 v[72:87], a[100:103], v[244:247], v[72:87]
 ds_read_b64_tr_b16 a[120:121], v1 offset:20480
 ds_read_b64_tr_b16 a[122:123], v1 offset:21504
 s_waitcnt vmcnt(10)
 ds_read2_b32 v[18:19], v12 offset0:3 offset1:131
 s_waitcnt lgkmcnt(7)
 v_mfma_f32_32x32x16_bf16 v[56:71], a[104:107], v[248:251], v[56:71]
 ds_read_b64_tr_b16 a[124:125], v2 offset:20480
 ds_read_b64_tr_b16 a[126:127], v2 offset:21504
 buffer_load_dwordx4 a[244:247], v11, s[16:19], s41 offen offset:3072 sc1
 v_mfma_f32_32x32x16_bf16 v[72:87], a[108:111], v[248:251], v[72:87]
 ds_read_b64_tr_b16 a[96:97], v1 offset:22528
 ds_read_b64_tr_b16 a[98:99], v1 offset:23552
 s_waitcnt lgkmcnt(7)
 buffer_store_dwordx4 v[100:103], v11, s[16:19], s39 offen offset:3072 sc1
 v_mfma_f32_32x32x16_bf16 v[56:71], a[112:115], v[252:255], v[56:71]
 ds_read_b64_tr_b16 a[100:101], v2 offset:22528
 ds_read_b64_tr_b16 a[102:103], v2 offset:23552
 s_waitcnt lgkmcnt(6)
 v_bitop3_b32 v19, v18, v19, s46 bitop3:0x7e
 v_cmp_ne_u32 vcc, 0, v19
 s_cbranch_vccnz L_fx5
L_fx5_b:
 v_mfma_f32_32x32x16_bf16 v[72:87], a[116:119], v[252:255], v[72:87]
 ds_read_b128 a[104:107], v12 offset:0
 s_waitcnt lgkmcnt(5)
 s_add_u32 s41, s44, 49152
 buffer_load_dwordx4 a[136:139], v11, s[16:19], s41 offen offset:0 sc1
 v_mfma_f32_32x32x16_bf16 v[56:71], a[120:123], a[128:131], v[56:71]
 ds_read_b128 a[108:111], v12 offset:512
 v_mfma_f32_32x32x16_bf16 v[72:87], a[124:127], a[128:131], v[72:87]
 s_barrier
 ds_read_b64_tr_b16 a[112:113], v1 offset:24576
 ds_read_b64_tr_b16 a[114:115], v1 offset:25600
 s_waitcnt lgkmcnt(4)
 v_mfma_f32_32x32x16_bf16 v[56:71], a[96:99], a[132:135], v[56:71]
 ds_read_b64_tr_b16 a[116:117], v2 offset:24576
 ds_read_b64_tr_b16 a[118:119], v2 offset:25600
 s_add_u32 m0, s36, 122880
 s_add_u32 s38, s34, 221184
 buffer_load_dwordx4 v3, s[12:15], s38 offen offset:0 lds
 v_mfma_f32_32x32x16_bf16 v[72:87], a[100:103], a[132:135], v[72:87]
 ds_read_b64_tr_b16 a[120:121], v1 offset:26624
 ds_read_b64_tr_b16 a[122:123], v1 offset:27648
 s_waitcnt lgkmcnt(6)
 buffer_load_dwordx4 a[140:143], v11, s[16:19], s41 offen offset:1024 sc1
 v_mfma_f32_32x32x16_bf16 v[56:71], a[104:107], a[250:253], v[56:71]
 ds_read_b64_tr_b16 a[124:125], v2 offset:26624
 ds_read_b64_tr_b16 a[126:127], v2 offset:27648
 v_mfma_f32_32x32x16_bf16 v[72:87], a[108:111], a[250:253], v[72:87]
 ds_read_b64_tr_b16 a[96:97], v1 offset:28672
 ds_read_b64_tr_b16 a[98:99], v1 offset:29696
 buffer_load_dwordx4 v4, s[12:15], s38 offen offset:1024 lds
 s_waitcnt lgkmcnt(6)
 v_mfma_f32_32x32x16_bf16 a[0:15], a[112:115], a[184:187], a[0:15]
 ds_read_b64_tr_b16 a[100:101], v2 offset:28672
 ds_read_b64_tr_b16 a[102:103], v2 offset:29696
 buffer_load_dwordx4 a[144:147], v11, s[16:19], s41 offen offset:2048 sc1
 v_mfma_f32_32x32x16_bf16 a[16:31], a[116:119], a[184:187], a[16:31]
 ds_read_b64_tr_b16 a[104:105], v1 offset:30720
 ds_read_b64_tr_b16 a[106:107], v1 offset:31744
 s_waitcnt lgkmcnt(6)
 s_add_u32 s39, s42, 81920
 v_mul_f32 v20, v56, v56
 v_mul_f32 v21, v57, v57
 v_fma_f32 v20, v20, v13, v14
 v_mfma_f32_32x32x16_bf16 a[32:47], a[120:123], a[184:187], a[32:47]
 ds_read_b64_tr_b16 a[108:109], v2 offset:30720
 ds_read_b64_tr_b16 a[110:111], v2 offset:31744
 buffer_load_dwordx4 v5, s[12:15], s38 offen offset:2048 lds
 v_mfma_f32_32x32x16_bf16 a[48:63], a[124:127], a[184:187], a[48:63]
 ds_read_b64_tr_b16 a[112:113], v1 offset:32768
 ds_read_b64_tr_b16 a[114:115], v1 offset:33792
 s_waitcnt lgkmcnt(6)
 buffer_load_dwordx4 a[148:151], v11, s[16:19], s41 offen offset:3072 sc1
 v_fma_f32 v21, v21, v13, v14
 v_mfma_f32_32x32x16_bf16 a[64:79], a[96:99], a[184:187], a[64:79]
 ds_read_b64_tr_b16 a[116:117], v2 offset:32768
 ds_read_b64_tr_b16 a[118:119], v2 offset:33792
 v_mul_f32 v20, v20, v56
 v_mul_f32 v21, v21, v57
 v_exp_f32 v20, v20
 v_exp_f32 v21, v21
 v_mfma_f32_32x32x16_bf16 a[80:95], a[100:103], a[184:187], a[80:95]
 ds_read_b64_tr_b16 a[120:121], v1 offset:34816
 ds_read_b64_tr_b16 a[122:123], v1 offset:35840
 buffer_load_dwordx4 v6, s[12:15], s38 offen offset:3072 lds
 s_waitcnt lgkmcnt(6)
 v_mfma_f32_32x32x16_bf16 a[0:15], a[104:107], a[188:191], a[0:15]
 ds_read_b64_tr_b16 a[124:125], v2 offset:34816
 ds_read_b64_tr_b16 a[126:127], v2 offset:35840
 v_fma_f32 v20, v20, v15, v15
 v_fma_f32 v21, v21, v15, v15
 v_rcp_f32 v20, v20
 v_rcp_f32 v21, v21
 v_mfma_f32_32x32x16_bf16 a[16:31], a[108:111], a[188:191], a[16:31]
 ds_read_b64_tr_b16 a[96:97], v1 offset:36864
 ds_read_b64_tr_b16 a[98:99], v1 offset:37888
 s_waitcnt lgkmcnt(6)
 v_mul_f32 v20, v20, v56
 v_mul_f32 v21, v21, v57
 v_cvt_pk_bf16_f32 v104, v20, v21
 v_mul_f32 v22, v58, v58
 v_mfma_f32_32x32x16_bf16 a[32:47], a[112:115], a[188:191], a[32:47]
 ds_read_b64_tr_b16 a[100:101], v2 offset:36864
 ds_read_b64_tr_b16 a[102:103], v2 offset:37888
 s_add_u32 m0, s36, 126976
 s_add_u32 s38, s34, 221440
 buffer_load_dwordx4 v3, s[12:15], s38 offen offset:0 lds
 v_mfma_f32_32x32x16_bf16 a[48:63], a[116:119], a[188:191], a[48:63]
 ds_read_b64_tr_b16 a[104:105], v1 offset:38912
 ds_read_b64_tr_b16 a[106:107], v1 offset:39936
 s_waitcnt lgkmcnt(6)
 v_mul_f32 v23, v59, v59
 v_fma_f32 v22, v22, v13, v14
 v_fma_f32 v23, v23, v13, v14
 v_mul_f32 v22, v22, v58
 v_mfma_f32_32x32x16_bf16 a[64:79], a[120:123], a[188:191], a[64:79]
 ds_read_b64_tr_b16 a[108:109], v2 offset:38912
 ds_read_b64_tr_b16 a[110:111], v2 offset:39936
 v_mul_f32 v23, v23, v59
 v_exp_f32 v22, v22
 v_exp_f32 v23, v23
 v_fma_f32 v22, v22, v15, v15
 v_mfma_f32_32x32x16_bf16 a[80:95], a[124:127], a[188:191], a[80:95]
 ds_read_b64_tr_b16 a[112:113], v1 offset:40960
 ds_read_b64_tr_b16 a[114:115], v1 offset:41984
 buffer_load_dwordx4 v4, s[12:15], s38 offen offset:1024 lds
 s_waitcnt lgkmcnt(6)
 v_mfma_f32_32x32x16_bf16 a[0:15], a[96:99], a[192:195], a[0:15]
 ds_read_b64_tr_b16 a[116:117], v2 offset:40960
 ds_read_b64_tr_b16 a[118:119], v2 offset:41984
 v_fma_f32 v23, v23, v15, v15
 v_rcp_f32 v22, v22
 v_rcp_f32 v23, v23
 v_mul_f32 v22, v22, v58
 v_mfma_f32_32x32x16_bf16 a[16:31], a[100:103], a[192:195], a[16:31]
 ds_read_b64_tr_b16 a[120:121], v1 offset:43008
 ds_read_b64_tr_b16 a[122:123], v1 offset:44032
 s_waitcnt lgkmcnt(6)
 v_mul_f32 v23, v23, v59
 v_cvt_pk_bf16_f32 v105, v22, v23
 v_mul_f32 v20, v60, v60
 v_mul_f32 v21, v61, v61
 v_mfma_f32_32x32x16_bf16 a[32:47], a[104:107], a[192:195], a[32:47]
 ds_read_b64_tr_b16 a[124:125], v2 offset:43008
 ds_read_b64_tr_b16 a[126:127], v2 offset:44032
 v_fma_f32 v20, v20, v13, v14
 v_fma_f32 v21, v21, v13, v14
 v_mul_f32 v20, v20, v60
 v_mul_f32 v21, v21, v61
 v_exp_f32 v20, v20
 v_mfma_f32_32x32x16_bf16 a[48:63], a[108:111], a[192:195], a[48:63]
 ds_read_b64_tr_b16 a[96:97], v1 offset:45056
 ds_read_b64_tr_b16 a[98:99], v1 offset:46080
 s_waitcnt lgkmcnt(6)
 v_exp_f32 v21, v21
 v_fma_f32 v20, v20, v15, v15
 v_fma_f32 v21, v21, v15, v15
 v_mfma_f32_32x32x16_bf16 a[64:79], a[112:115], a[192:195], a[64:79]
 ds_read_b64_tr_b16 a[100:101], v2 offset:45056
 ds_read_b64_tr_b16 a[102:103], v2 offset:46080
 v_rcp_f32 v20, v20
 v_rcp_f32 v21, v21
 v_mul_f32 v20, v20, v60
 v_mul_f32 v21, v21, v61
 v_mfma_f32_32x32x16_bf16 a[80:95], a[116:119], a[192:195], a[80:95]
 ds_read_b64_tr_b16 a[104:105], v1 offset:47104
 ds_read_b64_tr_b16 a[106:107], v1 offset:48128
 s_waitcnt lgkmcnt(6)
 v_cvt_pk_bf16_f32 v106, v20, v21
 v_mul_f32 v22, v62, v62
 v_mul_f32 v23, v63, v63
 v_fma_f32 v22, v22, v13, v14
 v_mfma_f32_32x32x16_bf16 a[0:15], a[120:123], a[196:199], a[0:15]
 ds_read_b64_tr_b16 a[108:109], v2 offset:47104
 ds_read_b64_tr_b16 a[110:111], v2 offset:48128
 v_fma_f32 v23, v23, v13, v14
 v_mul_f32 v22, v22, v62
 v_mul_f32 v23, v23, v63
 v_exp_f32 v22, v22
 v_mfma_f32_32x32x16_bf16 a[16:31], a[124:127], a[196:199], a[16:31]
 s_barrier
 v_add_u32 v1, 49152, v1
 v_add_u32 v2, 49152, v2
 ds_read_b64_tr_b16 a[112:113], v1 offset:0
 ds_read_b64_tr_b16 a[114:115], v1 offset:1024
 s_waitcnt lgkmcnt(6)
 v_mfma_f32_32x32x16_bf16 a[32:47], a[96:99], a[196:199], a[32:47]
 ds_read_b64_tr_b16 a[116:117], v2 offset:0
 ds_read_b64_tr_b16 a[118:119], v2 offset:1024
 s_add_u32 m0, s36, 0
 s_add_u32 s38, s35, 221184
 buffer_load_dwordx4 v3, s[12:15], s38 offen offset:0 lds
 v_mfma_f32_32x32x16_bf16 a[48:63], a[100:103], a[196:199], a[48:63]
 ds_read_b64_tr_b16 a[120:121], v1 offset:2048
 ds_read_b64_tr_b16 a[122:123], v1 offset:3072
 s_waitcnt lgkmcnt(6)
 v_exp_f32 v23, v23
 v_fma_f32 v22, v22, v15, v15
 v_fma_f32 v23, v23, v15, v15
 v_mfma_f32_32x32x16_bf16 a[64:79], a[104:107], a[196:199], a[64:79]
 ds_read_b64_tr_b16 a[124:125], v2 offset:2048
 ds_read_b64_tr_b16 a[126:127], v2 offset:3072
 v_rcp_f32 v22, v22
 v_rcp_f32 v23, v23
 v_mul_f32 v22, v22, v62
 v_mul_f32 v23, v23, v63
 v_mfma_f32_32x32x16_bf16 a[80:95], a[108:111], a[196:199], a[80:95]
 ds_read_b64_tr_b16 a[96:97], v1 offset:4096
 ds_read_b64_tr_b16 a[98:99], v1 offset:5120
 buffer_load_dwordx4 v4, s[12:15], s38 offen offset:1024 lds
 s_waitcnt lgkmcnt(6)
 v_cvt_pk_bf16_f32 v107, v22, v23
 v_mfma_f32_32x32x16_bf16 a[0:15], a[112:115], v[88:91], a[0:15]
 ds_read_b64_tr_b16 a[100:101], v2 offset:4096
 ds_read_b64_tr_b16 a[102:103], v2 offset:5120
 buffer_store_dwordx4 v[104:107], v11, s[16:19], s39 offen offset:0 sc1
 v_mul_f32 v20, v64, v64
 v_mul_f32 v21, v65, v65
 v_mfma_f32_32x32x16_bf16 a[16:31], a[116:119], v[88:91], a[16:31]
 ds_read_b64_tr_b16 a[104:105], v1 offset:6144
 ds_read_b64_tr_b16 a[106:107], v1 offset:7168
 s_waitcnt lgkmcnt(6)
 v_fma_f32 v20, v20, v13, v14
 v_fma_f32 v21, v21, v13, v14
 v_mul_f32 v20, v20, v64
 v_mul_f32 v21, v21, v65
 v_mfma_f32_32x32x16_bf16 a[32:47], a[120:123], v[88:91], a[32:47]
 ds_read_b64_tr_b16 a[108:109], v2 offset:6144
 ds_read_b64_tr_b16 a[110:111], v2 offset:7168
 buffer_load_dwordx4 v5, s[12:15], s38 offen offset:2048 lds
 v_exp_f32 v20, v20
 v_mfma_f32_32x32x16_bf16 a[48:63], a[124:127], v[88:91], a[48:63]
 ds_read_b64_tr_b16 a[112:113], v1 offset:8192
 ds_read_b64_tr_b16 a[114:115], v1 offset:9216
 s_waitcnt lgkmcnt(6)
 s_add_u32 s40, s45, 5
 v_mov_b32 v18, s40
 s_waitcnt vmcnt(14)
 s_mov_b64 exec, 1
 buffer_store_dword v18, off, s[16:19], s47 sc1
 s_mov_b64 exec, -1
 v_mfma_f32_32x32x16_bf16 a[64:79], a[96:99], v[88:91], a[64:79]
 ds_read_b64_tr_b16 a[116:117], v2 offset:8192
 ds_read_b64_tr_b16 a[118:119], v2 offset:9216
 v_exp_f32 v21, v21
 v_fma_f32 v20, v20, v15, v15
 v_mfma_f32_32x32x16_bf16 a[80:95], a[100:103], v[88:91], a[80:95]
 ds_read_b64_tr_b16 a[120:121], v1 offset:10240
 ds_read_b64_tr_b16 a[122:123], v1 offset:11264
 buffer_load_dwordx4 v6, s[12:15], s38 offen offset:3072 lds
 s_waitcnt lgkmcnt(6)
 v_fma_f32 v21, v21, v15, v15
 v_mfma_f32_32x32x16_bf16 a[0:15], a[104:107], v[92:95], a[0:15]
 ds_read_b64_tr_b16 a[124:125], v2 offset:10240
 ds_read_b64_tr_b16 a[126:127], v2 offset:11264
 v_rcp_f32 v20, v20
 v_rcp_f32 v21, v21
 v_mul_f32 v20, v20, v64
 v_mfma_f32_32x32x16_bf16 a[16:31], a[108:111], v[92:95], a[16:31]
 ds_read_b64_tr_b16 a[96:97], v1 offset:12288
 ds_read_b64_tr_b16 a[98:99], v1 offset:13312
 s_waitcnt lgkmcnt(6)
 v_mul_f32 v21, v21, v65
 v_cvt_pk_bf16_f32 v108, v20, v21
 v_mul_f32 v22, v66, v66
 v_mul_f32 v23, v67, v67
 v_fma_f32 v22, v22, v13, v14
 v_mfma_f32_32x32x16_bf16 a[32:47], a[112:115], v[92:95], a[32:47]
 ds_read_b64_tr_b16 a[100:101], v2 offset:12288
 ds_read_b64_tr_b16 a[102:103], v2 offset:13312
 s_add_u32 m0, s36, 4096
 s_add_u32 s38, s35, 221440
 buffer_load_dwordx4 v3, s[12:15], s38 offen offset:0 lds
 v_mfma_f32_32x32x16_bf16 a[48:63], a[116:119], v[92:95], a[48:63]
 ds_read_b64_tr_b16 a[104:105], v1 offset:14336
 ds_read_b64_tr_b16 a[106:107], v1 offset:15360
 s_waitcnt lgkmcnt(6)
 v_fma_f32 v23, v23, v13, v14
 v_mul_f32 v22, v22, v66
 v_mul_f32 v23, v23, v67
 v_mfma_f32_32x32x16_bf16 a[64:79], a[120:123], v[92:95], a[64:79]
 ds_read_b64_tr_b16 a[108:109], v2 offset:14336
 ds_read_b64_tr_b16 a[110:111], v2 offset:15360
 v_exp_f32 v22, v22
 v_exp_f32 v23, v23
 v_fma_f32 v22, v22, v15, v15
 v_fma_f32 v23, v23, v15, v15
 v_mfma_f32_32x32x16_bf16 a[80:95], a[124:127], v[92:95], a[80:95]
 ds_read_b64_tr_b16 a[112:113], v1 offset:16384
 ds_read_b64_tr_b16 a[114:115], v1 offset:17408
 buffer_load_dwordx4 v4, s[12:15], s38 offen offset:1024 lds
 s_waitcnt lgkmcnt(6)
 v_mfma_f32_32x32x16_bf16 a[0:15], a[96:99], v[96:99], a[0:15]
 ds_read_b64_tr_b16 a[116:117], v2 offset:16384
 ds_read_b64_tr_b16 a[118:119], v2 offset:17408
 v_rcp_f32 v22, v22
 v_rcp_f32 v23, v23
 v_mul_f32 v22, v22, v66
 v_mul_f32 v23, v23, v67
 v_mfma_f32_32x32x16_bf16 a[16:31], a[100:103], v[96:99], a[16:31]
 ds_read_b64_tr_b16 a[120:121], v1 offset:18432
 ds_read_b64_tr_b16 a[122:123], v1 offset:19456
 s_waitcnt lgkmcnt(6)
 v_cvt_pk_bf16_f32 v109, v22, v23
 v_mul_f32 v20, v68, v68
 v_mul_f32 v21, v69, v69
 v_fma_f32 v20, v20, v13, v14
 v_fma_f32 v21, v21, v13, v14
 v_mfma_f32_32x32x16_bf16 a[32:47], a[104:107], v[96:99], a[32:47]
 ds_read_b64_tr_b16 a[124:125], v2 offset:18432
 ds_read_b64_tr_b16 a[126:127], v2 offset:19456
 v_mul_f32 v20, v20, v68
 v_mul_f32 v21, v21, v69
 v_exp_f32 v20, v20
 v_mfma_f32_32x32x16_bf16 a[48:63], a[108:111], v[96:99], a[48:63]
 ds_read_b64_tr_b16 a[96:97], v1 offset:20480
 ds_read_b64_tr_b16 a[98:99], v1 offset:21504
 s_waitcnt lgkmcnt(6)
 v_exp_f32 v21, v21
 v_fma_f32 v20, v20, v15, v15
 v_fma_f32 v21, v21, v15, v15
 v_mfma_f32_32x32x16_bf16 a[64:79], a[112:115], v[96:99], a[64:79]
 ds_read_b64_tr_b16 a[100:101], v2 offset:20480
 ds_read_b64_tr_b16 a[102:103], v2 offset:21504
 v_rcp_f32 v20, v20
 v_rcp_f32 v21, v21
 v_mul_f32 v20, v20, v68
 v_mul_f32 v21, v21, v69
 v_mfma_f32_32x32x16_bf16 a[80:95], a[116:119], v[96:99], a[80:95]
 ds_read_b64_tr_b16 a[104:105], v1 offset:22528
 ds_read_b64_tr_b16 a[106:107], v1 offset:23552
 s_waitcnt lgkmcnt(6)
 v_cvt_pk_bf16_f32 v110, v20, v21
 v_mul_f32 v22, v70, v70
 v_mul_f32 v23, v71, v71
 v_fma_f32 v22, v22, v13, v14
 v_fma_f32 v23, v23, v13, v14
 v_mfma_f32_32x32x16_bf16 a[0:15], a[120:123], v[100:103], a[0:15]
 ds_read_b64_tr_b16 a[108:109], v2 offset:22528
 ds_read_b64_tr_b16 a[110:111], v2 offset:23552
 v_mul_f32 v22, v22, v70
 v_mul_f32 v23, v23, v71
 v_exp_f32 v22, v22
 v_mfma_f32_32x32x16_bf16 a[16:31], a[124:127], v[100:103], a[16:31]
 s_barrier
 ds_read_b64_tr_b16 a[112:113], v1 offset:24576
 ds_read_b64_tr_b16 a[114:115], v1 offset:25600
 s_waitcnt lgkmcnt(6)
 v_exp_f32 v23, v23
 v_fma_f32 v22, v22, v15, v15
 v_mfma_f32_32x32x16_bf16 a[32:47], a[96:99], v[100:103], a[32:47]
 ds_read_b64_tr_b16 a[116:117], v2 offset:24576
 ds_read_b64_tr_b16 a[118:119], v2 offset:25600
 s_add_u32 m0, s36, 24576
 s_add_u32 s38, s33, 368640
 buffer_load_dwordx4 v3, s[12:15], s38 offen offset:0 lds
 v_mfma_f32_32x32x16_bf16 a[48:63], a[100:103], v[100:103], a[48:63]
 ds_read_b64_tr_b16 a[120:121], v1 offset:26624
 ds_read_b64_tr_b16 a[122:123], v1 offset:27648
 s_waitcnt lgkmcnt(6)
 v_fma_f32 v23, v23, v15, v15
 v_rcp_f32 v22, v22
 v_mfma_f32_32x32x16_bf16 a[64:79], a[104:107], v[100:103], a[64:79]
 ds_read_b64_tr_b16 a[124:125], v2 offset:26624
 ds_read_b64_tr_b16 a[126:127], v2 offset:27648
 v_rcp_f32 v23, v23
 v_mul_f32 v22, v22, v70
 v_mul_f32 v23, v23, v71
 v_cvt_pk_bf16_f32 v111, v22, v23
 v_mfma_f32_32x32x16_bf16 a[80:95], a[108:111], v[100:103], a[80:95]
 ds_read_b64_tr_b16 a[96:97], v1 offset:28672
 ds_read_b64_tr_b16 a[98:99], v1 offset:29696
 buffer_load_dwordx4 v4, s[12:15], s38 offen offset:1024 lds
 s_waitcnt lgkmcnt(6)
 v_mfma_f32_32x32x16_bf16 a[0:15], a[112:115], a[200:203], a[0:15]
 ds_read_b64_tr_b16 a[100:101], v2 offset:28672
 ds_read_b64_tr_b16 a[102:103], v2 offset:29696
 buffer_store_dwordx4 v[108:111], v11, s[16:19], s39 offen offset:1024 sc1
 v_mul_f32 v20, v72, v72
 v_mul_f32 v21, v73, v73
 v_fma_f32 v20, v20, v13, v14
 v_mfma_f32_32x32x16_bf16 a[16:31], a[116:119], a[200:203], a[16:31]
 ds_read_b64_tr_b16 a[104:105], v1 offset:30720
 ds_read_b64_tr_b16 a[106:107], v1 offset:31744
 s_waitcnt lgkmcnt(6)
 v_fma_f32 v21, v21, v13, v14
 v_mul_f32 v20, v20, v72
 v_mul_f32 v21, v21, v73
 v_exp_f32 v20, v20
 v_mfma_f32_32x32x16_bf16 a[32:47], a[120:123], a[200:203], a[32:47]
 ds_read_b64_tr_b16 a[108:109], v2 offset:30720
 ds_read_b64_tr_b16 a[110:111], v2 offset:31744
 buffer_load_dwordx4 v5, s[12:15], s38 offen offset:2048 lds
 v_mfma_f32_32x32x16_bf16 a[48:63], a[124:127], a[200:203], a[48:63]
 ds_read_b64_tr_b16 a[112:113], v1 offset:32768
 ds_read_b64_tr_b16 a[114:115], v1 offset:33792
 s_waitcnt lgkmcnt(6)
 v_exp_f32 v21, v21
 v_fma_f32 v20, v20, v15, v15
 v_fma_f32 v21, v21, v15, v15
 v_mfma_f32_32x32x16_bf16 a[64:79], a[96:99], a[200:203], a[64:79]
 ds_read_b64_tr_b16 a[116:117], v2 offset:32768
 ds_read_b64_tr_b16 a[118:119], v2 offset:33792
 v_rcp_f32 v20, v20
 v_rcp_f32 v21, v21
 v_mul_f32 v20, v20, v72
 v_mul_f32 v21, v21, v73
 v_mfma_f32_32x32x16_bf16 a[80:95], a[100:103], a[200:203], a[80:95]
 ds_read_b64_tr_b16 a[120:121], v1 offset:34816
 ds_read_b64_tr_b16 a[122:123], v1 offset:35840
 buffer_load_dwordx4 v6, s[12:15], s38 offen offset:3072 lds
 s_waitcnt lgkmcnt(6)
 v_cvt_pk_bf16_f32 v112, v20, v21
 v_mfma_f32_32x32x16_bf16 a[0:15], a[104:107], a[204:207], a[0:15]
 ds_read_b64_tr_b16 a[124:125], v2 offset:34816
 ds_read_b64_tr_b16 a[126:127], v2 offset:35840
 v_mul_f32 v22, v74, v74
 v_mul_f32 v23, v75, v75
 v_fma_f32 v22, v22, v13, v14
 v_fma_f32 v23, v23, v13, v14
 v_mul_f32 v22, v22, v74
 v_mfma_f32_32x32x16_bf16 a[16:31], a[108:111], a[204:207], a[16:31]
 ds_read_b64_tr_b16 a[96:97], v1 offset:36864
 ds_read_b64_tr_b16 a[98:99], v1 offset:37888
 s_waitcnt lgkmcnt(6)
 v_mul_f32 v23, v23, v75
 v_exp_f32 v22, v22
 v_exp_f32 v23, v23
 v_mfma_f32_32x32x16_bf16 a[32:47], a[112:115], a[204:207], a[32:47]
 ds_read_b64_tr_b16 a[100:101], v2 offset:36864
 ds_read_b64_tr_b16 a[102:103], v2 offset:37888
 s_add_u32 m0, s36, 28672
 s_add_u32 s38, s33, 368896
 buffer_load_dwordx4 v3, s[12:15], s38 offen offset:0 lds
 v_mfma_f32_32x32x16_bf16 a[48:63], a[116:119], a[204:207], a[48:63]
 ds_read_b64_tr_b16 a[104:105], v1 offset:38912
 ds_read_b64_tr_b16 a[106:107], v1 offset:39936
 s_waitcnt lgkmcnt(6)
 v_fma_f32 v22, v22, v15, v15
 v_fma_f32 v23, v23, v15, v15
 v_rcp_f32 v22, v22
 v_mfma_f32_32x32x16_bf16 a[64:79], a[120:123], a[204:207], a[64:79]
 ds_read_b64_tr_b16 a[108:109], v2 offset:38912
 ds_read_b64_tr_b16 a[110:111], v2 offset:39936
 v_rcp_f32 v23, v23
 v_mul_f32 v22, v22, v74
 v_mul_f32 v23, v23, v75
 v_cvt_pk_bf16_f32 v113, v22, v23
 v_mfma_f32_32x32x16_bf16 a[80:95], a[124:127], a[204:207], a[80:95]
 ds_read_b64_tr_b16 a[112:113], v1 offset:40960
 ds_read_b64_tr_b16 a[114:115], v1 offset:41984
 buffer_load_dwordx4 v4, s[12:15], s38 offen offset:1024 lds
 s_waitcnt lgkmcnt(6)
 v_mul_f32 v20, v76, v76
 v_mfma_f32_32x32x16_bf16 a[0:15], a[96:99], a[208:211], a[0:15]
 ds_read_b64_tr_b16 a[116:117], v2 offset:40960
 ds_read_b64_tr_b16 a[118:119], v2 offset:41984
 v_mul_f32 v21, v77, v77
 v_fma_f32 v20, v20, v13, v14
 v_fma_f32 v21, v21, v13, v14
 v_mul_f32 v20, v20, v76
 v_mul_f32 v21, v21, v77
 v_mfma_f32_32x32x16_bf16 a[16:31], a[100:103], a[208:211], a[16:31]
 ds_read_b64_tr_b16 a[120:121], v1 offset:43008
 ds_read_b64_tr_b16 a[122:123], v1 offset:44032
 s_waitcnt lgkmcnt(6)
 v_exp_f32 v20, v20
 v_exp_f32 v21, v21
 v_fma_f32 v20, v20, v15, v15
 v_mfma_f32_32x32x16_bf16 a[32:47], a[104:107], a[208:211], a[32:47]
 ds_read_b64_tr_b16 a[124:125], v2 offset:43008
 ds_read_b64_tr_b16 a[126:127], v2 offset:44032
 v_fma_f32 v21, v21, v15, v15
 v_rcp_f32 v20, v20
 v_rcp_f32 v21, v21
 v_mfma_f32_32x32x16_bf16 a[48:63], a[108:111], a[208:211], a[48:63]
 ds_read_b64_tr_b16 a[96:97], v1 offset:45056
 ds_read_b64_tr_b16 a[98:99], v1 offset:46080
 s_waitcnt lgkmcnt(6)
 v_mul_f32 v20, v20, v76
 v_mul_f32 v21, v21, v77
 v_cvt_pk_bf16_f32 v114, v20, v21
 v_mul_f32 v22, v78, v78
 v_mul_f32 v23, v79, v79
 v_mfma_f32_32x32x16_bf16 a[64:79], a[112:115], a[208:211], a[64:79]
 ds_read_b64_tr_b16 a[100:101], v2 offset:45056
 ds_read_b64_tr_b16 a[102:103], v2 offset:46080
 v_fma_f32 v22, v22, v13, v14
 v_fma_f32 v23, v23, v13, v14
 v_mul_f32 v22, v22, v78
 v_mul_f32 v23, v23, v79
 v_mfma_f32_32x32x16_bf16 a[80:95], a[116:119], a[208:211], a[80:95]
 ds_read_b64_tr_b16 a[104:105], v1 offset:47104
 ds_read_b64_tr_b16 a[106:107], v1 offset:48128
 s_waitcnt lgkmcnt(6)
 v_exp_f32 v22, v22
 v_exp_f32 v23, v23
 v_fma_f32 v22, v22, v15, v15
 v_mfma_f32_32x32x16_bf16 a[0:15], a[120:123], a[212:215], a[0:15]
 ds_read_b64_tr_b16 a[108:109], v2 offset:47104
 ds_read_b64_tr_b16 a[110:111], v2 offset:48128
 v_fma_f32 v23, v23, v15, v15
 v_rcp_f32 v22, v22
 v_rcp_f32 v23, v23
 v_mul_f32 v22, v22, v78
 v_mfma_f32_32x32x16_bf16 a[16:31], a[124:127], a[212:215], a[16:31]
 s_barrier
 v_add_u32 v1, 49152, v1
 v_add_u32 v2, 49152, v2
 ds_read_b64_tr_b16 a[112:113], v1 offset:0
 ds_read_b64_tr_b16 a[114:115], v1 offset:1024
 s_waitcnt lgkmcnt(6)
 v_mfma_f32_32x32x16_bf16 a[32:47], a[96:99], a[212:215], a[32:47]
 ds_read_b64_tr_b16 a[116:117], v2 offset:0
 ds_read_b64_tr_b16 a[118:119], v2 offset:1024
 s_add_u32 m0, s36, 49152
 s_add_u32 s38, s34, 294912
 buffer_load_dwordx4 v3, s[12:15], s38 offen offset:0 lds
 v_mfma_f32_32x32x16_bf16 a[48:63], a[100:103], a[212:215], a[48:63]
 ds_read_b64_tr_b16 a[120:121], v1 offset:2048
 ds_read_b64_tr_b16 a[122:123], v1 offset:3072
 s_waitcnt lgkmcnt(6)
 buffer_load_dword v16, v17, s[16:19], 0 offen sc1
 v_mul_f32 v23, v23, v79
 v_mfma_f32_32x32x16_bf16 a[64:79], a[104:107], a[212:215], a[64:79]
 ds_read_b64_tr_b16 a[124:125], v2 offset:2048
 ds_read_b64_tr_b16 a[126:127], v2 offset:3072
 v_cvt_pk_bf16_f32 v115, v22, v23
 buffer_store_dwordx4 v[112:115], v11, s[16:19], s39 offen offset:2048 sc1
 v_mul_f32 v20, v80, v80
 v_mul_f32 v21, v81, v81
 v_mfma_f32_32x32x16_bf16 a[80:95], a[108:111], a[212:215], a[80:95]
 ds_read_b64_tr_b16 a[96:97], v1 offset:4096
 ds_read_b64_tr_b16 a[98:99], v1 offset:5120
 buffer_load_dwordx4 v4, s[12:15], s38 offen offset:1024 lds
 s_waitcnt lgkmcnt(6)
 v_mfma_f32_32x32x16_bf16 a[0:15], a[112:115], a[216:219], a[0:15]
 ds_read_b64_tr_b16 a[100:101], v2 offset:4096
 ds_read_b64_tr_b16 a[102:103], v2 offset:5120
 v_fma_f32 v20, v20, v13, v14
 v_fma_f32 v21, v21, v13, v14
 v_mul_f32 v20, v20, v80
 v_mul_f32 v21, v21, v81
 v_exp_f32 v20, v20
 v_mfma_f32_32x32x16_bf16 a[16:31], a[116:119], a[216:219], a[16:31]
 ds_read_b64_tr_b16 a[104:105], v1 offset:6144
 ds_read_b64_tr_b16 a[106:107], v1 offset:7168
 s_waitcnt lgkmcnt(6)
 v_exp_f32 v21, v21
 v_fma_f32 v20, v20, v15, v15
 v_fma_f32 v21, v21, v15, v15
 v_mfma_f32_32x32x16_bf16 a[32:47], a[120:123], a[216:219], a[32:47]
 ds_read_b64_tr_b16 a[108:109], v2 offset:6144
 ds_read_b64_tr_b16 a[110:111], v2 offset:7168
 buffer_load_dwordx4 v5, s[12:15], s38 offen offset:2048 lds
 v_rcp_f32 v20, v20
 v_mfma_f32_32x32x16_bf16 a[48:63], a[124:127], a[216:219], a[48:63]
 ds_read_b64_tr_b16 a[112:113], v1 offset:8192
 ds_read_b64_tr_b16 a[114:115], v1 offset:9216
 s_waitcnt lgkmcnt(6)
 v_rcp_f32 v21, v21
 v_mul_f32 v20, v20, v80
 v_mul_f32 v21, v21, v81
 v_mfma_f32_32x32x16_bf16 a[64:79], a[96:99], a[216:219], a[64:79]
 ds_read_b64_tr_b16 a[116:117], v2 offset:8192
 ds_read_b64_tr_b16 a[118:119], v2 offset:9216
 v_cvt_pk_bf16_f32 v116, v20, v21
 v_mul_f32 v22, v82, v82
 v_mul_f32 v23, v83, v83
 v_fma_f32 v22, v22, v13, v14
 v_fma_f32 v23, v23, v13, v14
 v_mul_f32 v22, v22, v82
 v_mfma_f32_32x32x16_bf16 a[80:95], a[100:103], a[216:219], a[80:95]
 ds_read_b64_tr_b16 a[120:121], v1 offset:10240
 ds_read_b64_tr_b16 a[122:123], v1 offset:11264
 buffer_load_dwordx4 v6, s[12:15], s38 offen offset:3072 lds
 s_waitcnt lgkmcnt(6)
 v_mfma_f32_32x32x16_bf16 a[0:15], a[104:107], a[220:223], a[0:15]
 ds_read_b64_tr_b16 a[124:125], v2 offset:10240
 ds_read_b64_tr_b16 a[126:127], v2 offset:11264
 v_mul_f32 v23, v23, v83
 v_exp_f32 v22, v22
 v_exp_f32 v23, v23
 v_fma_f32 v22, v22, v15, v15
 v_mfma_f32_32x32x16_bf16 a[16:31], a[108:111], a[220:223], a[16:31]
 ds_read_b64_tr_b16 a[96:97], v1 offset:12288
 ds_read_b64_tr_b16 a[98:99], v1 offset:13312
 s_waitcnt lgkmcnt(6)
 v_fma_f32 v23, v23, v15, v15
 v_rcp_f32 v22, v22
 v_mfma_f32_32x32x16_bf16 a[32:47], a[112:115], a[220:223], a[32:47]
 ds_read_b64_tr_b16 a[100:101], v2 offset:12288
 ds_read_b64_tr_b16 a[102:103], v2 offset:13312
 s_add_u32 m0, s36, 53248
 s_add_u32 s38, s34, 295168
 buffer_load_dwordx4 v3, s[12:15], s38 offen offset:0 lds
 v_mfma_f32_32x32x16_bf16 a[48:63], a[116:119], a[220:223], a[48:63]
 ds_read_b64_tr_b16 a[104:105], v1 offset:14336
 ds_read_b64_tr_b16 a[106:107], v1 offset:15360
 s_waitcnt lgkmcnt(6)
 v_rcp_f32 v23, v23
 v_mul_f32 v22, v22, v82
 v_mul_f32 v23, v23, v83
 v_cvt_pk_bf16_f32 v117, v22, v23
 v_mfma_f32_32x32x16_bf16 a[64:79], a[120:123], a[220:223], a[64:79]
 ds_read_b64_tr_b16 a[108:109], v2 offset:14336
 ds_read_b64_tr_b16 a[110:111], v2 offset:15360
 v_mul_f32 v20, v84, v84
 v_mul_f32 v21, v85, v85
 v_fma_f32 v20, v20, v13, v14
 v_fma_f32 v21, v21, v13, v14
 v_mul_f32 v20, v20, v84
 v_mfma_f32_32x32x16_bf16 a[80:95], a[124:127], a[220:223], a[80:95]
 ds_read_b64_tr_b16 a[112:113], v1 offset:16384
 ds_read_b64_tr_b16 a[114:115], v1 offset:17408
 buffer_load_dwordx4 v4, s[12:15], s38 offen offset:1024 lds
 s_waitcnt lgkmcnt(6)
 v_mul_f32 v21, v21, v85
 v_mfma_f32_32x32x16_bf16 a[0:15], a[96:99], a[224:227], a[0:15]
 ds_read_b64_tr_b16 a[116:117], v2 offset:16384
 ds_read_b64_tr_b16 a[118:119], v2 offset:17408
 v_exp_f32 v20, v20
 v_exp_f32 v21, v21
 v_fma_f32 v20, v20, v15, v15
 v_mfma_f32_32x32x16_bf16 a[16:31], a[100:103], a[224:227], a[16:31]
 ds_read_b64_tr_b16 a[120:121], v1 offset:18432
 ds_read_b64_tr_b16 a[122:123], v1 offset:19456
 s_waitcnt lgkmcnt(6)
 v_fma_f32 v21, v21, v15, v15
 v_rcp_f32 v20, v20
 v_rcp_f32 v21, v21
 v_mfma_f32_32x32x16_bf16 a[32:47], a[104:107], a[224:227], a[32:47]
 ds_read_b64_tr_b16 a[124:125], v2 offset:18432
 ds_read_b64_tr_b16 a[126:127], v2 offset:19456
 v_mul_f32 v20, v20, v84
 v_mul_f32 v21, v21, v85
 v_cvt_pk_bf16_f32 v118, v20, v21
 v_mul_f32 v22, v86, v86
 v_mul_f32 v23, v87, v87
 v_mfma_f32_32x32x16_bf16 a[48:63], a[108:111], a[224:227], a[48:63]
 ds_read_b64_tr_b16 a[96:97], v1 offset:20480
 ds_read_b64_tr_b16 a[98:99], v1 offset:21504
 s_waitcnt lgkmcnt(6)
 v_fma_f32 v22, v22, v13, v14
 v_fma_f32 v23, v23, v13, v14
 v_mul_f32 v22, v22, v86
 v_mul_f32 v23, v23, v87
 v_mfma_f32_32x32x16_bf16 a[64:79], a[112:115], a[224:227], a[64:79]
 ds_read_b64_tr_b16 a[100:101], v2 offset:20480
 ds_read_b64_tr_b16 a[102:103], v2 offset:21504
 v_exp_f32 v22, v22
 v_exp_f32 v23, v23
 v_fma_f32 v22, v22, v15, v15
 v_fma_f32 v23, v23, v15, v15
 v_mfma_f32_32x32x16_bf16 a[80:95], a[116:119], a[224:227], a[80:95]
 ds_read_b64_tr_b16 a[104:105], v1 offset:22528
 ds_read_b64_tr_b16 a[106:107], v1 offset:23552
 s_waitcnt lgkmcnt(6)
 v_rcp_f32 v22, v22
 v_rcp_f32 v23, v23
 v_mul_f32 v22, v22, v86
 v_mfma_f32_32x32x16_bf16 a[0:15], a[120:123], a[228:231], a[0:15]
 ds_read_b64_tr_b16 a[108:109], v2 offset:22528
 ds_read_b64_tr_b16 a[110:111], v2 offset:23552
 v_mul_f32 v23, v23, v87
 v_cvt_pk_bf16_f32 v119, v22, v23
 buffer_store_dwordx4 v[116:119], v11, s[16:19], s39 offen offset:3072 sc1
 v_mfma_f32_32x32x16_bf16 a[16:31], a[124:127], a[228:231], a[16:31]
 s_waitcnt vmcnt(24)
 s_barrier
 ds_read_b64_tr_b16 a[112:113], v1 offset:24576
 ds_read_b64_tr_b16 a[114:115], v1 offset:25600
 s_waitcnt lgkmcnt(6)
 v_bfe_u32 v156, v0, 3, 1
 v_bfe_u32 v157, v0, 4, 1
 v_lshrrev_b32 v158, 5, v0
 v_mfma_f32_32x32x16_bf16 a[32:47], a[96:99], a[228:231], a[32:47]
 ds_read_b64_tr_b16 a[116:117], v2 offset:24576
 ds_read_b64_tr_b16 a[118:119], v2 offset:25600
 s_add_u32 m0, s36, 73728
 s_add_u32 s38, s35, 294912
 buffer_load_dwordx4 v3, s[12:15], s38 offen offset:0 lds
 v_mfma_f32_32x32x16_bf16 a[48:63], a[100:103], a[228:231], a[48:63]
 ds_read_b64_tr_b16 a[120:121], v1 offset:26624
 ds_read_b64_tr_b16 a[122:123], v1 offset:27648
 s_waitcnt lgkmcnt(6)
 s_add_u32 s40, s45, 5
 s_waitcnt vmcnt(8)
 v_subrev_u32 v16, s40, v16
 v_cmp_lt_u32 vcc, 1, v16
 s_cbranch_vccnz L_fp4
L_fp4_b:
 v_mfma_f32_32x32x16_bf16 a[64:79], a[104:107], a[228:231], a[64:79]
 ds_read_b64_tr_b16 a[124:125], v2 offset:26624
 ds_read_b64_tr_b16 a[126:127], v2 offset:27648
 v_mul_u32_u24 v159, 48, v158
 v_lshl_add_u32 v159, v156, 3, v159
 v_lshl_add_u32 v160, v157, 4, v159
 v_lshl_add_u32 v161, v157, 2, v159
 v_mfma_f32_32x32x16_bf16 a[80:95], a[108:111], a[228:231], a[80:95]
 ds_read_b64_tr_b16 a[96:97], v1 offset:28672
 ds_read_b64_tr_b16 a[98:99], v1 offset:29696
 buffer_load_dwordx4 v4, s[12:15], s38 offen offset:1024 lds
 s_waitcnt lgkmcnt(6)
 v_mfma_f32_32x32x16_bf16 a[0:15], a[112:115], a[232:235], a[0:15]
 ds_read_b64_tr_b16 a[100:101], v2 offset:28672
 ds_read_b64_tr_b16 a[102:103], v2 offset:29696
 s_add_u32 s41, s43, 65536
 buffer_load_dwordx4 a[152:155], v11, s[16:19], s41 offen offset:0 sc1
 v_add_u32 v161, 32, v161
 v_and_b32 v162, 7, v0
 v_mfma_f32_32x32x16_bf16 a[16:31], a[116:119], a[232:235], a[16:31]
 ds_read_b64_tr_b16 a[104:105], v1 offset:30720
 ds_read_b64_tr_b16 a[106:107], v1 offset:31744
 s_waitcnt lgkmcnt(6)
 v_mul_u32_u24 v163, 1152, v162
 v_add_u32 v8, v163, v160
 v_add_u32 v9, v163, v161
 s_mul_i32 s32, s29, 9216
 s_add_u32 s32, s32, s37
 v_mfma_f32_32x32x16_bf16 a[32:47], a[120:123], a[232:235], a[32:47]
 ds_read_b64_tr_b16 a[108:109], v2 offset:30720
 ds_read_b64_tr_b16 a[110:111], v2 offset:31744
 buffer_load_dwordx4 v5, s[12:15], s38 offen offset:2048 lds
 v_mfma_f32_32x32x16_bf16 a[48:63], a[124:127], a[232:235], a[48:63]
 ds_read_b64_tr_b16 a[112:113], v1 offset:32768
 ds_read_b64_tr_b16 a[114:115], v1 offset:33792
 s_waitcnt lgkmcnt(6)
 buffer_load_dwordx4 a[156:159], v11, s[16:19], s41 offen offset:1024 sc1
 s_mul_i32 s37, s30, 0
 v_mfma_f32_32x32x16_bf16 a[64:79], a[96:99], a[232:235], a[64:79]
 ds_read_b64_tr_b16 a[116:117], v2 offset:32768
 ds_read_b64_tr_b16 a[118:119], v2 offset:33792
 s_add_u32 s32, s32, s37
 s_add_u32 s37, s32, 4096
 buffer_load_dwordx2 v[120:121], v8, s[4:7], s37 offen offset:0
 v_mfma_f32_32x32x16_bf16 a[80:95], a[100:103], a[232:235], a[80:95]
 ds_read_b64_tr_b16 a[120:121], v1 offset:34816
 ds_read_b64_tr_b16 a[122:123], v1 offset:35840
 buffer_load_dwordx4 v6, s[12:15], s38 offen offset:3072 lds
 s_waitcnt lgkmcnt(6)
 v_mfma_f32_32x32x16_bf16 a[0:15], a[104:107], a[236:239], a[0:15]
 ds_read_b64_tr_b16 a[124:125], v2 offset:34816
 ds_read_b64_tr_b16 a[126:127], v2 offset:35840
 buffer_load_dwordx4 a[160:163], v11, s[16:19], s41 offen offset:2048 sc1
 v_mfma_f32_32x32x16_bf16 a[16:31], a[108:111], a[236:239], a[16:31]
 ds_read_b64_tr_b16 a[96:97], v1 offset:36864
 ds_read_b64_tr_b16 a[98:99], v1 offset:37888
 s_waitcnt lgkmcnt(6)
 buffer_load_dword v122, v9, s[4:7], s37 offen offset:0
 v_mfma_f32_32x32x16_bf16 a[32:47], a[112:115], a[236:239], a[32:47]
 ds_read_b64_tr_b16 a[100:101], v2 offset:36864
 ds_read_b64_tr_b16 a[102:103], v2 offset:37888
 s_add_u32 m0, s36, 77824
 s_add_u32 s38, s35, 295168
 buffer_load_dwordx4 v3, s[12:15], s38 offen offset:0 lds
 v_mfma_f32_32x32x16_bf16 a[48:63], a[116:119], a[236:239], a[48:63]
 ds_read_b64_tr_b16 a[104:105], v1 offset:38912
 ds_read_b64_tr_b16 a[106:107], v1 offset:39936
 s_waitcnt lgkmcnt(6)
 buffer_load_dwordx4 a[164:167], v11, s[16:19], s41 offen offset:3072 sc1
 v_mfma_f32_32x32x16_bf16 a[64:79], a[120:123], a[236:239], a[64:79]
 ds_read_b64_tr_b16 a[108:109], v2 offset:38912
 ds_read_b64_tr_b16 a[110:111], v2 offset:39936
 buffer_load_dwordx2 v[124:125], v8, s[4:7], s37 offen offset:96
 buffer_load_dword v126, v9, s[4:7], s37 offen offset:96
 v_mfma_f32_32x32x16_bf16 a[80:95], a[124:127], a[236:239], a[80:95]
 ds_read_b64_tr_b16 a[112:113], v1 offset:40960
 ds_read_b64_tr_b16 a[114:115], v1 offset:41984
 buffer_load_dwordx4 v4, s[12:15], s38 offen offset:1024 lds
 s_waitcnt lgkmcnt(6)
 v_mfma_f32_32x32x16_bf16 a[0:15], a[96:99], a[240:243], a[0:15]
 ds_read_b64_tr_b16 a[116:117], v2 offset:40960
 ds_read_b64_tr_b16 a[118:119], v2 offset:41984
 s_add_u32 s41, s44, 65536
 buffer_load_dwordx4 a[168:171], v11, s[16:19], s41 offen offset:0 sc1
 v_mfma_f32_32x32x16_bf16 a[16:31], a[100:103], a[240:243], a[16:31]
 ds_read_b64_tr_b16 a[120:121], v1 offset:43008
 ds_read_b64_tr_b16 a[122:123], v1 offset:44032
 s_waitcnt lgkmcnt(6)
 buffer_load_dwordx2 v[128:129], v8, s[4:7], s37 offen offset:192
 v_mfma_f32_32x32x16_bf16 a[32:47], a[104:107], a[240:243], a[32:47]
 ds_read_b64_tr_b16 a[124:125], v2 offset:43008
 ds_read_b64_tr_b16 a[126:127], v2 offset:44032
 buffer_load_dwordx4 a[172:175], v11, s[16:19], s41 offen offset:1024 sc1
 v_mfma_f32_32x32x16_bf16 a[48:63], a[108:111], a[240:243], a[48:63]
 ds_read_b64_tr_b16 a[96:97], v1 offset:45056
 ds_read_b64_tr_b16 a[98:99], v1 offset:46080
 s_waitcnt lgkmcnt(6)
 buffer_load_dword v130, v9, s[4:7], s37 offen offset:192
 v_mfma_f32_32x32x16_bf16 a[64:79], a[112:115], a[240:243], a[64:79]
 ds_read_b64_tr_b16 a[100:101], v2 offset:45056
 ds_read_b64_tr_b16 a[102:103], v2 offset:46080
 buffer_load_dwordx4 a[176:179], v11, s[16:19], s41 offen offset:2048 sc1
 v_mfma_f32_32x32x16_bf16 a[80:95], a[116:119], a[240:243], a[80:95]
 ds_read_b64_tr_b16 a[104:105], v1 offset:47104
 ds_read_b64_tr_b16 a[106:107], v1 offset:48128
 s_waitcnt lgkmcnt(6)
 buffer_load_dwordx2 v[132:133], v8, s[4:7], s37 offen offset:288
 v_mfma_f32_32x32x16_bf16 a[0:15], a[120:123], a[244:247], a[0:15]
 ds_read_b64_tr_b16 a[108:109], v2 offset:47104
 ds_read_b64_tr_b16 a[110:111], v2 offset:48128
 s_add_u32 s40, s45, 6
 v_mov_b32 v18, s40
 s_waitcnt vmcnt(20)
 s_mov_b64 exec, 1
 buffer_store_dword v18, off, s[16:19], s47 sc1
 s_mov_b64 exec, -1
 v_mfma_f32_32x32x16_bf16 a[16:31], a[124:127], a[244:247], a[16:31]
 s_barrier
 v_add_u32 v1, -98304, v1
 v_add_u32 v2, -98304, v2
 ds_read_b64_tr_b16 a[112:113], v1 offset:0
 ds_read_b64_tr_b16 a[114:115], v1 offset:1024
 s_waitcnt lgkmcnt(6)
 v_mfma_f32_32x32x16_bf16 a[32:47], a[96:99], a[244:247], a[32:47]
 ds_read_b64_tr_b16 a[116:117], v2 offset:0
 ds_read_b64_tr_b16 a[118:119], v2 offset:1024
 s_add_u32 m0, s36, 98304
 s_add_u32 s38, s34, 368640
 buffer_load_dwordx4 v3, s[12:15], s38 offen offset:0 lds
 v_mfma_f32_32x32x16_bf16 a[48:63], a[100:103], a[244:247], a[48:63]
 ds_read_b64_tr_b16 a[120:121], v1 offset:2048
 ds_read_b64_tr_b16 a[122:123], v1 offset:3072
 s_waitcnt lgkmcnt(6)
 buffer_load_dwordx4 a[180:183], v11, s[16:19], s41 offen offset:3072 sc1
 v_mfma_f32_32x32x16_bf16 a[64:79], a[104:107], a[244:247], a[64:79]
 ds_read_b64_tr_b16 a[124:125], v2 offset:2048
 ds_read_b64_tr_b16 a[126:127], v2 offset:3072
 buffer_load_dword v134, v9, s[4:7], s37 offen offset:288
 v_lshlrev_b32 v160, 1, v160
 v_lshlrev_b32 v161, 1, v161
 v_mfma_f32_32x32x16_bf16 a[80:95], a[108:111], a[244:247], a[80:95]
 ds_read_b64_tr_b16 a[96:97], v1 offset:4096
 ds_read_b64_tr_b16 a[98:99], v1 offset:5120
 buffer_load_dwordx4 v4, s[12:15], s38 offen offset:1024 lds
 s_waitcnt lgkmcnt(6)
 v_add_u32 v160, 149504, v160
 v_mfma_f32_32x32x16_bf16 a[0:15], a[112:115], a[136:139], a[0:15]
 ds_read_b64_tr_b16 a[100:101], v2 offset:4096
 ds_read_b64_tr_b16 a[102:103], v2 offset:5120
 v_add_u32 v161, 149504, v161
 s_lshl_b32 s37, s29, 5
 v_lshl_add_u32 v163, v162, 2, s37
 v_accvgpr_read_b32 v164, a248
 v_accvgpr_read_b32 v165, a249
 v_mfma_f32_32x32x16_bf16 a[16:31], a[116:119], a[136:139], a[16:31]
 ds_read_b64_tr_b16 a[104:105], v1 offset:6144
 ds_read_b64_tr_b16 a[106:107], v1 offset:7168
 s_waitcnt lgkmcnt(6)
 v_mul_f32 v164, v164, v165
 ds_bpermute_b32 v166, v163, v165
 ds_bpermute_b32 v167, v163, v164
 ds_read_b128 v[208:211], v160 offset:0
 ds_read_b64 v[224:225], v161 offset:0
 v_mfma_f32_32x32x16_bf16 a[32:47], a[120:123], a[136:139], a[32:47]
 ds_read_b64_tr_b16 a[108:109], v2 offset:6144
 ds_read_b64_tr_b16 a[110:111], v2 offset:7168
 buffer_load_dwordx4 v5, s[12:15], s38 offen offset:2048 lds
 ds_read_b128 v[212:215], v160 offset:192
 v_mfma_f32_32x32x16_bf16 a[48:63], a[124:127], a[136:139], a[48:63]
 ds_read_b64_tr_b16 a[112:113], v1 offset:8192
 ds_read_b64_tr_b16 a[114:115], v1 offset:9216
 s_waitcnt lgkmcnt(11)
 ds_read_b64 v[226:227], v161 offset:192
 ds_read_b128 v[216:219], v160 offset:384
 ds_read_b64 v[228:229], v161 offset:384
 ds_read_b128 v[220:223], v160 offset:576
 ds_read_b64 v[230:231], v161 offset:576
 v_mfma_f32_32x32x16_bf16 a[64:79], a[96:99], a[136:139], a[64:79]
 ds_read_b64_tr_b16 a[116:117], v2 offset:8192
 ds_read_b64_tr_b16 a[118:119], v2 offset:9216
 buffer_load_dword v16, v17, s[16:19], 0 offen sc1
 ds_read_b128 v[232:235], v160 offset:1024
 ds_read_b64 v[248:249], v161 offset:1024
 v_mfma_f32_32x32x16_bf16 a[80:95], a[100:103], a[136:139], a[80:95]
 ds_read_b64_tr_b16 a[120:121], v1 offset:10240
 ds_read_b64_tr_b16 a[122:123], v1 offset:11264
 buffer_load_dwordx4 v6, s[12:15], s38 offen offset:3072 lds
 s_waitcnt lgkmcnt(14)
 ds_read_b128 v[236:239], v160 offset:1216
 v_mfma_f32_32x32x16_bf16 a[0:15], a[104:107], a[140:143], a[0:15]
 ds_read_b64_tr_b16 a[124:125], v2 offset:10240
 ds_read_b64_tr_b16 a[126:127], v2 offset:11264
 ds_read_b64 v[250:251], v161 offset:1216
 ds_read_b128 v[240:243], v160 offset:1408
 ds_read_b64 v[252:253], v161 offset:1408
 ds_read_b128 v[244:247], v160 offset:1600
 ds_read_b64 v[254:255], v161 offset:1600
 v_mfma_f32_32x32x16_bf16 a[16:31], a[108:111], a[140:143], a[16:31]
 ds_read_b64_tr_b16 a[96:97], v1 offset:12288
 ds_read_b64_tr_b16 a[98:99], v1 offset:13312
 s_waitcnt lgkmcnt(14)
 v_lshlrev_b32 v8, 1, v8
 v_lshlrev_b32 v9, 1, v9
 s_lshl_b32 s32, s32, 1
 v_bfe_u32 v156, v0, 3, 2
 s_add_u32 s37, s29, 3
 v_mfma_f32_32x32x16_bf16 a[32:47], a[112:115], a[140:143], a[32:47]
 ds_read_b64_tr_b16 a[100:101], v2 offset:12288
 ds_read_b64_tr_b16 a[102:103], v2 offset:13312
 s_add_u32 m0, s36, 102400
 s_add_u32 s38, s34, 368896
 buffer_load_dwordx4 v3, s[12:15], s38 offen offset:0 lds
 v_mfma_f32_32x32x16_bf16 a[48:63], a[116:119], a[140:143], a[48:63]
 ds_read_b64_tr_b16 a[104:105], v1 offset:14336
 ds_read_b64_tr_b16 a[106:107], v1 offset:15360
 s_waitcnt lgkmcnt(11)
 v_sub_u32 v157, s37, v156
 v_and_b32 v157, 3, v157
 v_lshlrev_b32 v162, 4, v162
 v_lshl_add_u32 v162, v158, 7, v162
 v_mfma_f32_32x32x16_bf16 a[64:79], a[120:123], a[140:143], a[64:79]
 ds_read_b64_tr_b16 a[108:109], v2 offset:14336
 ds_read_b64_tr_b16 a[110:111], v2 offset:15360
 v_mul_u32_u24 v156, 26112, v156
 v_mul_u32_u24 v159, 4352, v157
 v_add3_u32 v156, v156, v159, v162
 v_mul_u32_u24 v159, 4348, v157
 v_add_u32 v157, 1, v157
 v_mfma_f32_32x32x16_bf16 a[80:95], a[124:127], a[140:143], a[80:95]
 ds_read_b64_tr_b16 a[112:113], v1 offset:16384
 ds_read_b64_tr_b16 a[114:115], v1 offset:17408
 buffer_load_dwordx4 v4, s[12:15], s38 offen offset:1024 lds
 s_waitcnt lgkmcnt(6)
 v_lshlrev_b32 v157, 29, v157
 v_mfma_f32_32x32x16_bf16 a[0:15], a[96:99], a[144:147], a[0:15]
 ds_read_b64_tr_b16 a[116:117], v2 offset:16384
 ds_read_b64_tr_b16 a[118:119], v2 offset:17408
 v_and_b32 v157, 0x80000000, v157
 v_or_b32 v7, v156, v157
 v_sub_u32 v96, v7, v159
 v_add_u32 v96, 25856, v96
 v_lshl_or_b32 v96, v7, 24, v96
 v_mfma_f32_32x32x16_bf16 a[16:31], a[100:103], a[144:147], a[16:31]
 ds_read_b64_tr_b16 a[120:121], v1 offset:18432
 ds_read_b64_tr_b16 a[122:123], v1 offset:19456
 s_waitcnt lgkmcnt(6)
 v_min_u32 v97, 5, v0
 v_lshlrev_b32 v97, 2, v97
 v_add_u32 v97, 4096, v97
 s_lshl_b32 s37, s31, 12
 v_add_u32 v10, s37, v162
 v_mfma_f32_32x32x16_bf16 a[32:47], a[104:107], a[144:147], a[32:47]
 ds_read_b64_tr_b16 a[124:125], v2 offset:18432
 ds_read_b64_tr_b16 a[126:127], v2 offset:19456
 v_add_u32 v12, s37, v11
 v_mov_b32 v14, 0x3f80
 v_mov_b32 v15, 0x3f800000
 v_mov_b32 v27, s45
 v_mov_b32 v31, s45
 v_mfma_f32_32x32x16_bf16 a[48:63], a[108:111], a[144:147], a[48:63]
 ds_read_b64_tr_b16 a[96:97], v1 offset:20480
 ds_read_b64_tr_b16 a[98:99], v1 offset:21504
 s_waitcnt lgkmcnt(6)
 v_mov_b32 v35, s45
 v_mov_b32 v39, s45
 v_mov_b32 v43, s45
 v_mov_b32 v47, s45
 v_mov_b32 v51, s45
 v_mfma_f32_32x32x16_bf16 a[64:79], a[112:115], a[144:147], a[64:79]
 ds_read_b64_tr_b16 a[100:101], v2 offset:20480
 ds_read_b64_tr_b16 a[102:103], v2 offset:21504
 v_mov_b32 v55, s45
 v_mov_b32 v59, s45
 v_mov_b32 v63, s45
 v_mov_b32 v67, s45
 v_mov_b32 v71, s45
 v_mfma_f32_32x32x16_bf16 a[80:95], a[116:119], a[144:147], a[80:95]
 ds_read_b64_tr_b16 a[104:105], v1 offset:22528
 ds_read_b64_tr_b16 a[106:107], v1 offset:23552
 s_waitcnt lgkmcnt(6)
 v_mov_b32 v75, s45
 v_mov_b32 v79, s45
 v_mov_b32 v83, s45
 v_mov_b32 v87, s45
 v_add_u32 v98, 1, v27
 v_mfma_f32_32x32x16_bf16 a[0:15], a[120:123], a[148:151], a[0:15]
 ds_read_b64_tr_b16 a[108:109], v2 offset:22528
 ds_read_b64_tr_b16 a[110:111], v2 offset:23552
 v_add_u32 v99, 2, v27
 v_mfma_f32_32x32x16_bf16 a[16:31], a[124:127], a[148:151], a[16:31]
 s_barrier
 ds_read_b64_tr_b16 a[112:113], v1 offset:24576
 ds_read_b64_tr_b16 a[114:115], v1 offset:25600
 s_waitcnt lgkmcnt(6)
 v_mfma_f32_32x32x16_bf16 a[32:47], a[96:99], a[148:151], a[32:47]
 ds_read_b64_tr_b16 a[116:117], v2 offset:24576
 ds_read_b64_tr_b16 a[118:119], v2 offset:25600
 s_add_u32 m0, s36, 122880
 s_add_u32 s38, s35, 368640
 buffer_load_dwordx4 v3, s[12:15], s38 offen offset:0 lds
 v_mfma_f32_32x32x16_bf16 a[48:63], a[100:103], a[148:151], a[48:63]
 ds_read_b64_tr_b16 a[120:121], v1 offset:26624
 ds_read_b64_tr_b16 a[122:123], v1 offset:27648
 s_waitcnt lgkmcnt(6)
 v_mfma_f32_32x32x16_bf16 a[64:79], a[104:107], a[148:151], a[64:79]
 ds_read_b64_tr_b16 a[124:125], v2 offset:26624
 ds_read_b64_tr_b16 a[126:127], v2 offset:27648
 v_mfma_f32_32x32x16_bf16 a[80:95], a[108:111], a[148:151], a[80:95]
 ds_read_b64_tr_b16 a[96:97], v1 offset:28672
 ds_read_b64_tr_b16 a[98:99], v1 offset:29696
 buffer_load_dwordx4 v4, s[12:15], s38 offen offset:1024 lds
 s_waitcnt lgkmcnt(6)
 v_mfma_f32_32x32x16_bf16 a[0:15], a[112:115], v[104:107], a[0:15]
 ds_read_b64_tr_b16 a[100:101], v2 offset:28672
 ds_read_b64_tr_b16 a[102:103], v2 offset:29696
 v_mfma_f32_32x32x16_bf16 a[16:31], a[116:119], v[104:107], a[16:31]
 ds_read_b64_tr_b16 a[104:105], v1 offset:30720
 ds_read_b64_tr_b16 a[106:107], v1 offset:31744
 s_waitcnt lgkmcnt(6)
 v_mfma_f32_32x32x16_bf16 a[32:47], a[120:123], v[104:107], a[32:47]
 ds_read_b64_tr_b16 a[108:109], v2 offset:30720
 ds_read_b64_tr_b16 a[110:111], v2 offset:31744
 buffer_load_dwordx4 v5, s[12:15], s38 offen offset:2048 lds
 v_mfma_f32_32x32x16_bf16 a[48:63], a[124:127], v[104:107], a[48:63]
 ds_read_b64_tr_b16 a[112:113], v1 offset:32768
 ds_read_b64_tr_b16 a[114:115], v1 offset:33792
 s_waitcnt lgkmcnt(6)
 v_mfma_f32_32x32x16_bf16 a[64:79], a[96:99], v[104:107], a[64:79]
 ds_read_b64_tr_b16 a[116:117], v2 offset:32768
 ds_read_b64_tr_b16 a[118:119], v2 offset:33792
 s_add_u32 s40, s45, 6
 s_waitcnt vmcnt(6)
 v_subrev_u32 v16, s40, v16
 v_cmp_lt_u32 vcc, 0, v16
 s_cbranch_vccnz L_fp5
L_fp5_b:
 v_mfma_f32_32x32x16_bf16 a[80:95], a[100:103], v[104:107], a[80:95]
 ds_read_b64_tr_b16 a[120:121], v1 offset:34816
 ds_read_b64_tr_b16 a[122:123], v1 offset:35840
 buffer_load_dwordx4 v6, s[12:15], s38 offen offset:3072 lds
 s_waitcnt lgkmcnt(6)
 v_lshlrev_b32 v184, 16, v120
 v_mfma_f32_32x32x16_bf16 a[0:15], a[104:107], v[108:111], a[0:15]
 ds_read_b64_tr_b16 a[124:125], v2 offset:34816
 ds_read_b64_tr_b16 a[126:127], v2 offset:35840
 s_add_u32 s41, s43, 81920
 buffer_load_dwordx4 a[184:187], v11, s[16:19], s41 offen offset:0 sc1
 v_and_b32 v185, s50, v120
 v_mfma_f32_32x32x16_bf16 a[16:31], a[108:111], v[108:111], a[16:31]
 ds_read_b64_tr_b16 a[96:97], v1 offset:36864
 ds_read_b64_tr_b16 a[98:99], v1 offset:37888
 s_waitcnt lgkmcnt(6)
 v_lshlrev_b32 v186, 16, v121
 v_and_b32 v187, s50, v121
 v_lshlrev_b32 v200, 16, v122
 v_and_b32 v201, s50, v122
 v_fma_f32 v156, v184, v166, -v167
 v_mfma_f32_32x32x16_bf16 a[32:47], a[112:115], v[108:111], a[32:47]
 ds_read_b64_tr_b16 a[100:101], v2 offset:36864
 ds_read_b64_tr_b16 a[102:103], v2 offset:37888
 s_add_u32 m0, s36, 126976
 s_add_u32 s38, s35, 368896
 buffer_load_dwordx4 v3, s[12:15], s38 offen offset:0 lds
 v_mfma_f32_32x32x16_bf16 a[48:63], a[116:119], v[108:111], a[48:63]
 ds_read_b64_tr_b16 a[104:105], v1 offset:38912
 ds_read_b64_tr_b16 a[106:107], v1 offset:39936
 s_waitcnt lgkmcnt(6)
 buffer_load_dwordx4 a[188:191], v11, s[16:19], s41 offen offset:1024 sc1
 v_mfma_f32_32x32x16_bf16 a[64:79], a[120:123], v[108:111], a[64:79]
 ds_read_b64_tr_b16 a[108:109], v2 offset:38912
 ds_read_b64_tr_b16 a[110:111], v2 offset:39936
 v_mul_f32 v208, v208, v156
 v_fma_f32 v157, v185, v166, -v167
 v_mul_f32 v209, v209, v157
 v_fma_f32 v156, v186, v166, -v167
 v_mul_f32 v210, v210, v156
 v_mfma_f32_32x32x16_bf16 a[80:95], a[124:127], v[108:111], a[80:95]
 ds_read_b64_tr_b16 a[112:113], v1 offset:40960
 ds_read_b64_tr_b16 a[114:115], v1 offset:41984
 buffer_load_dwordx4 v4, s[12:15], s38 offen offset:1024 lds
 s_waitcnt lgkmcnt(6)
 v_mfma_f32_32x32x16_bf16 a[0:15], a[96:99], v[112:115], a[0:15]
 ds_read_b64_tr_b16 a[116:117], v2 offset:40960
 ds_read_b64_tr_b16 a[118:119], v2 offset:41984
 buffer_load_dwordx4 a[192:195], v11, s[16:19], s41 offen offset:2048 sc1
 v_fma_f32 v157, v187, v166, -v167
 v_mul_f32 v211, v211, v157
 v_mfma_f32_32x32x16_bf16 a[16:31], a[100:103], v[112:115], a[16:31]
 ds_read_b64_tr_b16 a[120:121], v1 offset:43008
 ds_read_b64_tr_b16 a[122:123], v1 offset:44032
 s_waitcnt lgkmcnt(6)
 v_fma_f32 v156, v200, v166, -v167
 v_mul_f32 v224, v224, v156
 v_fma_f32 v157, v201, v166, -v167
 v_mul_f32 v225, v225, v157
 v_lshlrev_b32 v188, 16, v124
 v_mfma_f32_32x32x16_bf16 a[32:47], a[104:107], v[112:115], a[32:47]
 ds_read_b64_tr_b16 a[124:125], v2 offset:43008
 ds_read_b64_tr_b16 a[126:127], v2 offset:44032
 buffer_load_dwordx4 a[196:199], v11, s[16:19], s41 offen offset:3072 sc1
 v_and_b32 v189, s50, v124
 v_mfma_f32_32x32x16_bf16 a[48:63], a[108:111], v[112:115], a[48:63]
 ds_read_b64_tr_b16 a[96:97], v1 offset:45056
 ds_read_b64_tr_b16 a[98:99], v1 offset:46080
 s_waitcnt lgkmcnt(6)
 v_lshlrev_b32 v190, 16, v125
 v_and_b32 v191, s50, v125
 v_lshlrev_b32 v202, 16, v126
 v_and_b32 v203, s50, v126
 v_fma_f32 v156, v188, v166, -v167
 v_mfma_f32_32x32x16_bf16 a[64:79], a[112:115], v[112:115], a[64:79]
 ds_read_b64_tr_b16 a[100:101], v2 offset:45056
 ds_read_b64_tr_b16 a[102:103], v2 offset:46080
 s_add_u32 s41, s44, 81920
 buffer_load_dwordx4 a[200:203], v11, s[16:19], s41 offen offset:0 sc1
 v_mul_f32 v212, v212, v156
 v_mfma_f32_32x32x16_bf16 a[80:95], a[116:119], v[112:115], a[80:95]
 ds_read_b64_tr_b16 a[104:105], v1 offset:47104
 ds_read_b64_tr_b16 a[106:107], v1 offset:48128
 s_waitcnt lgkmcnt(6)
 v_fma_f32 v157, v189, v166, -v167
 v_mul_f32 v213, v213, v157
 v_fma_f32 v156, v190, v166, -v167
 v_mul_f32 v214, v214, v156
 v_fma_f32 v157, v191, v166, -v167
 v_mfma_f32_32x32x16_bf16 a[0:15], a[120:123], v[116:119], a[0:15]
 ds_read_b64_tr_b16 a[108:109], v2 offset:47104
 ds_read_b64_tr_b16 a[110:111], v2 offset:48128
 buffer_load_dwordx4 a[204:207], v11, s[16:19], s41 offen offset:1024 sc1
 v_mul_f32 v215, v215, v157
 v_mfma_f32_32x32x16_bf16 a[16:31], a[124:127], v[116:119], a[16:31]
 s_barrier
 v_add_u32 v1, 49152, v1
 v_add_u32 v2, 49152, v2
 ds_read_b64_tr_b16 a[112:113], v1 offset:0
 ds_read_b64_tr_b16 a[114:115], v1 offset:1024
 s_waitcnt lgkmcnt(6)
 v_fma_f32 v156, v202, v166, -v167
 v_mfma_f32_32x32x16_bf16 a[32:47], a[96:99], v[116:119], a[32:47]
 ds_read_b64_tr_b16 a[116:117], v1 offset:6144
 ds_read_b64_tr_b16 a[118:119], v1 offset:7168
 buffer_load_dwordx4 a[208:211], v11, s[16:19], s41 offen offset:2048 sc1
 v_mul_f32 v226, v226, v156
 v_mfma_f32_32x32x16_bf16 a[48:63], a[100:103], v[116:119], a[48:63]
 ds_read_b64_tr_b16 a[120:121], v1 offset:12288
 ds_read_b64_tr_b16 a[122:123], v1 offset:13312
 s_waitcnt lgkmcnt(6)
 v_fma_f32 v157, v203, v166, -v167
 v_mul_f32 v227, v227, v157
 v_lshlrev_b32 v192, 16, v128
 v_and_b32 v193, s50, v128
 v_lshlrev_b32 v194, 16, v129
 v_mfma_f32_32x32x16_bf16 a[64:79], a[104:107], v[116:119], a[64:79]
 ds_read_b64_tr_b16 a[124:125], v1 offset:18432
 ds_read_b64_tr_b16 a[126:127], v1 offset:19456
 buffer_load_dwordx4 a[212:215], v11, s[16:19], s41 offen offset:3072 sc1
 v_and_b32 v195, s50, v129
 v_mfma_f32_32x32x16_bf16 a[80:95], a[108:111], v[116:119], a[80:95]
 s_barrier
 ds_read_b64_tr_b16 a[96:97], v1 offset:24576
 ds_read_b64_tr_b16 a[98:99], v1 offset:25600
 s_waitcnt lgkmcnt(6)
 v_lshlrev_b32 v204, 16, v130
 v_and_b32 v205, s50, v130
 v_fma_f32 v156, v192, v166, -v167
 v_mfma_f32_32x32x16_bf16 a[0:15], a[112:115], a[152:155], a[0:15]
 ds_read_b64_tr_b16 a[100:101], v1 offset:30720
 ds_read_b64_tr_b16 a[102:103], v1 offset:31744
 v_mul_f32 v216, v216, v156
 v_fma_f32 v157, v193, v166, -v167
 v_mul_f32 v217, v217, v157
 v_fma_f32 v156, v194, v166, -v167
 v_mul_f32 v218, v218, v156
 v_mfma_f32_32x32x16_bf16 a[0:15], a[116:119], a[156:159], a[0:15]
 ds_read_b64_tr_b16 a[104:105], v1 offset:36864
 ds_read_b64_tr_b16 a[106:107], v1 offset:37888
 s_waitcnt lgkmcnt(6)
 v_fma_f32 v157, v195, v166, -v167
 v_mul_f32 v219, v219, v157
 v_fma_f32 v156, v204, v166, -v167
 v_mul_f32 v228, v228, v156
 v_fma_f32 v157, v205, v166, -v167
 v_mfma_f32_32x32x16_bf16 a[0:15], a[120:123], a[160:163], a[0:15]
 ds_read_b64_tr_b16 a[108:109], v1 offset:43008
 ds_read_b64_tr_b16 a[110:111], v1 offset:44032
 v_mul_f32 v229, v229, v157
 v_lshlrev_b32 v196, 16, v132
 v_and_b32 v197, s50, v132
 v_lshlrev_b32 v198, 16, v133
 v_and_b32 v199, s50, v133
 v_mfma_f32_32x32x16_bf16 a[0:15], a[124:127], a[164:167], a[0:15]
 ds_read_b64_tr_b16 a[112:113], v2 offset:0
 ds_read_b64_tr_b16 a[114:115], v2 offset:1024
 s_waitcnt lgkmcnt(6)
 v_lshlrev_b32 v206, 16, v134
 v_and_b32 v207, s50, v134
 v_fma_f32 v156, v196, v166, -v167
 v_mul_f32 v220, v220, v156
 v_fma_f32 v157, v197, v166, -v167
 v_mfma_f32_32x32x16_bf16 a[0:15], a[96:99], a[168:171], a[0:15]
 ds_read_b64_tr_b16 a[116:117], v2 offset:6144
 ds_read_b64_tr_b16 a[118:119], v2 offset:7168
 v_mul_f32 v221, v221, v157
 v_fma_f32 v156, v198, v166, -v167
 v_mul_f32 v222, v222, v156
 v_fma_f32 v157, v199, v166, -v167
 v_mul_f32 v223, v223, v157
 v_mfma_f32_32x32x16_bf16 a[0:15], a[100:103], a[172:175], a[0:15]
 ds_read_b64_tr_b16 a[120:121], v2 offset:12288
 ds_read_b64_tr_b16 a[122:123], v2 offset:13312
 s_waitcnt lgkmcnt(6)
 v_fma_f32 v156, v206, v166, -v167
 v_mul_f32 v230, v230, v156
 v_fma_f32 v157, v207, v166, -v167
 v_mul_f32 v231, v231, v157
 v_mfma_f32_32x32x16_bf16 a[0:15], a[104:107], a[176:179], a[0:15]
 ds_read_b64_tr_b16 a[124:125], v2 offset:18432
 ds_read_b64_tr_b16 a[126:127], v2 offset:19456
 v_mfma_f32_32x32x16_bf16 a[0:15], a[108:111], a[180:183], a[0:15]
 ds_read_b64_tr_b16 a[96:97], v2 offset:24576
 ds_read_b64_tr_b16 a[98:99], v2 offset:25600
 s_waitcnt lgkmcnt(6)
 v_mfma_f32_32x32x16_bf16 a[16:31], a[112:115], a[152:155], a[16:31]
 ds_read_b64_tr_b16 a[100:101], v2 offset:30720
 ds_read_b64_tr_b16 a[102:103], v2 offset:31744
 v_mfma_f32_32x32x16_bf16 a[16:31], a[116:119], a[156:159], a[16:31]
 ds_read_b64_tr_b16 a[104:105], v2 offset:36864
 ds_read_b64_tr_b16 a[106:107], v2 offset:37888
 s_waitcnt lgkmcnt(6)
 v_mfma_f32_32x32x16_bf16 a[16:31], a[120:123], a[160:163], a[16:31]
 ds_read_b64_tr_b16 a[108:109], v2 offset:43008
 ds_read_b64_tr_b16 a[110:111], v2 offset:44032
 v_mfma_f32_32x32x16_bf16 a[16:31], a[124:127], a[164:167], a[16:31]
 s_waitcnt vmcnt(14)
 s_barrier
 v_add_u32 v1, 49152, v1
 v_add_u32 v2, 49152, v2
 ds_read_b64_tr_b16 a[112:113], v1 offset:0
 ds_read_b64_tr_b16 a[114:115], v1 offset:1024
 s_waitcnt lgkmcnt(6)
 v_mfma_f32_32x32x16_bf16 a[16:31], a[96:99], a[168:171], a[16:31]
 ds_read_b64_tr_b16 a[116:117], v1 offset:6144
 ds_read_b64_tr_b16 a[118:119], v1 offset:7168
 v_mfma_f32_32x32x16_bf16 a[16:31], a[100:103], a[172:175], a[16:31]
 ds_read_b64_tr_b16 a[120:121], v1 offset:12288
 ds_read_b64_tr_b16 a[122:123], v1 offset:13312
 s_waitcnt lgkmcnt(6)
 v_mfma_f32_32x32x16_bf16 a[16:31], a[104:107], a[176:179], a[16:31]
 ds_read_b64_tr_b16 a[124:125], v1 offset:18432
 ds_read_b64_tr_b16 a[126:127], v1 offset:19456
 v_mfma_f32_32x32x16_bf16 a[16:31], a[108:111], a[180:183], a[16:31]
 s_waitcnt vmcnt(6)
 s_barrier
 ds_read_b64_tr_b16 a[96:97], v1 offset:24576
 ds_read_b64_tr_b16 a[98:99], v1 offset:25600
 s_waitcnt lgkmcnt(6)
 v_mfma_f32_32x32x16_bf16 a[0:15], a[112:115], a[184:187], a[0:15]
 ds_read_b64_tr_b16 a[100:101], v1 offset:30720
 ds_read_b64_tr_b16 a[102:103], v1 offset:31744
 v_mfma_f32_32x32x16_bf16 a[0:15], a[116:119], a[188:191], a[0:15]
 ds_read_b64_tr_b16 a[104:105], v1 offset:36864
 ds_read_b64_tr_b16 a[106:107], v1 offset:37888
 s_waitcnt lgkmcnt(6)
 s_waitcnt vmcnt(5)
 v_mfma_f32_32x32x16_bf16 a[0:15], a[120:123], a[192:195], a[0:15]
 ds_read_b64_tr_b16 a[108:109], v1 offset:43008
 ds_read_b64_tr_b16 a[110:111], v1 offset:44032
 s_waitcnt vmcnt(4)
 v_mfma_f32_32x32x16_bf16 a[0:15], a[124:127], a[196:199], a[0:15]
 ds_read_b64_tr_b16 a[112:113], v2 offset:0
 ds_read_b64_tr_b16 a[114:115], v2 offset:1024
 s_waitcnt lgkmcnt(6)
 s_waitcnt vmcnt(3)
 v_mfma_f32_32x32x16_bf16 a[0:15], a[96:99], a[200:203], a[0:15]
 ds_read_b64_tr_b16 a[116:117], v2 offset:6144
 ds_read_b64_tr_b16 a[118:119], v2 offset:7168
 s_waitcnt vmcnt(2)
 v_mfma_f32_32x32x16_bf16 a[0:15], a[100:103], a[204:207], a[0:15]
 ds_read_b64_tr_b16 a[120:121], v2 offset:12288
 ds_read_b64_tr_b16 a[122:123], v2 offset:13312
 s_waitcnt lgkmcnt(6)
 s_waitcnt vmcnt(1)
 v_mfma_f32_32x32x16_bf16 a[0:15], a[104:107], a[208:211], a[0:15]
 ds_read_b64_tr_b16 a[124:125], v2 offset:18432
 ds_read_b64_tr_b16 a[126:127], v2 offset:19456
 s_waitcnt vmcnt(0)
 v_mfma_f32_32x32x16_bf16 a[0:15], a[108:111], a[212:215], a[0:15]
 ds_read_b64_tr_b16 a[96:97], v2 offset:24576
 ds_read_b64_tr_b16 a[98:99], v2 offset:25600
 s_waitcnt lgkmcnt(6)
 v_mfma_f32_32x32x16_bf16 a[16:31], a[112:115], a[184:187], a[16:31]
 ds_read_b64_tr_b16 a[100:101], v2 offset:30720
 ds_read_b64_tr_b16 a[102:103], v2 offset:31744
 s_mul_i32 s33, s29, 26112
 s_add_u32 s33, s33, s48
 s_add_u32 s34, s33, 4352
 s_add_u32 s35, s33, 8704
 s_add_u32 s42, s33, 13056
 v_mfma_f32_32x32x16_bf16 a[16:31], a[116:119], a[188:191], a[16:31]
 ds_read_b64_tr_b16 a[104:105], v2 offset:36864
 ds_read_b64_tr_b16 a[106:107], v2 offset:37888
 s_waitcnt lgkmcnt(6)
 s_add_u32 s43, s33, 17408
 s_add_u32 s44, s33, 21760
 v_accvgpr_read_b32 v20, a0
 v_accvgpr_read_b32 v21, a1
 v_cvt_pk_bf16_f32 v24, v20, v21
 v_mfma_f32_32x32x16_bf16 a[16:31], a[120:123], a[192:195], a[16:31]
 ds_read_b64_tr_b16 a[108:109], v2 offset:43008
 ds_read_b64_tr_b16 a[110:111], v2 offset:44032
 v_accvgpr_read_b32 v22, a2
 v_accvgpr_read_b32 v23, a3
 v_cvt_pk_bf16_f32 v25, v22, v23
 v_accvgpr_read_b32 v20, a8
 v_accvgpr_read_b32 v21, a9
 v_mfma_f32_32x32x16_bf16 a[16:31], a[124:127], a[196:199], a[16:31]
 ds_read_b64_tr_b16 a[112:113], v1 offset:2048
 ds_read_b64_tr_b16 a[114:115], v1 offset:3072
 s_waitcnt lgkmcnt(6)
 v_cvt_pk_bf16_f32 v26, v20, v21
 buffer_store_dwordx4 v[24:27], v7, s[16:19], s48 offen offset:0 sc1
 v_accvgpr_read_b32 v22, a4
 v_mfma_f32_32x32x16_bf16 a[16:31], a[96:99], a[200:203], a[16:31]
 ds_read_b64_tr_b16 a[116:117], v1 offset:8192
 ds_read_b64_tr_b16 a[118:119], v1 offset:9216
 v_accvgpr_read_b32 v23, a5
 v_cvt_pk_bf16_f32 v28, v22, v23
 v_accvgpr_read_b32 v20, a6
 v_accvgpr_read_b32 v21, a7
 v_cvt_pk_bf16_f32 v29, v20, v21
 v_mfma_f32_32x32x16_bf16 a[16:31], a[100:103], a[204:207], a[16:31]
 ds_read_b64_tr_b16 a[120:121], v1 offset:14336
 ds_read_b64_tr_b16 a[122:123], v1 offset:15360
 s_waitcnt lgkmcnt(6)
 v_accvgpr_read_b32 v22, a10
 v_accvgpr_read_b32 v23, a11
 v_cvt_pk_bf16_f32 v30, v22, v23
 v_mfma_f32_32x32x16_bf16 a[16:31], a[104:107], a[208:211], a[16:31]
 ds_read_b64_tr_b16 a[124:125], v1 offset:20480
 ds_read_b64_tr_b16 a[126:127], v1 offset:21504
 buffer_store_dwordx4 v[28:31], v7, s[16:19], s48 offen offset:256 sc1
 v_accvgpr_read_b32 v20, a12
 v_accvgpr_read_b32 v21, a13
 v_cvt_pk_bf16_f32 v32, v20, v21
 v_mfma_f32_32x32x16_bf16 a[16:31], a[108:111], a[212:215], a[16:31]
 ds_read_b64_tr_b16 a[96:97], v1 offset:26624
 ds_read_b64_tr_b16 a[98:99], v1 offset:27648
 s_waitcnt lgkmcnt(6)
 v_accvgpr_read_b32 v22, a14
 v_accvgpr_read_b32 v23, a15
 v_cvt_pk_bf16_f32 v33, v22, v23
 v_mfma_f32_32x32x16_bf16 a[32:47], a[112:115], a[184:187], a[32:47]
 ds_read_b64_tr_b16 a[100:101], v1 offset:32768
 ds_read_b64_tr_b16 a[102:103], v1 offset:33792
 v_mfma_f32_32x32x16_bf16 a[32:47], a[116:119], a[188:191], a[32:47]
 ds_read_b64_tr_b16 a[104:105], v1 offset:38912
 ds_read_b64_tr_b16 a[106:107], v1 offset:39936
 s_waitcnt lgkmcnt(6)
 v_accvgpr_read_b32 v20, a20
 v_accvgpr_read_b32 v21, a21
 v_cvt_pk_bf16_f32 v34, v20, v21
 v_mfma_f32_32x32x16_bf16 a[32:47], a[120:123], a[192:195], a[32:47]
 ds_read_b64_tr_b16 a[108:109], v1 offset:45056
 ds_read_b64_tr_b16 a[110:111], v1 offset:46080
 buffer_store_dwordx4 v[32:35], v7, s[16:19], s48 offen offset:512 sc1
 v_accvgpr_read_b32 v22, a16
 v_accvgpr_read_b32 v23, a17
 v_mfma_f32_32x32x16_bf16 a[32:47], a[124:127], a[196:199], a[32:47]
 v_add_u32 v1, -49152, v1
 v_add_u32 v2, -49152, v2
 ds_read_b64_tr_b16 a[112:113], v1 offset:2048
 ds_read_b64_tr_b16 a[114:115], v1 offset:3072
 s_waitcnt lgkmcnt(6)
 v_cvt_pk_bf16_f32 v36, v22, v23
 v_accvgpr_read_b32 v20, a18
 v_accvgpr_read_b32 v21, a19
 v_cvt_pk_bf16_f32 v37, v20, v21
 v_accvgpr_read_b32 v22, a22
 v_mfma_f32_32x32x16_bf16 a[32:47], a[96:99], a[200:203], a[32:47]
 ds_read_b64_tr_b16 a[116:117], v1 offset:8192
 ds_read_b64_tr_b16 a[118:119], v1 offset:9216
 v_accvgpr_read_b32 v23, a23
 v_cvt_pk_bf16_f32 v38, v22, v23
 v_mfma_f32_32x32x16_bf16 a[32:47], a[100:103], a[204:207], a[32:47]
 ds_read_b64_tr_b16 a[120:121], v1 offset:14336
 ds_read_b64_tr_b16 a[122:123], v1 offset:15360
 s_waitcnt lgkmcnt(6)
 v_mfma_f32_32x32x16_bf16 a[32:47], a[104:107], a[208:211], a[32:47]
 ds_read_b64_tr_b16 a[124:125], v1 offset:20480
 ds_read_b64_tr_b16 a[126:127], v1 offset:21504
 buffer_store_dwordx4 v[36:39], v7, s[16:19], s48 offen offset:768 sc1
 v_accvgpr_read_b32 v20, a24
 v_accvgpr_read_b32 v21, a25
 v_mfma_f32_32x32x16_bf16 a[32:47], a[108:111], a[212:215], a[32:47]
 ds_read_b64_tr_b16 a[96:97], v1 offset:26624
 ds_read_b64_tr_b16 a[98:99], v1 offset:27648
 s_waitcnt lgkmcnt(6)
 v_cvt_pk_bf16_f32 v40, v20, v21
 v_accvgpr_read_b32 v22, a26
 v_accvgpr_read_b32 v23, a27
 v_cvt_pk_bf16_f32 v41, v22, v23
 v_mfma_f32_32x32x16_bf16 a[32:47], a[112:115], a[152:155], a[32:47]
 ds_read_b64_tr_b16 a[100:101], v1 offset:32768
 ds_read_b64_tr_b16 a[102:103], v1 offset:33792
 v_mfma_f32_32x32x16_bf16 a[32:47], a[116:119], a[156:159], a[32:47]
 ds_read_b64_tr_b16 a[104:105], v1 offset:38912
 ds_read_b64_tr_b16 a[106:107], v1 offset:39936
 s_waitcnt lgkmcnt(6)
 v_mfma_f32_32x32x16_bf16 a[32:47], a[120:123], a[160:163], a[32:47]
 ds_read_b64_tr_b16 a[108:109], v1 offset:45056
 ds_read_b64_tr_b16 a[110:111], v1 offset:46080
 v_mfma_f32_32x32x16_bf16 a[32:47], a[124:127], a[164:167], a[32:47]
 ds_read_b64_tr_b16 a[112:113], v2 offset:2048
 ds_read_b64_tr_b16 a[114:115], v2 offset:3072
 s_waitcnt lgkmcnt(6)
 v_mfma_f32_32x32x16_bf16 a[32:47], a[96:99], a[168:171], a[32:47]
 ds_read_b64_tr_b16 a[116:117], v2 offset:8192
 ds_read_b64_tr_b16 a[118:119], v2 offset:9216
 v_mfma_f32_32x32x16_bf16 a[32:47], a[100:103], a[172:175], a[32:47]
 ds_read_b64_tr_b16 a[120:121], v2 offset:14336
 ds_read_b64_tr_b16 a[122:123], v2 offset:15360
 s_waitcnt lgkmcnt(6)
 v_mfma_f32_32x32x16_bf16 a[32:47], a[104:107], a[176:179], a[32:47]
 ds_read_b64_tr_b16 a[124:125], v2 offset:20480
 ds_read_b64_tr_b16 a[126:127], v2 offset:21504
 v_mfma_f32_32x32x16_bf16 a[32:47], a[108:111], a[180:183], a[32:47]
 ds_read_b64_tr_b16 a[96:97], v2 offset:26624
 ds_read_b64_tr_b16 a[98:99], v2 offset:27648
 s_waitcnt lgkmcnt(6)
 v_mfma_f32_32x32x16_bf16 a[48:63], a[112:115], a[152:155], a[48:63]
 ds_read_b64_tr_b16 a[100:101], v2 offset:32768
 ds_read_b64_tr_b16 a[102:103], v2 offset:33792
 v_mfma_f32_32x32x16_bf16 a[48:63], a[116:119], a[156:159], a[48:63]
 ds_read_b64_tr_b16 a[104:105], v2 offset:38912
 ds_read_b64_tr_b16 a[106:107], v2 offset:39936
 s_waitcnt lgkmcnt(6)
 s_nop 1
 v_accvgpr_read_b32 v20, a32
 v_accvgpr_read_b32 v21, a33
 v_cvt_pk_bf16_f32 v42, v20, v21
 v_mfma_f32_32x32x16_bf16 a[48:63], a[120:123], a[160:163], a[48:63]
 ds_read_b64_tr_b16 a[108:109], v2 offset:45056
 ds_read_b64_tr_b16 a[110:111], v2 offset:46080
 buffer_store_dwordx4 v[40:43], v7, s[16:19], s48 offen offset:1024 sc1
 v_accvgpr_read_b32 v22, a28
 v_accvgpr_read_b32 v23, a29
 v_cvt_pk_bf16_f32 v44, v22, v23
 v_mfma_f32_32x32x16_bf16 a[48:63], a[124:127], a[164:167], a[48:63]
 v_add_u32 v1, 49152, v1
 v_add_u32 v2, 49152, v2
 ds_read_b64_tr_b16 a[112:113], v2 offset:2048
 ds_read_b64_tr_b16 a[114:115], v2 offset:3072
 s_waitcnt lgkmcnt(6)
 v_accvgpr_read_b32 v20, a30
 v_accvgpr_read_b32 v21, a31
 v_cvt_pk_bf16_f32 v45, v20, v21
 v_accvgpr_read_b32 v22, a34
 v_accvgpr_read_b32 v23, a35
 v_mfma_f32_32x32x16_bf16 a[48:63], a[96:99], a[168:171], a[48:63]
 ds_read_b64_tr_b16 a[116:117], v2 offset:8192
 ds_read_b64_tr_b16 a[118:119], v2 offset:9216
 v_cvt_pk_bf16_f32 v46, v22, v23
 buffer_store_dwordx4 v[44:47], v7, s[16:19], s48 offen offset:1280 sc1
 v_accvgpr_read_b32 v20, a36
 v_mfma_f32_32x32x16_bf16 a[48:63], a[100:103], a[172:175], a[48:63]
 ds_read_b64_tr_b16 a[120:121], v2 offset:14336
 ds_read_b64_tr_b16 a[122:123], v2 offset:15360
 s_waitcnt lgkmcnt(6)
 v_accvgpr_read_b32 v21, a37
 v_cvt_pk_bf16_f32 v48, v20, v21
 v_accvgpr_read_b32 v22, a38
 v_accvgpr_read_b32 v23, a39
 v_cvt_pk_bf16_f32 v49, v22, v23
 v_mfma_f32_32x32x16_bf16 a[48:63], a[104:107], a[176:179], a[48:63]
 ds_read_b64_tr_b16 a[124:125], v2 offset:20480
 ds_read_b64_tr_b16 a[126:127], v2 offset:21504
 v_accvgpr_read_b32 v20, a44
 v_accvgpr_read_b32 v21, a45
 v_cvt_pk_bf16_f32 v50, v20, v21
 v_mfma_f32_32x32x16_bf16 a[48:63], a[108:111], a[180:183], a[48:63]
 ds_read_b64_tr_b16 a[96:97], v2 offset:26624
 ds_read_b64_tr_b16 a[98:99], v2 offset:27648
 s_waitcnt lgkmcnt(6)
 buffer_store_dwordx4 v[48:51], v7, s[16:19], s48 offen offset:1536 sc1
 v_accvgpr_read_b32 v22, a40
 v_accvgpr_read_b32 v23, a41
 v_mfma_f32_32x32x16_bf16 a[48:63], a[112:115], a[184:187], a[48:63]
 ds_read_b64_tr_b16 a[100:101], v2 offset:32768
 ds_read_b64_tr_b16 a[102:103], v2 offset:33792
 v_cvt_pk_bf16_f32 v52, v22, v23
 v_accvgpr_read_b32 v20, a42
 v_accvgpr_read_b32 v21, a43
 v_cvt_pk_bf16_f32 v53, v20, v21
 v_accvgpr_read_b32 v22, a46
 v_accvgpr_read_b32 v23, a47
 v_mfma_f32_32x32x16_bf16 a[48:63], a[116:119], a[188:191], a[48:63]
 ds_read_b64_tr_b16 a[104:105], v2 offset:38912
 ds_read_b64_tr_b16 a[106:107], v2 offset:39936
 s_waitcnt lgkmcnt(6)
 v_cvt_pk_bf16_f32 v54, v22, v23
 buffer_store_dwordx4 v[52:55], v7, s[16:19], s48 offen offset:1792 sc1
 v_mfma_f32_32x32x16_bf16 a[48:63], a[120:123], a[192:195], a[48:63]
 ds_read_b64_tr_b16 a[108:109], v2 offset:45056
 ds_read_b64_tr_b16 a[110:111], v2 offset:46080
 buffer_store_dword v98, v96, s[16:19], s48 offen sc1
 v_mfma_f32_32x32x16_bf16 a[48:63], a[124:127], a[196:199], a[48:63]
 ds_read_b64_tr_b16 a[112:113], v1 offset:4096
 ds_read_b64_tr_b16 a[114:115], v1 offset:5120
 s_waitcnt lgkmcnt(6)
 v_mfma_f32_32x32x16_bf16 a[48:63], a[96:99], a[200:203], a[48:63]
 ds_read_b64_tr_b16 a[116:117], v1 offset:10240
 ds_read_b64_tr_b16 a[118:119], v1 offset:11264
 v_mfma_f32_32x32x16_bf16 a[48:63], a[100:103], a[204:207], a[48:63]
 ds_read_b64_tr_b16 a[120:121], v1 offset:16384
 ds_read_b64_tr_b16 a[122:123], v1 offset:17408
 s_waitcnt lgkmcnt(6)
 v_mfma_f32_32x32x16_bf16 a[48:63], a[104:107], a[208:211], a[48:63]
 ds_read_b64_tr_b16 a[124:125], v1 offset:22528
 ds_read_b64_tr_b16 a[126:127], v1 offset:23552
 v_mfma_f32_32x32x16_bf16 a[48:63], a[108:111], a[212:215], a[48:63]
 ds_read_b64_tr_b16 a[96:97], v1 offset:28672
 ds_read_b64_tr_b16 a[98:99], v1 offset:29696
 s_waitcnt lgkmcnt(6)
 v_mfma_f32_32x32x16_bf16 a[64:79], a[112:115], a[184:187], a[64:79]
 ds_read_b64_tr_b16 a[100:101], v1 offset:34816
 ds_read_b64_tr_b16 a[102:103], v1 offset:35840
 v_mfma_f32_32x32x16_bf16 a[64:79], a[116:119], a[188:191], a[64:79]
 ds_read_b64_tr_b16 a[104:105], v1 offset:40960
 ds_read_b64_tr_b16 a[106:107], v1 offset:41984
 s_waitcnt lgkmcnt(6)
 s_nop 1
 v_accvgpr_read_b32 v20, a48
 v_accvgpr_read_b32 v21, a49
 v_cvt_pk_bf16_f32 v56, v20, v21
 v_accvgpr_read_b32 v22, a50
 v_mfma_f32_32x32x16_bf16 a[64:79], a[120:123], a[192:195], a[64:79]
 ds_read_b64_tr_b16 a[108:109], v1 offset:47104
 ds_read_b64_tr_b16 a[110:111], v1 offset:48128
 v_accvgpr_read_b32 v23, a51
 v_cvt_pk_bf16_f32 v57, v22, v23
 v_accvgpr_read_b32 v20, a56
 v_accvgpr_read_b32 v21, a57
 v_cvt_pk_bf16_f32 v58, v20, v21
 v_mfma_f32_32x32x16_bf16 a[64:79], a[124:127], a[196:199], a[64:79]
 v_add_u32 v1, -49152, v1
 v_add_u32 v2, -49152, v2
 ds_read_b64_tr_b16 a[112:113], v1 offset:4096
 ds_read_b64_tr_b16 a[114:115], v1 offset:5120
 s_waitcnt lgkmcnt(6)
 buffer_store_dwordx4 v[56:59], v7, s[16:19], s48 offen offset:2048 sc1
 v_accvgpr_read_b32 v22, a52
 v_accvgpr_read_b32 v23, a53
 v_mfma_f32_32x32x16_bf16 a[64:79], a[96:99], a[200:203], a[64:79]
 ds_read_b64_tr_b16 a[116:117], v1 offset:10240
 ds_read_b64_tr_b16 a[118:119], v1 offset:11264
 v_cvt_pk_bf16_f32 v60, v22, v23
 v_accvgpr_read_b32 v20, a54
 v_accvgpr_read_b32 v21, a55
 v_cvt_pk_bf16_f32 v61, v20, v21
 v_accvgpr_read_b32 v22, a58
 v_accvgpr_read_b32 v23, a59
 v_mfma_f32_32x32x16_bf16 a[64:79], a[100:103], a[204:207], a[64:79]
 ds_read_b64_tr_b16 a[120:121], v1 offset:16384
 ds_read_b64_tr_b16 a[122:123], v1 offset:17408
 s_waitcnt lgkmcnt(6)
 v_cvt_pk_bf16_f32 v62, v22, v23
 buffer_store_dwordx4 v[60:63], v7, s[16:19], s48 offen offset:2304 sc1
 v_mfma_f32_32x32x16_bf16 a[64:79], a[104:107], a[208:211], a[64:79]
 ds_read_b64_tr_b16 a[124:125], v1 offset:22528
 ds_read_b64_tr_b16 a[126:127], v1 offset:23552
 v_accvgpr_read_b32 v20, a60
 v_accvgpr_read_b32 v21, a61
 v_cvt_pk_bf16_f32 v64, v20, v21
 v_accvgpr_read_b32 v22, a62
 v_accvgpr_read_b32 v23, a63
 v_cvt_pk_bf16_f32 v65, v22, v23
 v_mfma_f32_32x32x16_bf16 a[64:79], a[108:111], a[212:215], a[64:79]
 ds_read_b64_tr_b16 a[96:97], v1 offset:28672
 ds_read_b64_tr_b16 a[98:99], v1 offset:29696
 s_waitcnt lgkmcnt(6)
 v_mfma_f32_32x32x16_bf16 a[64:79], a[112:115], a[152:155], a[64:79]
 ds_read_b64_tr_b16 a[100:101], v1 offset:34816
 ds_read_b64_tr_b16 a[102:103], v1 offset:35840
 v_mfma_f32_32x32x16_bf16 a[64:79], a[116:119], a[156:159], a[64:79]
 ds_read_b64_tr_b16 a[104:105], v1 offset:40960
 ds_read_b64_tr_b16 a[106:107], v1 offset:41984
 s_waitcnt lgkmcnt(6)
 v_mfma_f32_32x32x16_bf16 a[64:79], a[120:123], a[160:163], a[64:79]
 ds_read_b64_tr_b16 a[108:109], v1 offset:47104
 ds_read_b64_tr_b16 a[110:111], v1 offset:48128
 v_mfma_f32_32x32x16_bf16 a[64:79], a[124:127], a[164:167], a[64:79]
 ds_read_b64_tr_b16 a[112:113], v2 offset:4096
 ds_read_b64_tr_b16 a[114:115], v2 offset:5120
 s_waitcnt lgkmcnt(6)
 v_mfma_f32_32x32x16_bf16 a[64:79], a[96:99], a[168:171], a[64:79]
 ds_read_b64_tr_b16 a[116:117], v2 offset:10240
 ds_read_b64_tr_b16 a[118:119], v2 offset:11264
 v_mfma_f32_32x32x16_bf16 a[64:79], a[100:103], a[172:175], a[64:79]
 ds_read_b64_tr_b16 a[120:121], v2 offset:16384
 ds_read_b64_tr_b16 a[122:123], v2 offset:17408
 s_waitcnt lgkmcnt(6)
 v_mfma_f32_32x32x16_bf16 a[64:79], a[104:107], a[176:179], a[64:79]
 ds_read_b64_tr_b16 a[124:125], v2 offset:22528
 ds_read_b64_tr_b16 a[126:127], v2 offset:23552
 v_mfma_f32_32x32x16_bf16 a[64:79], a[108:111], a[180:183], a[64:79]
 ds_read_b64_tr_b16 a[96:97], v2 offset:28672
 ds_read_b64_tr_b16 a[98:99], v2 offset:29696
 s_waitcnt lgkmcnt(6)
 v_mfma_f32_32x32x16_bf16 a[80:95], a[112:115], a[152:155], a[80:95]
 ds_read_b64_tr_b16 a[100:101], v2 offset:34816
 ds_read_b64_tr_b16 a[102:103], v2 offset:35840
 v_mfma_f32_32x32x16_bf16 a[80:95], a[116:119], a[156:159], a[80:95]
 ds_read_b64_tr_b16 a[104:105], v2 offset:40960
 ds_read_b64_tr_b16 a[106:107], v2 offset:41984
 s_waitcnt lgkmcnt(6)
 s_nop 1
 v_accvgpr_read_b32 v20, a68
 v_accvgpr_read_b32 v21, a69
 v_cvt_pk_bf16_f32 v66, v20, v21
 v_mfma_f32_32x32x16_bf16 a[80:95], a[120:123], a[160:163], a[80:95]
 ds_read_b64_tr_b16 a[108:109], v2 offset:47104
 ds_read_b64_tr_b16 a[110:111], v2 offset:48128
 buffer_store_dwordx4 v[64:67], v7, s[16:19], s48 offen offset:2560 sc1
 v_accvgpr_read_b32 v22, a64
 v_accvgpr_read_b32 v23, a65
 v_cvt_pk_bf16_f32 v68, v22, v23
 v_mfma_f32_32x32x16_bf16 a[80:95], a[124:127], a[164:167], a[80:95]
 v_add_u32 v1, 49152, v1
 v_add_u32 v2, 49152, v2
 ds_read_b64_tr_b16 a[112:113], v2 offset:4096
 ds_read_b64_tr_b16 a[114:115], v2 offset:5120
 s_waitcnt lgkmcnt(6)
 v_accvgpr_read_b32 v20, a66
 v_accvgpr_read_b32 v21, a67
 v_cvt_pk_bf16_f32 v69, v20, v21
 v_accvgpr_read_b32 v22, a70
 v_accvgpr_read_b32 v23, a71
 v_mfma_f32_32x32x16_bf16 a[80:95], a[96:99], a[168:171], a[80:95]
 ds_read_b64_tr_b16 a[116:117], v2 offset:10240
 ds_read_b64_tr_b16 a[118:119], v2 offset:11264
 v_cvt_pk_bf16_f32 v70, v22, v23
 buffer_store_dwordx4 v[68:71], v7, s[16:19], s48 offen offset:2816 sc1
 v_accvgpr_read_b32 v20, a72
 v_mfma_f32_32x32x16_bf16 a[80:95], a[100:103], a[172:175], a[80:95]
 ds_read_b64_tr_b16 a[120:121], v2 offset:16384
 ds_read_b64_tr_b16 a[122:123], v2 offset:17408
 s_waitcnt lgkmcnt(6)
 v_accvgpr_read_b32 v21, a73
 v_cvt_pk_bf16_f32 v72, v20, v21
 v_accvgpr_read_b32 v22, a74
 v_accvgpr_read_b32 v23, a75
 v_cvt_pk_bf16_f32 v73, v22, v23
 v_mfma_f32_32x32x16_bf16 a[80:95], a[104:107], a[176:179], a[80:95]
 ds_read_b64_tr_b16 a[124:125], v2 offset:22528
 ds_read_b64_tr_b16 a[126:127], v2 offset:23552
 v_mfma_f32_32x32x16_bf16 a[80:95], a[108:111], a[180:183], a[80:95]
 ds_read_b64_tr_b16 a[96:97], v2 offset:28672
 ds_read_b64_tr_b16 a[98:99], v2 offset:29696
 s_waitcnt lgkmcnt(6)
 v_mfma_f32_32x32x16_bf16 a[80:95], a[112:115], a[184:187], a[80:95]
 ds_read_b64_tr_b16 a[100:101], v2 offset:34816
 ds_read_b64_tr_b16 a[102:103], v2 offset:35840
 v_mfma_f32_32x32x16_bf16 a[80:95], a[116:119], a[188:191], a[80:95]
 ds_read_b64_tr_b16 a[104:105], v2 offset:40960
 ds_read_b64_tr_b16 a[106:107], v2 offset:41984
 s_waitcnt lgkmcnt(6)
 v_mfma_f32_32x32x16_bf16 a[80:95], a[120:123], a[192:195], a[80:95]
 ds_read_b64_tr_b16 a[108:109], v2 offset:47104
 ds_read_b64_tr_b16 a[110:111], v2 offset:48128
 v_mfma_f32_32x32x16_bf16 a[80:95], a[124:127], a[196:199], a[80:95]
 s_waitcnt lgkmcnt(4)
 v_mfma_f32_32x32x16_bf16 a[80:95], a[96:99], a[200:203], a[80:95]
 v_mfma_f32_32x32x16_bf16 a[80:95], a[100:103], a[204:207], a[80:95]
 s_waitcnt lgkmcnt(0)
 v_mfma_f32_32x32x16_bf16 a[80:95], a[104:107], a[208:211], a[80:95]
 v_mfma_f32_32x32x16_bf16 a[80:95], a[108:111], a[212:215], a[80:95]
 buffer_load_dword v16, v97, s[16:19], s44 offen sc1
 s_nop 10
 v_accvgpr_read_b32 v20, a80
 v_accvgpr_read_b32 v21, a81
 v_cvt_pk_bf16_f32 v74, v20, v21
 buffer_store_dwordx4 v[72:75], v7, s[16:19], s48 offen offset:3072 sc1
 v_accvgpr_read_b32 v22, a76
 v_accvgpr_read_b32 v23, a77
 v_cvt_pk_bf16_f32 v76, v22, v23
 v_accvgpr_read_b32 v20, a78
 v_accvgpr_read_b32 v21, a79
 v_cvt_pk_bf16_f32 v77, v20, v21
 v_accvgpr_read_b32 v22, a82
 v_accvgpr_read_b32 v23, a83
 v_cvt_pk_bf16_f32 v78, v22, v23
 buffer_store_dwordx4 v[76:79], v7, s[16:19], s48 offen offset:3328 sc1
 v_accvgpr_read_b32 v20, a84
 v_accvgpr_read_b32 v21, a85
 v_cvt_pk_bf16_f32 v80, v20, v21
 v_accvgpr_read_b32 v22, a86
 v_accvgpr_read_b32 v23, a87
 v_cvt_pk_bf16_f32 v81, v22, v23
 v_accvgpr_read_b32 v20, a92
 v_accvgpr_read_b32 v21, a93
 v_cvt_pk_bf16_f32 v82, v20, v21
 buffer_store_dwordx4 v[80:83], v7, s[16:19], s48 offen offset:3584 sc1
 v_accvgpr_read_b32 v22, a88
 v_accvgpr_read_b32 v23, a89
 v_cvt_pk_bf16_f32 v84, v22, v23
 v_accvgpr_read_b32 v20, a90
 v_accvgpr_read_b32 v21, a91
 v_cvt_pk_bf16_f32 v85, v20, v21
 v_accvgpr_read_b32 v22, a94
 v_accvgpr_read_b32 v23, a95
 v_cvt_pk_bf16_f32 v86, v22, v23
 buffer_store_dwordx4 v[84:87], v7, s[16:19], s48 offen offset:3840 sc1
 buffer_store_dword v99, v96, s[16:19], s48 offen sc1
 s_lshl_b32 s38, s29, 3
 s_lshl_b32 s38, 0xff, s38
 s_mov_b32 exec_lo, s38
 s_mov_b32 exec_hi, s38
 ds_write_b96 v10, v[24:26] offset:0
 ds_write_b96 v10, v[28:30] offset:256
 ds_write_b96 v10, v[32:34] offset:512
 ds_write_b96 v10, v[36:38] offset:768
 ds_write_b96 v10, v[40:42] offset:1024
 ds_write_b96 v10, v[44:46] offset:1280
 ds_write_b96 v10, v[48:50] offset:1536
 ds_write_b96 v10, v[52:54] offset:1792
 ds_write_b96 v10, v[56:58] offset:2048
 ds_write_b96 v10, v[60:62] offset:2304
 ds_write_b96 v10, v[64:66] offset:2560
 ds_write_b96 v10, v[68:70] offset:2816
 ds_write_b96 v10, v[72:74] offset:3072
 ds_write_b96 v10, v[76:78] offset:3328
 ds_write_b96 v10, v[80:82] offset:3584
 ds_write_b96 v10, v[84:86] offset:3840
 s_mov_b64 exec, -1
 ds_read_b128 v[168:171], v12 offset:0
 ds_read_b128 v[172:175], v12 offset:1024
 ds_read_b128 v[176:179], v12 offset:2048
 ds_read_b128 v[180:183], v12 offset:3072
 s_and_b32 s25, s25, 0xffff
 s_mov_b32 s26, 0x480000
 s_mov_b32 s27, 0x20000
 s_waitcnt vmcnt(5)
 s_waitcnt lgkmcnt(0)
L_tl:
 v_sub_u32 v20, v16, v98
 v_cmp_ne_u32 vcc, 1, v20
 s_and_b64 vcc, vcc, 7
 s_cbranch_vccnz L_tBa
L_tBa_b:
 buffer_load_dwordx4 v[120:123], v11, s[16:19], s33 offen offset:0 sc1
 buffer_load_dwordx4 v[124:127], v11, s[16:19], s34 offen offset:0 sc1
 buffer_load_dwordx4 v[128:131], v11, s[16:19], s35 offen offset:0 sc1
 buffer_load_dwordx4 v[144:147], v11, s[16:19], s33 offen offset:1024 sc1
 buffer_load_dwordx4 v[148:151], v11, s[16:19], s34 offen offset:1024 sc1
 buffer_load_dwordx4 v[152:155], v11, s[16:19], s35 offen offset:1024 sc1
 buffer_load_dwordx4 v[24:27], v11, s[16:19], s33 offen offset:2048 sc1
 buffer_load_dwordx4 v[28:31], v11, s[16:19], s34 offen offset:2048 sc1
 buffer_load_dwordx4 v[32:35], v11, s[16:19], s35 offen offset:2048 sc1
 buffer_load_dwordx4 v[48:51], v11, s[16:19], s33 offen offset:3072 sc1
 buffer_load_dwordx4 v[52:55], v11, s[16:19], s34 offen offset:3072 sc1
 buffer_load_dwordx4 v[56:59], v11, s[16:19], s35 offen offset:3072 sc1
 v_sub_u32 v20, v16, v98
 v_cmp_lt_u32 vcc, 1, v20
 s_cbranch_vccnz L_tBb
L_tBb_b:
 buffer_load_dwordx4 v[132:135], v11, s[16:19], s42 offen offset:0 sc1
 buffer_load_dwordx4 v[136:139], v11, s[16:19], s43 offen offset:0 sc1
 buffer_load_dwordx4 v[140:143], v11, s[16:19], s44 offen offset:0 sc1
 buffer_load_dwordx4 v[156:159], v11, s[16:19], s42 offen offset:1024 sc1
 buffer_load_dwordx4 v[160:163], v11, s[16:19], s43 offen offset:1024 sc1
 buffer_load_dwordx4 v[164:167], v11, s[16:19], s44 offen offset:1024 sc1
 buffer_load_dword v16, v97, s[16:19], s44 offen sc1
 v_dot2_f32_bf16 v232, v168, v14, v232
 v_dot2_f32_bf16 v233, v168, v15, v233
 v_dot2_f32_bf16 v234, v169, v14, v234
 v_dot2_f32_bf16 v235, v169, v15, v235
 v_dot2_f32_bf16 v248, v170, v14, v248
 v_dot2_f32_bf16 v249, v170, v15, v249
 v_dot2_f32_bf16 v236, v172, v14, v236
 v_dot2_f32_bf16 v237, v172, v15, v237
 v_dot2_f32_bf16 v238, v173, v14, v238
 v_dot2_f32_bf16 v239, v173, v15, v239
 v_dot2_f32_bf16 v250, v174, v14, v250
 v_dot2_f32_bf16 v251, v174, v15, v251
 v_dot2_f32_bf16 v240, v176, v14, v240
 v_dot2_f32_bf16 v241, v176, v15, v241
 v_dot2_f32_bf16 v242, v177, v14, v242
 v_dot2_f32_bf16 v243, v177, v15, v243
 v_dot2_f32_bf16 v252, v178, v14, v252
 v_dot2_f32_bf16 v253, v178, v15, v253
 v_dot2_f32_bf16 v244, v180, v14, v244
 v_dot2_f32_bf16 v245, v180, v15, v245
 v_dot2_f32_bf16 v246, v181, v14, v246
 v_dot2_f32_bf16 v247, v181, v15, v247
 v_dot2_f32_bf16 v254, v182, v14, v254
 v_dot2_f32_bf16 v255, v182, v15, v255
 s_waitcnt vmcnt(17)
 v_bitop3_b32 v20, v123, v127, s45 bitop3:0x7e
 s_waitcnt vmcnt(16)
 v_bitop3_b32 v20, v20, v131, s45 bitop3:0xf6
 v_cmp_ne_u32 vcc, 0, v20
 s_cbranch_vccnz L_uB00
L_uB00_b:
 v_dot2_f32_bf16 v232, v120, v14, v232
 v_dot2_f32_bf16 v233, v120, v15, v233
 v_dot2_f32_bf16 v234, v121, v14, v234
 v_dot2_f32_bf16 v235, v121, v15, v235
 v_dot2_f32_bf16 v248, v122, v14, v248
 v_dot2_f32_bf16 v249, v122, v15, v249
 v_dot2_f32_bf16 v232, v124, v14, v232
 v_dot2_f32_bf16 v233, v124, v15, v233
 v_dot2_f32_bf16 v234, v125, v14, v234
 v_dot2_f32_bf16 v235, v125, v15, v235
 v_dot2_f32_bf16 v248, v126, v14, v248
 v_dot2_f32_bf16 v249, v126, v15, v249
 v_dot2_f32_bf16 v232, v128, v14, v232
 v_dot2_f32_bf16 v233, v128, v15, v233
 v_dot2_f32_bf16 v234, v129, v14, v234
 v_dot2_f32_bf16 v235, v129, v15, v235
 v_dot2_f32_bf16 v248, v130, v14, v248
 v_dot2_f32_bf16 v249, v130, v15, v249
 v_mul_f32 v88, 0xbfb8aa3b, v232
 v_mul_f32 v89, 0xbfb8aa3b, v233
 v_mul_f32 v90, 0xbfb8aa3b, v234
 v_mul_f32 v91, 0xbfb8aa3b, v235
 v_mul_f32 v92, 0xbfb8aa3b, v248
 v_mul_f32 v93, 0xbfb8aa3b, v249
 v_exp_f32 v88, v88
 v_exp_f32 v89, v89
 v_exp_f32 v90, v90
 v_exp_f32 v91, v91
 v_exp_f32 v92, v92
 v_exp_f32 v93, v93
 v_add_f32 v88, 1.0, v88
 v_add_f32 v89, 1.0, v89
 v_add_f32 v90, 1.0, v90
 v_add_f32 v91, 1.0, v91
 v_add_f32 v92, 1.0, v92
 v_add_f32 v93, 1.0, v93
 v_rcp_f32 v88, v88
 v_rcp_f32 v89, v89
 v_rcp_f32 v90, v90
 v_rcp_f32 v91, v91
 v_rcp_f32 v92, v92
 v_rcp_f32 v93, v93
 v_mul_f32 v232, v232, v88
 v_mul_f32 v233, v233, v89
 v_mul_f32 v234, v234, v90
 v_mul_f32 v235, v235, v91
 v_mul_f32 v248, v248, v92
 v_mul_f32 v249, v249, v93
 s_waitcnt vmcnt(14)
 v_bitop3_b32 v20, v147, v151, s45 bitop3:0x7e
 s_waitcnt vmcnt(13)
 v_bitop3_b32 v20, v20, v155, s45 bitop3:0xf6
 v_cmp_ne_u32 vcc, 0, v20
 s_cbranch_vccnz L_uB10
L_uB10_b:
 v_dot2_f32_bf16 v236, v144, v14, v236
 v_dot2_f32_bf16 v237, v144, v15, v237
 v_dot2_f32_bf16 v238, v145, v14, v238
 v_dot2_f32_bf16 v239, v145, v15, v239
 v_dot2_f32_bf16 v250, v146, v14, v250
 v_dot2_f32_bf16 v251, v146, v15, v251
 v_dot2_f32_bf16 v236, v148, v14, v236
 v_dot2_f32_bf16 v237, v148, v15, v237
 v_dot2_f32_bf16 v238, v149, v14, v238
 v_dot2_f32_bf16 v239, v149, v15, v239
 v_dot2_f32_bf16 v250, v150, v14, v250
 v_dot2_f32_bf16 v251, v150, v15, v251
 v_dot2_f32_bf16 v236, v152, v14, v236
 v_dot2_f32_bf16 v237, v152, v15, v237
 v_dot2_f32_bf16 v238, v153, v14, v238
 v_dot2_f32_bf16 v239, v153, v15, v239
 v_dot2_f32_bf16 v250, v154, v14, v250
 v_dot2_f32_bf16 v251, v154, v15, v251
 v_mul_f32 v88, 0xbfb8aa3b, v236
 v_mul_f32 v89, 0xbfb8aa3b, v237
 v_mul_f32 v90, 0xbfb8aa3b, v238
 v_mul_f32 v91, 0xbfb8aa3b, v239
 v_mul_f32 v92, 0xbfb8aa3b, v250
 v_mul_f32 v93, 0xbfb8aa3b, v251
 v_exp_f32 v88, v88
 v_exp_f32 v89, v89
 v_exp_f32 v90, v90
 v_exp_f32 v91, v91
 v_exp_f32 v92, v92
 v_exp_f32 v93, v93
 v_add_f32 v88, 1.0, v88
 v_add_f32 v89, 1.0, v89
 v_add_f32 v90, 1.0, v90
 v_add_f32 v91, 1.0, v91
 v_add_f32 v92, 1.0, v92
 v_add_f32 v93, 1.0, v93
 v_rcp_f32 v88, v88
 v_rcp_f32 v89, v89
 v_rcp_f32 v90, v90
 v_rcp_f32 v91, v91
 v_rcp_f32 v92, v92
 v_rcp_f32 v93, v93
 v_mul_f32 v236, v236, v88
 v_mul_f32 v237, v237, v89
 v_mul_f32 v238, v238, v90
 v_mul_f32 v239, v239, v91
 v_mul_f32 v250, v250, v92
 v_mul_f32 v251, v251, v93
 s_waitcnt vmcnt(11)
 v_bitop3_b32 v20, v27, v31, s45 bitop3:0x7e
 s_waitcnt vmcnt(10)
 v_bitop3_b32 v20, v20, v35, s45 bitop3:0xf6
 v_cmp_ne_u32 vcc, 0, v20
 s_cbranch_vccnz L_uB20
L_uB20_b:
 v_dot2_f32_bf16 v240, v24, v14, v240
 v_dot2_f32_bf16 v241, v24, v15, v241
 v_dot2_f32_bf16 v242, v25, v14, v242
 v_dot2_f32_bf16 v243, v25, v15, v243
 v_dot2_f32_bf16 v252, v26, v14, v252
 v_dot2_f32_bf16 v253, v26, v15, v253
 v_dot2_f32_bf16 v240, v28, v14, v240
 v_dot2_f32_bf16 v241, v28, v15, v241
 v_dot2_f32_bf16 v242, v29, v14, v242
 v_dot2_f32_bf16 v243, v29, v15, v243
 v_dot2_f32_bf16 v252, v30, v14, v252
 v_dot2_f32_bf16 v253, v30, v15, v253
 v_dot2_f32_bf16 v240, v32, v14, v240
 v_dot2_f32_bf16 v241, v32, v15, v241
 v_dot2_f32_bf16 v242, v33, v14, v242
 v_dot2_f32_bf16 v243, v33, v15, v243
 v_dot2_f32_bf16 v252, v34, v14, v252
 v_dot2_f32_bf16 v253, v34, v15, v253
 v_mul_f32 v88, 0xbfb8aa3b, v240
 v_mul_f32 v89, 0xbfb8aa3b, v241
 v_mul_f32 v90, 0xbfb8aa3b, v242
 v_mul_f32 v91, 0xbfb8aa3b, v243
 v_mul_f32 v92, 0xbfb8aa3b, v252
 v_mul_f32 v93, 0xbfb8aa3b, v253
 v_exp_f32 v88, v88
 v_exp_f32 v89, v89
 v_exp_f32 v90, v90
 v_exp_f32 v91, v91
 v_exp_f32 v92, v92
 v_exp_f32 v93, v93
 v_add_f32 v88, 1.0, v88
 v_add_f32 v89, 1.0, v89
 v_add_f32 v90, 1.0, v90
 v_add_f32 v91, 1.0, v91
 v_add_f32 v92, 1.0, v92
 v_add_f32 v93, 1.0, v93
 v_rcp_f32 v88, v88
 v_rcp_f32 v89, v89
 v_rcp_f32 v90, v90
 v_rcp_f32 v91, v91
 v_rcp_f32 v92, v92
 v_rcp_f32 v93, v93
 v_mul_f32 v240, v240, v88
 v_mul_f32 v241, v241, v89
 v_mul_f32 v242, v242, v90
 v_mul_f32 v243, v243, v91
 v_mul_f32 v252, v252, v92
 v_mul_f32 v253, v253, v93
 s_waitcnt vmcnt(8)
 v_bitop3_b32 v20, v51, v55, s45 bitop3:0x7e
 s_waitcnt vmcnt(7)
 v_bitop3_b32 v20, v20, v59, s45 bitop3:0xf6
 v_cmp_ne_u32 vcc, 0, v20
 s_cbranch_vccnz L_uB30
L_uB30_b:
 v_dot2_f32_bf16 v244, v48, v14, v244
 v_dot2_f32_bf16 v245, v48, v15, v245
 v_dot2_f32_bf16 v246, v49, v14, v246
 v_dot2_f32_bf16 v247, v49, v15, v247
 v_dot2_f32_bf16 v254, v50, v14, v254
 v_dot2_f32_bf16 v255, v50, v15, v255
 v_dot2_f32_bf16 v244, v52, v14, v244
 v_dot2_f32_bf16 v245, v52, v15, v245
 v_dot2_f32_bf16 v246, v53, v14, v246
 v_dot2_f32_bf16 v247, v53, v15, v247
 v_dot2_f32_bf16 v254, v54, v14, v254
 v_dot2_f32_bf16 v255, v54, v15, v255
 v_dot2_f32_bf16 v244, v56, v14, v244
 v_dot2_f32_bf16 v245, v56, v15, v245
 v_dot2_f32_bf16 v246, v57, v14, v246
 v_dot2_f32_bf16 v247, v57, v15, v247
 v_dot2_f32_bf16 v254, v58, v14, v254
 v_dot2_f32_bf16 v255, v58, v15, v255
 v_mul_f32 v88, 0xbfb8aa3b, v244
 v_mul_f32 v89, 0xbfb8aa3b, v245
 v_mul_f32 v90, 0xbfb8aa3b, v246
 v_mul_f32 v91, 0xbfb8aa3b, v247
 v_mul_f32 v92, 0xbfb8aa3b, v254
 v_mul_f32 v93, 0xbfb8aa3b, v255
 v_exp_f32 v88, v88
 v_exp_f32 v89, v89
 v_exp_f32 v90, v90
 v_exp_f32 v91, v91
 v_exp_f32 v92, v92
 v_exp_f32 v93, v93
 v_add_f32 v88, 1.0, v88
 v_add_f32 v89, 1.0, v89
 v_add_f32 v90, 1.0, v90
 v_add_f32 v91, 1.0, v91
 v_add_f32 v92, 1.0, v92
 v_add_f32 v93, 1.0, v93
 v_rcp_f32 v88, v88
 v_rcp_f32 v89, v89
 v_rcp_f32 v90, v90
 v_rcp_f32 v91, v91
 v_rcp_f32 v92, v92
 v_rcp_f32 v93, v93
 v_mul_f32 v244, v244, v88
 v_mul_f32 v245, v245, v89
 v_mul_f32 v246, v246, v90
 v_mul_f32 v247, v247, v91
 v_mul_f32 v254, v254, v92
 v_mul_f32 v255, v255, v93
 s_waitcnt vmcnt(0)
 v_sub_u32 v20, v16, v98
 v_cmp_ne_u32 vcc, 1, v20
 s_cbranch_vccnz L_tBc
L_tBc_b:
 buffer_load_dwordx4 v[36:39], v11, s[16:19], s42 offen offset:2048 sc1
 buffer_load_dwordx4 v[40:43], v11, s[16:19], s43 offen offset:2048 sc1
 buffer_load_dwordx4 v[44:47], v11, s[16:19], s44 offen offset:2048 sc1
 buffer_load_dwordx4 v[60:63], v11, s[16:19], s42 offen offset:3072 sc1
 buffer_load_dwordx4 v[64:67], v11, s[16:19], s43 offen offset:3072 sc1
 buffer_load_dwordx4 v[68:71], v11, s[16:19], s44 offen offset:3072 sc1
 v_bitop3_b32 v20, v135, v139, s45 bitop3:0x7e
 v_bitop3_b32 v20, v20, v143, s45 bitop3:0xf6
 v_cmp_ne_u32 vcc, 0, v20
 s_cbranch_vccnz L_uB03
L_uB03_b:
 v_dot2_f32_bf16 v208, v132, v14, v208
 v_dot2_f32_bf16 v209, v132, v15, v209
 v_dot2_f32_bf16 v210, v133, v14, v210
 v_dot2_f32_bf16 v211, v133, v15, v211
 v_dot2_f32_bf16 v224, v134, v14, v224
 v_dot2_f32_bf16 v225, v134, v15, v225
 v_dot2_f32_bf16 v208, v136, v14, v208
 v_dot2_f32_bf16 v209, v136, v15, v209
 v_dot2_f32_bf16 v210, v137, v14, v210
 v_dot2_f32_bf16 v211, v137, v15, v211
 v_dot2_f32_bf16 v224, v138, v14, v224
 v_dot2_f32_bf16 v225, v138, v15, v225
 v_dot2_f32_bf16 v208, v140, v14, v208
 v_dot2_f32_bf16 v209, v140, v15, v209
 v_dot2_f32_bf16 v210, v141, v14, v210
 v_dot2_f32_bf16 v211, v141, v15, v211
 v_dot2_f32_bf16 v224, v142, v14, v224
 v_dot2_f32_bf16 v225, v142, v15, v225
 v_fmac_f32 v184, v208, v232
 v_fmac_f32 v185, v209, v233
 v_fmac_f32 v186, v210, v234
 v_fmac_f32 v187, v211, v235
 v_fmac_f32 v200, v224, v248
 v_fmac_f32 v201, v225, v249
 buffer_store_dwordx4 v[184:187], v8, s[24:27], s32 offen offset:0
 buffer_store_dwordx2 v[200:201], v9, s[24:27], s32 offen offset:0
 v_bitop3_b32 v20, v159, v163, s45 bitop3:0x7e
 v_bitop3_b32 v20, v20, v167, s45 bitop3:0xf6
 v_cmp_ne_u32 vcc, 0, v20
 s_cbranch_vccnz L_uB13
L_uB13_b:
 v_dot2_f32_bf16 v212, v156, v14, v212
 v_dot2_f32_bf16 v213, v156, v15, v213
 v_dot2_f32_bf16 v214, v157, v14, v214
 v_dot2_f32_bf16 v215, v157, v15, v215
 v_dot2_f32_bf16 v226, v158, v14, v226
 v_dot2_f32_bf16 v227, v158, v15, v227
 v_dot2_f32_bf16 v212, v160, v14, v212
 v_dot2_f32_bf16 v213, v160, v15, v213
 v_dot2_f32_bf16 v214, v161, v14, v214
 v_dot2_f32_bf16 v215, v161, v15, v215
 v_dot2_f32_bf16 v226, v162, v14, v226
 v_dot2_f32_bf16 v227, v162, v15, v227
 v_dot2_f32_bf16 v212, v164, v14, v212
 v_dot2_f32_bf16 v213, v164, v15, v213
 v_dot2_f32_bf16 v214, v165, v14, v214
 v_dot2_f32_bf16 v215, v165, v15, v215
 v_dot2_f32_bf16 v226, v166, v14, v226
 v_dot2_f32_bf16 v227, v166, v15, v227
 v_fmac_f32 v188, v212, v236
 v_fmac_f32 v189, v213, v237
 v_fmac_f32 v190, v214, v238
 v_fmac_f32 v191, v215, v239
 v_fmac_f32 v202, v226, v250
 v_fmac_f32 v203, v227, v251
 buffer_store_dwordx4 v[188:191], v8, s[24:27], s32 offen offset:192
 buffer_store_dwordx2 v[202:203], v9, s[24:27], s32 offen offset:192
 s_waitcnt vmcnt(8)
 v_bitop3_b32 v20, v39, v43, s45 bitop3:0x7e
 s_waitcnt vmcnt(7)
 v_bitop3_b32 v20, v20, v47, s45 bitop3:0xf6
 v_cmp_ne_u32 vcc, 0, v20
 s_cbranch_vccnz L_uB23
L_uB23_b:
 v_dot2_f32_bf16 v216, v36, v14, v216
 v_dot2_f32_bf16 v217, v36, v15, v217
 v_dot2_f32_bf16 v218, v37, v14, v218
 v_dot2_f32_bf16 v219, v37, v15, v219
 v_dot2_f32_bf16 v228, v38, v14, v228
 v_dot2_f32_bf16 v229, v38, v15, v229
 v_dot2_f32_bf16 v216, v40, v14, v216
 v_dot2_f32_bf16 v217, v40, v15, v217
 v_dot2_f32_bf16 v218, v41, v14, v218
 v_dot2_f32_bf16 v219, v41, v15, v219
 v_dot2_f32_bf16 v228, v42, v14, v228
 v_dot2_f32_bf16 v229, v42, v15, v229
 v_dot2_f32_bf16 v216, v44, v14, v216
 v_dot2_f32_bf16 v217, v44, v15, v217
 v_dot2_f32_bf16 v218, v45, v14, v218
 v_dot2_f32_bf16 v219, v45, v15, v219
 v_dot2_f32_bf16 v228, v46, v14, v228
 v_dot2_f32_bf16 v229, v46, v15, v229
 v_fmac_f32 v192, v216, v240
 v_fmac_f32 v193, v217, v241
 v_fmac_f32 v194, v218, v242
 v_fmac_f32 v195, v219, v243
 v_fmac_f32 v204, v228, v252
 v_fmac_f32 v205, v229, v253
 buffer_store_dwordx4 v[192:195], v8, s[24:27], s32 offen offset:384
 buffer_store_dwordx2 v[204:205], v9, s[24:27], s32 offen offset:384
 s_waitcnt vmcnt(7)
 v_bitop3_b32 v20, v63, v67, s45 bitop3:0x7e
 s_waitcnt vmcnt(6)
 v_bitop3_b32 v20, v20, v71, s45 bitop3:0xf6
 v_cmp_ne_u32 vcc, 0, v20
 s_cbranch_vccnz L_uB33
L_uB33_b:
 v_dot2_f32_bf16 v220, v60, v14, v220
 v_dot2_f32_bf16 v221, v60, v15, v221
 v_dot2_f32_bf16 v222, v61, v14, v222
 v_dot2_f32_bf16 v223, v61, v15, v223
 v_dot2_f32_bf16 v230, v62, v14, v230
 v_dot2_f32_bf16 v231, v62, v15, v231
 v_dot2_f32_bf16 v220, v64, v14, v220
 v_dot2_f32_bf16 v221, v64, v15, v221
 v_dot2_f32_bf16 v222, v65, v14, v222
 v_dot2_f32_bf16 v223, v65, v15, v223
 v_dot2_f32_bf16 v230, v66, v14, v230
 v_dot2_f32_bf16 v231, v66, v15, v231
 v_dot2_f32_bf16 v220, v68, v14, v220
 v_dot2_f32_bf16 v221, v68, v15, v221
 v_dot2_f32_bf16 v222, v69, v14, v222
 v_dot2_f32_bf16 v223, v69, v15, v223
 v_dot2_f32_bf16 v230, v70, v14, v230
 v_dot2_f32_bf16 v231, v70, v15, v231
 v_fmac_f32 v196, v220, v244
 v_fmac_f32 v197, v221, v245
 v_fmac_f32 v198, v222, v246
 v_fmac_f32 v199, v223, v247
 v_fmac_f32 v206, v230, v254
 v_fmac_f32 v207, v231, v255
 buffer_store_dwordx4 v[196:199], v8, s[24:27], s32 offen offset:576
 buffer_store_dwordx2 v[206:207], v9, s[24:27], s32 offen offset:576
L_tend:
L_end:
 s_endpgm
L_mn:
 s_mov_b32 s49, 100000
L_mn_l:
 s_sleep 1
 buffer_load_dword v16, off, s[24:27], 0 sc1
 s_waitcnt vmcnt(0)
 v_cmp_eq_u32 vcc, 0, v16
 s_nop 1
 s_nop 3
 s_cbranch_vccz L_mn_b
 s_sub_u32 s49, s49, 1
 s_cmp_lg_u32 s49, 0
 s_cbranch_scc1 L_mn_l
 s_branch L_mn_b
L_fx0:
 s_mov_b32 s49, 100000
L_fx0_l:
 s_sleep 1
 s_mov_b32 m0, s23
 s_nop 0
 buffer_load_dwordx4 v11, s[16:19], s90 offen sc1 lds
 s_waitcnt vmcnt(0)
 ds_read2_b32 v[18:19], v12 offset0:3 offset1:131
 s_nop 1
 s_waitcnt lgkmcnt(0)
 s_nop 1
 v_bitop3_b32 v19, v18, v19, s46 bitop3:0x7e
 s_nop 1
 v_cmp_ne_u32 vcc, 0, v19
 s_nop 1
 s_nop 3
 s_cbranch_vccz L_fx0_b
 s_sub_u32 s49, s49, 1
 s_cmp_lg_u32 s49, 0
 s_cbranch_scc1 L_fx0_l
 s_branch L_fx0_b
L_fx1:
 s_mov_b32 s49, 100000
L_fx1_l:
 s_sleep 1
 s_mov_b32 m0, s23
 s_nop 0
 buffer_load_dwordx4 v11, s[16:19], s90 offen sc1 lds
 s_waitcnt vmcnt(0)
 ds_read2_b32 v[18:19], v12 offset0:3 offset1:131
 s_nop 1
 s_waitcnt lgkmcnt(0)
 s_nop 1
 v_bitop3_b32 v19, v18, v19, s46 bitop3:0x7e
 s_nop 1
 v_cmp_ne_u32 vcc, 0, v19
 s_nop 1
 s_nop 3
 s_cbranch_vccz L_fx1_b
 s_sub_u32 s49, s49, 1
 s_cmp_lg_u32 s49, 0
 s_cbranch_scc1 L_fx1_l
 s_branch L_fx1_b
L_fx2:
 s_mov_b32 s49, 100000
L_fx2_l:
 s_sleep 1
 s_mov_b32 m0, s23
 s_nop 0
 buffer_load_dwordx4 v11, s[16:19], s90 offen sc1 lds
 s_waitcnt vmcnt(0)
 ds_read2_b32 v[18:19], v12 offset0:3 offset1:131
 s_nop 1
 s_waitcnt lgkmcnt(0)
 s_nop 1
 v_bitop3_b32 v19, v18, v19, s46 bitop3:0x7e
 s_nop 1
 v_cmp_ne_u32 vcc, 0, v19
 s_nop 1
 s_nop 3
 s_cbranch_vccz L_fx2_b
 s_sub_u32 s49, s49, 1
 s_cmp_lg_u32 s49, 0
 s_cbranch_scc1 L_fx2_l
 s_branch L_fx2_b
L_fp0:
 s_mov_b32 s49, 100000
L_fp0_l:
 s_sleep 1
 buffer_load_dword v16, v17, s[16:19], 0 offen sc1
 s_waitcnt vmcnt(0)
 s_add_u32 s40, s45, 1
 s_nop 1
 v_subrev_u32 v16, s40, v16
 s_nop 1
 v_cmp_lt_u32 vcc, 5, v16
 s_nop 1
 s_nop 3
 s_cbranch_vccz L_fp0_b
 s_sub_u32 s49, s49, 1
 s_cmp_lg_u32 s49, 0
 s_cbranch_scc1 L_fp0_l
 s_branch L_fp0_b
L_fx3:
 s_mov_b32 s49, 100000
L_fx3_l:
 s_sleep 1
 s_mov_b32 m0, s23
 s_nop 0
 buffer_load_dwordx4 v11, s[16:19], s90 offen sc1 lds
 s_waitcnt vmcnt(0)
 ds_read2_b32 v[18:19], v12 offset0:3 offset1:131
 s_nop 1
 s_waitcnt lgkmcnt(0)
 s_nop 1
 v_bitop3_b32 v19, v18, v19, s46 bitop3:0x7e
 s_nop 1
 v_cmp_ne_u32 vcc, 0, v19
 s_nop 1
 s_nop 3
 s_cbranch_vccz L_fx3_b
 s_sub_u32 s49, s49, 1
 s_cmp_lg_u32 s49, 0
 s_cbranch_scc1 L_fx3_l
 s_branch L_fx3_b
L_fp1:
 s_mov_b32 s49, 100000
L_fp1_l:
 s_sleep 1
 buffer_load_dword v16, v17, s[16:19], 0 offen sc1
 s_waitcnt vmcnt(0)
 s_add_u32 s40, s45, 2
 s_nop 1
 v_subrev_u32 v16, s40, v16
 s_nop 1
 v_cmp_lt_u32 vcc, 4, v16
 s_nop 1
 s_nop 3
 s_cbranch_vccz L_fp1_b
 s_sub_u32 s49, s49, 1
 s_cmp_lg_u32 s49, 0
 s_cbranch_scc1 L_fp1_l
 s_branch L_fp1_b
L_fp2:
 s_mov_b32 s49, 100000
L_fp2_l:
 s_sleep 1
 buffer_load_dword v16, v17, s[16:19], 0 offen sc1
 s_waitcnt vmcnt(0)
 s_add_u32 s40, s45, 3
 s_nop 1
 v_subrev_u32 v16, s40, v16
 s_nop 1
 v_cmp_lt_u32 vcc, 3, v16
 s_nop 1
 s_nop 3
 s_cbranch_vccz L_fp2_b
 s_sub_u32 s49, s49, 1
 s_cmp_lg_u32 s49, 0
 s_cbranch_scc1 L_fp2_l
 s_branch L_fp2_b
L_fx4:
 s_mov_b32 s49, 100000
L_fx4_l:
 s_sleep 1
 s_mov_b32 m0, s23
 s_nop 0
 buffer_load_dwordx4 v11, s[16:19], s90 offen sc1 lds
 s_waitcnt vmcnt(0)
 ds_read2_b32 v[18:19], v12 offset0:3 offset1:131
 s_nop 1
 s_waitcnt lgkmcnt(0)
 s_nop 1
 v_bitop3_b32 v19, v18, v19, s46 bitop3:0x7e
 s_nop 1
 v_cmp_ne_u32 vcc, 0, v19
 s_nop 1
 s_nop 3
 s_cbranch_vccz L_fx4_b
 s_sub_u32 s49, s49, 1
 s_cmp_lg_u32 s49, 0
 s_cbranch_scc1 L_fx4_l
 s_branch L_fx4_b
L_fp3:
 s_mov_b32 s49, 100000
L_fp3_l:
 s_sleep 1
 buffer_load_dword v16, v17, s[16:19], 0 offen sc1
 s_waitcnt vmcnt(0)
 s_add_u32 s40, s45, 4
 s_nop 1
 v_subrev_u32 v16, s40, v16
 s_nop 1
 v_cmp_lt_u32 vcc, 2, v16
 s_nop 1
 s_nop 3
 s_cbranch_vccz L_fp3_b
 s_sub_u32 s49, s49, 1
 s_cmp_lg_u32 s49, 0
 s_cbranch_scc1 L_fp3_l
 s_branch L_fp3_b
L_fx5:
 s_mov_b32 s49, 100000
L_fx5_l:
 s_sleep 1
 s_mov_b32 m0, s23
 s_nop 0
 buffer_load_dwordx4 v11, s[16:19], s90 offen sc1 lds
 s_waitcnt vmcnt(0)
 ds_read2_b32 v[18:19], v12 offset0:3 offset1:131
 s_nop 1
 s_waitcnt lgkmcnt(0)
 s_nop 1
 v_bitop3_b32 v19, v18, v19, s46 bitop3:0x7e
 s_nop 1
 v_cmp_ne_u32 vcc, 0, v19
 s_nop 1
 s_nop 3
 s_cbranch_vccz L_fx5_b
 s_sub_u32 s49, s49, 1
 s_cmp_lg_u32 s49, 0
 s_cbranch_scc1 L_fx5_l
 s_branch L_fx5_b
L_fp4:
 s_mov_b32 s49, 100000
L_fp4_l:
 s_sleep 1
 buffer_load_dword v16, v17, s[16:19], 0 offen sc1
 s_waitcnt vmcnt(0)
 s_add_u32 s40, s45, 5
 s_nop 1
 v_subrev_u32 v16, s40, v16
 s_nop 1
 v_cmp_lt_u32 vcc, 1, v16
 s_nop 1
 s_nop 3
 s_cbranch_vccz L_fp4_b
 s_sub_u32 s49, s49, 1
 s_cmp_lg_u32 s49, 0
 s_cbranch_scc1 L_fp4_l
 s_branch L_fp4_b
L_fp5:
 s_mov_b32 s49, 100000
L_fp5_l:
 s_sleep 1
 buffer_load_dword v16, v17, s[16:19], 0 offen sc1
 s_waitcnt vmcnt(0)
 s_add_u32 s40, s45, 6
 s_nop 1
 v_subrev_u32 v16, s40, v16
 s_nop 1
 v_cmp_lt_u32 vcc, 0, v16
 s_nop 1
 s_nop 3
 s_cbranch_vccz L_fp5_b
 s_sub_u32 s49, s49, 1
 s_cmp_lg_u32 s49, 0
 s_cbranch_scc1 L_fp5_l
 s_branch L_fp5_b
L_tBa:
 s_mov_b32 s49, 100000
L_tBa_l:
 s_sleep 1
 buffer_load_dword v16, v97, s[16:19], s44 offen sc1
 s_waitcnt vmcnt(0)
 v_sub_u32 v20, v16, v98
 s_nop 1
 v_cmp_ne_u32 vcc, 1, v20
 s_nop 1
 s_and_b64 vcc, vcc, 7
 s_nop 1
 s_nop 3
 s_cbranch_vccz L_tBa_b
 s_sub_u32 s49, s49, 1
 s_cmp_lg_u32 s49, 0
 s_cbranch_scc1 L_tBa_l
 s_branch L_tBa_b
L_tBb:
 s_mov_b32 s49, 100000
L_tBb_l:
 s_sleep 1
 buffer_load_dword v16, v97, s[16:19], s44 offen sc1
 s_waitcnt vmcnt(0)
 v_sub_u32 v20, v16, v98
 s_nop 1
 v_cmp_lt_u32 vcc, 1, v20
 s_nop 1
 s_nop 3
 s_cbranch_vccz L_tBb_b
 s_sub_u32 s49, s49, 1
 s_cmp_lg_u32 s49, 0
 s_cbranch_scc1 L_tBb_l
 s_branch L_tBb_b
L_uB00:
 s_mov_b32 s49, 100000
L_uB00_l:
 s_sleep 1
 buffer_load_dwordx4 v[120:123], v11, s[16:19], s33 offen offset:0 sc1
 buffer_load_dwordx4 v[124:127], v11, s[16:19], s34 offen offset:0 sc1
 buffer_load_dwordx4 v[128:131], v11, s[16:19], s35 offen offset:0 sc1
 s_waitcnt vmcnt(0)
 v_bitop3_b32 v20, v123, v127, s45 bitop3:0x7e
 s_nop 1
 v_bitop3_b32 v20, v20, v131, s45 bitop3:0xf6
 s_nop 1
 v_cmp_ne_u32 vcc, 0, v20
 s_nop 1
 s_nop 3
 s_cbranch_vccz L_uB00_b
 s_sub_u32 s49, s49, 1
 s_cmp_lg_u32 s49, 0
 s_cbranch_scc1 L_uB00_l
 s_branch L_uB00_b
L_uB10:
 s_mov_b32 s49, 100000
L_uB10_l:
 s_sleep 1
 buffer_load_dwordx4 v[144:147], v11, s[16:19], s33 offen offset:1024 sc1
 buffer_load_dwordx4 v[148:151], v11, s[16:19], s34 offen offset:1024 sc1
 buffer_load_dwordx4 v[152:155], v11, s[16:19], s35 offen offset:1024 sc1
 s_waitcnt vmcnt(0)
 v_bitop3_b32 v20, v147, v151, s45 bitop3:0x7e
 s_nop 1
 v_bitop3_b32 v20, v20, v155, s45 bitop3:0xf6
 s_nop 1
 v_cmp_ne_u32 vcc, 0, v20
 s_nop 1
 s_nop 3
 s_cbranch_vccz L_uB10_b
 s_sub_u32 s49, s49, 1
 s_cmp_lg_u32 s49, 0
 s_cbranch_scc1 L_uB10_l
 s_branch L_uB10_b
L_uB20:
 s_mov_b32 s49, 100000
L_uB20_l:
 s_sleep 1
 buffer_load_dwordx4 v[24:27], v11, s[16:19], s33 offen offset:2048 sc1
 buffer_load_dwordx4 v[28:31], v11, s[16:19], s34 offen offset:2048 sc1
 buffer_load_dwordx4 v[32:35], v11, s[16:19], s35 offen offset:2048 sc1
 s_waitcnt vmcnt(0)
 v_bitop3_b32 v20, v27, v31, s45 bitop3:0x7e
 s_nop 1
 v_bitop3_b32 v20, v20, v35, s45 bitop3:0xf6
 s_nop 1
 v_cmp_ne_u32 vcc, 0, v20
 s_nop 1
 s_nop 3
 s_cbranch_vccz L_uB20_b
 s_sub_u32 s49, s49, 1
 s_cmp_lg_u32 s49, 0
 s_cbranch_scc1 L_uB20_l
 s_branch L_uB20_b
L_uB30:
 s_mov_b32 s49, 100000
L_uB30_l:
 s_sleep 1
 buffer_load_dwordx4 v[48:51], v11, s[16:19], s33 offen offset:3072 sc1
 buffer_load_dwordx4 v[52:55], v11, s[16:19], s34 offen offset:3072 sc1
 buffer_load_dwordx4 v[56:59], v11, s[16:19], s35 offen offset:3072 sc1
 s_waitcnt vmcnt(0)
 v_bitop3_b32 v20, v51, v55, s45 bitop3:0x7e
 s_nop 1
 v_bitop3_b32 v20, v20, v59, s45 bitop3:0xf6
 s_nop 1
 v_cmp_ne_u32 vcc, 0, v20
 s_nop 1
 s_nop 3
 s_cbranch_vccz L_uB30_b
 s_sub_u32 s49, s49, 1
 s_cmp_lg_u32 s49, 0
 s_cbranch_scc1 L_uB30_l
 s_branch L_uB30_b
L_tBc:
 s_mov_b32 s49, 100000
L_tBc_l:
 s_sleep 1
 buffer_load_dword v16, v97, s[16:19], s44 offen sc1
 s_waitcnt vmcnt(0)
 v_sub_u32 v20, v16, v98
 s_nop 1
 v_cmp_ne_u32 vcc, 1, v20
 s_nop 1
 s_nop 3
 s_cbranch_vccz L_tBc_b
 s_sub_u32 s49, s49, 1
 s_cmp_lg_u32 s49, 0
 s_cbranch_scc1 L_tBc_l
 s_branch L_tBc_b
L_uB03:
 s_mov_b32 s49, 100000
L_uB03_l:
 s_sleep 1
 buffer_load_dwordx4 v[132:135], v11, s[16:19], s42 offen offset:0 sc1
 buffer_load_dwordx4 v[136:139], v11, s[16:19], s43 offen offset:0 sc1
 buffer_load_dwordx4 v[140:143], v11, s[16:19], s44 offen offset:0 sc1
 s_waitcnt vmcnt(0)
 v_bitop3_b32 v20, v135, v139, s45 bitop3:0x7e
 s_nop 1
 v_bitop3_b32 v20, v20, v143, s45 bitop3:0xf6
 s_nop 1
 v_cmp_ne_u32 vcc, 0, v20
 s_nop 1
 s_nop 3
 s_cbranch_vccz L_uB03_b
 s_sub_u32 s49, s49, 1
 s_cmp_lg_u32 s49, 0
 s_cbranch_scc1 L_uB03_l
 s_branch L_uB03_b
L_uB13:
 s_mov_b32 s49, 100000
L_uB13_l:
 s_sleep 1
 buffer_load_dwordx4 v[156:159], v11, s[16:19], s42 offen offset:1024 sc1
 buffer_load_dwordx4 v[160:163], v11, s[16:19], s43 offen offset:1024 sc1
 buffer_load_dwordx4 v[164:167], v11, s[16:19], s44 offen offset:1024 sc1
 s_waitcnt vmcnt(0)
 v_bitop3_b32 v20, v159, v163, s45 bitop3:0x7e
 s_nop 1
 v_bitop3_b32 v20, v20, v167, s45 bitop3:0xf6
 s_nop 1
 v_cmp_ne_u32 vcc, 0, v20
 s_nop 1
 s_nop 3
 s_cbranch_vccz L_uB13_b
 s_sub_u32 s49, s49, 1
 s_cmp_lg_u32 s49, 0
 s_cbranch_scc1 L_uB13_l
 s_branch L_uB13_b
L_uB23:
 s_mov_b32 s49, 100000
L_uB23_l:
 s_sleep 1
 buffer_load_dwordx4 v[36:39], v11, s[16:19], s42 offen offset:2048 sc1
 buffer_load_dwordx4 v[40:43], v11, s[16:19], s43 offen offset:2048 sc1
 buffer_load_dwordx4 v[44:47], v11, s[16:19], s44 offen offset:2048 sc1
 s_waitcnt vmcnt(0)
 v_bitop3_b32 v20, v39, v43, s45 bitop3:0x7e
 s_nop 1
 v_bitop3_b32 v20, v20, v47, s45 bitop3:0xf6
 s_nop 1
 v_cmp_ne_u32 vcc, 0, v20
 s_nop 1
 s_nop 3
 s_cbranch_vccz L_uB23_b
 s_sub_u32 s49, s49, 1
 s_cmp_lg_u32 s49, 0
 s_cbranch_scc1 L_uB23_l
 s_branch L_uB23_b
L_uB33:
 s_mov_b32 s49, 100000
L_uB33_l:
 s_sleep 1
 buffer_load_dwordx4 v[60:63], v11, s[16:19], s42 offen offset:3072 sc1
 buffer_load_dwordx4 v[64:67], v11, s[16:19], s43 offen offset:3072 sc1
 buffer_load_dwordx4 v[68:71], v11, s[16:19], s44 offen offset:3072 sc1
 s_waitcnt vmcnt(0)
 v_bitop3_b32 v20, v63, v67, s45 bitop3:0x7e
 s_nop 1
 v_bitop3_b32 v20, v20, v71, s45 bitop3:0xf6
 s_nop 1
 v_cmp_ne_u32 vcc, 0, v20
 s_nop 1
 s_nop 3
 s_cbranch_vccz L_uB33_b
 s_sub_u32 s49, s49, 1
 s_cmp_lg_u32 s49, 0
 s_cbranch_scc1 L_uB33_l
 s_branch L_uB33_b
L_ssm:
 s_load_dwordx2 s[12:13], s[0:1], 40
 s_load_dwordx2 s[52:53], s[0:1], 48
 s_load_dwordx2 s[96:97], s[0:1], 8
 s_load_dwordx2 s[98:99], s[0:1], 16
 s_load_dwordx2 s[90:91], s[0:1], 56
 s_cmp_lt_u32 s31, 2
 s_cselect_b32 s8, s92, s94
 s_cselect_b32 s9, s93, s95
 s_sub_u32 s8, s8, 4096
 s_subb_u32 s9, s9, 0
 s_and_b32 s9, s9, 0xffff
 s_mov_b32 s10, 0xa3000
 s_mov_b32 s11, 0x20000
 s_mul_i32 s39, s30, 384
 v_and_b32 v64, 31, v0
 v_lshlrev_b32 v39, 3, v64
 v_lshlrev_b32 v65, 1, v64
 s_waitcnt lgkmcnt(0)
 s_mov_b32 s20, s96
 s_and_b32 s21, s97, 0xffff
 s_mov_b32 s22, 1152
 s_mov_b32 s23, 0x20000
 buffer_load_ushort v8, v65, s[20:23], s39 offen offset:0
 buffer_load_ushort v12, v65, s[20:23], s39 offen offset:64
 buffer_load_ushort v16, v65, s[20:23], s39 offen offset:128
 buffer_load_ushort v24, v65, s[20:23], s39 offen offset:192
 buffer_load_ushort v28, v65, s[20:23], s39 offen offset:256
 buffer_load_ushort v32, v65, s[20:23], s39 offen offset:320
 s_mov_b32 s20, s98
 s_and_b32 s21, s99, 0xffff
 s_mov_b32 s22, 1152
 s_mov_b32 s23, 0x20000
 buffer_load_ushort v9, v65, s[20:23], s39 offen offset:0
 buffer_load_ushort v13, v65, s[20:23], s39 offen offset:64
 buffer_load_ushort v17, v65, s[20:23], s39 offen offset:128
 buffer_load_ushort v25, v65, s[20:23], s39 offen offset:192
 buffer_load_ushort v29, v65, s[20:23], s39 offen offset:256
 buffer_load_ushort v33, v65, s[20:23], s39 offen offset:320
 s_mov_b32 s20, s90
 s_and_b32 s21, s91, 0xffff
 s_mov_b32 s22, 1152
 s_mov_b32 s23, 0x20000
 buffer_load_ushort v10, v65, s[20:23], s39 offen offset:0
 buffer_load_ushort v14, v65, s[20:23], s39 offen offset:64
 buffer_load_ushort v18, v65, s[20:23], s39 offen offset:128
 buffer_load_ushort v26, v65, s[20:23], s39 offen offset:192
 buffer_load_ushort v30, v65, s[20:23], s39 offen offset:256
 buffer_load_ushort v34, v65, s[20:23], s39 offen offset:320
 s_and_b32 s17, s17, 0xffff
 s_mov_b32 s18, 0x2700000
 s_mov_b32 s19, 0x20000
 s_and_b32 s25, s25, 0xffff
 s_mov_b32 s26, 0x100
 s_mov_b32 s27, 0x20000
 s_sub_u32 s12, s12, 4096
 s_subb_u32 s13, s13, 0
 s_and_b32 s13, s13, 0xffff
 s_mov_b32 s14, 0xa3000
 s_mov_b32 s15, 0x20000
 s_sub_u32 s52, s52, 4096
 s_subb_u32 s53, s53, 0
 s_and_b32 s53, s53, 0xffff
 s_mov_b32 s54, 0xa3000
 s_mov_b32 s55, 0x20000
 s_lshl_b32 s35, s39, 4
 s_add_u32 s35, s35, 0x72000
 v_min_u32 v66, 26, v0
 v_mul_u32_u24 v67, 43, v66
 v_lshrrev_b32 v67, 7, v67
 v_mul_u32_u24 v67, 768, v67
 v_lshl_add_u32 v57, v66, 7, v67
 s_mul_i32 s44, s51, 10368
 s_add_u32 s44, s44, s39
 s_add_u32 s44, s44, 4096
 s_and_b32 s38, s31, 1
 s_lshl_b32 s38, s38, 4
 s_mul_i32 s40, s30, 192
 s_add_u32 s40, s40, s38
 s_mul_i32 s32, s40, 1152
 s_lshr_b32 s40, s31, 1
 s_mul_i32 s40, s40, 96
 s_add_u32 s40, s40, s38
 s_mul_i32 s33, s40, 1152
 s_add_u32 s33, s33, s39
 s_mul_i32 s38, s30, 384
 s_add_u32 s20, s32, s38
 s_mov_b32 s40, 384
 s_cmp_eq_u32 s30, 2
 s_cselect_b32 s38, -768, s40
 s_add_u32 s21, s20, s38
 s_cmp_eq_u32 s30, 1
 s_cselect_b32 s38, -768, s40
 s_add_u32 s22, s21, s38
 s_mul_i32 s34, s30, 49152
 s_add_u32 s34, s34, 0x80000
 s_mul_i32 s38, s28, 12
 s_add_u32 s38, s38, s31
 s_mul_i32 s38, s38, 104704
 s_mul_i32 s40, s30, 4352
 s_add_u32 s38, s38, s40
 s_add_u32 s48, s38, 0x103300
 s_mov_b32 s50, 0xffff0000
 v_lshrrev_b32 v67, 5, v0
 s_lshl_b32 s38, s31, 1
 v_add_u32 v66, s38, v67
 v_cvt_f32_u32 v36, v66
 v_mov_b32 v68, 0x44e00000
 v_mov_b32 v69, 0xc3800000
 v_fma_f32 v37, v36, v69, v68
 v_mul_f32 v36, 0x41800000, v36
 v_lshl_add_u32 v38, v66, 8, v39
 v_add_u32 v38, 155648, v38
 v_lshlrev_b32 v68, 1, v66
 s_sub_u32 s38, s28, 16
 v_add_u32 v68, s38, v68
 v_lshlrev_b32 v69, 1, v39
 v_mov_b32 v70, 0x80000000
 v_lshl_add_u32 v71, v68, 9, v69
 v_cmp_le_i32 vcc, 0, v68
 s_nop 1
 v_cndmask_b32 v41, v70, v71, vcc
 s_mov_b64 s[42:43], vcc
 v_add_u32 v68, 1, v68
 v_lshl_add_u32 v71, v68, 9, v69
 v_cmp_le_i32 vcc, 0, v68
 s_nop 1
 v_cndmask_b32 v42, v70, v71, vcc
 s_mov_b64 s[46:47], vcc
 s_lshl_b32 s38, s28, 9
 v_add_u32 v71, s38, v69
 v_cmp_eq_u32 vcc, 7, v66
 s_nop 1
 v_cndmask_b32 v20, v70, v71, vcc
 s_lshl_b32 s38, s31, 11
 s_add_u32 s38, s38, 147456
 v_lshlrev_b32 v40, 3, v39
 v_bfe_u32 v68, v0, 1, 2
 v_lshlrev_b32 v69, 1, v67
 v_xor_b32 v68, v68, v69
 v_lshl_add_u32 v40, v68, 4, v40
 v_add_u32 v40, s38, v40
 v_bfe_u32 v68, v0, 2, 2
 v_lshl_add_u32 v68, v67, 3, v68
 v_lshlrev_b32 v68, 6, v68
 v_bfe_u32 v69, v0, 4, 1
 v_lshl_add_u32 v68, v69, 5, v68
 v_and_b32 v69, 3, v0
 v_lshl_add_u32 v68, v69, 3, v68
 v_and_b32 v69, 8, v0
 v_lshlrev_b32 v69, 1, v69
 v_xor_b32 v68, v68, v69
 v_add_u32 v55, s38, v68
 v_add_u32 v39, 159744, v39
 v_bfe_u32 v68, v0, 3, 2
 v_mul_u32_u24 v68, 26112, v68
 v_and_b32 v69, 7, v0
 v_lshl_add_u32 v68, v69, 4, v68
 v_lshl_add_u32 v7, v67, 7, v68
 v_mov_b32 v68, 0
 v_mov_b32 v69, 0
 ds_write_b64 v38, v[68:69]
 v_bfe_u32 v68, v0, 4, 1
 v_mul_u32_u24 v68, 6144, v68
 v_and_b32 v69, 15, v0
 v_lshl_add_u32 v68, v69, 7, v68
 v_lshrrev_b32 v69, 1, v69
 v_xor_b32 v69, v69, v67
 v_lshl_add_u32 v1, v69, 4, v68
 v_xor_b32 v2, 32, v1
 v_xor_b32 v53, 64, v1
 v_xor_b32 v54, 96, v1
 v_bfe_u32 v68, v0, 2, 1
 v_bfe_u32 v69, v0, 3, 2
 v_lshlrev_b32 v69, 2, v69
 v_lshl_add_u32 v68, v68, 4, v69
 v_and_b32 v69, 3, v0
 v_add_u32 v23, v68, v69
 v_lshrrev_b32 v68, 4, v23
 v_mul_u32_u24 v68, 24576, v68
 v_and_b32 v69, 15, v23
 v_lshl_add_u32 v68, v69, 7, v68
 v_add_u32 v68, s36, v68
 v_add_u32 v68, 49152, v68
 v_lshrrev_b32 v69, 1, v69
 v_lshrrev_b32 v79, 5, v0
 v_xor_b32 v69, v69, v79
 v_lshl_add_u32 v76, v69, 4, v68
 v_xor_b32 v77, 32, v76
 v_xor_b32 v78, 64, v76
 v_xor_b32 v79, 96, v76
 v_lshl_add_u32 v75, v23, 2, s38
 v_lshl_add_u32 v58, v67, 6, s38
 v_add_u32 v59, -1, v67
 v_lshlrev_b32 v23, 4, v0
 s_add_u32 m0, s36, 0
 s_add_u32 s38, s20, 0
 buffer_load_dwordx4 v3, s[8:11], s38 offen offset:0 lds
 buffer_load_dwordx4 v4, s[8:11], s38 offen offset:1024 lds
 buffer_load_dwordx4 v5, s[8:11], s38 offen offset:2048 lds
 buffer_load_dwordx4 v6, s[8:11], s38 offen offset:3072 lds
 s_add_u32 m0, s36, 4096
 s_add_u32 s38, s20, 256
 buffer_load_dwordx4 v3, s[8:11], s38 offen offset:0 lds
 buffer_load_dwordx4 v4, s[8:11], s38 offen offset:1024 lds
 s_cmp_eq_u32 s30, 2
 s_mov_b32 s38, 384
 s_cselect_b32 s38, -768, s38
 s_add_u32 s37, s37, s38
 s_add_u32 m0, s36, 49152
 s_add_u32 s38, s37, 0
 buffer_load_dwordx4 v3, s[4:7], s38 offen offset:0 lds
 buffer_load_dwordx4 v4, s[4:7], s38 offen offset:1024 lds
 buffer_load_dwordx4 v5, s[4:7], s38 offen offset:2048 lds
 buffer_load_dwordx4 v6, s[4:7], s38 offen offset:3072 lds
 s_add_u32 m0, s36, 53248
 s_add_u32 s38, s37, 256
 buffer_load_dwordx4 v3, s[4:7], s38 offen offset:0 lds
 buffer_load_dwordx4 v4, s[4:7], s38 offen offset:1024 lds
 s_add_u32 m0, s36, 73728
 s_add_u32 s38, s37, 18432
 buffer_load_dwordx4 v3, s[4:7], s38 offen offset:0 lds
 buffer_load_dwordx4 v4, s[4:7], s38 offen offset:1024 lds
 buffer_load_dwordx4 v5, s[4:7], s38 offen offset:2048 lds
 buffer_load_dwordx4 v6, s[4:7], s38 offen offset:3072 lds
 s_add_u32 m0, s36, 77824
 s_add_u32 s38, s37, 18688
 buffer_load_dwordx4 v3, s[4:7], s38 offen offset:0 lds
 buffer_load_dwordx4 v4, s[4:7], s38 offen offset:1024 lds
 s_add_u32 m0, s36, 24576
 s_add_u32 s38, s21, 0
 buffer_load_dwordx4 v3, s[8:11], s38 offen offset:0 lds
 buffer_load_dwordx4 v4, s[8:11], s38 offen offset:1024 lds
 buffer_load_dwordx4 v5, s[8:11], s38 offen offset:2048 lds
 buffer_load_dwordx4 v6, s[8:11], s38 offen offset:3072 lds
 s_add_u32 m0, s36, 28672
 s_add_u32 s38, s21, 256
 buffer_load_dwordx4 v3, s[8:11], s38 offen offset:0 lds
 buffer_load_dwordx4 v4, s[8:11], s38 offen offset:1024 lds
 v_accvgpr_write_b32 a162, v57
 v_mov_b32 v0, v55
 v_mov_b32 v74, 0x3f803f80
 s_waitcnt vmcnt(42)
 ds_read_b128 a[0:3], v76 offset:49152
 ds_read_b128 a[4:7], v77 offset:49152
 ds_read_b128 a[8:11], v78 offset:49152
 ds_read_b128 a[12:15], v79 offset:49152
 ds_read_b128 a[16:19], v76 offset:51200
 ds_read_b128 a[20:23], v77 offset:51200
 ds_read_b128 a[24:27], v78 offset:51200
 ds_read_b128 a[28:31], v79 offset:51200
 ds_read_b128 a[32:35], v76 offset:53248
 ds_read_b128 a[36:39], v77 offset:53248
 ds_read_b128 a[40:43], v78 offset:53248
 ds_read_b128 a[44:47], v79 offset:53248
 ds_read_b128 v[128:131], v76 offset:49152
 ds_read_b128 v[132:135], v77 offset:49152
 ds_read_b128 v[136:139], v78 offset:49152
 ds_read_b128 v[140:143], v79 offset:49152
 ds_read_b128 v[144:147], v76 offset:51200
 ds_read_b128 v[148:151], v77 offset:51200
 ds_read_b128 v[152:155], v78 offset:51200
 ds_read_b128 v[156:159], v79 offset:51200
 ds_read_b128 v[160:163], v76 offset:53248
 ds_read_b128 v[164:167], v77 offset:53248
 ds_read_b128 v[168:171], v78 offset:53248
 ds_read_b128 v[172:175], v79 offset:53248
 s_waitcnt lgkmcnt(0)
 s_cmp_eq_u32 s30, 1
 s_mov_b32 s38, 384
 s_cselect_b32 s38, -768, s38
 s_add_u32 s37, s37, s38
 s_add_u32 m0, s36, 98304
 s_add_u32 s38, s37, 0
 buffer_load_dwordx4 v3, s[4:7], s38 offen offset:0 lds
 v_dot2_f32_bf16 v70, v128, v74, 0
 v_dot2_f32_bf16 v71, v128, v128, 0
 v_dot2_f32_bf16 v72, v129, v74, 0
 v_dot2_f32_bf16 v73, v129, v129, 0
 v_dot2_f32_bf16 v70, v130, v74, v70
 v_dot2_f32_bf16 v71, v130, v130, v71
 v_dot2_f32_bf16 v72, v131, v74, v72
 v_dot2_f32_bf16 v73, v131, v131, v73
 buffer_load_dwordx4 v4, s[4:7], s38 offen offset:1024 lds
 v_dot2_f32_bf16 v70, v132, v74, v70
 v_dot2_f32_bf16 v71, v132, v132, v71
 v_dot2_f32_bf16 v72, v133, v74, v72
 v_dot2_f32_bf16 v73, v133, v133, v73
 v_dot2_f32_bf16 v70, v134, v74, v70
 v_dot2_f32_bf16 v71, v134, v134, v71
 v_dot2_f32_bf16 v72, v135, v74, v72
 v_dot2_f32_bf16 v73, v135, v135, v73
 buffer_load_dwordx4 v5, s[4:7], s38 offen offset:2048 lds
 v_dot2_f32_bf16 v70, v136, v74, v70
 v_dot2_f32_bf16 v71, v136, v136, v71
 v_dot2_f32_bf16 v72, v137, v74, v72
 v_dot2_f32_bf16 v73, v137, v137, v73
 v_dot2_f32_bf16 v70, v138, v74, v70
 v_dot2_f32_bf16 v71, v138, v138, v71
 v_dot2_f32_bf16 v72, v139, v74, v72
 v_dot2_f32_bf16 v73, v139, v139, v73
 buffer_load_dwordx4 v6, s[4:7], s38 offen offset:3072 lds
 v_dot2_f32_bf16 v70, v140, v74, v70
 v_dot2_f32_bf16 v71, v140, v140, v71
 v_dot2_f32_bf16 v72, v141, v74, v72
 v_dot2_f32_bf16 v73, v141, v141, v73
 v_dot2_f32_bf16 v70, v142, v74, v70
 v_dot2_f32_bf16 v71, v142, v142, v71
 v_dot2_f32_bf16 v72, v143, v74, v72
 v_dot2_f32_bf16 v73, v143, v143, v73
 s_add_u32 m0, s36, 102400
 s_add_u32 s38, s37, 256
 buffer_load_dwordx4 v3, s[4:7], s38 offen offset:0 lds
 v_dot2_f32_bf16 v70, v144, v74, v70
 v_dot2_f32_bf16 v71, v144, v144, v71
 v_dot2_f32_bf16 v72, v145, v74, v72
 v_dot2_f32_bf16 v73, v145, v145, v73
 v_dot2_f32_bf16 v70, v146, v74, v70
 v_dot2_f32_bf16 v71, v146, v146, v71
 v_dot2_f32_bf16 v72, v147, v74, v72
 v_dot2_f32_bf16 v73, v147, v147, v73
 buffer_load_dwordx4 v4, s[4:7], s38 offen offset:1024 lds
 v_dot2_f32_bf16 v70, v148, v74, v70
 v_dot2_f32_bf16 v71, v148, v148, v71
 v_dot2_f32_bf16 v72, v149, v74, v72
 v_dot2_f32_bf16 v73, v149, v149, v73
 v_dot2_f32_bf16 v70, v150, v74, v70
 v_dot2_f32_bf16 v71, v150, v150, v71
 v_dot2_f32_bf16 v72, v151, v74, v72
 v_dot2_f32_bf16 v73, v151, v151, v73
 s_add_u32 m0, s36, 122880
 s_add_u32 s38, s37, 18432
 buffer_load_dwordx4 v3, s[4:7], s38 offen offset:0 lds
 v_dot2_f32_bf16 v70, v152, v74, v70
 v_dot2_f32_bf16 v71, v152, v152, v71
 v_dot2_f32_bf16 v72, v153, v74, v72
 v_dot2_f32_bf16 v73, v153, v153, v73
 v_dot2_f32_bf16 v70, v154, v74, v70
 v_dot2_f32_bf16 v71, v154, v154, v71
 v_dot2_f32_bf16 v72, v155, v74, v72
 v_dot2_f32_bf16 v73, v155, v155, v73
 buffer_load_dwordx4 v4, s[4:7], s38 offen offset:1024 lds
 v_dot2_f32_bf16 v70, v156, v74, v70
 v_dot2_f32_bf16 v71, v156, v156, v71
 v_dot2_f32_bf16 v72, v157, v74, v72
 v_dot2_f32_bf16 v73, v157, v157, v73
 v_dot2_f32_bf16 v70, v158, v74, v70
 v_dot2_f32_bf16 v71, v158, v158, v71
 v_dot2_f32_bf16 v72, v159, v74, v72
 v_dot2_f32_bf16 v73, v159, v159, v73
 buffer_load_dwordx4 v5, s[4:7], s38 offen offset:2048 lds
 v_dot2_f32_bf16 v70, v160, v74, v70
 v_dot2_f32_bf16 v71, v160, v160, v71
 v_dot2_f32_bf16 v72, v161, v74, v72
 v_dot2_f32_bf16 v73, v161, v161, v73
 v_dot2_f32_bf16 v70, v162, v74, v70
 v_dot2_f32_bf16 v71, v162, v162, v71
 v_dot2_f32_bf16 v72, v163, v74, v72
 v_dot2_f32_bf16 v73, v163, v163, v73
 buffer_load_dwordx4 v6, s[4:7], s38 offen offset:3072 lds
 v_dot2_f32_bf16 v70, v164, v74, v70
 v_dot2_f32_bf16 v71, v164, v164, v71
 v_dot2_f32_bf16 v72, v165, v74, v72
 v_dot2_f32_bf16 v73, v165, v165, v73
 v_dot2_f32_bf16 v70, v166, v74, v70
 v_dot2_f32_bf16 v71, v166, v166, v71
 v_dot2_f32_bf16 v72, v167, v74, v72
 v_dot2_f32_bf16 v73, v167, v167, v73
 s_add_u32 m0, s36, 126976
 s_add_u32 s38, s37, 18688
 buffer_load_dwordx4 v3, s[4:7], s38 offen offset:0 lds
 v_dot2_f32_bf16 v70, v168, v74, v70
 v_dot2_f32_bf16 v71, v168, v168, v71
 v_dot2_f32_bf16 v72, v169, v74, v72
 v_dot2_f32_bf16 v73, v169, v169, v73
 v_dot2_f32_bf16 v70, v170, v74, v70
 v_dot2_f32_bf16 v71, v170, v170, v71
 v_dot2_f32_bf16 v72, v171, v74, v72
 v_dot2_f32_bf16 v73, v171, v171, v73
 buffer_load_dwordx4 v4, s[4:7], s38 offen offset:1024 lds
 v_dot2_f32_bf16 v70, v172, v74, v70
 v_dot2_f32_bf16 v71, v172, v172, v71
 v_dot2_f32_bf16 v72, v173, v74, v72
 v_dot2_f32_bf16 v73, v173, v173, v73
 v_dot2_f32_bf16 v70, v174, v74, v70
 v_dot2_f32_bf16 v71, v174, v174, v71
 v_dot2_f32_bf16 v72, v175, v74, v72
 v_dot2_f32_bf16 v73, v175, v175, v73
 s_waitcnt vmcnt(30)
 s_waitcnt lgkmcnt(0)
 s_barrier
 ds_read_b128 a[224:227], v1 offset:0
 ds_read_b128 a[228:231], v1 offset:12288
 ds_read_b128 a[232:235], v2 offset:0
 ds_read_b128 a[236:239], v2 offset:12288
 s_waitcnt lgkmcnt(3)
 v_mfma_f32_32x32x16_bf16 v[96:111], a[0:3], a[224:227], 0
 ds_read_b128 a[224:227], v53 offset:0
 v_lshlrev_b32 v10, 16, v10
 v_mul_f32 v10, 0x3fb8aa3b, v10
 v_exp_f32 v10, v10
 v_lshlrev_b32 v64, 16, v8
 v_lshlrev_b32 v65, 16, v9
 v_cvt_pk_bf16_f32 v10, v10, v10
 v_lshlrev_b32 v10, 16, v10
 s_waitcnt lgkmcnt(3)
 v_mfma_f32_32x32x16_bf16 v[112:127], a[0:3], a[228:231], 0
 ds_read_b128 a[228:231], v53 offset:12288
 s_waitcnt lgkmcnt(2)
 v_mul_f32 v8, v10, v64
 v_mul_f32 v9, v10, v65
 v_mul_f32 v8, 0x3fb8aa3b, v8
 v_mul_f32 v9, 0x3e22f983, v9
 v_exp_f32 v66, v8
 v_fract_f32 v67, v9
 v_mfma_f32_32x32x16_bf16 v[96:111], a[4:7], a[232:235], v[96:111]
 ds_read_b128 a[232:235], v54 offset:0
 v_cos_f32 v68, v67
 v_sin_f32 v67, v67
 v_mul_f32 v69, v64, v64
 v_fma_f32 v69, v65, v65, v69
 v_rcp_f32 v69, v69
 v_fma_f32 v68, v68, v66, -1.0
 v_mfma_f32_32x32x16_bf16 v[112:127], a[4:7], a[236:239], v[112:127]
 ds_read_b128 a[236:239], v54 offset:12288
 s_waitcnt lgkmcnt(2)
 v_mul_f32 v67, v67, v66
 v_add_f32 v69, v69, v69
 v_mul_f32 v10, v68, v64
 v_mul_f32 v11, v67, v64
 v_fma_f32 v10, v67, v65, v10
 v_fma_f32 v11, -v68, v65, v11
 v_mul_f32 v10, v10, v69
 v_mul_f32_e64 v11, -v11, v69
 v_mfma_f32_32x32x16_bf16 v[96:111], a[8:11], a[224:227], v[96:111]
 ds_read_b128 a[224:227], v1 offset:2048
 v_mfma_f32_32x32x16_bf16 v[112:127], a[8:11], a[228:231], v[112:127]
 ds_read_b128 a[228:231], v1 offset:14336
 s_waitcnt lgkmcnt(2)
 v_mfma_f32_32x32x16_bf16 v[96:111], a[12:15], a[232:235], v[96:111]
 ds_read_b128 a[232:235], v2 offset:2048
 s_waitcnt vmcnt(18)
 ds_read_b128 a[48:51], v76 offset:0
 ds_read_b128 a[52:55], v77 offset:0
 ds_read_b128 a[56:59], v78 offset:0
 ds_read_b128 a[60:63], v79 offset:0
 v_mfma_f32_32x32x16_bf16 v[112:127], a[12:15], a[236:239], v[112:127]
 ds_read_b128 a[236:239], v2 offset:14336
 ds_read_b128 a[64:67], v76 offset:2048
 ds_read_b128 a[68:71], v77 offset:2048
 ds_read_b128 a[72:75], v78 offset:2048
 ds_read_b128 a[76:79], v79 offset:2048
 s_waitcnt lgkmcnt(10)
 v_mfma_f32_32x32x16_bf16 v[96:111], a[16:19], a[224:227], v[96:111]
 ds_read_b128 a[224:227], v53 offset:2048
 ds_read_b128 a[80:83], v76 offset:4096
 ds_read_b128 a[84:87], v77 offset:4096
 ds_read_b128 a[88:91], v78 offset:4096
 ds_read_b128 a[92:95], v79 offset:4096
 v_mfma_f32_32x32x16_bf16 v[112:127], a[16:19], a[228:231], v[112:127]
 ds_read_b128 a[228:231], v53 offset:14336
 ds_read_b128 v[176:179], v76 offset:0
 ds_read_b128 v[180:183], v77 offset:0
 ds_read_b128 v[184:187], v78 offset:0
 ds_read_b128 v[188:191], v79 offset:0
 s_waitcnt lgkmcnt(14)
 v_mfma_f32_32x32x16_bf16 v[96:111], a[20:23], a[232:235], v[96:111]
 ds_read_b128 a[232:235], v54 offset:2048
 ds_read_b128 v[192:195], v76 offset:2048
 ds_read_b128 v[196:199], v77 offset:2048
 ds_read_b128 v[200:203], v78 offset:2048
 ds_read_b128 v[204:207], v79 offset:2048
 v_mfma_f32_32x32x16_bf16 v[112:127], a[20:23], a[236:239], v[112:127]
 ds_read_b128 a[236:239], v54 offset:14336
 ds_read_b128 v[208:211], v76 offset:4096
 ds_read_b128 v[212:215], v77 offset:4096
 ds_read_b128 v[216:219], v78 offset:4096
 ds_read_b128 v[220:223], v79 offset:4096
 s_waitcnt lgkmcnt(14)
 v_mfma_f32_32x32x16_bf16 v[96:111], a[24:27], a[224:227], v[96:111]
 ds_read_b128 a[224:227], v1 offset:4096
 v_mfma_f32_32x32x16_bf16 v[112:127], a[24:27], a[228:231], v[112:127]
 ds_read_b128 a[228:231], v1 offset:16384
 s_waitcnt lgkmcnt(2)
 s_add_u32 m0, s36, 49152
 s_add_u32 s38, s22, 0
 buffer_load_dwordx4 v3, s[8:11], s38 offen offset:0 lds
 v_dot2_f32_bf16 v70, v176, v74, v70
 v_mfma_f32_32x32x16_bf16 v[96:111], a[28:31], a[232:235], v[96:111]
 ds_read_b128 a[232:235], v2 offset:4096
 buffer_load_dwordx4 v4, s[8:11], s38 offen offset:1024 lds
 v_dot2_f32_bf16 v71, v176, v176, v71
 v_dot2_f32_bf16 v72, v177, v74, v72
 v_dot2_f32_bf16 v73, v177, v177, v73
 v_dot2_f32_bf16 v70, v178, v74, v70
 v_dot2_f32_bf16 v71, v178, v178, v71
 v_mfma_f32_32x32x16_bf16 v[112:127], a[28:31], a[236:239], v[112:127]
 ds_read_b128 a[236:239], v2 offset:16384
 buffer_load_dwordx4 v5, s[8:11], s38 offen offset:2048 lds
 s_waitcnt lgkmcnt(2)
 v_dot2_f32_bf16 v72, v179, v74, v72
 v_dot2_f32_bf16 v73, v179, v179, v73
 v_dot2_f32_bf16 v70, v180, v74, v70
 v_mfma_f32_32x32x16_bf16 v[96:111], a[32:35], a[224:227], v[96:111]
 ds_read_b128 a[224:227], v53 offset:4096
 buffer_load_dwordx4 v6, s[8:11], s38 offen offset:3072 lds
 v_dot2_f32_bf16 v71, v180, v180, v71
 v_dot2_f32_bf16 v72, v181, v74, v72
 v_dot2_f32_bf16 v73, v181, v181, v73
 v_dot2_f32_bf16 v70, v182, v74, v70
 v_dot2_f32_bf16 v71, v182, v182, v71
 v_mfma_f32_32x32x16_bf16 v[112:127], a[32:35], a[228:231], v[112:127]
 ds_read_b128 a[228:231], v53 offset:16384
 s_add_u32 m0, s36, 53248
 s_add_u32 s38, s22, 256
 buffer_load_dwordx4 v3, s[8:11], s38 offen offset:0 lds
 s_waitcnt lgkmcnt(2)
 v_dot2_f32_bf16 v72, v183, v74, v72
 v_mfma_f32_32x32x16_bf16 v[96:111], a[36:39], a[232:235], v[96:111]
 ds_read_b128 a[232:235], v54 offset:4096
 buffer_load_dwordx4 v4, s[8:11], s38 offen offset:1024 lds
 v_dot2_f32_bf16 v73, v183, v183, v73
 v_dot2_f32_bf16 v70, v184, v74, v70
 v_dot2_f32_bf16 v71, v184, v184, v71
 v_dot2_f32_bf16 v72, v185, v74, v72
 v_dot2_f32_bf16 v73, v185, v185, v73
 v_mfma_f32_32x32x16_bf16 v[112:127], a[36:39], a[236:239], v[112:127]
 ds_read_b128 a[236:239], v54 offset:16384
 s_add_u32 m0, s36, 73728
 s_add_u32 s38, s20, 36864
 buffer_load_dwordx4 v3, s[8:11], s38 offen offset:0 lds
 s_waitcnt lgkmcnt(2)
 v_dot2_f32_bf16 v70, v186, v74, v70
 v_mfma_f32_32x32x16_bf16 v[96:111], a[40:43], a[224:227], v[96:111]
 s_waitcnt vmcnt(19)
 s_barrier
 ds_read_b128 a[224:227], v1 offset:24576
 buffer_load_dwordx4 v4, s[8:11], s38 offen offset:1024 lds
 v_dot2_f32_bf16 v71, v186, v186, v71
 v_dot2_f32_bf16 v72, v187, v74, v72
 v_dot2_f32_bf16 v73, v187, v187, v73
 v_mfma_f32_32x32x16_bf16 v[112:127], a[40:43], a[228:231], v[112:127]
 ds_read_b128 a[228:231], v1 offset:36864
 buffer_load_dwordx4 v5, s[8:11], s38 offen offset:2048 lds
 s_waitcnt lgkmcnt(2)
 v_dot2_f32_bf16 v70, v188, v74, v70
 v_dot2_f32_bf16 v71, v188, v188, v71
 v_dot2_f32_bf16 v72, v189, v74, v72
 v_mfma_f32_32x32x16_bf16 v[96:111], a[44:47], a[232:235], v[96:111]
 ds_read_b128 a[232:235], v2 offset:24576
 buffer_load_dwordx4 v6, s[8:11], s38 offen offset:3072 lds
 v_dot2_f32_bf16 v73, v189, v189, v73
 v_dot2_f32_bf16 v70, v190, v74, v70
 v_dot2_f32_bf16 v71, v190, v190, v71
 v_dot2_f32_bf16 v72, v191, v74, v72
 v_dot2_f32_bf16 v73, v191, v191, v73
 v_mfma_f32_32x32x16_bf16 v[112:127], a[44:47], a[236:239], v[112:127]
 ds_read_b128 a[236:239], v2 offset:36864
 s_add_u32 m0, s36, 77824
 s_add_u32 s38, s20, 37120
 buffer_load_dwordx4 v3, s[8:11], s38 offen offset:0 lds
 s_waitcnt lgkmcnt(2)
 v_dot2_f32_bf16 v70, v192, v74, v70
 v_mfma_f32_32x32x16_bf16 v[96:111], a[48:51], a[224:227], v[96:111]
 ds_read_b128 a[224:227], v53 offset:24576
 buffer_load_dwordx4 v4, s[8:11], s38 offen offset:1024 lds
 v_dot2_f32_bf16 v71, v192, v192, v71
 v_dot2_f32_bf16 v72, v193, v74, v72
 v_dot2_f32_bf16 v73, v193, v193, v73
 v_dot2_f32_bf16 v70, v194, v74, v70
 v_dot2_f32_bf16 v71, v194, v194, v71
 v_mfma_f32_32x32x16_bf16 v[112:127], a[48:51], a[228:231], v[112:127]
 ds_read_b128 a[228:231], v53 offset:36864
 s_waitcnt lgkmcnt(2)
 v_dot2_f32_bf16 v72, v195, v74, v72
 v_dot2_f32_bf16 v73, v195, v195, v73
 v_dot2_f32_bf16 v70, v196, v74, v70
 v_dot2_f32_bf16 v71, v196, v196, v71
 v_dot2_f32_bf16 v72, v197, v74, v72
 v_dot2_f32_bf16 v73, v197, v197, v73
 v_dot2_f32_bf16 v70, v198, v74, v70
 v_mfma_f32_32x32x16_bf16 v[96:111], a[52:55], a[232:235], v[96:111]
 ds_read_b128 a[232:235], v54 offset:24576
 s_waitcnt vmcnt(12)
 ds_read_b128 a[96:99], v76 offset:49152
 ds_read_b128 a[100:103], v77 offset:49152
 ds_read_b128 a[104:107], v78 offset:49152
 ds_read_b128 a[108:111], v79 offset:49152
 v_dot2_f32_bf16 v71, v198, v198, v71
 v_dot2_f32_bf16 v72, v199, v74, v72
 v_dot2_f32_bf16 v73, v199, v199, v73
 v_dot2_f32_bf16 v70, v200, v74, v70
 v_dot2_f32_bf16 v71, v200, v200, v71
 v_mfma_f32_32x32x16_bf16 v[112:127], a[52:55], a[236:239], v[112:127]
 ds_read_b128 a[236:239], v54 offset:36864
 ds_read_b128 a[112:115], v76 offset:51200
 ds_read_b128 a[116:119], v77 offset:51200
 ds_read_b128 a[120:123], v78 offset:51200
 ds_read_b128 a[124:127], v79 offset:51200
 s_waitcnt lgkmcnt(10)
 v_dot2_f32_bf16 v72, v201, v74, v72
 v_dot2_f32_bf16 v73, v201, v201, v73
 v_dot2_f32_bf16 v70, v202, v74, v70
 v_mfma_f32_32x32x16_bf16 v[96:111], a[56:59], a[224:227], v[96:111]
 ds_read_b128 a[224:227], v1 offset:26624
 ds_read_b128 a[128:131], v76 offset:53248
 ds_read_b128 a[132:135], v77 offset:53248
 ds_read_b128 a[136:139], v78 offset:53248
 ds_read_b128 a[140:143], v79 offset:53248
 v_dot2_f32_bf16 v71, v202, v202, v71
 v_dot2_f32_bf16 v72, v203, v74, v72
 v_dot2_f32_bf16 v73, v203, v203, v73
 v_dot2_f32_bf16 v70, v204, v74, v70
 v_dot2_f32_bf16 v71, v204, v204, v71
 v_mfma_f32_32x32x16_bf16 v[112:127], a[56:59], a[228:231], v[112:127]
 ds_read_b128 a[228:231], v1 offset:38912
 ds_read_b128 v[224:227], v76 offset:49152
 ds_read_b128 v[228:231], v77 offset:49152
 ds_read_b128 v[232:235], v78 offset:49152
 ds_read_b128 v[236:239], v79 offset:49152
 s_waitcnt lgkmcnt(14)
 v_dot2_f32_bf16 v72, v205, v74, v72
 v_dot2_f32_bf16 v73, v205, v205, v73
 v_dot2_f32_bf16 v70, v206, v74, v70
 v_mfma_f32_32x32x16_bf16 v[96:111], a[60:63], a[232:235], v[96:111]
 ds_read_b128 a[232:235], v2 offset:26624
 ds_read_b128 v[240:243], v76 offset:51200
 ds_read_b128 v[244:247], v77 offset:51200
 ds_read_b128 v[248:251], v78 offset:51200
 ds_read_b128 v[252:255], v79 offset:51200
 buffer_load_dword v56, off, s[24:27], 0 sc1
 v_dot2_f32_bf16 v71, v206, v206, v71
 v_dot2_f32_bf16 v72, v207, v74, v72
 v_dot2_f32_bf16 v73, v207, v207, v73
 v_mfma_f32_32x32x16_bf16 v[112:127], a[60:63], a[236:239], v[112:127]
 ds_read_b128 a[236:239], v2 offset:38912
 ds_read_b128 v[80:83], v76 offset:53248
 ds_read_b128 v[84:87], v77 offset:53248
 ds_read_b128 v[88:91], v78 offset:53248
 ds_read_b128 v[92:95], v79 offset:53248
 s_waitcnt lgkmcnt(14)
 v_dot2_f32_bf16 v70, v208, v74, v70
 v_dot2_f32_bf16 v71, v208, v208, v71
 v_dot2_f32_bf16 v72, v209, v74, v72
 v_mfma_f32_32x32x16_bf16 v[96:111], a[64:67], a[224:227], v[96:111]
 ds_read_b128 a[224:227], v53 offset:26624
 v_dot2_f32_bf16 v73, v209, v209, v73
 v_dot2_f32_bf16 v70, v210, v74, v70
 v_dot2_f32_bf16 v71, v210, v210, v71
 v_dot2_f32_bf16 v72, v211, v74, v72
 v_dot2_f32_bf16 v73, v211, v211, v73
 v_dot2_f32_bf16 v70, v212, v74, v70
 v_dot2_f32_bf16 v71, v212, v212, v71
 v_dot2_f32_bf16 v72, v213, v74, v72
 v_dot2_f32_bf16 v73, v213, v213, v73
 v_mfma_f32_32x32x16_bf16 v[112:127], a[64:67], a[228:231], v[112:127]
 ds_read_b128 a[228:231], v53 offset:38912
 s_waitcnt lgkmcnt(2)
 s_add_u32 m0, s36, 98304
 s_add_u32 s38, s21, 36864
 buffer_load_dwordx4 v3, s[8:11], s38 offen offset:0 lds
 v_dot2_f32_bf16 v70, v214, v74, v70
 v_mfma_f32_32x32x16_bf16 v[96:111], a[68:71], a[232:235], v[96:111]
 ds_read_b128 a[232:235], v54 offset:26624
 buffer_load_dwordx4 v4, s[8:11], s38 offen offset:1024 lds
 v_dot2_f32_bf16 v71, v214, v214, v71
 v_dot2_f32_bf16 v72, v215, v74, v72
 v_dot2_f32_bf16 v73, v215, v215, v73
 v_dot2_f32_bf16 v70, v216, v74, v70
 v_dot2_f32_bf16 v71, v216, v216, v71
 v_mfma_f32_32x32x16_bf16 v[112:127], a[68:71], a[236:239], v[112:127]
 ds_read_b128 a[236:239], v54 offset:38912
 buffer_load_dwordx4 v5, s[8:11], s38 offen offset:2048 lds
 s_waitcnt lgkmcnt(2)
 v_dot2_f32_bf16 v72, v217, v74, v72
 v_dot2_f32_bf16 v73, v217, v217, v73
 v_dot2_f32_bf16 v70, v218, v74, v70
 v_mfma_f32_32x32x16_bf16 v[96:111], a[72:75], a[224:227], v[96:111]
 ds_read_b128 a[224:227], v1 offset:28672
 buffer_load_dwordx4 v6, s[8:11], s38 offen offset:3072 lds
 v_dot2_f32_bf16 v71, v218, v218, v71
 v_dot2_f32_bf16 v72, v219, v74, v72
 v_dot2_f32_bf16 v73, v219, v219, v73
 v_dot2_f32_bf16 v70, v220, v74, v70
 v_dot2_f32_bf16 v71, v220, v220, v71
 v_mfma_f32_32x32x16_bf16 v[112:127], a[72:75], a[228:231], v[112:127]
 ds_read_b128 a[228:231], v1 offset:40960
 s_add_u32 m0, s36, 102400
 s_add_u32 s38, s21, 37120
 buffer_load_dwordx4 v3, s[8:11], s38 offen offset:0 lds
 s_waitcnt lgkmcnt(2)
 v_dot2_f32_bf16 v72, v221, v74, v72
 v_mfma_f32_32x32x16_bf16 v[96:111], a[76:79], a[232:235], v[96:111]
 ds_read_b128 a[232:235], v2 offset:28672
 buffer_load_dwordx4 v4, s[8:11], s38 offen offset:1024 lds
 v_dot2_f32_bf16 v73, v221, v221, v73
 v_dot2_f32_bf16 v70, v222, v74, v70
 v_dot2_f32_bf16 v71, v222, v222, v71
 v_dot2_f32_bf16 v72, v223, v74, v72
 v_dot2_f32_bf16 v73, v223, v223, v73
 v_mfma_f32_32x32x16_bf16 v[112:127], a[76:79], a[236:239], v[112:127]
 ds_read_b128 a[236:239], v2 offset:40960
 s_add_u32 m0, s36, 122880
 s_add_u32 s38, s22, 36864
 buffer_load_dwordx4 v3, s[8:11], s38 offen offset:0 lds
 s_waitcnt lgkmcnt(2)
 v_dot2_f32_bf16 v70, v224, v74, v70
 v_mfma_f32_32x32x16_bf16 v[96:111], a[80:83], a[224:227], v[96:111]
 ds_read_b128 a[224:227], v53 offset:28672
 buffer_load_dwordx4 v4, s[8:11], s38 offen offset:1024 lds
 v_dot2_f32_bf16 v71, v224, v224, v71
 v_dot2_f32_bf16 v72, v225, v74, v72
 v_dot2_f32_bf16 v73, v225, v225, v73
 v_dot2_f32_bf16 v70, v226, v74, v70
 v_dot2_f32_bf16 v71, v226, v226, v71
 v_mfma_f32_32x32x16_bf16 v[112:127], a[80:83], a[228:231], v[112:127]
 ds_read_b128 a[228:231], v53 offset:40960
 buffer_load_dwordx4 v5, s[8:11], s38 offen offset:2048 lds
 s_waitcnt lgkmcnt(2)
 v_dot2_f32_bf16 v72, v227, v74, v72
 v_dot2_f32_bf16 v73, v227, v227, v73
 v_dot2_f32_bf16 v70, v228, v74, v70
 v_mfma_f32_32x32x16_bf16 v[96:111], a[84:87], a[232:235], v[96:111]
 ds_read_b128 a[232:235], v54 offset:28672
 buffer_load_dwordx4 v6, s[8:11], s38 offen offset:3072 lds
 v_dot2_f32_bf16 v71, v228, v228, v71
 v_dot2_f32_bf16 v72, v229, v74, v72
 v_dot2_f32_bf16 v73, v229, v229, v73
 v_dot2_f32_bf16 v70, v230, v74, v70
 v_dot2_f32_bf16 v71, v230, v230, v71
 v_mfma_f32_32x32x16_bf16 v[112:127], a[84:87], a[236:239], v[112:127]
 ds_read_b128 a[236:239], v54 offset:40960
 s_add_u32 m0, s36, 126976
 s_add_u32 s38, s22, 37120
 buffer_load_dwordx4 v3, s[8:11], s38 offen offset:0 lds
 s_waitcnt lgkmcnt(2)
 v_dot2_f32_bf16 v72, v231, v74, v72
 v_mfma_f32_32x32x16_bf16 v[96:111], a[88:91], a[224:227], v[96:111]
 s_waitcnt vmcnt(18)
 s_barrier
 v_add_u32 v1, 49152, v1
 v_add_u32 v2, 49152, v2
 v_add_u32 v53, 49152, v53
 v_add_u32 v54, 49152, v54
 ds_read_b128 a[224:227], v1 offset:0
 buffer_load_dwordx4 v4, s[8:11], s38 offen offset:1024 lds
 v_mfma_f32_32x32x16_bf16 v[112:127], a[88:91], a[228:231], v[112:127]
 ds_read_b128 a[228:231], v1 offset:12288
 s_add_u32 m0, s36, 0
 s_add_u32 s38, s20, 73728
 buffer_load_dwordx4 v3, s[8:11], s38 offen offset:0 lds
 s_waitcnt lgkmcnt(2)
 v_mfma_f32_32x32x16_bf16 v[96:111], a[92:95], a[232:235], v[96:111]
 ds_read_b128 a[232:235], v2 offset:0
 v_dot2_f32_bf16 v73, v231, v231, v73
 v_dot2_f32_bf16 v70, v232, v74, v70
 v_dot2_f32_bf16 v71, v232, v232, v71
 v_dot2_f32_bf16 v72, v233, v74, v72
 v_dot2_f32_bf16 v73, v233, v233, v73
 v_dot2_f32_bf16 v70, v234, v74, v70
 v_dot2_f32_bf16 v71, v234, v234, v71
 v_dot2_f32_bf16 v72, v235, v74, v72
 v_dot2_f32_bf16 v73, v235, v235, v73
 v_mfma_f32_32x32x16_bf16 v[112:127], a[92:95], a[236:239], v[112:127]
 ds_read_b128 a[236:239], v2 offset:12288
 s_waitcnt lgkmcnt(2)
 v_dot2_f32_bf16 v70, v236, v74, v70
 v_dot2_f32_bf16 v71, v236, v236, v71
 v_dot2_f32_bf16 v72, v237, v74, v72
 v_dot2_f32_bf16 v73, v237, v237, v73
 v_dot2_f32_bf16 v70, v238, v74, v70
 v_dot2_f32_bf16 v71, v238, v238, v71
 v_dot2_f32_bf16 v72, v239, v74, v72
 v_mfma_f32_32x32x16_bf16 v[96:111], a[96:99], a[224:227], v[96:111]
 ds_read_b128 a[224:227], v53 offset:0
 buffer_load_dwordx4 v4, s[8:11], s38 offen offset:1024 lds
 v_dot2_f32_bf16 v73, v239, v239, v73
 v_dot2_f32_bf16 v70, v240, v74, v70
 v_dot2_f32_bf16 v71, v240, v240, v71
 v_dot2_f32_bf16 v72, v241, v74, v72
 v_dot2_f32_bf16 v73, v241, v241, v73
 v_mfma_f32_32x32x16_bf16 v[112:127], a[96:99], a[228:231], v[112:127]
 ds_read_b128 a[228:231], v53 offset:12288
 s_waitcnt lgkmcnt(2)
 v_dot2_f32_bf16 v70, v242, v74, v70
 v_dot2_f32_bf16 v71, v242, v242, v71
 v_dot2_f32_bf16 v72, v243, v74, v72
 v_dot2_f32_bf16 v73, v243, v243, v73
 v_dot2_f32_bf16 v70, v244, v74, v70
 v_dot2_f32_bf16 v71, v244, v244, v71
 v_dot2_f32_bf16 v72, v245, v74, v72
 v_mfma_f32_32x32x16_bf16 v[96:111], a[100:103], a[232:235], v[96:111]
 ds_read_b128 a[232:235], v54 offset:0
 s_waitcnt vmcnt(14)
 v_cmp_eq_u32 vcc, 0, v56
 s_cbranch_vccnz L_sn
L_sn_b:
 v_readfirstlane_b32 s45, v56
 s_and_b32 s90, s45, 0xbfffbfff
 v_dot2_f32_bf16 v73, v245, v245, v73
 v_dot2_f32_bf16 v70, v246, v74, v70
 v_dot2_f32_bf16 v71, v246, v246, v71
 v_dot2_f32_bf16 v72, v247, v74, v72
 v_dot2_f32_bf16 v73, v247, v247, v73
 v_dot2_f32_bf16 v70, v248, v74, v70
 v_mfma_f32_32x32x16_bf16 v[112:127], a[100:103], a[236:239], v[112:127]
 ds_read_b128 a[236:239], v54 offset:12288
 buffer_load_dwordx4 v5, s[8:11], s38 offen offset:2048 lds
 s_waitcnt lgkmcnt(2)
 v_dot2_f32_bf16 v71, v248, v248, v71
 v_dot2_f32_bf16 v72, v249, v74, v72
 v_dot2_f32_bf16 v73, v249, v249, v73
 v_mfma_f32_32x32x16_bf16 v[96:111], a[104:107], a[224:227], v[96:111]
 ds_read_b128 a[224:227], v1 offset:2048
 v_dot2_f32_bf16 v70, v250, v74, v70
 v_dot2_f32_bf16 v71, v250, v250, v71
 v_dot2_f32_bf16 v72, v251, v74, v72
 v_dot2_f32_bf16 v73, v251, v251, v73
 v_dot2_f32_bf16 v70, v252, v74, v70
 v_dot2_f32_bf16 v71, v252, v252, v71
 v_dot2_f32_bf16 v72, v253, v74, v72
 v_dot2_f32_bf16 v73, v253, v253, v73
 v_dot2_f32_bf16 v70, v254, v74, v70
 v_mfma_f32_32x32x16_bf16 v[112:127], a[104:107], a[228:231], v[112:127]
 ds_read_b128 a[228:231], v1 offset:14336
 s_waitcnt lgkmcnt(2)
 v_dot2_f32_bf16 v71, v254, v254, v71
 v_dot2_f32_bf16 v72, v255, v74, v72
 v_dot2_f32_bf16 v73, v255, v255, v73
 v_dot2_f32_bf16 v70, v80, v74, v70
 v_dot2_f32_bf16 v71, v80, v80, v71
 v_dot2_f32_bf16 v72, v81, v74, v72
 v_dot2_f32_bf16 v73, v81, v81, v73
 v_mfma_f32_32x32x16_bf16 v[96:111], a[108:111], a[232:235], v[96:111]
 ds_read_b128 a[232:235], v2 offset:2048
 buffer_load_dwordx4 v6, s[8:11], s38 offen offset:3072 lds
 buffer_load_dwordx4 a[152:155], v23, s[16:19], s35 offen sc1
 v_dot2_f32_bf16 v70, v82, v74, v70
 v_mfma_f32_32x32x16_bf16 v[112:127], a[108:111], a[236:239], v[112:127]
 ds_read_b128 a[236:239], v2 offset:14336
 s_waitcnt lgkmcnt(2)
 v_dot2_f32_bf16 v71, v82, v82, v71
 v_dot2_f32_bf16 v72, v83, v74, v72
 v_dot2_f32_bf16 v73, v83, v83, v73
 v_dot2_f32_bf16 v70, v84, v74, v70
 v_dot2_f32_bf16 v71, v84, v84, v71
 v_dot2_f32_bf16 v72, v85, v74, v72
 v_dot2_f32_bf16 v73, v85, v85, v73
 v_mfma_f32_32x32x16_bf16 v[96:111], a[112:115], a[224:227], v[96:111]
 ds_read_b128 a[224:227], v53 offset:2048
 v_dot2_f32_bf16 v70, v86, v74, v70
 v_dot2_f32_bf16 v71, v86, v86, v71
 v_dot2_f32_bf16 v72, v87, v74, v72
 v_dot2_f32_bf16 v73, v87, v87, v73
 v_dot2_f32_bf16 v70, v88, v74, v70
 v_dot2_f32_bf16 v71, v88, v88, v71
 v_dot2_f32_bf16 v72, v89, v74, v72
 v_dot2_f32_bf16 v73, v89, v89, v73
 v_dot2_f32_bf16 v70, v90, v74, v70
 v_mfma_f32_32x32x16_bf16 v[112:127], a[112:115], a[228:231], v[112:127]
 ds_read_b128 a[228:231], v53 offset:14336
 s_add_u32 m0, s36, 4096
 s_add_u32 s38, s20, 73984
 buffer_load_dwordx4 v3, s[8:11], s38 offen offset:0 lds
 s_waitcnt lgkmcnt(2)
 v_dot2_f32_bf16 v71, v90, v90, v71
 v_mfma_f32_32x32x16_bf16 v[96:111], a[116:119], a[232:235], v[96:111]
 ds_read_b128 a[232:235], v54 offset:2048
 v_dot2_f32_bf16 v72, v91, v74, v72
 v_dot2_f32_bf16 v73, v91, v91, v73
 v_dot2_f32_bf16 v70, v92, v74, v70
 v_dot2_f32_bf16 v71, v92, v92, v71
 v_dot2_f32_bf16 v72, v93, v74, v72
 v_dot2_f32_bf16 v73, v93, v93, v73
 v_dot2_f32_bf16 v70, v94, v74, v70
 v_dot2_f32_bf16 v71, v94, v94, v71
 v_dot2_f32_bf16 v72, v95, v74, v72
 v_mfma_f32_32x32x16_bf16 v[112:127], a[116:119], a[236:239], v[112:127]
 ds_read_b128 a[236:239], v54 offset:14336
 s_waitcnt lgkmcnt(2)
 v_dot2_f32_bf16 v73, v95, v95, v73
 v_add_f32 v70, v70, v72
 s_nop 1
 v_add_f32 v71, v71, v73
 v_mov_b32 v72, v70
 v_mov_b32 v73, v71
 s_nop 0
 v_permlane32_swap_b32 v70, v72
 v_permlane32_swap_b32 v71, v73
 v_mfma_f32_32x32x16_bf16 v[96:111], a[120:123], a[224:227], v[96:111]
 ds_read_b128 a[224:227], v1 offset:4096
 buffer_load_dwordx4 v4, s[8:11], s38 offen offset:1024 lds
 v_add_f32 v70, v70, v72
 v_add_f32 v71, v71, v73
 v_mul_f32 v70, 0x3ae38e39, v70
 v_mul_f32 v71, 0x3ae38e39, v71
 v_fma_f32 v71, -v70, v70, v71
 v_mfma_f32_32x32x16_bf16 v[112:127], a[120:123], a[228:231], v[112:127]
 ds_read_b128 a[228:231], v1 offset:16384
 s_waitcnt lgkmcnt(2)
 v_max_f32 v71, 0, v71
 v_add_f32 v71, 0x3727c5ac, v71
 v_rsq_f32 v71, v71
 v_cvt_pk_bf16_f32 v72, -v70, -v70
 v_lshlrev_b32 v73, 16, v72
 ds_write_b32 v75, v71
 v_mfma_f32_32x32x16_bf16 v[96:111], a[124:127], a[232:235], v[96:111]
 ds_read_b128 a[232:235], v2 offset:4096
 v_add_f32 v73, v73, v70
 v_cvt_pk_bf16_f32 v73, -v73, 0
 ds_read_b128 v[80:83], v58 offset:0
 ds_read_b128 v[84:87], v58 offset:16
 ds_read_b128 v[88:91], v58 offset:32
 ds_read_b128 v[92:95], v58 offset:48
 v_and_b32 v70, v72, v59
 v_and_b32 v71, v73, v59
 v_xor_b32 v72, v72, v70
 v_mfma_f32_32x32x16_bf16 v[112:127], a[124:127], a[236:239], v[112:127]
 ds_read_b128 a[236:239], v2 offset:16384
 s_waitcnt lgkmcnt(7)
 v_xor_b32 v73, v73, v71
 v_accvgpr_write_b32 a146, 0
 v_accvgpr_write_b32 a147, 0
 v_accvgpr_write_b32 a150, 0
 v_accvgpr_write_b32 a151, 0
 v_accvgpr_write_b32 a144, v70
 v_accvgpr_write_b32 a145, v71
 v_mfma_f32_32x32x16_bf16 v[96:111], a[128:131], a[224:227], v[96:111]
 ds_read_b128 a[224:227], v53 offset:4096
 v_accvgpr_write_b32 a148, v72
 v_accvgpr_write_b32 a149, v73
 v_mfma_f32_32x32x16_bf16 v[112:127], a[128:131], a[228:231], v[112:127]
 ds_read_b128 a[228:231], v53 offset:16384
 s_waitcnt lgkmcnt(2)
 v_mfma_f32_32x32x16_bf16 v[96:111], a[132:135], a[232:235], v[96:111]
 ds_read_b128 a[232:235], v54 offset:4096
 v_mfma_f32_32x32x16_bf16 v[112:127], a[132:135], a[236:239], v[112:127]
 ds_read_b128 a[236:239], v54 offset:16384
 s_waitcnt lgkmcnt(2)
 v_mfma_f32_32x32x16_bf16 v[96:111], a[136:139], a[224:227], v[96:111]
 v_exp_f32 v55, v8
 v_fract_f32 v22, v9
 v_cos_f32 v21, v22
 v_sin_f32 v22, v22
 v_mul_f32 v21, v21, v55
 v_mfma_f32_32x32x16_bf16 v[112:127], a[136:139], a[228:231], v[112:127]
 s_waitcnt lgkmcnt(0)
 v_mul_f32 v22, v22, v55
 v_mfma_f32_32x32x16_bf16 v[96:111], a[140:143], a[232:235], v[96:111]
 s_barrier
 ds_read_b128 a[232:235], v1 offset:24576
 s_waitcnt vmcnt(2)
 v_accvgpr_read_b32 v63, a155
 v_cmp_ne_u32 vcc, s90, v63
 s_cbranch_vccnz L_sx0
L_sx0_b:
 v_mfma_f32_32x32x16_bf16 v[112:127], a[140:143], a[236:239], v[112:127]
 ds_read_b128 a[236:239], v1 offset:36864
 s_add_u32 m0, s36, 24576
 s_add_u32 s38, s21, 73728
 buffer_load_dwordx4 v3, s[8:11], s38 offen offset:0 lds
 v_mfma_f32_32x32x16_bf16 v[96:111], a[144:147], a[152:155], v[96:111]
 ds_read_b128 a[224:227], v2 offset:24576
 v_mfma_f32_32x32x16_bf16 v[112:127], a[148:151], a[152:155], v[112:127]
 ds_read_b128 a[228:231], v2 offset:36864
 s_waitcnt lgkmcnt(2)
 v_mfma_f32_32x32x16_bf16 v[128:143], a[0:3], a[232:235], 0
 ds_read_b128 a[232:235], v53 offset:24576
 buffer_load_dwordx4 v4, s[8:11], s38 offen offset:1024 lds
 v_mfma_f32_32x32x16_bf16 v[144:159], a[0:3], a[236:239], 0
 ds_read_b128 a[236:239], v53 offset:36864
 s_waitcnt lgkmcnt(2)
 v_mfma_f32_32x32x16_bf16 v[128:143], a[4:7], a[224:227], v[128:143]
 ds_read_b128 a[224:227], v54 offset:24576
 v_mul_f32 v96, v96, v80
 s_nop 0
 v_mul_f32 v112, v112, v80
 v_mul_f32 v97, v97, v81
 v_mul_f32 v113, v113, v81
 v_mul_f32 v98, v98, v82
 v_mul_f32 v114, v114, v82
 v_mfma_f32_32x32x16_bf16 v[144:159], a[4:7], a[228:231], v[144:159]
 ds_read_b128 a[228:231], v54 offset:36864
 buffer_load_dwordx4 v5, s[8:11], s38 offen offset:2048 lds
 s_waitcnt lgkmcnt(2)
 v_mul_f32 v99, v99, v83
 v_mfma_f32_32x32x16_bf16 v[128:143], a[8:11], a[232:235], v[128:143]
 ds_read_b128 a[232:235], v1 offset:26624
 v_mul_f32 v115, v115, v83
 v_mul_f32 v100, v100, v84
 v_mul_f32 v116, v116, v84
 v_mul_f32 v101, v101, v85
 v_mul_f32 v117, v117, v85
 v_mul_f32 v102, v102, v86
 v_mfma_f32_32x32x16_bf16 v[144:159], a[8:11], a[236:239], v[144:159]
 ds_read_b128 a[236:239], v1 offset:38912
 s_waitcnt lgkmcnt(2)
 v_mul_f32 v118, v118, v86
 v_mul_f32 v103, v103, v87
 v_mul_f32 v119, v119, v87
 v_mul_f32 v104, v104, v88
 v_mul_f32 v120, v120, v88
 v_mfma_f32_32x32x16_bf16 v[128:143], a[12:15], a[224:227], v[128:143]
 ds_read_b128 a[224:227], v2 offset:26624
 buffer_load_dwordx4 v6, s[8:11], s38 offen offset:3072 lds
 v_mul_f32 v105, v105, v89
 v_mul_f32 v121, v121, v89
 v_mfma_f32_32x32x16_bf16 v[144:159], a[12:15], a[228:231], v[144:159]
 ds_read_b128 a[228:231], v2 offset:38912
 s_waitcnt lgkmcnt(2)
 v_mul_f32 v106, v106, v90
 v_mul_f32 v122, v122, v90
 v_mul_f32 v107, v107, v91
 v_mul_f32 v123, v123, v91
 v_mul_f32 v108, v108, v92
 v_mfma_f32_32x32x16_bf16 v[128:143], a[16:19], a[232:235], v[128:143]
 ds_read_b128 a[232:235], v53 offset:26624
 v_mul_f32 v124, v124, v92
 v_mul_f32 v109, v109, v93
 v_mul_f32 v125, v125, v93
 v_mul_f32 v110, v110, v94
 v_mul_f32 v126, v126, v94
 v_mul_f32 v111, v111, v95
 v_mfma_f32_32x32x16_bf16 v[144:159], a[16:19], a[236:239], v[144:159]
 ds_read_b128 a[236:239], v53 offset:38912
 s_add_u32 m0, s36, 28672
 s_add_u32 s38, s21, 73984
 buffer_load_dwordx4 v3, s[8:11], s38 offen offset:0 lds
 s_waitcnt lgkmcnt(2)
 v_mfma_f32_32x32x16_bf16 v[128:143], a[20:23], a[224:227], v[128:143]
 ds_read_b128 a[224:227], v54 offset:26624
 v_mul_f32 v127, v127, v95
 v_sub_f32 v70, 0, v22
 v_fma_f32 v66, v21, v96, v97
 v_fma_f32 v67, v21, v112, v113
 v_fmac_f32 v66, v70, v112
 v_mfma_f32_32x32x16_bf16 v[144:159], a[20:23], a[228:231], v[144:159]
 ds_read_b128 a[228:231], v54 offset:38912
 s_waitcnt lgkmcnt(2)
 v_fmac_f32 v67, v22, v96
 v_fma_f32 v64, v21, v66, v98
 v_fma_f32 v65, v21, v67, v114
 v_fmac_f32 v64, v70, v67
 v_fmac_f32 v65, v22, v66
 v_mfma_f32_32x32x16_bf16 v[128:143], a[24:27], a[232:235], v[128:143]
 ds_read_b128 a[232:235], v1 offset:28672
 buffer_load_dwordx4 v4, s[8:11], s38 offen offset:1024 lds
 v_fma_f32 v66, v21, v64, v99
 v_fma_f32 v67, v21, v65, v115
 v_mfma_f32_32x32x16_bf16 v[144:159], a[24:27], a[236:239], v[144:159]
 ds_read_b128 a[236:239], v1 offset:40960
 s_waitcnt lgkmcnt(2)
 v_fmac_f32 v66, v70, v65
 v_fmac_f32 v67, v22, v64
 v_fma_f32 v64, v21, v66, v100
 v_fma_f32 v65, v21, v67, v116
 v_fmac_f32 v64, v70, v67
 v_mfma_f32_32x32x16_bf16 v[128:143], a[28:31], a[224:227], v[128:143]
 ds_read_b128 a[224:227], v2 offset:28672
 v_fmac_f32 v65, v22, v66
 v_fma_f32 v66, v21, v64, v101
 v_fma_f32 v67, v21, v65, v117
 v_fmac_f32 v66, v70, v65
 v_fmac_f32 v67, v22, v64
 v_fma_f32 v64, v21, v66, v102
 v_mfma_f32_32x32x16_bf16 v[144:159], a[28:31], a[228:231], v[144:159]
 ds_read_b128 a[228:231], v2 offset:40960
 s_waitcnt lgkmcnt(2)
 v_fma_f32 v65, v21, v67, v118
 v_fmac_f32 v64, v70, v67
 v_fmac_f32 v65, v22, v66
 v_fma_f32 v66, v21, v64, v103
 v_fma_f32 v67, v21, v65, v119
 v_mfma_f32_32x32x16_bf16 v[128:143], a[32:35], a[232:235], v[128:143]
 ds_read_b128 a[232:235], v53 offset:28672
 v_fmac_f32 v66, v70, v65
 v_fmac_f32 v67, v22, v64
 v_fma_f32 v64, v21, v66, v104
 v_fma_f32 v65, v21, v67, v120
 v_fmac_f32 v64, v70, v67
 v_fmac_f32 v65, v22, v66
 v_mfma_f32_32x32x16_bf16 v[144:159], a[32:35], a[236:239], v[144:159]
 ds_read_b128 a[236:239], v53 offset:40960
 s_waitcnt lgkmcnt(2)
 v_fma_f32 v66, v21, v64, v105
 v_fma_f32 v67, v21, v65, v121
 v_fmac_f32 v66, v70, v65
 v_fmac_f32 v67, v22, v64
 v_fma_f32 v64, v21, v66, v106
 v_mfma_f32_32x32x16_bf16 v[128:143], a[36:39], a[224:227], v[128:143]
 ds_read_b128 a[224:227], v54 offset:28672
 v_fma_f32 v65, v21, v67, v122
 v_fmac_f32 v64, v70, v67
 v_fmac_f32 v65, v22, v66
 v_fma_f32 v66, v21, v64, v107
 v_fma_f32 v67, v21, v65, v123
 v_fmac_f32 v66, v70, v65
 v_mfma_f32_32x32x16_bf16 v[144:159], a[36:39], a[228:231], v[144:159]
 ds_read_b128 a[228:231], v54 offset:40960
 s_waitcnt lgkmcnt(2)
 v_fmac_f32 v67, v22, v64
 v_fma_f32 v64, v21, v66, v108
 v_fma_f32 v65, v21, v67, v124
 v_fmac_f32 v64, v70, v67
 v_fmac_f32 v65, v22, v66
 v_mfma_f32_32x32x16_bf16 v[128:143], a[40:43], a[232:235], v[128:143]
 v_fma_f32 v66, v21, v64, v109
 v_fma_f32 v67, v21, v65, v125
 v_fmac_f32 v66, v70, v65
 v_fmac_f32 v67, v22, v64
 v_fma_f32 v64, v21, v66, v110
 v_fma_f32 v65, v21, v67, v126
 v_fmac_f32 v64, v70, v67
 v_fmac_f32 v65, v22, v66
 v_fma_f32 v66, v21, v64, v111
 v_fma_f32 v67, v21, v65, v127
 v_fmac_f32 v66, v70, v65
 v_fmac_f32 v67, v22, v64
 v_mul_f32 v68, v10, v66
 v_mul_f32 v69, v10, v67
 v_fmac_f32 v68, v11, v67
 v_fma_f32 v69, -v11, v66, v69
 ds_write_b64 v38, v[68:69] offset:1792
 s_waitcnt lgkmcnt(0)
 s_barrier
 v_add_u32 v1, 49152, v1
 v_add_u32 v2, 49152, v2
 v_add_u32 v53, 49152, v53
 v_add_u32 v54, 49152, v54
 ds_read_b128 a[232:235], v1 offset:0
 v_mfma_f32_32x32x16_bf16 v[144:159], a[40:43], a[236:239], v[144:159]
 ds_read_b128 a[236:239], v1 offset:12288
 s_add_u32 m0, s36, 49152
 s_add_u32 s38, s22, 73728
 buffer_load_dwordx4 v3, s[8:11], s38 offen offset:0 lds
 v_mfma_f32_32x32x16_bf16 v[128:143], a[44:47], a[224:227], v[128:143]
 ds_read_b128 a[224:227], v2 offset:0
 ds_read2_b64 v[64:67], v38 offset0:0 offset1:32
 ds_read2_b64 v[68:71], v38 offset0:64 offset1:96
 ds_read2_b64 v[72:75], v38 offset0:128 offset1:160
 ds_read2_b64 v[76:79], v38 offset0:192 offset1:224
 v_mul_f32 v55, 0x41800000, v8
 v_mfma_f32_32x32x16_bf16 v[144:159], a[44:47], a[228:231], v[144:159]
 ds_read_b128 a[228:231], v2 offset:12288
 s_waitcnt lgkmcnt(6)
 v_mul_f32 v22, 0x41800000, v9
 v_exp_f32 v55, v55
 v_fract_f32 v22, v22
 v_mfma_f32_32x32x16_bf16 v[128:143], a[48:51], a[232:235], v[128:143]
 ds_read_b128 a[232:235], v53 offset:0
 buffer_load_dwordx4 v4, s[8:11], s38 offen offset:1024 lds
 v_cos_f32 v21, v22
 v_mfma_f32_32x32x16_bf16 v[144:159], a[48:51], a[236:239], v[144:159]
 ds_read_b128 a[236:239], v53 offset:12288
 s_waitcnt lgkmcnt(2)
 v_sin_f32 v22, v22
 v_mul_f32 v21, v21, v55
 v_mul_f32 v22, v22, v55
 v_fmac_f32 v66, v21, v64
 v_fmac_f32 v67, v21, v65
 v_mfma_f32_32x32x16_bf16 v[128:143], a[52:55], a[224:227], v[128:143]
 ds_read_b128 a[224:227], v54 offset:0
 v_fma_f32 v66, -v22, v65, v66
 v_fmac_f32 v67, v22, v64
 v_fmac_f32 v68, v21, v66
 v_fmac_f32 v69, v21, v67
 v_fma_f32 v68, -v22, v67, v68
 v_fmac_f32 v69, v22, v66
 v_mfma_f32_32x32x16_bf16 v[144:159], a[52:55], a[228:231], v[144:159]
 ds_read_b128 a[228:231], v54 offset:12288
 buffer_load_dwordx4 v5, s[8:11], s38 offen offset:2048 lds
 s_waitcnt lgkmcnt(2)
 v_fmac_f32 v70, v21, v68
 v_mfma_f32_32x32x16_bf16 v[128:143], a[56:59], a[232:235], v[128:143]
 ds_read_b128 a[232:235], v1 offset:2048
 v_fmac_f32 v71, v21, v69
 v_fma_f32 v70, -v22, v69, v70
 v_fmac_f32 v71, v22, v68
 v_fmac_f32 v72, v21, v70
 v_fmac_f32 v73, v21, v71
 v_fma_f32 v72, -v22, v71, v72
 v_mfma_f32_32x32x16_bf16 v[144:159], a[56:59], a[236:239], v[144:159]
 ds_read_b128 a[236:239], v1 offset:14336
 s_waitcnt lgkmcnt(2)
 v_fmac_f32 v73, v22, v70
 v_fmac_f32 v74, v21, v72
 v_fmac_f32 v75, v21, v73
 v_fma_f32 v74, -v22, v73, v74
 v_fmac_f32 v75, v22, v72
 v_mfma_f32_32x32x16_bf16 v[128:143], a[60:63], a[224:227], v[128:143]
 ds_read_b128 a[224:227], v2 offset:2048
 buffer_load_dwordx4 v6, s[8:11], s38 offen offset:3072 lds
 v_fma_f32 v47, v21, v74, v76
 v_fma_f32 v48, v21, v75, v77
 v_mfma_f32_32x32x16_bf16 v[144:159], a[60:63], a[228:231], v[144:159]
 ds_read_b128 a[228:231], v2 offset:14336
 s_waitcnt lgkmcnt(2)
 v_fma_f32 v47, -v22, v75, v47
 v_fmac_f32 v48, v22, v74
 v_fma_f32 v64, v21, v47, v78
 v_fma_f32 v65, v21, v48, v79
 v_fma_f32 v64, -v22, v48, v64
 v_mfma_f32_32x32x16_bf16 v[128:143], a[64:67], a[232:235], v[128:143]
 ds_read_b128 a[232:235], v53 offset:2048
 v_fmac_f32 v65, v22, v47
 v_mov_b32 v66, s45
 v_mov_b32 v67, s45
 s_add_u32 s39, s34, 0
 buffer_store_dwordx4 v[64:67], v20, s[16:19], s39 offen sc1
 v_mfma_f32_32x32x16_bf16 v[144:159], a[64:67], a[236:239], v[144:159]
 ds_read_b128 a[236:239], v53 offset:14336
 s_add_u32 m0, s36, 53248
 s_add_u32 s38, s22, 73984
 buffer_load_dwordx4 v3, s[8:11], s38 offen offset:0 lds
 s_waitcnt lgkmcnt(2)
 v_mfma_f32_32x32x16_bf16 v[128:143], a[68:71], a[224:227], v[128:143]
 ds_read_b128 a[224:227], v54 offset:2048
 v_mul_f32 v45, v11, v96
 v_mul_f32 v96, v10, v96
 v_fmac_f32 v96, v11, v112
 v_fma_f32 v112, v10, v112, -v45
 v_mul_f32 v46, v11, v97
 v_mfma_f32_32x32x16_bf16 v[144:159], a[68:71], a[228:231], v[144:159]
 ds_read_b128 a[228:231], v54 offset:14336
 s_waitcnt lgkmcnt(2)
 v_mul_f32 v97, v10, v97
 v_fmac_f32 v97, v11, v113
 v_fma_f32 v113, v10, v113, -v46
 v_mul_f32 v45, v11, v98
 v_mul_f32 v98, v10, v98
 v_mfma_f32_32x32x16_bf16 v[128:143], a[72:75], a[232:235], v[128:143]
 ds_read_b128 a[232:235], v1 offset:4096
 buffer_load_dwordx4 v4, s[8:11], s38 offen offset:1024 lds
 v_fmac_f32 v98, v11, v114
 v_fma_f32 v114, v10, v114, -v45
 v_mfma_f32_32x32x16_bf16 v[144:159], a[72:75], a[236:239], v[144:159]
 ds_read_b128 a[236:239], v1 offset:16384
 s_waitcnt lgkmcnt(2)
 v_mul_f32 v46, v11, v99
 v_mul_f32 v99, v10, v99
 v_fmac_f32 v99, v11, v115
 v_fma_f32 v115, v10, v115, -v46
 v_mul_f32 v45, v11, v100
 v_mfma_f32_32x32x16_bf16 v[128:143], a[76:79], a[224:227], v[128:143]
 ds_read_b128 a[224:227], v2 offset:4096
 v_lshlrev_b32 v14, 16, v14
 v_mul_f32 v14, 0x3fb8aa3b, v14
 v_exp_f32 v14, v14
 v_lshlrev_b32 v64, 16, v12
 v_lshlrev_b32 v65, 16, v13
 v_mfma_f32_32x32x16_bf16 v[144:159], a[76:79], a[228:231], v[144:159]
 ds_read_b128 a[228:231], v2 offset:16384
 s_waitcnt lgkmcnt(2)
 v_cvt_pk_bf16_f32 v14, v14, v14
 v_lshlrev_b32 v14, 16, v14
 v_mul_f32 v12, v14, v64
 v_mul_f32 v13, v14, v65
 v_mul_f32 v12, 0x3fb8aa3b, v12
 v_mfma_f32_32x32x16_bf16 v[128:143], a[80:83], a[232:235], v[128:143]
 ds_read_b128 a[232:235], v53 offset:4096
 s_add_u32 s35, s35, 1024
 buffer_load_dwordx4 a[152:155], v23, s[16:19], s35 offen sc1
 v_mul_f32 v13, 0x3e22f983, v13
 v_mfma_f32_32x32x16_bf16 v[144:159], a[80:83], a[236:239], v[144:159]
 ds_read_b128 a[236:239], v53 offset:16384
 s_waitcnt lgkmcnt(2)
 v_exp_f32 v66, v12
 v_fract_f32 v67, v13
 v_cos_f32 v68, v67
 v_mfma_f32_32x32x16_bf16 v[128:143], a[84:87], a[224:227], v[128:143]
 ds_read_b128 a[224:227], v54 offset:4096
 v_sin_f32 v67, v67
 v_mul_f32 v69, v64, v64
 v_fma_f32 v69, v65, v65, v69
 v_rcp_f32 v69, v69
 v_fma_f32 v68, v68, v66, -1.0
 v_mfma_f32_32x32x16_bf16 v[144:159], a[84:87], a[228:231], v[144:159]
 ds_read_b128 a[228:231], v54 offset:16384
 s_waitcnt lgkmcnt(2)
 v_mul_f32 v67, v67, v66
 v_add_f32 v69, v69, v69
 v_mul_f32 v14, v68, v64
 v_mul_f32 v15, v67, v64
 v_fma_f32 v14, v67, v65, v14
 v_mfma_f32_32x32x16_bf16 v[128:143], a[88:91], a[232:235], v[128:143]
 s_barrier
 ds_read_b128 a[232:235], v1 offset:24576
 v_fma_f32 v15, -v68, v65, v15
 v_mul_f32 v14, v14, v69
 v_mul_f32_e64 v15, -v15, v69
 v_lshlrev_b32 v18, 16, v18
 v_mfma_f32_32x32x16_bf16 v[144:159], a[88:91], a[236:239], v[144:159]
 ds_read_b128 a[236:239], v1 offset:36864
 s_add_u32 m0, s36, 73728
 s_add_u32 s38, s20, 110592
 buffer_load_dwordx4 v3, s[8:11], s38 offen offset:0 lds
 s_waitcnt lgkmcnt(2)
 v_mfma_f32_32x32x16_bf16 v[128:143], a[92:95], a[224:227], v[128:143]
 ds_read_b128 a[224:227], v2 offset:24576
 v_mul_f32 v18, 0x3fb8aa3b, v18
 v_exp_f32 v18, v18
 v_lshlrev_b32 v64, 16, v16
 v_lshlrev_b32 v65, 16, v17
 v_mfma_f32_32x32x16_bf16 v[144:159], a[92:95], a[228:231], v[144:159]
 ds_read_b128 a[228:231], v2 offset:36864
 s_waitcnt lgkmcnt(2)
 v_cvt_pk_bf16_f32 v18, v18, v18
 v_lshlrev_b32 v18, 16, v18
 v_mul_f32 v16, v18, v64
 v_mul_f32 v17, v18, v65
 v_mul_f32 v16, 0x3fb8aa3b, v16
 v_mfma_f32_32x32x16_bf16 v[128:143], a[96:99], a[232:235], v[128:143]
 ds_read_b128 a[232:235], v53 offset:24576
 buffer_load_dwordx4 v4, s[8:11], s38 offen offset:1024 lds
 v_mul_f32 v17, 0x3e22f983, v17
 v_mfma_f32_32x32x16_bf16 v[144:159], a[96:99], a[236:239], v[144:159]
 ds_read_b128 a[236:239], v53 offset:36864
 s_waitcnt lgkmcnt(2)
 v_exp_f32 v66, v16
 v_fract_f32 v67, v17
 v_cos_f32 v68, v67
 v_mfma_f32_32x32x16_bf16 v[128:143], a[100:103], a[224:227], v[128:143]
 ds_read_b128 a[224:227], v54 offset:24576
 v_sin_f32 v67, v67
 v_mul_f32 v69, v64, v64
 v_fma_f32 v69, v65, v65, v69
 v_rcp_f32 v69, v69
 v_fma_f32 v68, v68, v66, -1.0
 v_mfma_f32_32x32x16_bf16 v[144:159], a[100:103], a[228:231], v[144:159]
 ds_read_b128 a[228:231], v54 offset:36864
 buffer_load_dwordx4 v5, s[8:11], s38 offen offset:2048 lds
 s_waitcnt lgkmcnt(2)
 v_mul_f32 v67, v67, v66
 v_mfma_f32_32x32x16_bf16 v[128:143], a[104:107], a[232:235], v[128:143]
 ds_read_b128 a[232:235], v1 offset:26624
 v_add_f32 v69, v69, v69
 v_mul_f32 v18, v68, v64
 v_mul_f32 v19, v67, v64
 v_fma_f32 v18, v67, v65, v18
 v_fma_f32 v19, -v68, v65, v19
 v_mul_f32 v18, v18, v69
 v_mfma_f32_32x32x16_bf16 v[144:159], a[104:107], a[236:239], v[144:159]
 ds_read_b128 a[236:239], v1 offset:38912
 s_waitcnt lgkmcnt(2)
 v_mul_f32_e64 v19, -v19, v69
 v_mul_f32 v100, v10, v100
 v_fmac_f32 v100, v11, v116
 v_fma_f32 v116, v10, v116, -v45
 v_mul_f32 v46, v11, v101
 v_mfma_f32_32x32x16_bf16 v[128:143], a[108:111], a[224:227], v[128:143]
 ds_read_b128 a[224:227], v2 offset:26624
 buffer_load_dwordx4 v6, s[8:11], s38 offen offset:3072 lds
 v_mul_f32 v101, v10, v101
 v_fmac_f32 v101, v11, v117
 v_mfma_f32_32x32x16_bf16 v[144:159], a[108:111], a[228:231], v[144:159]
 ds_read_b128 a[228:231], v2 offset:38912
 s_waitcnt lgkmcnt(2)
 v_fma_f32 v117, v10, v117, -v46
 v_mul_f32 v45, v11, v102
 v_mul_f32 v102, v10, v102
 v_fmac_f32 v102, v11, v118
 v_fma_f32 v118, v10, v118, -v45
 v_mfma_f32_32x32x16_bf16 v[128:143], a[112:115], a[232:235], v[128:143]
 ds_read_b128 a[232:235], v53 offset:26624
 v_mul_f32 v46, v11, v103
 v_mul_f32 v103, v10, v103
 v_fmac_f32 v103, v11, v119
 v_fma_f32 v119, v10, v119, -v46
 v_mul_f32 v45, v11, v104
 v_mul_f32 v104, v10, v104
 v_mfma_f32_32x32x16_bf16 v[144:159], a[112:115], a[236:239], v[144:159]
 ds_read_b128 a[236:239], v53 offset:38912
 s_add_u32 m0, s36, 77824
 s_add_u32 s38, s20, 110848
 buffer_load_dwordx4 v3, s[8:11], s38 offen offset:0 lds
 s_waitcnt lgkmcnt(2)
 v_mfma_f32_32x32x16_bf16 v[128:143], a[116:119], a[224:227], v[128:143]
 ds_read_b128 a[224:227], v54 offset:26624
 v_fmac_f32 v104, v11, v120
 v_fma_f32 v120, v10, v120, -v45
 v_mul_f32 v46, v11, v105
 v_mul_f32 v105, v10, v105
 v_fmac_f32 v105, v11, v121
 v_mfma_f32_32x32x16_bf16 v[144:159], a[116:119], a[228:231], v[144:159]
 ds_read_b128 a[228:231], v54 offset:38912
 s_waitcnt lgkmcnt(2)
 v_fma_f32 v121, v10, v121, -v46
 v_mul_f32 v45, v11, v106
 v_mul_f32 v106, v10, v106
 v_fmac_f32 v106, v11, v122
 v_fma_f32 v122, v10, v122, -v45
 v_mfma_f32_32x32x16_bf16 v[128:143], a[120:123], a[232:235], v[128:143]
 ds_read_b128 a[232:235], v1 offset:28672
 buffer_load_dwordx4 v4, s[8:11], s38 offen offset:1024 lds
 v_mul_f32 v46, v11, v107
 v_mul_f32 v107, v10, v107
 v_mfma_f32_32x32x16_bf16 v[144:159], a[120:123], a[236:239], v[144:159]
 ds_read_b128 a[236:239], v1 offset:40960
 s_waitcnt lgkmcnt(2)
 v_fmac_f32 v107, v11, v123
 v_fma_f32 v123, v10, v123, -v46
 v_mul_f32 v45, v11, v108
 v_mul_f32 v108, v10, v108
 v_fmac_f32 v108, v11, v124
 v_mfma_f32_32x32x16_bf16 v[128:143], a[124:127], a[224:227], v[128:143]
 ds_read_b128 a[224:227], v2 offset:28672
 v_fma_f32 v124, v10, v124, -v45
 v_mul_f32 v46, v11, v109
 v_mul_f32 v109, v10, v109
 v_fmac_f32 v109, v11, v125
 v_fma_f32 v125, v10, v125, -v46
 v_mul_f32 v45, v11, v110
 v_mfma_f32_32x32x16_bf16 v[144:159], a[124:127], a[228:231], v[144:159]
 ds_read_b128 a[228:231], v2 offset:40960
 s_waitcnt lgkmcnt(2)
 v_mul_f32 v110, v10, v110
 v_fmac_f32 v110, v11, v126
 v_fma_f32 v126, v10, v126, -v45
 v_mul_f32 v46, v11, v111
 v_mul_f32 v111, v10, v111
 v_mfma_f32_32x32x16_bf16 v[128:143], a[128:131], a[232:235], v[128:143]
 ds_read_b128 a[232:235], v53 offset:28672
 v_fmac_f32 v111, v11, v127
 v_fma_f32 v127, v10, v127, -v46
 v_mfma_f32_32x32x16_bf16 v[144:159], a[128:131], a[236:239], v[144:159]
 ds_read_b128 a[236:239], v53 offset:40960
 s_waitcnt lgkmcnt(2)
 v_mfma_f32_32x32x16_bf16 v[128:143], a[132:135], a[224:227], v[128:143]
 ds_read_b128 a[224:227], v54 offset:28672
 v_mfma_f32_32x32x16_bf16 v[144:159], a[132:135], a[228:231], v[144:159]
 ds_read_b128 a[228:231], v54 offset:40960
 s_waitcnt lgkmcnt(2)
 v_mfma_f32_32x32x16_bf16 v[128:143], a[136:139], a[232:235], v[128:143]
 v_exp_f32 v55, v12
 v_fract_f32 v22, v13
 v_cos_f32 v21, v22
 v_mfma_f32_32x32x16_bf16 v[144:159], a[136:139], a[236:239], v[144:159]
 s_waitcnt lgkmcnt(0)
 v_sin_f32 v22, v22
 v_mul_f32 v21, v21, v55
 v_mul_f32 v22, v22, v55
 v_mfma_f32_32x32x16_bf16 v[128:143], a[140:143], a[224:227], v[128:143]
 s_waitcnt vmcnt(20)
 s_barrier
 v_add_u32 v1, -98304, v1
 v_add_u32 v2, -98304, v2
 v_add_u32 v53, -98304, v53
 v_add_u32 v54, -98304, v54
 ds_read_b128 a[224:227], v1 offset:0
 s_waitcnt vmcnt(6)
 v_accvgpr_read_b32 v63, a155
 v_cmp_ne_u32 vcc, s90, v63
 s_cbranch_vccnz L_sx1
L_sx1_b:
 v_mfma_f32_32x32x16_bf16 v[144:159], a[140:143], a[228:231], v[144:159]
 ds_read_b128 a[228:231], v1 offset:12288
 s_add_u32 m0, s36, 98304
 s_add_u32 s38, s21, 110592
 buffer_load_dwordx4 v3, s[8:11], s38 offen offset:0 lds
 v_mfma_f32_32x32x16_bf16 v[128:143], a[144:147], a[152:155], v[128:143]
 ds_read_b128 a[232:235], v2 offset:0
 v_mfma_f32_32x32x16_bf16 v[144:159], a[148:151], a[152:155], v[144:159]
 ds_read_b128 a[236:239], v2 offset:12288
 s_waitcnt lgkmcnt(2)
 v_mfma_f32_32x32x16_bf16 v[160:175], a[0:3], a[224:227], 0
 ds_read_b128 a[224:227], v53 offset:0
 buffer_load_dwordx4 v4, s[8:11], s38 offen offset:1024 lds
 v_mfma_f32_32x32x16_bf16 v[176:191], a[0:3], a[228:231], 0
 ds_read_b128 a[228:231], v53 offset:12288
 s_waitcnt lgkmcnt(2)
 v_mfma_f32_32x32x16_bf16 v[160:175], a[4:7], a[232:235], v[160:175]
 ds_read_b128 a[232:235], v54 offset:0
 v_mul_f32 v128, v128, v80
 s_nop 0
 v_mul_f32 v144, v144, v80
 v_mul_f32 v129, v129, v81
 v_mul_f32 v145, v145, v81
 v_mul_f32 v130, v130, v82
 v_mul_f32 v146, v146, v82
 v_mfma_f32_32x32x16_bf16 v[176:191], a[4:7], a[236:239], v[176:191]
 ds_read_b128 a[236:239], v54 offset:12288
 buffer_load_dwordx4 v5, s[8:11], s38 offen offset:2048 lds
 s_waitcnt lgkmcnt(2)
 v_mul_f32 v131, v131, v83
 v_mfma_f32_32x32x16_bf16 v[160:175], a[8:11], a[224:227], v[160:175]
 ds_read_b128 a[224:227], v1 offset:2048
 v_mul_f32 v147, v147, v83
 v_mul_f32 v132, v132, v84
 v_mul_f32 v148, v148, v84
 v_mul_f32 v133, v133, v85
 v_mul_f32 v149, v149, v85
 v_mul_f32 v134, v134, v86
 v_mfma_f32_32x32x16_bf16 v[176:191], a[8:11], a[228:231], v[176:191]
 ds_read_b128 a[228:231], v1 offset:14336
 s_waitcnt lgkmcnt(2)
 v_mul_f32 v150, v150, v86
 v_mul_f32 v135, v135, v87
 v_mul_f32 v151, v151, v87
 v_mul_f32 v136, v136, v88
 v_mul_f32 v152, v152, v88
 v_mfma_f32_32x32x16_bf16 v[160:175], a[12:15], a[232:235], v[160:175]
 ds_read_b128 a[232:235], v2 offset:2048
 buffer_load_dwordx4 v6, s[8:11], s38 offen offset:3072 lds
 v_mul_f32 v137, v137, v89
 v_mul_f32 v153, v153, v89
 v_mfma_f32_32x32x16_bf16 v[176:191], a[12:15], a[236:239], v[176:191]
 ds_read_b128 a[236:239], v2 offset:14336
 s_waitcnt lgkmcnt(2)
 v_mul_f32 v138, v138, v90
 v_mul_f32 v154, v154, v90
 v_mul_f32 v139, v139, v91
 v_mul_f32 v155, v155, v91
 v_mul_f32 v140, v140, v92
 v_mfma_f32_32x32x16_bf16 v[160:175], a[16:19], a[224:227], v[160:175]
 ds_read_b128 a[224:227], v53 offset:2048
 v_mul_f32 v156, v156, v92
 v_mul_f32 v141, v141, v93
 v_mul_f32 v157, v157, v93
 v_mul_f32 v142, v142, v94
 v_mul_f32 v158, v158, v94
 v_mul_f32 v143, v143, v95
 v_mfma_f32_32x32x16_bf16 v[176:191], a[16:19], a[228:231], v[176:191]
 ds_read_b128 a[228:231], v53 offset:14336
 s_add_u32 m0, s36, 102400
 s_add_u32 s38, s21, 110848
 buffer_load_dwordx4 v3, s[8:11], s38 offen offset:0 lds
 s_waitcnt lgkmcnt(2)
 v_mfma_f32_32x32x16_bf16 v[160:175], a[20:23], a[232:235], v[160:175]
 ds_read_b128 a[232:235], v54 offset:2048
 v_mul_f32 v159, v159, v95
 v_sub_f32 v70, 0, v22
 v_fma_f32 v66, v21, v128, v129
 v_fma_f32 v67, v21, v144, v145
 v_fmac_f32 v66, v70, v144
 v_mfma_f32_32x32x16_bf16 v[176:191], a[20:23], a[236:239], v[176:191]
 ds_read_b128 a[236:239], v54 offset:14336
 s_waitcnt lgkmcnt(2)
 v_fmac_f32 v67, v22, v128
 v_fma_f32 v64, v21, v66, v130
 v_fma_f32 v65, v21, v67, v146
 v_fmac_f32 v64, v70, v67
 v_fmac_f32 v65, v22, v66
 v_mfma_f32_32x32x16_bf16 v[160:175], a[24:27], a[224:227], v[160:175]
 ds_read_b128 a[224:227], v1 offset:4096
 buffer_load_dwordx4 v4, s[8:11], s38 offen offset:1024 lds
 v_fma_f32 v66, v21, v64, v131
 v_fma_f32 v67, v21, v65, v147
 v_mfma_f32_32x32x16_bf16 v[176:191], a[24:27], a[228:231], v[176:191]
 ds_read_b128 a[228:231], v1 offset:16384
 s_waitcnt lgkmcnt(2)
 v_fmac_f32 v66, v70, v65
 v_fmac_f32 v67, v22, v64
 v_fma_f32 v64, v21, v66, v132
 v_fma_f32 v65, v21, v67, v148
 v_fmac_f32 v64, v70, v67
 v_mfma_f32_32x32x16_bf16 v[160:175], a[28:31], a[232:235], v[160:175]
 ds_read_b128 a[232:235], v2 offset:4096
 v_fmac_f32 v65, v22, v66
 v_fma_f32 v66, v21, v64, v133
 v_fma_f32 v67, v21, v65, v149
 v_fmac_f32 v66, v70, v65
 v_fmac_f32 v67, v22, v64
 v_fma_f32 v64, v21, v66, v134
 v_mfma_f32_32x32x16_bf16 v[176:191], a[28:31], a[236:239], v[176:191]
 ds_read_b128 a[236:239], v2 offset:16384
 s_waitcnt lgkmcnt(2)
 v_fma_f32 v65, v21, v67, v150
 v_fmac_f32 v64, v70, v67
 v_fmac_f32 v65, v22, v66
 v_fma_f32 v66, v21, v64, v135
 v_fma_f32 v67, v21, v65, v151
 v_mfma_f32_32x32x16_bf16 v[160:175], a[32:35], a[224:227], v[160:175]
 ds_read_b128 a[224:227], v53 offset:4096
 v_fmac_f32 v66, v70, v65
 v_fmac_f32 v67, v22, v64
 v_fma_f32 v64, v21, v66, v136
 v_fma_f32 v65, v21, v67, v152
 v_fmac_f32 v64, v70, v67
 v_fmac_f32 v65, v22, v66
 v_mfma_f32_32x32x16_bf16 v[176:191], a[32:35], a[228:231], v[176:191]
 ds_read_b128 a[228:231], v53 offset:16384
 s_waitcnt lgkmcnt(2)
 v_fma_f32 v66, v21, v64, v137
 v_fma_f32 v67, v21, v65, v153
 v_fmac_f32 v66, v70, v65
 v_fmac_f32 v67, v22, v64
 v_fma_f32 v64, v21, v66, v138
 v_mfma_f32_32x32x16_bf16 v[160:175], a[36:39], a[232:235], v[160:175]
 ds_read_b128 a[232:235], v54 offset:4096
 v_fma_f32 v65, v21, v67, v154
 v_fmac_f32 v64, v70, v67
 v_fmac_f32 v65, v22, v66
 v_fma_f32 v66, v21, v64, v139
 v_fma_f32 v67, v21, v65, v155
 v_fmac_f32 v66, v70, v65
 v_mfma_f32_32x32x16_bf16 v[176:191], a[36:39], a[236:239], v[176:191]
 ds_read_b128 a[236:239], v54 offset:16384
 s_waitcnt lgkmcnt(2)
 v_fmac_f32 v67, v22, v64
 v_fma_f32 v64, v21, v66, v140
 v_fma_f32 v65, v21, v67, v156
 v_fmac_f32 v64, v70, v67
 v_fmac_f32 v65, v22, v66
 v_mfma_f32_32x32x16_bf16 v[160:175], a[40:43], a[224:227], v[160:175]
 v_fma_f32 v66, v21, v64, v141
 v_fma_f32 v67, v21, v65, v157
 v_fmac_f32 v66, v70, v65
 v_fmac_f32 v67, v22, v64
 v_fma_f32 v64, v21, v66, v142
 v_fma_f32 v65, v21, v67, v158
 v_fmac_f32 v64, v70, v67
 v_fmac_f32 v65, v22, v66
 v_fma_f32 v66, v21, v64, v143
 v_fma_f32 v67, v21, v65, v159
 v_fmac_f32 v66, v70, v65
 v_fmac_f32 v67, v22, v64
 v_mul_f32 v68, v14, v66
 v_mul_f32 v69, v14, v67
 v_fmac_f32 v68, v15, v67
 v_fma_f32 v69, -v15, v66, v69
 ds_write_b64 v38, v[68:69] offset:1792
 s_waitcnt lgkmcnt(0)
 s_barrier
 ds_read_b128 a[224:227], v1 offset:24576
 s_add_u32 s37, s34, 0
 buffer_load_dwordx4 v[56:59], v41, s[16:19], s37 offen sc1
 buffer_load_dwordx4 v[60:63], v42, s[16:19], s37 offen sc1
 v_mfma_f32_32x32x16_bf16 v[176:191], a[40:43], a[228:231], v[176:191]
 ds_read_b128 a[228:231], v1 offset:36864
 s_add_u32 m0, s36, 122880
 s_add_u32 s38, s22, 110592
 buffer_load_dwordx4 v3, s[8:11], s38 offen offset:0 lds
 v_mfma_f32_32x32x16_bf16 v[160:175], a[44:47], a[232:235], v[160:175]
 ds_read_b128 a[232:235], v2 offset:24576
 ds_read2_b64 v[64:67], v38 offset0:0 offset1:32
 ds_read2_b64 v[68:71], v38 offset0:64 offset1:96
 ds_read2_b64 v[72:75], v38 offset0:128 offset1:160
 ds_read2_b64 v[76:79], v38 offset0:192 offset1:224
 v_mfma_f32_32x32x16_bf16 v[176:191], a[44:47], a[236:239], v[176:191]
 ds_read_b128 a[236:239], v2 offset:36864
 s_waitcnt lgkmcnt(6)
 v_mul_f32 v55, 0x41800000, v12
 v_mul_f32 v22, 0x41800000, v13
 v_exp_f32 v55, v55
 v_fract_f32 v22, v22
 v_mfma_f32_32x32x16_bf16 v[160:175], a[48:51], a[224:227], v[160:175]
 ds_read_b128 a[224:227], v53 offset:24576
 buffer_load_dwordx4 v4, s[8:11], s38 offen offset:1024 lds
 v_cos_f32 v21, v22
 v_mfma_f32_32x32x16_bf16 v[176:191], a[48:51], a[228:231], v[176:191]
 ds_read_b128 a[228:231], v53 offset:36864
 s_waitcnt lgkmcnt(2)
 v_sin_f32 v22, v22
 v_mul_f32 v21, v21, v55
 v_mul_f32 v22, v22, v55
 v_fmac_f32 v66, v21, v64
 v_mfma_f32_32x32x16_bf16 v[160:175], a[52:55], a[232:235], v[160:175]
 ds_read_b128 a[232:235], v54 offset:24576
 v_fmac_f32 v67, v21, v65
 v_fma_f32 v66, -v22, v65, v66
 v_fmac_f32 v67, v22, v64
 v_fmac_f32 v68, v21, v66
 v_fmac_f32 v69, v21, v67
 v_fma_f32 v68, -v22, v67, v68
 v_mfma_f32_32x32x16_bf16 v[176:191], a[52:55], a[236:239], v[176:191]
 ds_read_b128 a[236:239], v54 offset:36864
 buffer_load_dwordx4 v5, s[8:11], s38 offen offset:2048 lds
 s_waitcnt lgkmcnt(2)
 v_fmac_f32 v69, v22, v66
 v_mfma_f32_32x32x16_bf16 v[160:175], a[56:59], a[224:227], v[160:175]
 ds_read_b128 a[224:227], v1 offset:26624
 v_fmac_f32 v70, v21, v68
 v_fmac_f32 v71, v21, v69
 v_fma_f32 v70, -v22, v69, v70
 v_fmac_f32 v71, v22, v68
 v_fmac_f32 v72, v21, v70
 v_fmac_f32 v73, v21, v71
 v_mfma_f32_32x32x16_bf16 v[176:191], a[56:59], a[228:231], v[176:191]
 ds_read_b128 a[228:231], v1 offset:38912
 s_waitcnt lgkmcnt(2)
 v_fma_f32 v72, -v22, v71, v72
 v_fmac_f32 v73, v22, v70
 v_fmac_f32 v74, v21, v72
 v_fmac_f32 v75, v21, v73
 v_fma_f32 v74, -v22, v73, v74
 v_mfma_f32_32x32x16_bf16 v[160:175], a[60:63], a[232:235], v[160:175]
 ds_read_b128 a[232:235], v2 offset:26624
 buffer_load_dwordx4 v6, s[8:11], s38 offen offset:3072 lds
 v_fmac_f32 v75, v22, v72
 v_fma_f32 v49, v21, v74, v76
 v_mfma_f32_32x32x16_bf16 v[176:191], a[60:63], a[236:239], v[176:191]
 ds_read_b128 a[236:239], v2 offset:38912
 s_waitcnt lgkmcnt(2)
 v_fma_f32 v50, v21, v75, v77
 v_fma_f32 v49, -v22, v75, v49
 v_fmac_f32 v50, v22, v74
 v_fma_f32 v64, v21, v49, v78
 v_fma_f32 v65, v21, v50, v79
 v_mfma_f32_32x32x16_bf16 v[160:175], a[64:67], a[224:227], v[160:175]
 ds_read_b128 a[224:227], v53 offset:26624
 v_fma_f32 v64, -v22, v50, v64
 v_fmac_f32 v65, v22, v49
 v_mov_b32 v66, s45
 v_mov_b32 v67, s45
 s_add_u32 s39, s34, 8192
 v_mfma_f32_32x32x16_bf16 v[176:191], a[64:67], a[228:231], v[176:191]
 ds_read_b128 a[228:231], v53 offset:38912
 s_add_u32 m0, s36, 126976
 s_add_u32 s38, s22, 110848
 buffer_load_dwordx4 v3, s[8:11], s38 offen offset:0 lds
 s_waitcnt lgkmcnt(2)
 v_mfma_f32_32x32x16_bf16 v[160:175], a[68:71], a[232:235], v[160:175]
 ds_read_b128 a[232:235], v54 offset:26624
 buffer_store_dwordx4 v[64:67], v20, s[16:19], s39 offen sc1
 v_mul_f32 v45, v15, v128
 v_mul_f32 v128, v14, v128
 v_fmac_f32 v128, v15, v144
 v_fma_f32 v144, v14, v144, -v45
 v_mfma_f32_32x32x16_bf16 v[176:191], a[68:71], a[236:239], v[176:191]
 ds_read_b128 a[236:239], v54 offset:38912
 s_waitcnt lgkmcnt(2)
 v_mul_f32 v46, v15, v129
 v_mul_f32 v129, v14, v129
 v_fmac_f32 v129, v15, v145
 v_fma_f32 v145, v14, v145, -v46
 v_mul_f32 v45, v15, v130
 v_mfma_f32_32x32x16_bf16 v[160:175], a[72:75], a[224:227], v[160:175]
 ds_read_b128 a[224:227], v1 offset:28672
 buffer_load_dwordx4 v4, s[8:11], s38 offen offset:1024 lds
 v_mul_f32 v130, v14, v130
 v_fmac_f32 v130, v15, v146
 v_mfma_f32_32x32x16_bf16 v[176:191], a[72:75], a[228:231], v[176:191]
 ds_read_b128 a[228:231], v1 offset:40960
 s_waitcnt lgkmcnt(2)
 v_fma_f32 v146, v14, v146, -v45
 v_mul_f32 v46, v15, v131
 v_mul_f32 v131, v14, v131
 v_fmac_f32 v131, v15, v147
 v_fma_f32 v147, v14, v147, -v46
 v_mfma_f32_32x32x16_bf16 v[160:175], a[76:79], a[232:235], v[160:175]
 ds_read_b128 a[232:235], v2 offset:28672
 v_lshlrev_b32 v26, 16, v26
 v_mul_f32 v26, 0x3fb8aa3b, v26
 v_exp_f32 v26, v26
 v_lshlrev_b32 v64, 16, v24
 v_lshlrev_b32 v65, 16, v25
 v_mfma_f32_32x32x16_bf16 v[176:191], a[76:79], a[236:239], v[176:191]
 ds_read_b128 a[236:239], v2 offset:40960
 s_waitcnt lgkmcnt(2)
 v_cvt_pk_bf16_f32 v26, v26, v26
 v_lshlrev_b32 v26, 16, v26
 v_mul_f32 v24, v26, v64
 v_mul_f32 v25, v26, v65
 v_mul_f32 v24, 0x3fb8aa3b, v24
 v_mfma_f32_32x32x16_bf16 v[160:175], a[80:83], a[224:227], v[160:175]
 ds_read_b128 a[224:227], v53 offset:28672
 s_add_u32 s35, s35, 1024
 buffer_load_dwordx4 a[152:155], v23, s[16:19], s35 offen sc1
 v_mul_f32 v25, 0x3e22f983, v25
 v_mfma_f32_32x32x16_bf16 v[176:191], a[80:83], a[228:231], v[176:191]
 ds_read_b128 a[228:231], v53 offset:40960
 s_waitcnt lgkmcnt(2)
 v_exp_f32 v66, v24
 v_fract_f32 v67, v25
 v_cos_f32 v68, v67
 v_mfma_f32_32x32x16_bf16 v[160:175], a[84:87], a[232:235], v[160:175]
 ds_read_b128 a[232:235], v54 offset:28672
 v_sin_f32 v67, v67
 v_mul_f32 v69, v64, v64
 v_fma_f32 v69, v65, v65, v69
 v_rcp_f32 v69, v69
 v_fma_f32 v68, v68, v66, -1.0
 v_mfma_f32_32x32x16_bf16 v[176:191], a[84:87], a[236:239], v[176:191]
 ds_read_b128 a[236:239], v54 offset:40960
 s_waitcnt lgkmcnt(2)
 v_mul_f32 v67, v67, v66
 v_add_f32 v69, v69, v69
 v_mul_f32 v26, v68, v64
 v_mul_f32 v27, v67, v64
 v_fma_f32 v26, v67, v65, v26
 v_mfma_f32_32x32x16_bf16 v[160:175], a[88:91], a[224:227], v[160:175]
 s_barrier
 v_add_u32 v1, 49152, v1
 v_add_u32 v2, 49152, v2
 v_add_u32 v53, 49152, v53
 v_add_u32 v54, 49152, v54
 ds_read_b128 a[224:227], v1 offset:0
 v_mfma_f32_32x32x16_bf16 v[176:191], a[88:91], a[228:231], v[176:191]
 ds_read_b128 a[228:231], v1 offset:12288
 s_add_u32 m0, s36, 0
 s_add_u32 s38, s20, 147456
 buffer_load_dwordx4 v3, s[8:11], s38 offen offset:0 lds
 s_waitcnt lgkmcnt(2)
 v_mfma_f32_32x32x16_bf16 v[160:175], a[92:95], a[232:235], v[160:175]
 ds_read_b128 a[232:235], v2 offset:0
 v_fma_f32 v27, -v68, v65, v27
 v_mul_f32 v26, v26, v69
 v_mul_f32_e64 v27, -v27, v69
 v_lshlrev_b32 v30, 16, v30
 v_mul_f32 v30, 0x3fb8aa3b, v30
 v_mfma_f32_32x32x16_bf16 v[176:191], a[92:95], a[236:239], v[176:191]
 ds_read_b128 a[236:239], v2 offset:12288
 s_waitcnt lgkmcnt(2)
 v_exp_f32 v30, v30
 v_lshlrev_b32 v64, 16, v28
 v_lshlrev_b32 v65, 16, v29
 v_cvt_pk_bf16_f32 v30, v30, v30
 v_mfma_f32_32x32x16_bf16 v[160:175], a[96:99], a[224:227], v[160:175]
 ds_read_b128 a[224:227], v53 offset:0
 buffer_load_dwordx4 v4, s[8:11], s38 offen offset:1024 lds
 v_lshlrev_b32 v30, 16, v30
 v_mul_f32 v28, v30, v64
 v_mfma_f32_32x32x16_bf16 v[176:191], a[96:99], a[228:231], v[176:191]
 ds_read_b128 a[228:231], v53 offset:12288
 s_waitcnt lgkmcnt(2)
 v_mul_f32 v29, v30, v65
 v_mul_f32 v28, 0x3fb8aa3b, v28
 v_mul_f32 v29, 0x3e22f983, v29
 v_exp_f32 v66, v28
 v_mfma_f32_32x32x16_bf16 v[160:175], a[100:103], a[232:235], v[160:175]
 ds_read_b128 a[232:235], v54 offset:0
 v_fract_f32 v67, v29
 v_cos_f32 v68, v67
 v_sin_f32 v67, v67
 v_mul_f32 v69, v64, v64
 v_mfma_f32_32x32x16_bf16 v[176:191], a[100:103], a[236:239], v[176:191]
 ds_read_b128 a[236:239], v54 offset:12288
 buffer_load_dwordx4 v5, s[8:11], s38 offen offset:2048 lds
 s_waitcnt lgkmcnt(2)
 v_fma_f32 v69, v65, v65, v69
 v_mfma_f32_32x32x16_bf16 v[160:175], a[104:107], a[224:227], v[160:175]
 ds_read_b128 a[224:227], v1 offset:2048
 v_rcp_f32 v69, v69
 v_fma_f32 v68, v68, v66, -1.0
 v_mul_f32 v67, v67, v66
 v_add_f32 v69, v69, v69
 v_mul_f32 v30, v68, v64
 v_mfma_f32_32x32x16_bf16 v[176:191], a[104:107], a[228:231], v[176:191]
 ds_read_b128 a[228:231], v1 offset:14336
 s_waitcnt lgkmcnt(2)
 v_mul_f32 v31, v67, v64
 v_fma_f32 v30, v67, v65, v30
 v_fma_f32 v31, -v68, v65, v31
 v_mul_f32 v30, v30, v69
 v_mul_f32_e64 v31, -v31, v69
 v_mfma_f32_32x32x16_bf16 v[160:175], a[108:111], a[232:235], v[160:175]
 ds_read_b128 a[232:235], v2 offset:2048
 buffer_load_dwordx4 v6, s[8:11], s38 offen offset:3072 lds
 v_lshlrev_b32 v34, 16, v34
 v_mul_f32 v34, 0x3fb8aa3b, v34
 v_mfma_f32_32x32x16_bf16 v[176:191], a[108:111], a[236:239], v[176:191]
 ds_read_b128 a[236:239], v2 offset:14336
 s_waitcnt lgkmcnt(2)
 v_exp_f32 v34, v34
 v_lshlrev_b32 v64, 16, v32
 v_lshlrev_b32 v65, 16, v33
 v_cvt_pk_bf16_f32 v34, v34, v34
 v_mfma_f32_32x32x16_bf16 v[160:175], a[112:115], a[224:227], v[160:175]
 ds_read_b128 a[224:227], v53 offset:2048
 v_lshlrev_b32 v34, 16, v34
 v_mul_f32 v32, v34, v64
 v_mul_f32 v33, v34, v65
 v_mul_f32 v32, 0x3fb8aa3b, v32
 v_mul_f32 v33, 0x3e22f983, v33
 v_mfma_f32_32x32x16_bf16 v[176:191], a[112:115], a[228:231], v[176:191]
 ds_read_b128 a[228:231], v53 offset:14336
 s_add_u32 m0, s36, 4096
 s_add_u32 s38, s20, 147712
 buffer_load_dwordx4 v3, s[8:11], s38 offen offset:0 lds
 s_waitcnt lgkmcnt(2)
 v_mfma_f32_32x32x16_bf16 v[160:175], a[116:119], a[232:235], v[160:175]
 ds_read_b128 a[232:235], v54 offset:2048
 v_exp_f32 v66, v32
 v_fract_f32 v67, v33
 v_cos_f32 v68, v67
 v_mfma_f32_32x32x16_bf16 v[176:191], a[116:119], a[236:239], v[176:191]
 ds_read_b128 a[236:239], v54 offset:14336
 s_waitcnt lgkmcnt(2)
 v_sin_f32 v67, v67
 v_mul_f32 v69, v64, v64
 v_fma_f32 v69, v65, v65, v69
 v_rcp_f32 v69, v69
 v_mfma_f32_32x32x16_bf16 v[160:175], a[120:123], a[224:227], v[160:175]
 ds_read_b128 a[224:227], v1 offset:4096
 buffer_load_dwordx4 v4, s[8:11], s38 offen offset:1024 lds
 v_fma_f32 v68, v68, v66, -1.0
 v_mul_f32 v67, v67, v66
 v_mfma_f32_32x32x16_bf16 v[176:191], a[120:123], a[228:231], v[176:191]
 ds_read_b128 a[228:231], v1 offset:16384
 s_waitcnt lgkmcnt(2)
 v_add_f32 v69, v69, v69
 v_mul_f32 v34, v68, v64
 v_mul_f32 v35, v67, v64
 v_fma_f32 v34, v67, v65, v34
 v_fma_f32 v35, -v68, v65, v35
 v_mfma_f32_32x32x16_bf16 v[160:175], a[124:127], a[232:235], v[160:175]
 ds_read_b128 a[232:235], v2 offset:4096
 v_mul_f32 v34, v34, v69
 v_mul_f32_e64 v35, -v35, v69
 v_mul_f32 v55, 0x43000000, v8
 v_mul_f32 v69, 0x43000000, v9
 v_exp_f32 v55, v55
 v_mfma_f32_32x32x16_bf16 v[176:191], a[124:127], a[236:239], v[176:191]
 ds_read_b128 a[236:239], v2 offset:16384
 s_waitcnt lgkmcnt(2)
 v_fract_f32 v69, v69
 v_cos_f32 v68, v69
 v_sin_f32 v69, v69
 v_mfma_f32_32x32x16_bf16 v[160:175], a[128:131], a[224:227], v[160:175]
 ds_read_b128 a[224:227], v53 offset:4096
 v_mul_f32 v68, v68, v55
 v_mul_f32 v69, v69, v55
 v_mul_f32 v55, v37, v8
 v_mul_f32 v71, v37, v9
 v_exp_f32 v55, v55
 v_mfma_f32_32x32x16_bf16 v[176:191], a[128:131], a[228:231], v[176:191]
 ds_read_b128 a[228:231], v53 offset:16384
 s_waitcnt lgkmcnt(2)
 v_fract_f32 v71, v71
 v_cos_f32 v70, v71
 v_sin_f32 v71, v71
 v_mfma_f32_32x32x16_bf16 v[160:175], a[132:135], a[232:235], v[160:175]
 ds_read_b128 a[232:235], v54 offset:4096
 v_mul_f32 v70, v70, v55
 v_mul_f32 v71, v71, v55
 v_mfma_f32_32x32x16_bf16 v[176:191], a[132:135], a[236:239], v[176:191]
 ds_read_b128 a[236:239], v54 offset:16384
 s_waitcnt lgkmcnt(2)
 s_waitcnt vmcnt(15)
 v_cmp_ne_u32 vcc, s45, v58
 s_and_b64 s[40:41], vcc, s[42:43]
 s_waitcnt vmcnt(14)
 v_cmp_ne_u32 vcc, s45, v62
 s_and_b64 vcc, vcc, s[46:47]
 s_or_b64 vcc, vcc, s[40:41]
 s_cbranch_vccnz L_lb0
L_lb0_b:
 v_mfma_f32_32x32x16_bf16 v[160:175], a[136:139], a[224:227], v[160:175]
 v_fma_f32 v72, v68, v56, v60
 v_fma_f32 v73, v68, v57, v61
 v_fma_f32 v72, -v69, v57, v72
 v_fmac_f32 v73, v69, v56
 v_mul_f32 v74, v70, v72
 v_mul_f32 v75, v70, v73
 v_mfma_f32_32x32x16_bf16 v[176:191], a[136:139], a[228:231], v[176:191]
 s_waitcnt lgkmcnt(0)
 v_fma_f32 v74, -v71, v73, v74
 v_fmac_f32 v75, v71, v72
 ds_write_b64 v38, v[74:75] offset:4096
 v_exp_f32 v55, v16
 v_mfma_f32_32x32x16_bf16 v[160:175], a[140:143], a[232:235], v[160:175]
 s_waitcnt lgkmcnt(0)
 s_barrier
 ds_read_b128 a[232:235], v1 offset:24576
 s_waitcnt vmcnt(6)
 v_accvgpr_read_b32 v63, a155
 v_cmp_ne_u32 vcc, s90, v63
 s_cbranch_vccnz L_sx2
L_sx2_b:
 v_mfma_f32_32x32x16_bf16 v[176:191], a[140:143], a[236:239], v[176:191]
 ds_read_b128 a[236:239], v1 offset:36864
 s_add_u32 m0, s36, 24576
 s_add_u32 s38, s21, 147456
 buffer_load_dwordx4 v3, s[8:11], s38 offen offset:0 lds
 v_mfma_f32_32x32x16_bf16 v[160:175], a[144:147], a[152:155], v[160:175]
 ds_read_b128 a[224:227], v2 offset:24576
 v_fract_f32 v22, v17
 v_cos_f32 v21, v22
 v_sin_f32 v22, v22
 v_mfma_f32_32x32x16_bf16 v[176:191], a[148:151], a[152:155], v[176:191]
 ds_read_b128 a[228:231], v2 offset:36864
 s_waitcnt lgkmcnt(2)
 v_mul_f32 v21, v21, v55
 v_mul_f32 v22, v22, v55
 v_mul_f32 v45, v15, v132
 v_mul_f32 v132, v14, v132
 v_fmac_f32 v132, v15, v148
 v_mfma_f32_32x32x16_bf16 v[192:207], a[0:3], a[232:235], 0
 ds_read_b128 a[232:235], v53 offset:24576
 buffer_load_dwordx4 v4, s[8:11], s38 offen offset:1024 lds
 v_fma_f32 v148, v14, v148, -v45
 v_mul_f32 v46, v15, v133
 v_mfma_f32_32x32x16_bf16 v[208:223], a[0:3], a[236:239], 0
 ds_read_b128 a[236:239], v53 offset:36864
 s_waitcnt lgkmcnt(2)
 v_mul_f32 v133, v14, v133
 v_fmac_f32 v133, v15, v149
 v_fma_f32 v149, v14, v149, -v46
 v_mul_f32 v45, v15, v134
 v_mul_f32 v134, v14, v134
 v_mfma_f32_32x32x16_bf16 v[192:207], a[4:7], a[224:227], v[192:207]
 ds_read_b128 a[224:227], v54 offset:24576
 v_accvgpr_read_b32 v63, a162
 buffer_load_dword a160, v63, s[12:15], s44 offen
 v_mul_f32 v160, v160, v80
 v_mul_f32 v176, v176, v80
 v_mfma_f32_32x32x16_bf16 v[208:223], a[4:7], a[228:231], v[208:223]
 ds_read_b128 a[228:231], v54 offset:36864
 buffer_load_dwordx4 v5, s[8:11], s38 offen offset:2048 lds
 s_waitcnt lgkmcnt(2)
 v_mul_f32 v161, v161, v81
 v_mfma_f32_32x32x16_bf16 v[192:207], a[8:11], a[232:235], v[192:207]
 ds_read_b128 a[232:235], v1 offset:26624
 v_mul_f32 v177, v177, v81
 v_mul_f32 v162, v162, v82
 v_mul_f32 v178, v178, v82
 v_mul_f32 v163, v163, v83
 v_mul_f32 v179, v179, v83
 v_mul_f32 v164, v164, v84
 v_mfma_f32_32x32x16_bf16 v[208:223], a[8:11], a[236:239], v[208:223]
 ds_read_b128 a[236:239], v1 offset:38912
 s_waitcnt lgkmcnt(2)
 v_mul_f32 v180, v180, v84
 v_mul_f32 v165, v165, v85
 v_mul_f32 v181, v181, v85
 v_mul_f32 v166, v166, v86
 v_mul_f32 v182, v182, v86
 v_mfma_f32_32x32x16_bf16 v[192:207], a[12:15], a[224:227], v[192:207]
 ds_read_b128 a[224:227], v2 offset:26624
 buffer_load_dwordx4 v6, s[8:11], s38 offen offset:3072 lds
 v_mul_f32 v167, v167, v87
 v_mul_f32 v183, v183, v87
 v_mfma_f32_32x32x16_bf16 v[208:223], a[12:15], a[228:231], v[208:223]
 ds_read_b128 a[228:231], v2 offset:38912
 s_waitcnt lgkmcnt(2)
 v_mul_f32 v168, v168, v88
 v_mul_f32 v184, v184, v88
 v_mul_f32 v169, v169, v89
 v_mul_f32 v185, v185, v89
 v_mul_f32 v170, v170, v90
 v_mfma_f32_32x32x16_bf16 v[192:207], a[16:19], a[232:235], v[192:207]
 ds_read_b128 a[232:235], v53 offset:26624
 v_mul_f32 v186, v186, v90
 v_mul_f32 v171, v171, v91
 v_mul_f32 v187, v187, v91
 v_mul_f32 v172, v172, v92
 v_mul_f32 v188, v188, v92
 v_mul_f32 v173, v173, v93
 v_mfma_f32_32x32x16_bf16 v[208:223], a[16:19], a[236:239], v[208:223]
 ds_read_b128 a[236:239], v53 offset:38912
 s_add_u32 m0, s36, 28672
 s_add_u32 s38, s21, 147712
 buffer_load_dwordx4 v3, s[8:11], s38 offen offset:0 lds
 s_waitcnt lgkmcnt(2)
 v_mfma_f32_32x32x16_bf16 v[192:207], a[20:23], a[224:227], v[192:207]
 ds_read_b128 a[224:227], v54 offset:26624
 v_accvgpr_read_b32 v63, a162
 buffer_load_dword a161, v63, s[52:55], s44 offen
 v_mul_f32 v189, v189, v93
 v_mfma_f32_32x32x16_bf16 v[208:223], a[20:23], a[228:231], v[208:223]
 ds_read_b128 a[228:231], v54 offset:38912
 s_waitcnt lgkmcnt(2)
 v_mul_f32 v174, v174, v94
 v_mul_f32 v190, v190, v94
 v_mul_f32 v175, v175, v95
 v_mul_f32 v191, v191, v95
 v_sub_f32 v70, 0, v22
 v_mfma_f32_32x32x16_bf16 v[192:207], a[24:27], a[232:235], v[192:207]
 ds_read_b128 a[232:235], v1 offset:28672
 buffer_load_dwordx4 v4, s[8:11], s38 offen offset:1024 lds
 v_fma_f32 v66, v21, v160, v161
 v_fma_f32 v67, v21, v176, v177
 v_mfma_f32_32x32x16_bf16 v[208:223], a[24:27], a[236:239], v[208:223]
 ds_read_b128 a[236:239], v1 offset:40960
 s_waitcnt lgkmcnt(2)
 v_fmac_f32 v66, v70, v176
 v_fmac_f32 v67, v22, v160
 v_fma_f32 v64, v21, v66, v162
 v_fma_f32 v65, v21, v67, v178
 v_fmac_f32 v64, v70, v67
 v_mfma_f32_32x32x16_bf16 v[192:207], a[28:31], a[224:227], v[192:207]
 ds_read_b128 a[224:227], v2 offset:28672
 v_fmac_f32 v65, v22, v66
 v_fma_f32 v66, v21, v64, v163
 v_fma_f32 v67, v21, v65, v179
 v_fmac_f32 v66, v70, v65
 v_fmac_f32 v67, v22, v64
 v_fma_f32 v64, v21, v66, v164
 v_mfma_f32_32x32x16_bf16 v[208:223], a[28:31], a[228:231], v[208:223]
 ds_read_b128 a[228:231], v2 offset:40960
 s_waitcnt lgkmcnt(2)
 v_fma_f32 v65, v21, v67, v180
 v_fmac_f32 v64, v70, v67
 v_fmac_f32 v65, v22, v66
 v_fma_f32 v66, v21, v64, v165
 v_fma_f32 v67, v21, v65, v181
 v_mfma_f32_32x32x16_bf16 v[192:207], a[32:35], a[232:235], v[192:207]
 ds_read_b128 a[232:235], v53 offset:28672
 v_fmac_f32 v66, v70, v65
 v_fmac_f32 v67, v22, v64
 v_fma_f32 v64, v21, v66, v166
 v_fma_f32 v65, v21, v67, v182
 v_fmac_f32 v64, v70, v67
 v_fmac_f32 v65, v22, v66
 v_mfma_f32_32x32x16_bf16 v[208:223], a[32:35], a[236:239], v[208:223]
 ds_read_b128 a[236:239], v53 offset:40960
 s_waitcnt lgkmcnt(2)
 v_fma_f32 v66, v21, v64, v167
 v_fma_f32 v67, v21, v65, v183
 v_fmac_f32 v66, v70, v65
 v_fmac_f32 v67, v22, v64
 v_fma_f32 v64, v21, v66, v168
 v_mfma_f32_32x32x16_bf16 v[192:207], a[36:39], a[224:227], v[192:207]
 ds_read_b128 a[224:227], v54 offset:28672
 v_fma_f32 v65, v21, v67, v184
 v_fmac_f32 v64, v70, v67
 v_fmac_f32 v65, v22, v66
 v_fma_f32 v66, v21, v64, v169
 v_fma_f32 v67, v21, v65, v185
 v_fmac_f32 v66, v70, v65
 v_mfma_f32_32x32x16_bf16 v[208:223], a[36:39], a[228:231], v[208:223]
 ds_read_b128 a[228:231], v54 offset:40960
 s_waitcnt lgkmcnt(2)
 v_fmac_f32 v67, v22, v64
 v_fma_f32 v64, v21, v66, v170
 v_fma_f32 v65, v21, v67, v186
 v_fmac_f32 v64, v70, v67
 v_fmac_f32 v65, v22, v66
 v_mfma_f32_32x32x16_bf16 v[192:207], a[40:43], a[232:235], v[192:207]
 v_fma_f32 v66, v21, v64, v171
 v_fma_f32 v67, v21, v65, v187
 v_fmac_f32 v66, v70, v65
 v_fmac_f32 v67, v22, v64
 v_fma_f32 v64, v21, v66, v172
 v_fma_f32 v65, v21, v67, v188
 v_fmac_f32 v64, v70, v67
 v_fmac_f32 v65, v22, v66
 v_fma_f32 v66, v21, v64, v173
 v_fma_f32 v67, v21, v65, v189
 v_fmac_f32 v66, v70, v65
 v_fmac_f32 v67, v22, v64
 v_fma_f32 v64, v21, v66, v174
 v_fma_f32 v65, v21, v67, v190
 v_fmac_f32 v64, v70, v67
 v_fmac_f32 v65, v22, v66
 v_fma_f32 v66, v21, v64, v175
 v_fma_f32 v67, v21, v65, v191
 v_fmac_f32 v66, v70, v65
 v_fmac_f32 v67, v22, v64
 v_mul_f32 v68, v18, v66
 v_mul_f32 v69, v18, v67
 v_fmac_f32 v68, v19, v67
 v_fma_f32 v69, -v19, v66, v69
 ds_write_b64 v38, v[68:69] offset:1792
 s_waitcnt lgkmcnt(0)
 s_barrier
 v_add_u32 v1, 49152, v1
 v_add_u32 v2, 49152, v2
 v_add_u32 v53, 49152, v53
 v_add_u32 v54, 49152, v54
 ds_read_b128 a[232:235], v1 offset:0
 s_add_u32 s37, s34, 8192
 buffer_load_dwordx4 v[56:59], v41, s[16:19], s37 offen sc1
 buffer_load_dwordx4 v[60:63], v42, s[16:19], s37 offen sc1
 v_mfma_f32_32x32x16_bf16 v[208:223], a[40:43], a[236:239], v[208:223]
 ds_read_b128 a[236:239], v1 offset:12288
 s_add_u32 m0, s36, 49152
 s_add_u32 s38, s22, 147456
 buffer_load_dwordx4 v3, s[8:11], s38 offen offset:0 lds
 v_mfma_f32_32x32x16_bf16 v[192:207], a[44:47], a[224:227], v[192:207]
 ds_read_b128 a[224:227], v2 offset:0
 ds_read2_b64 v[64:67], v39 offset0:0 offset1:32
 ds_read2_b64 v[68:71], v39 offset0:64 offset1:96
 ds_read2_b64 v[72:75], v39 offset0:128 offset1:160
 ds_read2_b64 v[76:79], v39 offset0:192 offset1:224
 v_mfma_f32_32x32x16_bf16 v[208:223], a[44:47], a[228:231], v[208:223]
 ds_read_b128 a[228:231], v2 offset:12288
 s_waitcnt lgkmcnt(6)
 v_fmac_f32 v134, v15, v150
 v_fma_f32 v150, v14, v150, -v45
 v_mul_f32 v46, v15, v135
 v_mul_f32 v135, v14, v135
 v_fmac_f32 v135, v15, v151
 v_mfma_f32_32x32x16_bf16 v[192:207], a[48:51], a[232:235], v[192:207]
 ds_read_b128 a[232:235], v53 offset:0
 buffer_load_dwordx4 v4, s[8:11], s38 offen offset:1024 lds
 v_fma_f32 v151, v14, v151, -v46
 v_mul_f32 v45, v15, v136
 v_mfma_f32_32x32x16_bf16 v[208:223], a[48:51], a[236:239], v[208:223]
 ds_read_b128 a[236:239], v53 offset:12288
 s_waitcnt lgkmcnt(2)
 v_add_f32 v64, v64, v66
 v_add_f32 v65, v65, v67
 v_add_f32 v68, v68, v70
 v_add_f32 v69, v69, v71
 v_add_f32 v72, v72, v74
 v_mfma_f32_32x32x16_bf16 v[192:207], a[52:55], a[224:227], v[192:207]
 ds_read_b128 a[224:227], v54 offset:0
 v_add_f32 v73, v73, v75
 v_add_f32 v76, v76, v78
 v_add_f32 v77, v77, v79
 v_add_f32 v64, v64, v68
 v_add_f32 v65, v65, v69
 v_add_f32 v72, v72, v76
 v_mfma_f32_32x32x16_bf16 v[208:223], a[52:55], a[228:231], v[208:223]
 ds_read_b128 a[228:231], v54 offset:12288
 buffer_load_dwordx4 v5, s[8:11], s38 offen offset:2048 lds
 s_waitcnt lgkmcnt(2)
 v_add_f32 v73, v73, v77
 v_mfma_f32_32x32x16_bf16 v[192:207], a[56:59], a[232:235], v[192:207]
 ds_read_b128 a[232:235], v1 offset:2048
 v_add_f32 v64, v64, v72
 v_add_f32 v65, v65, v73
 v_mul_f32 v55, v36, v8
 v_mul_f32 v67, v36, v9
 v_exp_f32 v55, v55
 v_mfma_f32_32x32x16_bf16 v[208:223], a[56:59], a[236:239], v[208:223]
 ds_read_b128 a[236:239], v1 offset:14336
 s_waitcnt lgkmcnt(2)
 v_fract_f32 v67, v67
 v_cos_f32 v66, v67
 v_sin_f32 v67, v67
 v_mfma_f32_32x32x16_bf16 v[192:207], a[60:63], a[224:227], v[192:207]
 ds_read_b128 a[224:227], v2 offset:2048
 buffer_load_dwordx4 v6, s[8:11], s38 offen offset:3072 lds
 v_mul_f32 v66, v66, v55
 v_mul_f32 v67, v67, v55
 v_mfma_f32_32x32x16_bf16 v[208:223], a[60:63], a[228:231], v[208:223]
 ds_read_b128 a[228:231], v2 offset:14336
 s_waitcnt lgkmcnt(2)
 v_fmac_f32 v47, v66, v64
 v_fmac_f32 v48, v66, v65
 v_fma_f32 v47, -v67, v65, v47
 v_fmac_f32 v48, v67, v64
 ds_read2_b64 v[64:67], v38 offset0:0 offset1:32
 v_mfma_f32_32x32x16_bf16 v[192:207], a[64:67], a[232:235], v[192:207]
 ds_read_b128 a[232:235], v53 offset:2048
 ds_read2_b64 v[68:71], v38 offset0:64 offset1:96
 ds_read2_b64 v[72:75], v38 offset0:128 offset1:160
 ds_read2_b64 v[76:79], v38 offset0:192 offset1:224
 v_mul_f32 v55, 0x41800000, v16
 v_mul_f32 v22, 0x41800000, v17
 v_mfma_f32_32x32x16_bf16 v[208:223], a[64:67], a[236:239], v[208:223]
 ds_read_b128 a[236:239], v53 offset:14336
 s_add_u32 m0, s36, 53248
 s_add_u32 s38, s22, 147712
 buffer_load_dwordx4 v3, s[8:11], s38 offen offset:0 lds
 s_waitcnt lgkmcnt(6)
 v_mfma_f32_32x32x16_bf16 v[192:207], a[68:71], a[224:227], v[192:207]
 ds_read_b128 a[224:227], v54 offset:2048
 v_exp_f32 v55, v55
 v_fract_f32 v22, v22
 v_cos_f32 v21, v22
 v_mfma_f32_32x32x16_bf16 v[208:223], a[68:71], a[228:231], v[208:223]
 ds_read_b128 a[228:231], v54 offset:14336
 s_waitcnt lgkmcnt(2)
 v_sin_f32 v22, v22
 v_mul_f32 v21, v21, v55
 v_mul_f32 v22, v22, v55
 v_fmac_f32 v66, v21, v64
 v_fmac_f32 v67, v21, v65
 v_mfma_f32_32x32x16_bf16 v[192:207], a[72:75], a[232:235], v[192:207]
 ds_read_b128 a[232:235], v1 offset:4096
 buffer_load_dwordx4 v4, s[8:11], s38 offen offset:1024 lds
 v_fma_f32 v66, -v22, v65, v66
 v_fmac_f32 v67, v22, v64
 v_mfma_f32_32x32x16_bf16 v[208:223], a[72:75], a[236:239], v[208:223]
 ds_read_b128 a[236:239], v1 offset:16384
 s_waitcnt lgkmcnt(2)
 v_fmac_f32 v68, v21, v66
 v_fmac_f32 v69, v21, v67
 v_fma_f32 v68, -v22, v67, v68
 v_fmac_f32 v69, v22, v66
 v_fmac_f32 v70, v21, v68
 v_mfma_f32_32x32x16_bf16 v[192:207], a[76:79], a[224:227], v[192:207]
 ds_read_b128 a[224:227], v2 offset:4096
 v_fmac_f32 v71, v21, v69
 v_fma_f32 v70, -v22, v69, v70
 v_fmac_f32 v71, v22, v68
 v_fmac_f32 v72, v21, v70
 v_fmac_f32 v73, v21, v71
 v_fma_f32 v72, -v22, v71, v72
 v_mfma_f32_32x32x16_bf16 v[208:223], a[76:79], a[228:231], v[208:223]
 ds_read_b128 a[228:231], v2 offset:16384
 s_waitcnt lgkmcnt(2)
 v_fmac_f32 v73, v22, v70
 v_fmac_f32 v74, v21, v72
 v_fmac_f32 v75, v21, v73
 v_fma_f32 v74, -v22, v73, v74
 v_fmac_f32 v75, v22, v72
 v_mfma_f32_32x32x16_bf16 v[192:207], a[80:83], a[232:235], v[192:207]
 ds_read_b128 a[232:235], v53 offset:4096
 s_add_u32 s35, s35, 1024
 buffer_load_dwordx4 a[152:155], v23, s[16:19], s35 offen sc1
 v_fma_f32 v51, v21, v74, v76
 v_fma_f32 v52, v21, v75, v77
 v_mfma_f32_32x32x16_bf16 v[208:223], a[80:83], a[236:239], v[208:223]
 ds_read_b128 a[236:239], v53 offset:16384
 s_waitcnt lgkmcnt(2)
 v_fma_f32 v51, -v22, v75, v51
 v_fmac_f32 v52, v22, v74
 v_fma_f32 v64, v21, v51, v78
 v_fma_f32 v65, v21, v52, v79
 v_fma_f32 v64, -v22, v52, v64
 v_mfma_f32_32x32x16_bf16 v[192:207], a[84:87], a[224:227], v[192:207]
 ds_read_b128 a[224:227], v54 offset:4096
 v_fmac_f32 v65, v22, v51
 v_mov_b32 v66, s45
 v_mov_b32 v67, s45
 s_add_u32 s39, s34, 16384
 buffer_store_dwordx4 v[64:67], v20, s[16:19], s39 offen sc1
 v_mfma_f32_32x32x16_bf16 v[208:223], a[84:87], a[228:231], v[208:223]
 ds_read_b128 a[228:231], v54 offset:16384
 s_waitcnt lgkmcnt(2)
 v_mul_f32 v136, v14, v136
 v_fmac_f32 v136, v15, v152
 v_fma_f32 v152, v14, v152, -v45
 v_mul_f32 v46, v15, v137
 v_mul_f32 v137, v14, v137
 v_mfma_f32_32x32x16_bf16 v[192:207], a[88:91], a[232:235], v[192:207]
 s_barrier
 ds_read_b128 a[232:235], v1 offset:24576
 v_mul_f32 v55, 0x43000000, v12
 v_mul_f32 v69, 0x43000000, v13
 v_exp_f32 v55, v55
 v_mfma_f32_32x32x16_bf16 v[208:223], a[88:91], a[236:239], v[208:223]
 ds_read_b128 a[236:239], v1 offset:36864
 s_add_u32 m0, s36, 73728
 s_add_u32 s38, s20, 184320
 buffer_load_dwordx4 v3, s[8:11], s38 offen offset:0 lds
 s_waitcnt lgkmcnt(2)
 v_mfma_f32_32x32x16_bf16 v[192:207], a[92:95], a[224:227], v[192:207]
 ds_read_b128 a[224:227], v2 offset:24576
 v_fract_f32 v69, v69
 v_cos_f32 v68, v69
 v_sin_f32 v69, v69
 v_mfma_f32_32x32x16_bf16 v[208:223], a[92:95], a[228:231], v[208:223]
 ds_read_b128 a[228:231], v2 offset:36864
 s_waitcnt lgkmcnt(2)
 v_mul_f32 v68, v68, v55
 v_mul_f32 v69, v69, v55
 v_mul_f32 v55, v37, v12
 v_mul_f32 v71, v37, v13
 v_mfma_f32_32x32x16_bf16 v[192:207], a[96:99], a[232:235], v[192:207]
 ds_read_b128 a[232:235], v53 offset:24576
 buffer_load_dwordx4 v4, s[8:11], s38 offen offset:1024 lds
 v_exp_f32 v55, v55
 v_fract_f32 v71, v71
 v_mfma_f32_32x32x16_bf16 v[208:223], a[96:99], a[236:239], v[208:223]
 ds_read_b128 a[236:239], v53 offset:36864
 s_waitcnt lgkmcnt(2)
 v_cos_f32 v70, v71
 v_sin_f32 v71, v71
 v_mul_f32 v70, v70, v55
 v_mfma_f32_32x32x16_bf16 v[192:207], a[100:103], a[224:227], v[192:207]
 ds_read_b128 a[224:227], v54 offset:24576
 v_mul_f32 v71, v71, v55
 v_fmac_f32 v137, v15, v153
 v_fma_f32 v153, v14, v153, -v46
 v_mul_f32 v45, v15, v138
 v_mul_f32 v138, v14, v138
 v_fmac_f32 v138, v15, v154
 v_mfma_f32_32x32x16_bf16 v[208:223], a[100:103], a[228:231], v[208:223]
 ds_read_b128 a[228:231], v54 offset:36864
 buffer_load_dwordx4 v5, s[8:11], s38 offen offset:2048 lds
 s_waitcnt lgkmcnt(2)
 v_fma_f32 v154, v14, v154, -v45
 v_mfma_f32_32x32x16_bf16 v[192:207], a[104:107], a[232:235], v[192:207]
 ds_read_b128 a[232:235], v1 offset:26624
 v_mul_f32 v46, v15, v139
 v_mul_f32 v139, v14, v139
 v_fmac_f32 v139, v15, v155
 v_fma_f32 v155, v14, v155, -v46
 v_mul_f32 v45, v15, v140
 v_mul_f32 v140, v14, v140
 v_mfma_f32_32x32x16_bf16 v[208:223], a[104:107], a[236:239], v[208:223]
 ds_read_b128 a[236:239], v1 offset:38912
 s_waitcnt lgkmcnt(2)
 v_fmac_f32 v140, v15, v156
 v_fma_f32 v156, v14, v156, -v45
 v_mul_f32 v46, v15, v141
 v_mul_f32 v141, v14, v141
 v_fmac_f32 v141, v15, v157
 v_mfma_f32_32x32x16_bf16 v[192:207], a[108:111], a[224:227], v[192:207]
 ds_read_b128 a[224:227], v2 offset:26624
 buffer_load_dwordx4 v6, s[8:11], s38 offen offset:3072 lds
 v_fma_f32 v157, v14, v157, -v46
 v_mul_f32 v45, v15, v142
 v_mfma_f32_32x32x16_bf16 v[208:223], a[108:111], a[228:231], v[208:223]
 ds_read_b128 a[228:231], v2 offset:38912
 s_waitcnt lgkmcnt(2)
 v_mul_f32 v142, v14, v142
 v_fmac_f32 v142, v15, v158
 v_fma_f32 v158, v14, v158, -v45
 v_mul_f32 v46, v15, v143
 v_mul_f32 v143, v14, v143
 v_mfma_f32_32x32x16_bf16 v[192:207], a[112:115], a[232:235], v[192:207]
 ds_read_b128 a[232:235], v53 offset:26624
 v_fmac_f32 v143, v15, v159
 v_fma_f32 v159, v14, v159, -v46
 v_exp_f32 v45, v8
 v_fract_f32 v44, v9
 v_mfma_f32_32x32x16_bf16 v[208:223], a[112:115], a[236:239], v[208:223]
 ds_read_b128 a[236:239], v53 offset:38912
 s_add_u32 m0, s36, 77824
 s_add_u32 s38, s20, 184576
 buffer_load_dwordx4 v3, s[8:11], s38 offen offset:0 lds
 s_waitcnt lgkmcnt(2)
 v_mfma_f32_32x32x16_bf16 v[192:207], a[116:119], a[224:227], v[192:207]
 ds_read_b128 a[224:227], v54 offset:26624
 v_cos_f32 v43, v44
 v_sin_f32 v44, v44
 v_mul_f32 v43, v43, v45
 v_mul_f32 v44, v44, v45
 v_mfma_f32_32x32x16_bf16 v[208:223], a[116:119], a[228:231], v[208:223]
 ds_read_b128 a[228:231], v54 offset:38912
 s_waitcnt lgkmcnt(2)
 v_sub_f32 v45, 0, v44
 v_fmac_f32 v96, v43, v47
 v_fmac_f32 v112, v43, v48
 v_fmac_f32 v96, v45, v48
 v_fmac_f32 v112, v44, v47
 v_mfma_f32_32x32x16_bf16 v[192:207], a[120:123], a[232:235], v[192:207]
 ds_read_b128 a[232:235], v1 offset:28672
 buffer_load_dwordx4 v4, s[8:11], s38 offen offset:1024 lds
 v_mfma_f32_32x32x16_bf16 v[208:223], a[120:123], a[236:239], v[208:223]
 ds_read_b128 a[236:239], v1 offset:40960
 s_waitcnt lgkmcnt(2)
 s_waitcnt vmcnt(15)
 v_cmp_ne_u32 vcc, s45, v58
 s_and_b64 s[40:41], vcc, s[42:43]
 s_waitcnt vmcnt(14)
 v_cmp_ne_u32 vcc, s45, v62
 s_and_b64 vcc, vcc, s[46:47]
 s_or_b64 vcc, vcc, s[40:41]
 s_cbranch_vccnz L_lb1
L_lb1_b:
 v_mfma_f32_32x32x16_bf16 v[192:207], a[124:127], a[224:227], v[192:207]
 ds_read_b128 a[224:227], v2 offset:28672
 v_fma_f32 v72, v68, v56, v60
 v_fma_f32 v73, v68, v57, v61
 v_fma_f32 v72, -v69, v57, v72
 v_fmac_f32 v73, v69, v56
 v_mul_f32 v74, v70, v72
 v_mul_f32 v75, v70, v73
 v_mfma_f32_32x32x16_bf16 v[208:223], a[124:127], a[228:231], v[208:223]
 ds_read_b128 a[228:231], v2 offset:40960
 s_waitcnt lgkmcnt(2)
 v_fma_f32 v74, -v71, v73, v74
 v_fmac_f32 v75, v71, v72
 ds_write_b64 v38, v[74:75] offset:4096
 v_fmac_f32 v97, v43, v96
 v_fmac_f32 v113, v43, v112
 v_mfma_f32_32x32x16_bf16 v[192:207], a[128:131], a[232:235], v[192:207]
 ds_read_b128 a[232:235], v53 offset:28672
 v_fmac_f32 v97, v45, v112
 v_fmac_f32 v113, v44, v96
 v_fmac_f32 v98, v43, v97
 v_fmac_f32 v114, v43, v113
 v_fmac_f32 v98, v45, v113
 v_fmac_f32 v114, v44, v97
 v_mfma_f32_32x32x16_bf16 v[208:223], a[128:131], a[236:239], v[208:223]
 ds_read_b128 a[236:239], v53 offset:40960
 s_waitcnt lgkmcnt(3)
 v_fmac_f32 v99, v43, v98
 v_fmac_f32 v115, v43, v114
 v_fmac_f32 v99, v45, v114
 v_fmac_f32 v115, v44, v98
 v_fmac_f32 v100, v43, v99
 v_mfma_f32_32x32x16_bf16 v[192:207], a[132:135], a[224:227], v[192:207]
 ds_read_b128 a[224:227], v54 offset:28672
 v_fmac_f32 v116, v43, v115
 v_fmac_f32 v100, v45, v115
 v_fmac_f32 v116, v44, v99
 v_fmac_f32 v101, v43, v100
 v_fmac_f32 v117, v43, v116
 v_fmac_f32 v101, v45, v116
 v_mfma_f32_32x32x16_bf16 v[208:223], a[132:135], a[228:231], v[208:223]
 ds_read_b128 a[228:231], v54 offset:40960
 s_waitcnt lgkmcnt(2)
 v_fmac_f32 v117, v44, v100
 v_fmac_f32 v102, v43, v101
 v_fmac_f32 v118, v43, v117
 v_fmac_f32 v102, v45, v117
 v_fmac_f32 v118, v44, v101
 v_mfma_f32_32x32x16_bf16 v[192:207], a[136:139], a[232:235], v[192:207]
 v_exp_f32 v55, v24
 v_fract_f32 v22, v25
 v_cos_f32 v21, v22
 v_mfma_f32_32x32x16_bf16 v[208:223], a[136:139], a[236:239], v[208:223]
 s_waitcnt lgkmcnt(0)
 v_sin_f32 v22, v22
 v_mul_f32 v21, v21, v55
 v_mul_f32 v22, v22, v55
 v_fmac_f32 v103, v43, v102
 v_fmac_f32 v119, v43, v118
 v_mfma_f32_32x32x16_bf16 v[192:207], a[140:143], a[224:227], v[192:207]
 s_barrier
 v_add_u32 v1, -98304, v1
 v_add_u32 v2, -98304, v2
 v_add_u32 v53, -98304, v53
 v_add_u32 v54, -98304, v54
 ds_read_b128 a[224:227], v1 offset:0
 s_waitcnt vmcnt(7)
 v_accvgpr_read_b32 v63, a155
 v_cmp_ne_u32 vcc, s90, v63
 s_cbranch_vccnz L_sx3
L_sx3_b:
 v_mfma_f32_32x32x16_bf16 v[208:223], a[140:143], a[228:231], v[208:223]
 ds_read_b128 a[228:231], v1 offset:12288
 s_add_u32 m0, s36, 98304
 s_add_u32 s38, s21, 184320
 buffer_load_dwordx4 v3, s[8:11], s38 offen offset:0 lds
 v_mfma_f32_32x32x16_bf16 v[192:207], a[144:147], a[152:155], v[192:207]
 ds_read_b128 a[232:235], v2 offset:0
 v_fmac_f32 v103, v45, v118
 v_fmac_f32 v119, v44, v102
 v_fmac_f32 v104, v43, v103
 v_fmac_f32 v120, v43, v119
 v_mfma_f32_32x32x16_bf16 v[208:223], a[148:151], a[152:155], v[208:223]
 ds_read_b128 a[236:239], v2 offset:12288
 s_waitcnt lgkmcnt(2)
 v_fmac_f32 v104, v45, v119
 v_fmac_f32 v120, v44, v103
 v_fmac_f32 v105, v43, v104
 v_fmac_f32 v121, v43, v120
 v_fmac_f32 v105, v45, v120
 v_mfma_f32_32x32x16_bf16 v[224:239], a[0:3], a[224:227], 0
 ds_read_b128 a[224:227], v53 offset:0
 buffer_load_dwordx4 v4, s[8:11], s38 offen offset:1024 lds
 v_fmac_f32 v121, v44, v104
 v_fmac_f32 v106, v43, v105
 v_mfma_f32_32x32x16_bf16 v[240:255], a[0:3], a[228:231], 0
 ds_read_b128 a[228:231], v53 offset:12288
 s_waitcnt lgkmcnt(2)
 v_fmac_f32 v122, v43, v121
 v_fmac_f32 v106, v45, v121
 v_fmac_f32 v122, v44, v105
 v_fmac_f32 v107, v43, v106
 v_fmac_f32 v123, v43, v122
 v_mfma_f32_32x32x16_bf16 v[224:239], a[4:7], a[232:235], v[224:239]
 ds_read_b128 a[232:235], v54 offset:0
 v_mul_f32 v192, v192, v80
 v_mul_f32 v208, v208, v80
 v_mul_f32 v193, v193, v81
 v_mul_f32 v209, v209, v81
 v_mul_f32 v194, v194, v82
 v_mul_f32 v210, v210, v82
 v_mfma_f32_32x32x16_bf16 v[240:255], a[4:7], a[236:239], v[240:255]
 ds_read_b128 a[236:239], v54 offset:12288
 buffer_load_dwordx4 v5, s[8:11], s38 offen offset:2048 lds
 s_waitcnt lgkmcnt(2)
 v_mul_f32 v195, v195, v83
 v_mfma_f32_32x32x16_bf16 v[224:239], a[8:11], a[224:227], v[224:239]
 ds_read_b128 a[224:227], v1 offset:2048
 v_mul_f32 v211, v211, v83
 v_mul_f32 v196, v196, v84
 v_mul_f32 v212, v212, v84
 v_mul_f32 v197, v197, v85
 v_mul_f32 v213, v213, v85
 v_mul_f32 v198, v198, v86
 v_mfma_f32_32x32x16_bf16 v[240:255], a[8:11], a[228:231], v[240:255]
 ds_read_b128 a[228:231], v1 offset:14336
 s_waitcnt lgkmcnt(2)
 v_mul_f32 v214, v214, v86
 v_mul_f32 v199, v199, v87
 v_mul_f32 v215, v215, v87
 v_mul_f32 v200, v200, v88
 v_mul_f32 v216, v216, v88
 v_mfma_f32_32x32x16_bf16 v[224:239], a[12:15], a[232:235], v[224:239]
 ds_read_b128 a[232:235], v2 offset:2048
 buffer_load_dwordx4 v6, s[8:11], s38 offen offset:3072 lds
 v_mul_f32 v201, v201, v89
 v_mul_f32 v217, v217, v89
 v_mfma_f32_32x32x16_bf16 v[240:255], a[12:15], a[236:239], v[240:255]
 ds_read_b128 a[236:239], v2 offset:14336
 s_waitcnt lgkmcnt(2)
 v_mul_f32 v202, v202, v90
 v_mul_f32 v218, v218, v90
 v_mul_f32 v203, v203, v91
 v_mul_f32 v219, v219, v91
 v_mul_f32 v204, v204, v92
 v_mfma_f32_32x32x16_bf16 v[224:239], a[16:19], a[224:227], v[224:239]
 ds_read_b128 a[224:227], v53 offset:2048
 v_mul_f32 v220, v220, v92
 v_mul_f32 v205, v205, v93
 v_mul_f32 v221, v221, v93
 v_mul_f32 v206, v206, v94
 v_mul_f32 v222, v222, v94
 v_mul_f32 v207, v207, v95
 v_mfma_f32_32x32x16_bf16 v[240:255], a[16:19], a[228:231], v[240:255]
 ds_read_b128 a[228:231], v53 offset:14336
 s_add_u32 m0, s36, 102400
 s_add_u32 s38, s21, 184576
 buffer_load_dwordx4 v3, s[8:11], s38 offen offset:0 lds
 s_waitcnt lgkmcnt(2)
 v_mfma_f32_32x32x16_bf16 v[224:239], a[20:23], a[232:235], v[224:239]
 ds_read_b128 a[232:235], v54 offset:2048
 v_mul_f32 v223, v223, v95
 v_sub_f32 v70, 0, v22
 v_fma_f32 v66, v21, v192, v193
 v_fma_f32 v67, v21, v208, v209
 v_fmac_f32 v66, v70, v208
 v_mfma_f32_32x32x16_bf16 v[240:255], a[20:23], a[236:239], v[240:255]
 ds_read_b128 a[236:239], v54 offset:14336
 s_waitcnt lgkmcnt(2)
 v_fmac_f32 v67, v22, v192
 v_fma_f32 v64, v21, v66, v194
 v_fma_f32 v65, v21, v67, v210
 v_fmac_f32 v64, v70, v67
 v_fmac_f32 v65, v22, v66
 v_mfma_f32_32x32x16_bf16 v[224:239], a[24:27], a[224:227], v[224:239]
 ds_read_b128 a[224:227], v1 offset:4096
 buffer_load_dwordx4 v4, s[8:11], s38 offen offset:1024 lds
 v_fma_f32 v66, v21, v64, v195
 v_fma_f32 v67, v21, v65, v211
 v_mfma_f32_32x32x16_bf16 v[240:255], a[24:27], a[228:231], v[240:255]
 ds_read_b128 a[228:231], v1 offset:16384
 s_waitcnt lgkmcnt(2)
 v_fmac_f32 v66, v70, v65
 v_fmac_f32 v67, v22, v64
 v_fma_f32 v64, v21, v66, v196
 v_fma_f32 v65, v21, v67, v212
 v_fmac_f32 v64, v70, v67
 v_mfma_f32_32x32x16_bf16 v[224:239], a[28:31], a[232:235], v[224:239]
 ds_read_b128 a[232:235], v2 offset:4096
 v_fmac_f32 v65, v22, v66
 v_fma_f32 v66, v21, v64, v197
 v_fma_f32 v67, v21, v65, v213
 v_fmac_f32 v66, v70, v65
 v_fmac_f32 v67, v22, v64
 v_fma_f32 v64, v21, v66, v198
 v_mfma_f32_32x32x16_bf16 v[240:255], a[28:31], a[236:239], v[240:255]
 ds_read_b128 a[236:239], v2 offset:16384
 s_waitcnt lgkmcnt(2)
 v_fma_f32 v65, v21, v67, v214
 v_fmac_f32 v64, v70, v67
 v_fmac_f32 v65, v22, v66
 v_fma_f32 v66, v21, v64, v199
 v_fma_f32 v67, v21, v65, v215
 v_mfma_f32_32x32x16_bf16 v[224:239], a[32:35], a[224:227], v[224:239]
 ds_read_b128 a[224:227], v53 offset:4096
 v_fmac_f32 v66, v70, v65
 v_fmac_f32 v67, v22, v64
 v_fma_f32 v64, v21, v66, v200
 v_fma_f32 v65, v21, v67, v216
 v_fmac_f32 v64, v70, v67
 v_fmac_f32 v65, v22, v66
 v_mfma_f32_32x32x16_bf16 v[240:255], a[32:35], a[228:231], v[240:255]
 ds_read_b128 a[228:231], v53 offset:16384
 s_waitcnt lgkmcnt(2)
 v_fma_f32 v66, v21, v64, v201
 v_fma_f32 v67, v21, v65, v217
 v_fmac_f32 v66, v70, v65
 v_fmac_f32 v67, v22, v64
 v_fma_f32 v64, v21, v66, v202
 v_mfma_f32_32x32x16_bf16 v[224:239], a[36:39], a[232:235], v[224:239]
 ds_read_b128 a[232:235], v54 offset:4096
 v_fma_f32 v65, v21, v67, v218
 v_fmac_f32 v64, v70, v67
 v_fmac_f32 v65, v22, v66
 v_fma_f32 v66, v21, v64, v203
 v_fma_f32 v67, v21, v65, v219
 v_fmac_f32 v66, v70, v65
 v_mfma_f32_32x32x16_bf16 v[240:255], a[36:39], a[236:239], v[240:255]
 ds_read_b128 a[236:239], v54 offset:16384
 s_waitcnt lgkmcnt(2)
 v_fmac_f32 v67, v22, v64
 v_fma_f32 v64, v21, v66, v204
 v_fma_f32 v65, v21, v67, v220
 v_fmac_f32 v64, v70, v67
 v_fmac_f32 v65, v22, v66
 v_mfma_f32_32x32x16_bf16 v[224:239], a[40:43], a[224:227], v[224:239]
 v_fma_f32 v66, v21, v64, v205
 v_fma_f32 v67, v21, v65, v221
 v_fmac_f32 v66, v70, v65
 v_fmac_f32 v67, v22, v64
 v_fma_f32 v64, v21, v66, v206
 v_fma_f32 v65, v21, v67, v222
 v_fmac_f32 v64, v70, v67
 v_fmac_f32 v65, v22, v66
 v_fma_f32 v66, v21, v64, v207
 v_fma_f32 v67, v21, v65, v223
 v_fmac_f32 v66, v70, v65
 v_fmac_f32 v67, v22, v64
 v_mul_f32 v68, v26, v66
 v_mul_f32 v69, v26, v67
 v_fmac_f32 v68, v27, v67
 v_fma_f32 v69, -v27, v66, v69
 ds_write_b64 v38, v[68:69] offset:1792
 s_waitcnt lgkmcnt(0)
 s_barrier
 ds_read_b128 a[224:227], v1 offset:24576
 s_add_u32 s37, s34, 16384
 buffer_load_dwordx4 v[56:59], v41, s[16:19], s37 offen sc1
 buffer_load_dwordx4 v[60:63], v42, s[16:19], s37 offen sc1
 v_mfma_f32_32x32x16_bf16 v[240:255], a[40:43], a[228:231], v[240:255]
 ds_read_b128 a[228:231], v1 offset:36864
 s_add_u32 m0, s36, 122880
 s_add_u32 s38, s22, 184320
 buffer_load_dwordx4 v3, s[8:11], s38 offen offset:0 lds
 v_mfma_f32_32x32x16_bf16 v[224:239], a[44:47], a[232:235], v[224:239]
 ds_read_b128 a[232:235], v2 offset:24576
 ds_read2_b64 v[64:67], v39 offset0:0 offset1:32
 ds_read2_b64 v[68:71], v39 offset0:64 offset1:96
 ds_read2_b64 v[72:75], v39 offset0:128 offset1:160
 ds_read2_b64 v[76:79], v39 offset0:192 offset1:224
 v_mfma_f32_32x32x16_bf16 v[240:255], a[44:47], a[236:239], v[240:255]
 ds_read_b128 a[236:239], v2 offset:36864
 s_waitcnt lgkmcnt(6)
 v_fmac_f32 v107, v45, v122
 v_fmac_f32 v123, v44, v106
 v_fmac_f32 v108, v43, v107
 v_fmac_f32 v124, v43, v123
 v_fmac_f32 v108, v45, v123
 v_mfma_f32_32x32x16_bf16 v[224:239], a[48:51], a[224:227], v[224:239]
 ds_read_b128 a[224:227], v53 offset:24576
 buffer_load_dwordx4 v4, s[8:11], s38 offen offset:1024 lds
 v_fmac_f32 v124, v44, v107
 v_fmac_f32 v109, v43, v108
 v_mfma_f32_32x32x16_bf16 v[240:255], a[48:51], a[228:231], v[240:255]
 ds_read_b128 a[228:231], v53 offset:36864
 s_waitcnt lgkmcnt(2)
 v_add_f32 v64, v64, v66
 v_add_f32 v65, v65, v67
 v_add_f32 v68, v68, v70
 v_add_f32 v69, v69, v71
 v_add_f32 v72, v72, v74
 v_mfma_f32_32x32x16_bf16 v[224:239], a[52:55], a[232:235], v[224:239]
 ds_read_b128 a[232:235], v54 offset:24576
 v_add_f32 v73, v73, v75
 v_add_f32 v76, v76, v78
 v_add_f32 v77, v77, v79
 v_add_f32 v64, v64, v68
 v_add_f32 v65, v65, v69
 v_add_f32 v72, v72, v76
 v_mfma_f32_32x32x16_bf16 v[240:255], a[52:55], a[236:239], v[240:255]
 ds_read_b128 a[236:239], v54 offset:36864
 buffer_load_dwordx4 v5, s[8:11], s38 offen offset:2048 lds
 s_waitcnt lgkmcnt(2)
 v_add_f32 v73, v73, v77
 v_mfma_f32_32x32x16_bf16 v[224:239], a[56:59], a[224:227], v[224:239]
 ds_read_b128 a[224:227], v1 offset:26624
 v_add_f32 v64, v64, v72
 v_add_f32 v65, v65, v73
 v_mul_f32 v55, v36, v12
 v_mul_f32 v67, v36, v13
 v_exp_f32 v55, v55
 v_mfma_f32_32x32x16_bf16 v[240:255], a[56:59], a[228:231], v[240:255]
 ds_read_b128 a[228:231], v1 offset:38912
 s_waitcnt lgkmcnt(2)
 v_fract_f32 v67, v67
 v_cos_f32 v66, v67
 v_sin_f32 v67, v67
 v_mfma_f32_32x32x16_bf16 v[224:239], a[60:63], a[232:235], v[224:239]
 ds_read_b128 a[232:235], v2 offset:26624
 buffer_load_dwordx4 v6, s[8:11], s38 offen offset:3072 lds
 v_mul_f32 v66, v66, v55
 v_mul_f32 v67, v67, v55
 v_mfma_f32_32x32x16_bf16 v[240:255], a[60:63], a[236:239], v[240:255]
 ds_read_b128 a[236:239], v2 offset:38912
 s_waitcnt lgkmcnt(2)
 v_fmac_f32 v49, v66, v64
 v_fmac_f32 v50, v66, v65
 v_fma_f32 v49, -v67, v65, v49
 v_fmac_f32 v50, v67, v64
 ds_read2_b64 v[64:67], v38 offset0:0 offset1:32
 v_mfma_f32_32x32x16_bf16 v[224:239], a[64:67], a[224:227], v[224:239]
 ds_read_b128 a[224:227], v53 offset:26624
 ds_read2_b64 v[68:71], v38 offset0:64 offset1:96
 ds_read2_b64 v[72:75], v38 offset0:128 offset1:160
 ds_read2_b64 v[76:79], v38 offset0:192 offset1:224
 v_mul_f32 v55, 0x41800000, v24
 v_mul_f32 v22, 0x41800000, v25
 v_mfma_f32_32x32x16_bf16 v[240:255], a[64:67], a[228:231], v[240:255]
 ds_read_b128 a[228:231], v53 offset:38912
 s_add_u32 m0, s36, 126976
 s_add_u32 s38, s22, 184576
 buffer_load_dwordx4 v3, s[8:11], s38 offen offset:0 lds
 s_waitcnt lgkmcnt(6)
 v_mfma_f32_32x32x16_bf16 v[224:239], a[68:71], a[232:235], v[224:239]
 ds_read_b128 a[232:235], v54 offset:26624
 v_exp_f32 v55, v55
 v_fract_f32 v22, v22
 v_cos_f32 v21, v22
 v_mfma_f32_32x32x16_bf16 v[240:255], a[68:71], a[236:239], v[240:255]
 ds_read_b128 a[236:239], v54 offset:38912
 s_waitcnt lgkmcnt(2)
 v_sin_f32 v22, v22
 v_mul_f32 v21, v21, v55
 v_mul_f32 v22, v22, v55
 v_fmac_f32 v66, v21, v64
 v_fmac_f32 v67, v21, v65
 v_mfma_f32_32x32x16_bf16 v[224:239], a[72:75], a[224:227], v[224:239]
 ds_read_b128 a[224:227], v1 offset:28672
 buffer_load_dwordx4 v4, s[8:11], s38 offen offset:1024 lds
 v_fma_f32 v66, -v22, v65, v66
 v_fmac_f32 v67, v22, v64
 v_mfma_f32_32x32x16_bf16 v[240:255], a[72:75], a[228:231], v[240:255]
 ds_read_b128 a[228:231], v1 offset:40960
 s_waitcnt lgkmcnt(2)
 v_fmac_f32 v68, v21, v66
 v_fmac_f32 v69, v21, v67
 v_fma_f32 v68, -v22, v67, v68
 v_fmac_f32 v69, v22, v66
 v_fmac_f32 v70, v21, v68
 v_mfma_f32_32x32x16_bf16 v[224:239], a[76:79], a[232:235], v[224:239]
 ds_read_b128 a[232:235], v2 offset:28672
 v_fmac_f32 v71, v21, v69
 v_fma_f32 v70, -v22, v69, v70
 v_fmac_f32 v71, v22, v68
 v_fmac_f32 v72, v21, v70
 v_fmac_f32 v73, v21, v71
 v_fma_f32 v72, -v22, v71, v72
 v_mfma_f32_32x32x16_bf16 v[240:255], a[76:79], a[236:239], v[240:255]
 ds_read_b128 a[236:239], v2 offset:40960
 s_waitcnt lgkmcnt(2)
 v_fmac_f32 v73, v22, v70
 v_fmac_f32 v74, v21, v72
 v_fmac_f32 v75, v21, v73
 v_fma_f32 v74, -v22, v73, v74
 v_fmac_f32 v75, v22, v72
 v_mfma_f32_32x32x16_bf16 v[224:239], a[80:83], a[224:227], v[224:239]
 ds_read_b128 a[224:227], v53 offset:28672
 s_add_u32 s35, s35, 1024
 buffer_load_dwordx4 a[152:155], v23, s[16:19], s35 offen sc1
 v_fma_f32 v47, v21, v74, v76
 v_fma_f32 v48, v21, v75, v77
 v_mfma_f32_32x32x16_bf16 v[240:255], a[80:83], a[228:231], v[240:255]
 ds_read_b128 a[228:231], v53 offset:40960
 s_waitcnt lgkmcnt(2)
 v_fma_f32 v47, -v22, v75, v47
 v_fmac_f32 v48, v22, v74
 v_fma_f32 v64, v21, v47, v78
 v_fma_f32 v65, v21, v48, v79
 v_fma_f32 v64, -v22, v48, v64
 v_mfma_f32_32x32x16_bf16 v[224:239], a[84:87], a[232:235], v[224:239]
 ds_read_b128 a[232:235], v54 offset:28672
 v_fmac_f32 v65, v22, v47
 v_mov_b32 v66, s45
 v_mov_b32 v67, s45
 s_add_u32 s39, s34, 24576
 buffer_store_dwordx4 v[64:67], v20, s[16:19], s39 offen sc1
 v_mfma_f32_32x32x16_bf16 v[240:255], a[84:87], a[236:239], v[240:255]
 ds_read_b128 a[236:239], v54 offset:40960
 s_waitcnt lgkmcnt(2)
 v_fmac_f32 v125, v43, v124
 v_fmac_f32 v109, v45, v124
 v_fmac_f32 v125, v44, v108
 v_fmac_f32 v110, v43, v109
 v_fmac_f32 v126, v43, v125
 v_mfma_f32_32x32x16_bf16 v[224:239], a[88:91], a[224:227], v[224:239]
 s_barrier
 v_add_u32 v1, 49152, v1
 v_add_u32 v2, 49152, v2
 v_add_u32 v53, 49152, v53
 v_add_u32 v54, 49152, v54
 ds_read_b128 a[224:227], v1 offset:0
 v_mfma_f32_32x32x16_bf16 v[240:255], a[88:91], a[228:231], v[240:255]
 ds_read_b128 a[228:231], v1 offset:12288
 v_add_u32 v5, 36736, v5
 v_add_u32 v6, 36736, v6
 s_add_u32 m0, s36, 0
 s_add_u32 s38, s33, 0
 buffer_load_dwordx4 v3, s[12:15], s38 offen offset:0 lds
 s_waitcnt lgkmcnt(2)
 v_mfma_f32_32x32x16_bf16 v[224:239], a[92:95], a[232:235], v[224:239]
 ds_read_b128 a[232:235], v2 offset:0
 v_mul_f32 v55, 0x43000000, v16
 v_mul_f32 v69, 0x43000000, v17
 v_exp_f32 v55, v55
 v_mfma_f32_32x32x16_bf16 v[240:255], a[92:95], a[236:239], v[240:255]
 ds_read_b128 a[236:239], v2 offset:12288
 s_waitcnt lgkmcnt(2)
 v_fract_f32 v69, v69
 v_cos_f32 v68, v69
 v_sin_f32 v69, v69
 v_mfma_f32_32x32x16_bf16 v[224:239], a[96:99], a[224:227], v[224:239]
 ds_read_b128 a[224:227], v53 offset:0
 buffer_load_dwordx4 v4, s[12:15], s38 offen offset:1024 lds
 v_mul_f32 v68, v68, v55
 v_mul_f32 v69, v69, v55
 v_mfma_f32_32x32x16_bf16 v[240:255], a[96:99], a[228:231], v[240:255]
 ds_read_b128 a[228:231], v53 offset:12288
 s_waitcnt lgkmcnt(2)
 v_mul_f32 v55, v37, v16
 v_mul_f32 v71, v37, v17
 v_exp_f32 v55, v55
 v_fract_f32 v71, v71
 v_mfma_f32_32x32x16_bf16 v[224:239], a[100:103], a[232:235], v[224:239]
 ds_read_b128 a[232:235], v54 offset:0
 v_cos_f32 v70, v71
 v_sin_f32 v71, v71
 v_mul_f32 v70, v70, v55
 v_mul_f32 v71, v71, v55
 v_mfma_f32_32x32x16_bf16 v[240:255], a[100:103], a[236:239], v[240:255]
 ds_read_b128 a[236:239], v54 offset:12288
 buffer_load_dwordx4 v5, s[12:15], s38 offen offset:2048 lds
 s_waitcnt lgkmcnt(2)
 v_fmac_f32 v110, v45, v125
 v_mfma_f32_32x32x16_bf16 v[224:239], a[104:107], a[224:227], v[224:239]
 ds_read_b128 a[224:227], v1 offset:2048
 v_fmac_f32 v126, v44, v109
 v_fmac_f32 v111, v43, v110
 v_fmac_f32 v127, v43, v126
 v_fmac_f32 v111, v45, v126
 v_fmac_f32 v127, v44, v110
 v_cvt_pk_bf16_f32 v96, v96, v97
 v_mfma_f32_32x32x16_bf16 v[240:255], a[104:107], a[228:231], v[240:255]
 ds_read_b128 a[228:231], v1 offset:14336
 s_waitcnt lgkmcnt(2)
 v_cvt_pk_bf16_f32 v97, v98, v99
 v_cvt_pk_bf16_f32 v98, v100, v101
 v_cvt_pk_bf16_f32 v99, v102, v103
 v_cvt_pk_bf16_f32 v100, v104, v105
 v_cvt_pk_bf16_f32 v101, v106, v107
 v_mfma_f32_32x32x16_bf16 v[224:239], a[108:111], a[232:235], v[224:239]
 ds_read_b128 a[232:235], v2 offset:2048
 buffer_load_dwordx4 v6, s[12:15], s38 offen offset:3072 lds
 v_cvt_pk_bf16_f32 v102, v108, v109
 v_cvt_pk_bf16_f32 v103, v110, v111
 v_mfma_f32_32x32x16_bf16 v[240:255], a[108:111], a[236:239], v[240:255]
 ds_read_b128 a[236:239], v2 offset:14336
 s_waitcnt lgkmcnt(2)
 v_cvt_pk_bf16_f32 v112, -v112, -v113
 v_cvt_pk_bf16_f32 v113, -v114, -v115
 v_cvt_pk_bf16_f32 v114, -v116, -v117
 v_cvt_pk_bf16_f32 v115, -v118, -v119
 v_cvt_pk_bf16_f32 v116, -v120, -v121
 v_mfma_f32_32x32x16_bf16 v[224:239], a[112:115], a[224:227], v[224:239]
 ds_read_b128 a[224:227], v53 offset:2048
 v_cvt_pk_bf16_f32 v117, -v122, -v123
 v_cvt_pk_bf16_f32 v118, -v124, -v125
 v_cvt_pk_bf16_f32 v119, -v126, -v127
 ds_write_b128 v40, v[96:99]
 v_mfma_f32_32x32x16_bf16 v[240:255], a[112:115], a[228:231], v[240:255]
 ds_read_b128 a[228:231], v53 offset:14336
 s_add_u32 m0, s36, 4096
 s_add_u32 s38, s33, 73728
 buffer_load_dwordx4 v3, s[12:15], s38 offen offset:0 lds
 s_waitcnt lgkmcnt(3)
 v_mfma_f32_32x32x16_bf16 v[224:239], a[116:119], a[232:235], v[224:239]
 ds_read_b128 a[232:235], v54 offset:2048
 v_xor_b32 v40, 16, v40
 ds_write_b128 v40, v[100:103]
 ds_read_b64_tr_b16 a[248:249], v0 offset:0
 v_mfma_f32_32x32x16_bf16 v[240:255], a[116:119], a[236:239], v[240:255]
 ds_read_b128 a[236:239], v54 offset:14336
 s_waitcnt lgkmcnt(4)
 ds_read_b64_tr_b16 a[252:253], v0 offset:1024
 v_xor_b32 v0, 32, v0
 ds_read_b64_tr_b16 a[250:251], v0 offset:256
 ds_read_b64_tr_b16 a[254:255], v0 offset:1280
 v_mfma_f32_32x32x16_bf16 v[224:239], a[120:123], a[224:227], v[224:239]
 ds_read_b128 a[224:227], v1 offset:4096
 buffer_load_dwordx4 v4, s[12:15], s38 offen offset:1024 lds
 v_mfma_f32_32x32x16_bf16 v[240:255], a[120:123], a[228:231], v[240:255]
 ds_read_b128 a[228:231], v1 offset:16384
 s_waitcnt lgkmcnt(5)
 s_waitcnt vmcnt(15)
 v_cmp_ne_u32 vcc, s45, v58
 s_and_b64 s[40:41], vcc, s[42:43]
 s_waitcnt vmcnt(14)
 v_cmp_ne_u32 vcc, s45, v62
 s_and_b64 vcc, vcc, s[46:47]
 s_or_b64 vcc, vcc, s[40:41]
 s_cbranch_vccnz L_lb2
L_lb2_b:
 v_mfma_f32_32x32x16_bf16 v[224:239], a[124:127], a[232:235], v[224:239]
 ds_read_b128 a[232:235], v2 offset:4096
 v_fma_f32 v72, v68, v56, v60
 v_fma_f32 v73, v68, v57, v61
 v_fma_f32 v72, -v69, v57, v72
 v_fmac_f32 v73, v69, v56
 v_mul_f32 v74, v70, v72
 v_mul_f32 v75, v70, v73
 v_mfma_f32_32x32x16_bf16 v[240:255], a[124:127], a[236:239], v[240:255]
 ds_read_b128 a[236:239], v2 offset:16384
 s_waitcnt lgkmcnt(2)
 v_fma_f32 v74, -v71, v73, v74
 v_fmac_f32 v75, v71, v72
 ds_write_b64 v38, v[74:75] offset:4096
 v_mfma_f32_32x32x16_bf16 v[224:239], a[128:131], a[224:227], v[224:239]
 ds_read_b128 a[224:227], v53 offset:4096
 ds_write_b128 v40, v[116:119]
 v_xor_b32 v40, 16, v40
 ds_write_b128 v40, v[112:115]
 v_mfma_f32_32x32x16_bf16 v[240:255], a[128:131], a[228:231], v[240:255]
 ds_read_b128 a[228:231], v53 offset:16384
 s_waitcnt lgkmcnt(5)
 ds_read_b64_tr_b16 a[242:243], v0 offset:256
 ds_read_b64_tr_b16 a[246:247], v0 offset:1280
 v_xor_b32 v0, 32, v0
 ds_read_b64_tr_b16 a[240:241], v0 offset:0
 ds_read_b64_tr_b16 a[244:245], v0 offset:1024
 v_mfma_f32_32x32x16_bf16 v[224:239], a[132:135], a[232:235], v[224:239]
 ds_read_b128 a[232:235], v54 offset:4096
 v_exp_f32 v45, v12
 v_fract_f32 v44, v13
 v_cos_f32 v43, v44
 v_mfma_f32_32x32x16_bf16 v[240:255], a[132:135], a[236:239], v[240:255]
 ds_read_b128 a[236:239], v54 offset:16384
 s_waitcnt lgkmcnt(6)
 v_sin_f32 v44, v44
 v_mul_f32 v43, v43, v45
 v_mul_f32 v44, v44, v45
 v_sub_f32 v45, 0, v44
 v_fmac_f32 v128, v43, v49
 v_mfma_f32_32x32x16_bf16 v[224:239], a[136:139], a[224:227], v[224:239]
 v_exp_f32 v55, v28
 v_fract_f32 v22, v29
 v_cos_f32 v21, v22
 v_mfma_f32_32x32x16_bf16 v[240:255], a[136:139], a[228:231], v[240:255]
 s_waitcnt lgkmcnt(0)
 v_sin_f32 v22, v22
 v_mul_f32 v21, v21, v55
 v_mul_f32 v22, v22, v55
 v_fmac_f32 v144, v43, v50
 v_fmac_f32 v128, v45, v50
 v_mfma_f32_32x32x16_bf16 v[224:239], a[140:143], a[232:235], v[224:239]
 s_barrier
 ds_read_b128 a[232:235], v1 offset:24576
 s_waitcnt vmcnt(7)
 v_accvgpr_read_b32 v63, a155
 v_cmp_ne_u32 vcc, s90, v63
 s_cbranch_vccnz L_sx4
L_sx4_b:
 v_mfma_f32_32x32x16_bf16 v[240:255], a[140:143], a[236:239], v[240:255]
 ds_read_b128 a[236:239], v1 offset:36864
 s_add_u32 m0, s36, 24576
 s_add_u32 s38, s33, 0
 buffer_load_dwordx4 v3, s[52:55], s38 offen offset:0 lds
 v_mfma_f32_32x32x16_bf16 v[224:239], a[144:147], a[152:155], v[224:239]
 ds_read_b128 a[224:227], v2 offset:24576
 v_fmac_f32 v144, v44, v49
 v_fmac_f32 v129, v43, v128
 v_fmac_f32 v145, v43, v144
 v_fmac_f32 v129, v45, v144
 v_fmac_f32 v145, v44, v128
 v_mfma_f32_32x32x16_bf16 v[240:255], a[148:151], a[152:155], v[240:255]
 ds_read_b128 a[228:231], v2 offset:36864
 s_waitcnt lgkmcnt(2)
 v_fmac_f32 v130, v43, v129
 v_fmac_f32 v146, v43, v145
 v_fmac_f32 v130, v45, v145
 v_fmac_f32 v146, v44, v129
 v_fmac_f32 v131, v43, v130
 v_mfma_f32_32x32x16_bf16 v[96:111], a[0:3], a[232:235], 0
 ds_read_b128 a[232:235], v53 offset:24576
 buffer_load_dwordx4 v4, s[52:55], s38 offen offset:1024 lds
 v_fmac_f32 v147, v43, v146
 v_fmac_f32 v131, v45, v146
 v_mfma_f32_32x32x16_bf16 v[112:127], a[0:3], a[236:239], 0
 ds_read_b128 a[236:239], v53 offset:36864
 s_waitcnt lgkmcnt(2)
 v_fmac_f32 v147, v44, v130
 v_fmac_f32 v132, v43, v131
 v_fmac_f32 v148, v43, v147
 v_fmac_f32 v132, v45, v147
 v_fmac_f32 v148, v44, v131
 v_mfma_f32_32x32x16_bf16 v[96:111], a[4:7], a[224:227], v[96:111]
 ds_read_b128 a[224:227], v54 offset:24576
 v_mul_f32 v224, v224, v80
 v_mul_f32 v240, v240, v80
 v_mul_f32 v225, v225, v81
 v_mul_f32 v241, v241, v81
 v_mul_f32 v226, v226, v82
 v_mul_f32 v242, v242, v82
 v_mfma_f32_32x32x16_bf16 v[112:127], a[4:7], a[228:231], v[112:127]
 ds_read_b128 a[228:231], v54 offset:36864
 buffer_load_dwordx4 v5, s[52:55], s38 offen offset:2048 lds
 s_waitcnt lgkmcnt(2)
 v_mul_f32 v227, v227, v83
 v_mfma_f32_32x32x16_bf16 v[96:111], a[8:11], a[232:235], v[96:111]
 ds_read_b128 a[232:235], v1 offset:26624
 v_mul_f32 v243, v243, v83
 v_mul_f32 v228, v228, v84
 v_mul_f32 v244, v244, v84
 v_mul_f32 v229, v229, v85
 v_mul_f32 v245, v245, v85
 v_mul_f32 v230, v230, v86
 v_mfma_f32_32x32x16_bf16 v[112:127], a[8:11], a[236:239], v[112:127]
 ds_read_b128 a[236:239], v1 offset:38912
 s_waitcnt lgkmcnt(2)
 v_mul_f32 v246, v246, v86
 v_mul_f32 v231, v231, v87
 v_mul_f32 v247, v247, v87
 v_mul_f32 v232, v232, v88
 v_mul_f32 v248, v248, v88
 v_mfma_f32_32x32x16_bf16 v[96:111], a[12:15], a[224:227], v[96:111]
 ds_read_b128 a[224:227], v2 offset:26624
 buffer_load_dwordx4 v6, s[52:55], s38 offen offset:3072 lds
 v_mul_f32 v233, v233, v89
 v_mul_f32 v249, v249, v89
 v_mfma_f32_32x32x16_bf16 v[112:127], a[12:15], a[228:231], v[112:127]
 ds_read_b128 a[228:231], v2 offset:38912
 s_waitcnt lgkmcnt(2)
 v_mul_f32 v234, v234, v90
 v_mul_f32 v250, v250, v90
 v_mul_f32 v235, v235, v91
 v_mul_f32 v251, v251, v91
 v_mul_f32 v236, v236, v92
 v_mfma_f32_32x32x16_bf16 v[96:111], a[16:19], a[232:235], v[96:111]
 ds_read_b128 a[232:235], v53 offset:26624
 v_mul_f32 v252, v252, v92
 v_mul_f32 v237, v237, v93
 v_mul_f32 v253, v253, v93
 v_mul_f32 v238, v238, v94
 v_mul_f32 v254, v254, v94
 v_mul_f32 v239, v239, v95
 v_mfma_f32_32x32x16_bf16 v[112:127], a[16:19], a[236:239], v[112:127]
 ds_read_b128 a[236:239], v53 offset:38912
 s_add_u32 m0, s36, 28672
 s_add_u32 s38, s33, 73728
 buffer_load_dwordx4 v3, s[52:55], s38 offen offset:0 lds
 s_waitcnt lgkmcnt(2)
 v_mfma_f32_32x32x16_bf16 v[96:111], a[20:23], a[224:227], v[96:111]
 ds_read_b128 a[224:227], v54 offset:26624
 v_mul_f32 v255, v255, v95
 v_sub_f32 v70, 0, v22
 v_fma_f32 v66, v21, v224, v225
 v_fma_f32 v67, v21, v240, v241
 v_fmac_f32 v66, v70, v240
 v_mfma_f32_32x32x16_bf16 v[112:127], a[20:23], a[228:231], v[112:127]
 ds_read_b128 a[228:231], v54 offset:38912
 s_waitcnt lgkmcnt(2)
 v_fmac_f32 v67, v22, v224
 v_fma_f32 v64, v21, v66, v226
 v_fma_f32 v65, v21, v67, v242
 v_fmac_f32 v64, v70, v67
 v_fmac_f32 v65, v22, v66
 v_mfma_f32_32x32x16_bf16 v[96:111], a[24:27], a[232:235], v[96:111]
 ds_read_b128 a[232:235], v1 offset:28672
 buffer_load_dwordx4 v4, s[52:55], s38 offen offset:1024 lds
 v_fma_f32 v66, v21, v64, v227
 v_fma_f32 v67, v21, v65, v243
 v_mfma_f32_32x32x16_bf16 v[112:127], a[24:27], a[236:239], v[112:127]
 ds_read_b128 a[236:239], v1 offset:40960
 s_waitcnt lgkmcnt(2)
 v_fmac_f32 v66, v70, v65
 v_fmac_f32 v67, v22, v64
 v_fma_f32 v64, v21, v66, v228
 v_fma_f32 v65, v21, v67, v244
 v_fmac_f32 v64, v70, v67
 v_mfma_f32_32x32x16_bf16 v[96:111], a[28:31], a[224:227], v[96:111]
 ds_read_b128 a[224:227], v2 offset:28672
 v_fmac_f32 v65, v22, v66
 v_fma_f32 v66, v21, v64, v229
 v_fma_f32 v67, v21, v65, v245
 v_fmac_f32 v66, v70, v65
 v_fmac_f32 v67, v22, v64
 v_fma_f32 v64, v21, v66, v230
 v_mfma_f32_32x32x16_bf16 v[112:127], a[28:31], a[228:231], v[112:127]
 ds_read_b128 a[228:231], v2 offset:40960
 s_waitcnt lgkmcnt(2)
 v_fma_f32 v65, v21, v67, v246
 v_fmac_f32 v64, v70, v67
 v_fmac_f32 v65, v22, v66
 v_fma_f32 v66, v21, v64, v231
 v_fma_f32 v67, v21, v65, v247
 v_mfma_f32_32x32x16_bf16 v[96:111], a[32:35], a[232:235], v[96:111]
 ds_read_b128 a[232:235], v53 offset:28672
 v_fmac_f32 v66, v70, v65
 v_fmac_f32 v67, v22, v64
 v_fma_f32 v64, v21, v66, v232
 v_fma_f32 v65, v21, v67, v248
 v_fmac_f32 v64, v70, v67
 v_fmac_f32 v65, v22, v66
 v_mfma_f32_32x32x16_bf16 v[112:127], a[32:35], a[236:239], v[112:127]
 ds_read_b128 a[236:239], v53 offset:40960
 s_waitcnt lgkmcnt(2)
 v_fma_f32 v66, v21, v64, v233
 v_fma_f32 v67, v21, v65, v249
 v_fmac_f32 v66, v70, v65
 v_fmac_f32 v67, v22, v64
 v_fma_f32 v64, v21, v66, v234
 v_mfma_f32_32x32x16_bf16 v[96:111], a[36:39], a[224:227], v[96:111]
 ds_read_b128 a[224:227], v54 offset:28672
 v_fma_f32 v65, v21, v67, v250
 v_fmac_f32 v64, v70, v67
 v_fmac_f32 v65, v22, v66
 v_fma_f32 v66, v21, v64, v235
 v_fma_f32 v67, v21, v65, v251
 v_fmac_f32 v66, v70, v65
 v_mfma_f32_32x32x16_bf16 v[112:127], a[36:39], a[228:231], v[112:127]
 ds_read_b128 a[228:231], v54 offset:40960
 s_waitcnt lgkmcnt(2)
 v_fmac_f32 v67, v22, v64
 v_fma_f32 v64, v21, v66, v236
 v_fma_f32 v65, v21, v67, v252
 v_fmac_f32 v64, v70, v67
 v_fmac_f32 v65, v22, v66
 v_mfma_f32_32x32x16_bf16 v[96:111], a[40:43], a[232:235], v[96:111]
 v_fma_f32 v66, v21, v64, v237
 v_fma_f32 v67, v21, v65, v253
 v_fmac_f32 v66, v70, v65
 v_fmac_f32 v67, v22, v64
 v_fma_f32 v64, v21, v66, v238
 v_fma_f32 v65, v21, v67, v254
 v_fmac_f32 v64, v70, v67
 v_fmac_f32 v65, v22, v66
 v_fma_f32 v66, v21, v64, v239
 v_fma_f32 v67, v21, v65, v255
 v_fmac_f32 v66, v70, v65
 v_fmac_f32 v67, v22, v64
 v_mul_f32 v68, v30, v66
 v_mul_f32 v69, v30, v67
 v_fmac_f32 v68, v31, v67
 v_fma_f32 v69, -v31, v66, v69
 ds_write_b64 v38, v[68:69] offset:1792
 s_waitcnt lgkmcnt(0)
 s_barrier
 v_add_u32 v1, 49152, v1
 v_add_u32 v2, 49152, v2
 v_add_u32 v53, 49152, v53
 v_add_u32 v54, 49152, v54
 ds_read_b128 a[232:235], v1 offset:0
 s_add_u32 s37, s34, 24576
 buffer_load_dwordx4 v[56:59], v41, s[16:19], s37 offen sc1
 buffer_load_dwordx4 v[60:63], v42, s[16:19], s37 offen sc1
 v_mfma_f32_32x32x16_bf16 v[112:127], a[40:43], a[236:239], v[112:127]
 ds_read_b128 a[236:239], v1 offset:12288
 s_add_u32 m0, s36, 49152
 s_add_u32 s38, s33, 221184
 buffer_load_dwordx4 v3, s[12:15], s38 offen offset:0 lds
 v_mfma_f32_32x32x16_bf16 v[96:111], a[44:47], a[224:227], v[96:111]
 ds_read_b128 a[224:227], v2 offset:0
 ds_read2_b64 v[64:67], v39 offset0:0 offset1:32
 ds_read2_b64 v[68:71], v39 offset0:64 offset1:96
 ds_read2_b64 v[72:75], v39 offset0:128 offset1:160
 ds_read2_b64 v[76:79], v39 offset0:192 offset1:224
 v_mfma_f32_32x32x16_bf16 v[112:127], a[44:47], a[228:231], v[112:127]
 ds_read_b128 a[228:231], v2 offset:12288
 s_waitcnt lgkmcnt(6)
 v_fmac_f32 v133, v43, v132
 v_fmac_f32 v149, v43, v148
 v_fmac_f32 v133, v45, v148
 v_fmac_f32 v149, v44, v132
 v_fmac_f32 v134, v43, v133
 v_mfma_f32_32x32x16_bf16 v[96:111], a[48:51], a[232:235], v[96:111]
 ds_read_b128 a[232:235], v53 offset:0
 buffer_load_dwordx4 v4, s[12:15], s38 offen offset:1024 lds
 v_fmac_f32 v150, v43, v149
 v_fmac_f32 v134, v45, v149
 v_mfma_f32_32x32x16_bf16 v[112:127], a[48:51], a[236:239], v[112:127]
 ds_read_b128 a[236:239], v53 offset:12288
 s_waitcnt lgkmcnt(2)
 v_add_f32 v64, v64, v66
 v_add_f32 v65, v65, v67
 v_add_f32 v68, v68, v70
 v_add_f32 v69, v69, v71
 v_add_f32 v72, v72, v74
 v_mfma_f32_32x32x16_bf16 v[96:111], a[52:55], a[224:227], v[96:111]
 ds_read_b128 a[224:227], v54 offset:0
 v_add_f32 v73, v73, v75
 v_add_f32 v76, v76, v78
 v_add_f32 v77, v77, v79
 v_add_f32 v64, v64, v68
 v_add_f32 v65, v65, v69
 v_add_f32 v72, v72, v76
 v_mfma_f32_32x32x16_bf16 v[112:127], a[52:55], a[228:231], v[112:127]
 ds_read_b128 a[228:231], v54 offset:12288
 buffer_load_dwordx4 v5, s[12:15], s38 offen offset:2048 lds
 s_waitcnt lgkmcnt(2)
 v_add_f32 v73, v73, v77
 v_mfma_f32_32x32x16_bf16 v[96:111], a[56:59], a[232:235], v[96:111]
 ds_read_b128 a[232:235], v1 offset:2048
 v_add_f32 v64, v64, v72
 v_add_f32 v65, v65, v73
 v_mul_f32 v55, v36, v16
 v_mul_f32 v67, v36, v17
 v_exp_f32 v55, v55
 v_mfma_f32_32x32x16_bf16 v[112:127], a[56:59], a[236:239], v[112:127]
 ds_read_b128 a[236:239], v1 offset:14336
 s_waitcnt lgkmcnt(2)
 v_fract_f32 v67, v67
 v_cos_f32 v66, v67
 v_sin_f32 v67, v67
 v_mfma_f32_32x32x16_bf16 v[96:111], a[60:63], a[224:227], v[96:111]
 ds_read_b128 a[224:227], v2 offset:2048
 buffer_load_dwordx4 v6, s[12:15], s38 offen offset:3072 lds
 v_mul_f32 v66, v66, v55
 v_mul_f32 v67, v67, v55
 v_mfma_f32_32x32x16_bf16 v[112:127], a[60:63], a[228:231], v[112:127]
 ds_read_b128 a[228:231], v2 offset:14336
 s_waitcnt lgkmcnt(2)
 v_fmac_f32 v51, v66, v64
 v_fmac_f32 v52, v66, v65
 v_fma_f32 v51, -v67, v65, v51
 v_fmac_f32 v52, v67, v64
 ds_read2_b64 v[64:67], v38 offset0:0 offset1:32
 v_mfma_f32_32x32x16_bf16 v[96:111], a[64:67], a[232:235], v[96:111]
 ds_read_b128 a[232:235], v53 offset:2048
 ds_read2_b64 v[68:71], v38 offset0:64 offset1:96
 ds_read2_b64 v[72:75], v38 offset0:128 offset1:160
 ds_read2_b64 v[76:79], v38 offset0:192 offset1:224
 v_mul_f32 v55, 0x41800000, v28
 v_mul_f32 v22, 0x41800000, v29
 v_mfma_f32_32x32x16_bf16 v[112:127], a[64:67], a[236:239], v[112:127]
 ds_read_b128 a[236:239], v53 offset:14336
 s_add_u32 m0, s36, 53248
 s_add_u32 s38, s33, 294912
 buffer_load_dwordx4 v3, s[12:15], s38 offen offset:0 lds
 s_waitcnt lgkmcnt(6)
 v_mfma_f32_32x32x16_bf16 v[96:111], a[68:71], a[224:227], v[96:111]
 ds_read_b128 a[224:227], v54 offset:2048
 v_exp_f32 v55, v55
 v_fract_f32 v22, v22
 v_cos_f32 v21, v22
 v_mfma_f32_32x32x16_bf16 v[112:127], a[68:71], a[228:231], v[112:127]
 ds_read_b128 a[228:231], v54 offset:14336
 s_waitcnt lgkmcnt(2)
 v_sin_f32 v22, v22
 v_mul_f32 v21, v21, v55
 v_mul_f32 v22, v22, v55
 v_fmac_f32 v66, v21, v64
 v_fmac_f32 v67, v21, v65
 v_mfma_f32_32x32x16_bf16 v[96:111], a[72:75], a[232:235], v[96:111]
 ds_read_b128 a[232:235], v1 offset:4096
 buffer_load_dwordx4 v4, s[12:15], s38 offen offset:1024 lds
 v_fma_f32 v66, -v22, v65, v66
 v_fmac_f32 v67, v22, v64
 v_mfma_f32_32x32x16_bf16 v[112:127], a[72:75], a[236:239], v[112:127]
 ds_read_b128 a[236:239], v1 offset:16384
 s_waitcnt lgkmcnt(2)
 v_fmac_f32 v68, v21, v66
 v_fmac_f32 v69, v21, v67
 v_fma_f32 v68, -v22, v67, v68
 v_fmac_f32 v69, v22, v66
 v_fmac_f32 v70, v21, v68
 v_mfma_f32_32x32x16_bf16 v[96:111], a[76:79], a[224:227], v[96:111]
 ds_read_b128 a[224:227], v2 offset:4096
 v_fmac_f32 v71, v21, v69
 v_fma_f32 v70, -v22, v69, v70
 v_fmac_f32 v71, v22, v68
 v_fmac_f32 v72, v21, v70
 v_fmac_f32 v73, v21, v71
 v_fma_f32 v72, -v22, v71, v72
 v_mfma_f32_32x32x16_bf16 v[112:127], a[76:79], a[228:231], v[112:127]
 ds_read_b128 a[228:231], v2 offset:16384
 s_waitcnt lgkmcnt(2)
 v_fmac_f32 v73, v22, v70
 v_fmac_f32 v74, v21, v72
 v_fmac_f32 v75, v21, v73
 v_fma_f32 v74, -v22, v73, v74
 v_fmac_f32 v75, v22, v72
 v_mfma_f32_32x32x16_bf16 v[96:111], a[80:83], a[232:235], v[96:111]
 ds_read_b128 a[232:235], v53 offset:4096
 s_add_u32 s35, s35, 1024
 buffer_load_dwordx4 a[152:155], v23, s[16:19], s35 offen sc1
 v_fma_f32 v49, v21, v74, v76
 v_fma_f32 v50, v21, v75, v77
 v_mfma_f32_32x32x16_bf16 v[112:127], a[80:83], a[236:239], v[112:127]
 ds_read_b128 a[236:239], v53 offset:16384
 s_waitcnt lgkmcnt(2)
 v_fma_f32 v49, -v22, v75, v49
 v_fmac_f32 v50, v22, v74
 v_fma_f32 v64, v21, v49, v78
 v_fma_f32 v65, v21, v50, v79
 v_fma_f32 v64, -v22, v50, v64
 v_mfma_f32_32x32x16_bf16 v[96:111], a[84:87], a[224:227], v[96:111]
 ds_read_b128 a[224:227], v54 offset:4096
 v_fmac_f32 v65, v22, v49
 v_mov_b32 v66, s45
 v_mov_b32 v67, s45
 s_add_u32 s39, s34, 32768
 buffer_store_dwordx4 v[64:67], v20, s[16:19], s39 offen sc1
 v_mfma_f32_32x32x16_bf16 v[112:127], a[84:87], a[228:231], v[112:127]
 ds_read_b128 a[228:231], v54 offset:16384
 s_waitcnt lgkmcnt(2)
 v_fmac_f32 v150, v44, v133
 v_fmac_f32 v135, v43, v134
 v_fmac_f32 v151, v43, v150
 v_fmac_f32 v135, v45, v150
 v_fmac_f32 v151, v44, v134
 v_mfma_f32_32x32x16_bf16 v[96:111], a[88:91], a[232:235], v[96:111]
 s_barrier
 ds_read_b128 a[232:235], v1 offset:24576
 v_mul_f32 v55, 0x43000000, v24
 v_mul_f32 v69, 0x43000000, v25
 v_exp_f32 v55, v55
 v_mfma_f32_32x32x16_bf16 v[112:127], a[88:91], a[236:239], v[112:127]
 ds_read_b128 a[236:239], v1 offset:36864
 s_add_u32 m0, s36, 73728
 s_add_u32 s38, s33, 221184
 buffer_load_dwordx4 v3, s[52:55], s38 offen offset:0 lds
 s_waitcnt lgkmcnt(2)
 v_mfma_f32_32x32x16_bf16 v[96:111], a[92:95], a[224:227], v[96:111]
 ds_read_b128 a[224:227], v2 offset:24576
 v_fract_f32 v69, v69
 v_cos_f32 v68, v69
 v_sin_f32 v69, v69
 v_mfma_f32_32x32x16_bf16 v[112:127], a[92:95], a[228:231], v[112:127]
 ds_read_b128 a[228:231], v2 offset:36864
 s_waitcnt lgkmcnt(2)
 v_mul_f32 v68, v68, v55
 v_mul_f32 v69, v69, v55
 v_mul_f32 v55, v37, v24
 v_mul_f32 v71, v37, v25
 v_mfma_f32_32x32x16_bf16 v[96:111], a[96:99], a[232:235], v[96:111]
 ds_read_b128 a[232:235], v53 offset:24576
 buffer_load_dwordx4 v4, s[52:55], s38 offen offset:1024 lds
 v_exp_f32 v55, v55
 v_fract_f32 v71, v71
 v_mfma_f32_32x32x16_bf16 v[112:127], a[96:99], a[236:239], v[112:127]
 ds_read_b128 a[236:239], v53 offset:36864
 s_waitcnt lgkmcnt(2)
 v_cos_f32 v70, v71
 v_sin_f32 v71, v71
 v_mul_f32 v70, v70, v55
 v_mfma_f32_32x32x16_bf16 v[96:111], a[100:103], a[224:227], v[96:111]
 ds_read_b128 a[224:227], v54 offset:24576
 v_mul_f32 v71, v71, v55
 v_fmac_f32 v136, v43, v135
 v_fmac_f32 v152, v43, v151
 v_fmac_f32 v136, v45, v151
 v_fmac_f32 v152, v44, v135
 v_fmac_f32 v137, v43, v136
 v_mfma_f32_32x32x16_bf16 v[112:127], a[100:103], a[228:231], v[112:127]
 ds_read_b128 a[228:231], v54 offset:36864
 buffer_load_dwordx4 v5, s[52:55], s38 offen offset:2048 lds
 s_waitcnt lgkmcnt(2)
 v_fmac_f32 v153, v43, v152
 v_mfma_f32_32x32x16_bf16 v[96:111], a[104:107], a[232:235], v[96:111]
 ds_read_b128 a[232:235], v1 offset:26624
 v_fmac_f32 v137, v45, v152
 v_fmac_f32 v153, v44, v136
 v_fmac_f32 v138, v43, v137
 v_fmac_f32 v154, v43, v153
 v_fmac_f32 v138, v45, v153
 v_fmac_f32 v154, v44, v137
 v_mfma_f32_32x32x16_bf16 v[112:127], a[104:107], a[236:239], v[112:127]
 ds_read_b128 a[236:239], v1 offset:38912
 s_waitcnt lgkmcnt(2)
 v_fmac_f32 v139, v43, v138
 v_fmac_f32 v155, v43, v154
 v_fmac_f32 v139, v45, v154
 v_fmac_f32 v155, v44, v138
 v_fmac_f32 v140, v43, v139
 v_mfma_f32_32x32x16_bf16 v[96:111], a[108:111], a[224:227], v[96:111]
 ds_read_b128 a[224:227], v2 offset:26624
 buffer_load_dwordx4 v6, s[52:55], s38 offen offset:3072 lds
 v_fmac_f32 v156, v43, v155
 v_fmac_f32 v140, v45, v155
 v_mfma_f32_32x32x16_bf16 v[112:127], a[108:111], a[228:231], v[112:127]
 ds_read_b128 a[228:231], v2 offset:38912
 s_waitcnt lgkmcnt(2)
 v_fmac_f32 v156, v44, v139
 v_fmac_f32 v141, v43, v140
 v_fmac_f32 v157, v43, v156
 v_fmac_f32 v141, v45, v156
 v_fmac_f32 v157, v44, v140
 v_mfma_f32_32x32x16_bf16 v[96:111], a[112:115], a[232:235], v[96:111]
 ds_read_b128 a[232:235], v53 offset:26624
 v_fmac_f32 v142, v43, v141
 v_fmac_f32 v158, v43, v157
 v_fmac_f32 v142, v45, v157
 v_fmac_f32 v158, v44, v141
 v_fmac_f32 v143, v43, v142
 v_fmac_f32 v159, v43, v158
 v_mfma_f32_32x32x16_bf16 v[112:127], a[112:115], a[236:239], v[112:127]
 ds_read_b128 a[236:239], v53 offset:38912
 s_add_u32 m0, s36, 77824
 s_add_u32 s38, s33, 294912
 buffer_load_dwordx4 v3, s[52:55], s38 offen offset:0 lds
 s_waitcnt lgkmcnt(2)
 v_mfma_f32_32x32x16_bf16 v[96:111], a[116:119], a[224:227], v[96:111]
 ds_read_b128 a[224:227], v54 offset:26624
 v_fmac_f32 v143, v45, v158
 v_fmac_f32 v159, v44, v142
 v_cvt_pk_bf16_f32 v128, v128, v129
 v_cvt_pk_bf16_f32 v129, v130, v131
 v_cvt_pk_bf16_f32 v130, v132, v133
 v_mfma_f32_32x32x16_bf16 v[112:127], a[116:119], a[228:231], v[112:127]
 ds_read_b128 a[228:231], v54 offset:38912
 s_waitcnt lgkmcnt(2)
 v_cvt_pk_bf16_f32 v131, v134, v135
 v_cvt_pk_bf16_f32 v132, v136, v137
 v_cvt_pk_bf16_f32 v133, v138, v139
 v_cvt_pk_bf16_f32 v134, v140, v141
 v_cvt_pk_bf16_f32 v135, v142, v143
 v_mfma_f32_32x32x16_bf16 v[96:111], a[120:123], a[232:235], v[96:111]
 ds_read_b128 a[232:235], v1 offset:28672
 buffer_load_dwordx4 v4, s[52:55], s38 offen offset:1024 lds
 v_mfma_f32_32x32x16_bf16 v[112:127], a[120:123], a[236:239], v[112:127]
 ds_read_b128 a[236:239], v1 offset:40960
 s_waitcnt lgkmcnt(2)
 s_waitcnt vmcnt(15)
 v_cmp_ne_u32 vcc, s45, v58
 s_and_b64 s[40:41], vcc, s[42:43]
 s_waitcnt vmcnt(14)
 v_cmp_ne_u32 vcc, s45, v62
 s_and_b64 vcc, vcc, s[46:47]
 s_or_b64 vcc, vcc, s[40:41]
 s_cbranch_vccnz L_lb3
L_lb3_b:
 v_mfma_f32_32x32x16_bf16 v[96:111], a[124:127], a[224:227], v[96:111]
 ds_read_b128 a[224:227], v2 offset:28672
 v_fma_f32 v72, v68, v56, v60
 v_fma_f32 v73, v68, v57, v61
 v_fma_f32 v72, -v69, v57, v72
 v_fmac_f32 v73, v69, v56
 v_mul_f32 v74, v70, v72
 v_mul_f32 v75, v70, v73
 v_mfma_f32_32x32x16_bf16 v[112:127], a[124:127], a[228:231], v[112:127]
 ds_read_b128 a[228:231], v2 offset:40960
 s_waitcnt lgkmcnt(2)
 v_fma_f32 v74, -v71, v73, v74
 v_fmac_f32 v75, v71, v72
 ds_write_b64 v38, v[74:75] offset:4096
 v_cvt_pk_bf16_f32 v144, -v144, -v145
 v_cvt_pk_bf16_f32 v145, -v146, -v147
 v_mfma_f32_32x32x16_bf16 v[96:111], a[128:131], a[232:235], v[96:111]
 ds_read_b128 a[232:235], v53 offset:28672
 v_cvt_pk_bf16_f32 v146, -v148, -v149
 v_cvt_pk_bf16_f32 v147, -v150, -v151
 v_cvt_pk_bf16_f32 v148, -v152, -v153
 v_cvt_pk_bf16_f32 v149, -v154, -v155
 v_cvt_pk_bf16_f32 v150, -v156, -v157
 v_cvt_pk_bf16_f32 v151, -v158, -v159
 v_mfma_f32_32x32x16_bf16 v[112:127], a[128:131], a[236:239], v[112:127]
 ds_read_b128 a[236:239], v53 offset:40960
 s_waitcnt lgkmcnt(3)
 ds_write_b128 v40, v[128:131]
 v_xor_b32 v40, 16, v40
 v_mfma_f32_32x32x16_bf16 v[96:111], a[132:135], a[224:227], v[96:111]
 ds_read_b128 a[224:227], v54 offset:28672
 ds_write_b128 v40, v[132:135]
 ds_read_b64_tr_b16 v[136:137], v0 offset:0
 ds_read_b64_tr_b16 v[140:141], v0 offset:1024
 v_xor_b32 v0, 32, v0
 ds_read_b64_tr_b16 v[138:139], v0 offset:256
 v_mfma_f32_32x32x16_bf16 v[112:127], a[132:135], a[228:231], v[112:127]
 ds_read_b128 a[228:231], v54 offset:40960
 s_waitcnt lgkmcnt(7)
 ds_read_b64_tr_b16 v[142:143], v0 offset:1280
 ds_write_b128 v40, v[148:151]
 v_xor_b32 v40, 16, v40
 v_mfma_f32_32x32x16_bf16 v[96:111], a[136:139], a[232:235], v[96:111]
 v_exp_f32 v55, v32
 v_fract_f32 v22, v33
 v_cos_f32 v21, v22
 v_mfma_f32_32x32x16_bf16 v[112:127], a[136:139], a[236:239], v[112:127]
 s_waitcnt lgkmcnt(2)
 v_sin_f32 v22, v22
 v_mul_f32 v21, v21, v55
 v_mul_f32 v22, v22, v55
 v_mfma_f32_32x32x16_bf16 v[96:111], a[140:143], a[224:227], v[96:111]
 s_barrier
 v_add_u32 v1, -98304, v1
 v_add_u32 v2, -98304, v2
 v_add_u32 v53, -98304, v53
 v_add_u32 v54, -98304, v54
 ds_read_b128 a[224:227], v1 offset:0
 s_waitcnt vmcnt(7)
 v_accvgpr_read_b32 v63, a155
 v_cmp_ne_u32 vcc, s90, v63
 s_cbranch_vccnz L_sx5
L_sx5_b:
 v_mfma_f32_32x32x16_bf16 v[112:127], a[140:143], a[228:231], v[112:127]
 ds_read_b128 a[228:231], v1 offset:2048
 s_add_u32 m0, s36, 98304
 s_add_u32 s38, s33, 442368
 buffer_load_dwordx4 v3, s[12:15], s38 offen offset:0 lds
 v_mfma_f32_32x32x16_bf16 v[96:111], a[144:147], a[152:155], v[96:111]
 ds_read_b128 a[232:235], v1 offset:4096
 ds_write_b128 v40, v[144:147]
 ds_read_b64_tr_b16 v[130:131], v0 offset:256
 v_mfma_f32_32x32x16_bf16 v[112:127], a[148:151], a[152:155], v[112:127]
 ds_read_b128 a[236:239], v1 offset:12288
 s_waitcnt lgkmcnt(4)
 ds_read_b64_tr_b16 v[134:135], v0 offset:1280
 v_xor_b32 v0, 32, v0
 ds_read_b64_tr_b16 v[128:129], v0 offset:0
 ds_read_b64_tr_b16 v[132:133], v0 offset:1024
 v_mfma_f32_32x32x16_bf16 a[0:15], a[224:227], a[248:251], 0
 ds_read_b128 a[224:227], v1 offset:14336
 buffer_load_dwordx4 v4, s[12:15], s38 offen offset:1024 lds
 v_exp_f32 v45, v16
 v_fract_f32 v44, v17
 v_mfma_f32_32x32x16_bf16 a[16:31], a[228:231], a[248:251], 0
 ds_read_b128 a[228:231], v1 offset:16384
 s_waitcnt lgkmcnt(5)
 v_cos_f32 v43, v44
 v_sin_f32 v44, v44
 v_mul_f32 v43, v43, v45
 v_mfma_f32_32x32x16_bf16 a[32:47], a[232:235], a[248:251], 0
 ds_read_b128 a[232:235], v2 offset:0
 v_mul_f32 v96, v96, v80
 v_mul_f32 v112, v112, v80
 v_mul_f32 v97, v97, v81
 v_mul_f32 v113, v113, v81
 v_mul_f32 v98, v98, v82
 v_mul_f32 v114, v114, v82
 v_mfma_f32_32x32x16_bf16 a[48:63], a[236:239], a[248:251], 0
 ds_read_b128 a[236:239], v2 offset:2048
 buffer_load_dwordx4 v5, s[12:15], s38 offen offset:2048 lds
 s_waitcnt lgkmcnt(2)
 v_mul_f32 v99, v99, v83
 v_mfma_f32_32x32x16_bf16 a[64:79], a[224:227], a[248:251], 0
 ds_read_b128 a[224:227], v2 offset:4096
 v_mul_f32 v115, v115, v83
 v_mul_f32 v100, v100, v84
 v_mul_f32 v116, v116, v84
 v_mul_f32 v101, v101, v85
 v_mul_f32 v117, v117, v85
 v_mul_f32 v102, v102, v86
 v_mfma_f32_32x32x16_bf16 a[80:95], a[228:231], a[248:251], 0
 ds_read_b128 a[228:231], v2 offset:12288
 s_waitcnt lgkmcnt(2)
 v_mul_f32 v118, v118, v86
 v_mul_f32 v103, v103, v87
 v_mul_f32 v119, v119, v87
 v_mul_f32 v104, v104, v88
 v_mul_f32 v120, v120, v88
 v_mfma_f32_32x32x16_bf16 a[0:15], a[232:235], a[252:255], a[0:15]
 ds_read_b128 a[232:235], v2 offset:14336
 buffer_load_dwordx4 v6, s[12:15], s38 offen offset:3072 lds
 v_mul_f32 v105, v105, v89
 v_mul_f32 v121, v121, v89
 v_mfma_f32_32x32x16_bf16 a[16:31], a[236:239], a[252:255], a[16:31]
 ds_read_b128 a[236:239], v2 offset:16384
 s_waitcnt lgkmcnt(2)
 v_mul_f32 v106, v106, v90
 v_mul_f32 v122, v122, v90
 v_mul_f32 v107, v107, v91
 v_mul_f32 v123, v123, v91
 v_mul_f32 v108, v108, v92
 v_mfma_f32_32x32x16_bf16 a[32:47], a[224:227], a[252:255], a[32:47]
 ds_read_b128 a[224:227], v53 offset:0
 v_mul_f32 v124, v124, v92
 v_mul_f32 v109, v109, v93
 v_mul_f32 v125, v125, v93
 v_mul_f32 v110, v110, v94
 v_mul_f32 v126, v126, v94
 v_mul_f32 v111, v111, v95
 v_mfma_f32_32x32x16_bf16 a[48:63], a[228:231], a[252:255], a[48:63]
 ds_read_b128 a[228:231], v53 offset:2048
 s_add_u32 m0, s36, 102400
 s_add_u32 s38, s33, 516096
 buffer_load_dwordx4 v3, s[12:15], s38 offen offset:0 lds
 s_waitcnt lgkmcnt(2)
 v_mfma_f32_32x32x16_bf16 a[64:79], a[232:235], a[252:255], a[64:79]
 ds_read_b128 a[232:235], v53 offset:4096
 v_mul_f32 v127, v127, v95
 v_sub_f32 v70, 0, v22
 v_fma_f32 v66, v21, v96, v97
 v_fma_f32 v67, v21, v112, v113
 v_fmac_f32 v66, v70, v112
 v_mfma_f32_32x32x16_bf16 a[80:95], a[236:239], a[252:255], a[80:95]
 ds_read_b128 a[236:239], v53 offset:12288
 s_waitcnt lgkmcnt(2)
 v_fmac_f32 v67, v22, v96
 v_fma_f32 v64, v21, v66, v98
 v_fma_f32 v65, v21, v67, v114
 v_fmac_f32 v64, v70, v67
 v_fmac_f32 v65, v22, v66
 v_mfma_f32_32x32x16_bf16 a[0:15], a[224:227], v[136:139], a[0:15]
 ds_read_b128 a[224:227], v53 offset:14336
 buffer_load_dwordx4 v4, s[12:15], s38 offen offset:1024 lds
 v_fma_f32 v66, v21, v64, v99
 v_fma_f32 v67, v21, v65, v115
 v_mfma_f32_32x32x16_bf16 a[16:31], a[228:231], v[136:139], a[16:31]
 ds_read_b128 a[228:231], v53 offset:16384
 s_waitcnt lgkmcnt(2)
 v_fmac_f32 v66, v70, v65
 v_fmac_f32 v67, v22, v64
 v_fma_f32 v64, v21, v66, v100
 v_fma_f32 v65, v21, v67, v116
 v_fmac_f32 v64, v70, v67
 v_mfma_f32_32x32x16_bf16 a[32:47], a[232:235], v[136:139], a[32:47]
 ds_read_b128 a[232:235], v54 offset:0
 v_fmac_f32 v65, v22, v66
 v_fma_f32 v66, v21, v64, v101
 v_fma_f32 v67, v21, v65, v117
 v_fmac_f32 v66, v70, v65
 v_fmac_f32 v67, v22, v64
 v_fma_f32 v64, v21, v66, v102
 v_mfma_f32_32x32x16_bf16 a[48:63], a[236:239], v[136:139], a[48:63]
 ds_read_b128 a[236:239], v54 offset:2048
 s_waitcnt lgkmcnt(2)
 v_fma_f32 v65, v21, v67, v118
 v_fmac_f32 v64, v70, v67
 v_fmac_f32 v65, v22, v66
 v_fma_f32 v66, v21, v64, v103
 v_fma_f32 v67, v21, v65, v119
 v_mfma_f32_32x32x16_bf16 a[64:79], a[224:227], v[136:139], a[64:79]
 ds_read_b128 a[224:227], v54 offset:4096
 v_fmac_f32 v66, v70, v65
 v_fmac_f32 v67, v22, v64
 v_fma_f32 v64, v21, v66, v104
 v_fma_f32 v65, v21, v67, v120
 v_fmac_f32 v64, v70, v67
 v_fmac_f32 v65, v22, v66
 v_mfma_f32_32x32x16_bf16 a[80:95], a[228:231], v[136:139], a[80:95]
 ds_read_b128 a[228:231], v54 offset:12288
 s_waitcnt lgkmcnt(2)
 v_fma_f32 v66, v21, v64, v105
 v_fma_f32 v67, v21, v65, v121
 v_fmac_f32 v66, v70, v65
 v_fmac_f32 v67, v22, v64
 v_fma_f32 v64, v21, v66, v106
 v_mfma_f32_32x32x16_bf16 a[0:15], a[232:235], v[140:143], a[0:15]
 ds_read_b128 a[232:235], v54 offset:14336
 v_fma_f32 v65, v21, v67, v122
 v_fmac_f32 v64, v70, v67
 v_fmac_f32 v65, v22, v66
 v_fma_f32 v66, v21, v64, v107
 v_fma_f32 v67, v21, v65, v123
 v_fmac_f32 v66, v70, v65
 v_mfma_f32_32x32x16_bf16 a[16:31], a[236:239], v[140:143], a[16:31]
 ds_read_b128 a[236:239], v54 offset:16384
 s_waitcnt lgkmcnt(2)
 v_fmac_f32 v67, v22, v64
 v_fma_f32 v64, v21, v66, v108
 v_fma_f32 v65, v21, v67, v124
 v_fmac_f32 v64, v70, v67
 v_fmac_f32 v65, v22, v66
 v_mfma_f32_32x32x16_bf16 a[32:47], a[224:227], v[140:143], a[32:47]
 v_fma_f32 v66, v21, v64, v109
 v_fma_f32 v67, v21, v65, v125
 v_fmac_f32 v66, v70, v65
 v_fmac_f32 v67, v22, v64
 v_fma_f32 v64, v21, v66, v110
 v_fma_f32 v65, v21, v67, v126
 v_fmac_f32 v64, v70, v67
 v_fmac_f32 v65, v22, v66
 v_fma_f32 v66, v21, v64, v111
 v_fma_f32 v67, v21, v65, v127
 v_fmac_f32 v66, v70, v65
 v_fmac_f32 v67, v22, v64
 v_mul_f32 v68, v34, v66
 v_mul_f32 v69, v34, v67
 v_fmac_f32 v68, v35, v67
 v_fma_f32 v69, -v35, v66, v69
 ds_write_b64 v38, v[68:69] offset:1792
 s_waitcnt lgkmcnt(0)
 s_barrier
 ds_read_b128 a[224:227], v1 offset:24576
 s_add_u32 s37, s34, 32768
 buffer_load_dwordx4 v[56:59], v41, s[16:19], s37 offen sc1
 buffer_load_dwordx4 v[60:63], v42, s[16:19], s37 offen sc1
 v_mfma_f32_32x32x16_bf16 a[48:63], a[228:231], v[140:143], a[48:63]
 ds_read_b128 a[228:231], v1 offset:26624
 s_add_u32 m0, s36, 122880
 s_add_u32 s38, s33, 442368
 buffer_load_dwordx4 v3, s[52:55], s38 offen offset:0 lds
 v_mfma_f32_32x32x16_bf16 a[64:79], a[232:235], v[140:143], a[64:79]
 ds_read_b128 a[232:235], v1 offset:28672
 ds_read2_b64 v[64:67], v39 offset0:0 offset1:32
 ds_read2_b64 v[68:71], v39 offset0:64 offset1:96
 ds_read2_b64 v[72:75], v39 offset0:128 offset1:160
 ds_read2_b64 v[76:79], v39 offset0:192 offset1:224
 v_mfma_f32_32x32x16_bf16 a[80:95], a[236:239], v[140:143], a[80:95]
 ds_read_b128 a[236:239], v1 offset:36864
 s_waitcnt lgkmcnt(6)
 v_mul_f32 v44, v44, v45
 v_mul_f32 v45, v19, v160
 v_mul_f32 v160, v18, v160
 v_fmac_f32 v160, v19, v176
 v_fma_f32 v176, v18, v176, -v45
 v_mfma_f32_32x32x16_bf16 a[0:15], a[224:227], a[240:243], a[0:15]
 ds_read_b128 a[224:227], v1 offset:38912
 buffer_load_dwordx4 v4, s[52:55], s38 offen offset:1024 lds
 v_mul_f32 v46, v19, v161
 v_mul_f32 v161, v18, v161
 v_mfma_f32_32x32x16_bf16 a[16:31], a[228:231], a[240:243], a[16:31]
 ds_read_b128 a[228:231], v1 offset:40960
 s_waitcnt lgkmcnt(2)
 v_add_f32 v64, v64, v66
 v_add_f32 v65, v65, v67
 v_add_f32 v68, v68, v70
 v_add_f32 v69, v69, v71
 v_add_f32 v72, v72, v74
 v_mfma_f32_32x32x16_bf16 a[32:47], a[232:235], a[240:243], a[32:47]
 ds_read_b128 a[232:235], v2 offset:24576
 v_add_f32 v73, v73, v75
 v_add_f32 v76, v76, v78
 v_add_f32 v77, v77, v79
 v_add_f32 v64, v64, v68
 v_add_f32 v65, v65, v69
 v_add_f32 v72, v72, v76
 v_mfma_f32_32x32x16_bf16 a[48:63], a[236:239], a[240:243], a[48:63]
 ds_read_b128 a[236:239], v2 offset:26624
 buffer_load_dwordx4 v5, s[52:55], s38 offen offset:2048 lds
 s_waitcnt lgkmcnt(2)
 v_add_f32 v73, v73, v77
 v_mfma_f32_32x32x16_bf16 a[64:79], a[224:227], a[240:243], a[64:79]
 ds_read_b128 a[224:227], v2 offset:28672
 v_add_f32 v64, v64, v72
 v_add_f32 v65, v65, v73
 v_mul_f32 v55, v36, v24
 v_mul_f32 v67, v36, v25
 v_exp_f32 v55, v55
 v_mfma_f32_32x32x16_bf16 a[80:95], a[228:231], a[240:243], a[80:95]
 ds_read_b128 a[228:231], v2 offset:36864
 s_waitcnt lgkmcnt(2)
 v_fract_f32 v67, v67
 v_cos_f32 v66, v67
 v_sin_f32 v67, v67
 v_mfma_f32_32x32x16_bf16 a[0:15], a[232:235], a[244:247], a[0:15]
 ds_read_b128 a[232:235], v2 offset:38912
 buffer_load_dwordx4 v6, s[52:55], s38 offen offset:3072 lds
 v_mul_f32 v66, v66, v55
 v_mul_f32 v67, v67, v55
 v_mfma_f32_32x32x16_bf16 a[16:31], a[236:239], a[244:247], a[16:31]
 ds_read_b128 a[236:239], v2 offset:40960
 s_waitcnt lgkmcnt(2)
 v_fmac_f32 v47, v66, v64
 v_fmac_f32 v48, v66, v65
 v_fma_f32 v47, -v67, v65, v47
 v_fmac_f32 v48, v67, v64
 ds_read2_b64 v[64:67], v38 offset0:0 offset1:32
 v_mfma_f32_32x32x16_bf16 a[32:47], a[224:227], a[244:247], a[32:47]
 ds_read_b128 a[224:227], v53 offset:24576
 ds_read2_b64 v[68:71], v38 offset0:64 offset1:96
 ds_read2_b64 v[72:75], v38 offset0:128 offset1:160
 ds_read2_b64 v[76:79], v38 offset0:192 offset1:224
 v_mul_f32 v55, 0x41800000, v32
 v_mul_f32 v22, 0x41800000, v33
 v_mfma_f32_32x32x16_bf16 a[48:63], a[228:231], a[244:247], a[48:63]
 ds_read_b128 a[228:231], v53 offset:26624
 s_add_u32 m0, s36, 126976
 s_add_u32 s38, s33, 516096
 buffer_load_dwordx4 v3, s[52:55], s38 offen offset:0 lds
 s_waitcnt lgkmcnt(6)
 v_mfma_f32_32x32x16_bf16 a[64:79], a[232:235], a[244:247], a[64:79]
 ds_read_b128 a[232:235], v53 offset:28672
 v_exp_f32 v55, v55
 v_fract_f32 v22, v22
 v_cos_f32 v21, v22
 v_mfma_f32_32x32x16_bf16 a[80:95], a[236:239], a[244:247], a[80:95]
 ds_read_b128 a[236:239], v53 offset:36864
 s_waitcnt lgkmcnt(2)
 v_sin_f32 v22, v22
 v_mul_f32 v21, v21, v55
 v_mul_f32 v22, v22, v55
 v_fmac_f32 v66, v21, v64
 v_fmac_f32 v67, v21, v65
 v_mfma_f32_32x32x16_bf16 a[0:15], a[224:227], v[128:131], a[0:15]
 ds_read_b128 a[224:227], v53 offset:38912
 buffer_load_dwordx4 v4, s[52:55], s38 offen offset:1024 lds
 v_fma_f32 v66, -v22, v65, v66
 v_fmac_f32 v67, v22, v64
 v_mfma_f32_32x32x16_bf16 a[16:31], a[228:231], v[128:131], a[16:31]
 ds_read_b128 a[228:231], v53 offset:40960
 s_waitcnt lgkmcnt(2)
 v_fmac_f32 v68, v21, v66
 v_fmac_f32 v69, v21, v67
 v_fma_f32 v68, -v22, v67, v68
 v_fmac_f32 v69, v22, v66
 v_fmac_f32 v70, v21, v68
 v_mfma_f32_32x32x16_bf16 a[32:47], a[232:235], v[128:131], a[32:47]
 ds_read_b128 a[232:235], v54 offset:24576
 v_fmac_f32 v71, v21, v69
 v_fma_f32 v70, -v22, v69, v70
 v_fmac_f32 v71, v22, v68
 v_fmac_f32 v72, v21, v70
 v_fmac_f32 v73, v21, v71
 v_fma_f32 v72, -v22, v71, v72
 v_mfma_f32_32x32x16_bf16 a[48:63], a[236:239], v[128:131], a[48:63]
 ds_read_b128 a[236:239], v54 offset:26624
 s_waitcnt lgkmcnt(2)
 v_fmac_f32 v73, v22, v70
 v_fmac_f32 v74, v21, v72
 v_fmac_f32 v75, v21, v73
 v_fma_f32 v74, -v22, v73, v74
 v_fmac_f32 v75, v22, v72
 v_mfma_f32_32x32x16_bf16 a[64:79], a[224:227], v[128:131], a[64:79]
 ds_read_b128 a[224:227], v54 offset:28672
 v_fmac_f32 v161, v19, v177
 v_fma_f32 v177, v18, v177, -v46
 v_mul_f32 v45, v19, v162
 v_mul_f32 v162, v18, v162
 v_fmac_f32 v162, v19, v178
 v_fma_f32 v178, v18, v178, -v45
 v_mfma_f32_32x32x16_bf16 a[80:95], a[228:231], v[128:131], a[80:95]
 ds_read_b128 a[228:231], v54 offset:36864
 s_waitcnt lgkmcnt(2)
 v_mul_f32 v46, v19, v163
 v_mul_f32 v163, v18, v163
 v_fmac_f32 v163, v19, v179
 v_fma_f32 v179, v18, v179, -v46
 v_mul_f32 v45, v19, v164
 v_mfma_f32_32x32x16_bf16 a[0:15], a[232:235], v[132:135], a[0:15]
 ds_read_b128 a[232:235], v54 offset:38912
 v_mul_f32 v164, v18, v164
 v_fmac_f32 v164, v19, v180
 v_fma_f32 v180, v18, v180, -v45
 v_mul_f32 v46, v19, v165
 v_mul_f32 v165, v18, v165
 v_fmac_f32 v165, v19, v181
 v_mfma_f32_32x32x16_bf16 a[16:31], a[236:239], v[132:135], a[16:31]
 ds_read_b128 a[236:239], v54 offset:40960
 s_waitcnt lgkmcnt(2)
 v_fma_f32 v181, v18, v181, -v46
 v_mul_f32 v45, v19, v166
 v_mul_f32 v166, v18, v166
 v_fmac_f32 v166, v19, v182
 v_fma_f32 v182, v18, v182, -v45
 v_mfma_f32_32x32x16_bf16 a[32:47], a[224:227], v[132:135], a[32:47]
 s_barrier
 v_add_u32 v1, 49152, v1
 v_add_u32 v2, 49152, v2
 v_add_u32 v53, 49152, v53
 v_add_u32 v54, 49152, v54
 ds_read_b128 a[224:227], v1 offset:0
 v_mfma_f32_32x32x16_bf16 a[48:63], a[228:231], v[132:135], a[48:63]
 ds_read_b128 a[228:231], v1 offset:2048
 s_add_u32 m0, s36, 0
 s_add_u32 s38, s33, 128
 buffer_load_dwordx4 v3, s[12:15], s38 offen offset:0 lds
 s_waitcnt lgkmcnt(2)
 v_mfma_f32_32x32x16_bf16 a[64:79], a[232:235], v[132:135], a[64:79]
 ds_read_b128 a[232:235], v1 offset:4096
 v_mul_f32 v46, v19, v167
 v_mul_f32 v167, v18, v167
 v_fmac_f32 v167, v19, v183
 v_fma_f32 v183, v18, v183, -v46
 v_mul_f32 v45, v19, v168
 v_mfma_f32_32x32x16_bf16 a[80:95], a[236:239], v[132:135], a[80:95]
 ds_read_b128 a[236:239], v1 offset:12288
 s_waitcnt lgkmcnt(2)
 v_mul_f32 v168, v18, v168
 v_fmac_f32 v168, v19, v184
 v_fma_f32 v184, v18, v184, -v45
 v_mul_f32 v46, v19, v169
 v_mul_f32 v169, v18, v169
 v_mfma_f32_32x32x16_bf16 a[96:111], a[224:227], a[248:251], 0
 ds_read_b128 a[224:227], v1 offset:14336
 buffer_load_dwordx4 v4, s[12:15], s38 offen offset:1024 lds
 v_fmac_f32 v169, v19, v185
 v_fma_f32 v185, v18, v185, -v46
 v_mfma_f32_32x32x16_bf16 a[112:127], a[228:231], a[248:251], 0
 ds_read_b128 a[228:231], v1 offset:16384
 s_waitcnt lgkmcnt(2)
 v_mul_f32 v45, v19, v170
 v_mul_f32 v170, v18, v170
 v_fmac_f32 v170, v19, v186
 v_fma_f32 v186, v18, v186, -v45
 v_mul_f32 v46, v19, v171
 v_mfma_f32_32x32x16_bf16 a[128:143], a[232:235], a[248:251], 0
 ds_read_b128 a[232:235], v2 offset:0
 v_mul_f32 v171, v18, v171
 v_fmac_f32 v171, v19, v187
 v_fma_f32 v187, v18, v187, -v46
 v_mul_f32 v45, v19, v172
 v_mul_f32 v172, v18, v172
 v_fmac_f32 v172, v19, v188
 v_mfma_f32_32x32x16_bf16 a[144:159], a[236:239], a[248:251], 0
 ds_read_b128 a[236:239], v2 offset:2048
 buffer_load_dwordx4 v5, s[12:15], s38 offen offset:2048 lds
 s_waitcnt lgkmcnt(2)
 v_fma_f32 v188, v18, v188, -v45
 v_mfma_f32_32x32x16_bf16 a[160:175], a[224:227], a[248:251], 0
 ds_read_b128 a[224:227], v2 offset:4096
 v_mul_f32 v46, v19, v173
 v_mul_f32 v173, v18, v173
 v_fmac_f32 v173, v19, v189
 v_fma_f32 v189, v18, v189, -v46
 v_mul_f32 v45, v19, v174
 v_mul_f32 v174, v18, v174
 v_mfma_f32_32x32x16_bf16 a[176:191], a[228:231], a[248:251], 0
 ds_read_b128 a[228:231], v2 offset:12288
 s_waitcnt lgkmcnt(2)
 v_fmac_f32 v174, v19, v190
 v_fma_f32 v190, v18, v190, -v45
 v_mul_f32 v46, v19, v175
 v_mul_f32 v175, v18, v175
 v_fmac_f32 v175, v19, v191
 v_mfma_f32_32x32x16_bf16 a[96:111], a[232:235], a[252:255], a[96:111]
 ds_read_b128 a[232:235], v2 offset:14336
 buffer_load_dwordx4 v6, s[12:15], s38 offen offset:3072 lds
 v_fma_f32 v191, v18, v191, -v46
 v_sub_f32 v45, 0, v44
 v_mfma_f32_32x32x16_bf16 a[112:127], a[236:239], a[252:255], a[112:127]
 ds_read_b128 a[236:239], v2 offset:16384
 s_waitcnt lgkmcnt(2)
 v_fmac_f32 v160, v43, v51
 v_fmac_f32 v176, v43, v52
 v_fmac_f32 v160, v45, v52
 v_fmac_f32 v176, v44, v51
 v_fma_f32 v51, v21, v74, v76
 v_mfma_f32_32x32x16_bf16 a[128:143], a[224:227], a[252:255], a[128:143]
 ds_read_b128 a[224:227], v53 offset:0
 v_fma_f32 v52, v21, v75, v77
 v_fma_f32 v51, -v22, v75, v51
 v_fmac_f32 v52, v22, v74
 v_fma_f32 v64, v21, v51, v78
 v_fma_f32 v65, v21, v52, v79
 v_fma_f32 v64, -v22, v52, v64
 v_mfma_f32_32x32x16_bf16 a[144:159], a[228:231], a[252:255], a[144:159]
 ds_read_b128 a[228:231], v53 offset:2048
 s_add_u32 m0, s36, 4096
 s_add_u32 s38, s33, 73856
 buffer_load_dwordx4 v3, s[12:15], s38 offen offset:0 lds
 s_waitcnt lgkmcnt(2)
 v_mfma_f32_32x32x16_bf16 a[160:175], a[232:235], a[252:255], a[160:175]
 ds_read_b128 a[232:235], v53 offset:4096
 v_fmac_f32 v65, v22, v51
 v_mov_b32 v66, s45
 v_mov_b32 v67, s45
 s_add_u32 s39, s34, 40960
 v_mfma_f32_32x32x16_bf16 a[176:191], a[236:239], a[252:255], a[176:191]
 ds_read_b128 a[236:239], v53 offset:12288
 s_waitcnt lgkmcnt(2)
 buffer_store_dwordx4 v[64:67], v20, s[16:19], s39 offen sc1
 v_mul_f32 v55, 0x43000000, v28
 v_mul_f32 v69, 0x43000000, v29
 v_exp_f32 v55, v55
 v_mfma_f32_32x32x16_bf16 a[96:111], a[224:227], v[136:139], a[96:111]
 ds_read_b128 a[224:227], v53 offset:14336
 buffer_load_dwordx4 v4, s[12:15], s38 offen offset:1024 lds
 v_fract_f32 v69, v69
 v_mfma_f32_32x32x16_bf16 a[112:127], a[228:231], v[136:139], a[112:127]
 ds_read_b128 a[228:231], v53 offset:16384
 s_waitcnt lgkmcnt(2)
 v_cos_f32 v68, v69
 v_sin_f32 v69, v69
 v_mul_f32 v68, v68, v55
 v_mul_f32 v69, v69, v55
 v_mfma_f32_32x32x16_bf16 a[128:143], a[232:235], v[136:139], a[128:143]
 ds_read_b128 a[232:235], v54 offset:0
 v_mul_f32 v55, v37, v28
 v_mul_f32 v71, v37, v29
 v_exp_f32 v55, v55
 v_fract_f32 v71, v71
 v_mfma_f32_32x32x16_bf16 a[144:159], a[236:239], v[136:139], a[144:159]
 ds_read_b128 a[236:239], v54 offset:2048
 s_waitcnt lgkmcnt(2)
 v_cos_f32 v70, v71
 v_sin_f32 v71, v71
 v_mul_f32 v70, v70, v55
 v_mul_f32 v71, v71, v55
 v_mfma_f32_32x32x16_bf16 a[160:175], a[224:227], v[136:139], a[160:175]
 ds_read_b128 a[224:227], v54 offset:4096
 s_waitcnt vmcnt(14)
 v_cmp_ne_u32 vcc, s45, v58
 s_and_b64 s[40:41], vcc, s[42:43]
 s_waitcnt vmcnt(13)
 v_cmp_ne_u32 vcc, s45, v62
 s_and_b64 vcc, vcc, s[46:47]
 s_or_b64 vcc, vcc, s[40:41]
 s_cbranch_vccnz L_lb4
L_lb4_b:
 v_mfma_f32_32x32x16_bf16 a[176:191], a[228:231], v[136:139], a[176:191]
 ds_read_b128 a[228:231], v54 offset:12288
 s_waitcnt lgkmcnt(2)
 v_fma_f32 v72, v68, v56, v60
 v_fma_f32 v73, v68, v57, v61
 v_fma_f32 v72, -v69, v57, v72
 v_fmac_f32 v73, v69, v56
 v_mul_f32 v74, v70, v72
 v_mfma_f32_32x32x16_bf16 a[96:111], a[232:235], v[140:143], a[96:111]
 ds_read_b128 a[232:235], v54 offset:14336
 v_mul_f32 v75, v70, v73
 v_fma_f32 v74, -v71, v73, v74
 v_fmac_f32 v75, v71, v72
 ds_write_b64 v38, v[74:75] offset:4096
 v_fmac_f32 v161, v43, v160
 v_fmac_f32 v177, v43, v176
 v_mfma_f32_32x32x16_bf16 a[112:127], a[236:239], v[140:143], a[112:127]
 ds_read_b128 a[236:239], v54 offset:16384
 s_waitcnt lgkmcnt(3)
 v_fmac_f32 v161, v45, v176
 v_fmac_f32 v177, v44, v160
 v_fmac_f32 v162, v43, v161
 v_fmac_f32 v178, v43, v177
 v_fmac_f32 v162, v45, v177
 v_mfma_f32_32x32x16_bf16 a[128:143], a[224:227], v[140:143], a[128:143]
 s_waitcnt lgkmcnt(1)
 s_barrier
 ds_read_b128 a[224:227], v1 offset:24576
 ds_read2_b64 v[64:67], v39 offset0:0 offset1:32
 ds_read2_b64 v[68:71], v39 offset0:64 offset1:96
 ds_read2_b64 v[72:75], v39 offset0:128 offset1:160
 ds_read2_b64 v[76:79], v39 offset0:192 offset1:224
 v_mfma_f32_32x32x16_bf16 a[144:159], a[228:231], v[140:143], a[144:159]
 ds_read_b128 a[228:231], v1 offset:26624
 s_add_u32 m0, s36, 24576
 s_add_u32 s38, s33, 128
 buffer_load_dwordx4 v3, s[52:55], s38 offen offset:0 lds
 s_waitcnt lgkmcnt(6)
 v_mfma_f32_32x32x16_bf16 a[160:175], a[232:235], v[140:143], a[160:175]
 ds_read_b128 a[232:235], v1 offset:28672
 v_fmac_f32 v178, v44, v161
 v_fmac_f32 v163, v43, v162
 v_fmac_f32 v179, v43, v178
 v_fmac_f32 v163, v45, v178
 v_fmac_f32 v179, v44, v162
 v_mfma_f32_32x32x16_bf16 a[176:191], a[236:239], v[140:143], a[176:191]
 ds_read_b128 a[236:239], v1 offset:36864
 s_waitcnt lgkmcnt(2)
 v_add_f32 v64, v64, v66
 v_add_f32 v65, v65, v67
 v_add_f32 v68, v68, v70
 v_add_f32 v69, v69, v71
 v_add_f32 v72, v72, v74
 v_mfma_f32_32x32x16_bf16 a[96:111], a[224:227], a[240:243], a[96:111]
 ds_read_b128 a[224:227], v1 offset:38912
 buffer_load_dwordx4 v4, s[52:55], s38 offen offset:1024 lds
 v_add_f32 v73, v73, v75
 v_add_f32 v76, v76, v78
 v_mfma_f32_32x32x16_bf16 a[112:127], a[228:231], a[240:243], a[112:127]
 ds_read_b128 a[228:231], v1 offset:40960
 s_waitcnt lgkmcnt(2)
 v_add_f32 v77, v77, v79
 v_add_f32 v64, v64, v68
 v_add_f32 v65, v65, v69
 v_add_f32 v72, v72, v76
 v_add_f32 v73, v73, v77
 v_mfma_f32_32x32x16_bf16 a[128:143], a[232:235], a[240:243], a[128:143]
 ds_read_b128 a[232:235], v2 offset:24576
 v_add_f32 v64, v64, v72
 v_add_f32 v65, v65, v73
 v_mul_f32 v55, v36, v28
 v_mul_f32 v67, v36, v29
 v_exp_f32 v55, v55
 v_mfma_f32_32x32x16_bf16 a[144:159], a[236:239], a[240:243], a[144:159]
 ds_read_b128 a[236:239], v2 offset:26624
 buffer_load_dwordx4 v5, s[52:55], s38 offen offset:2048 lds
 s_waitcnt lgkmcnt(2)
 v_fract_f32 v67, v67
 v_mfma_f32_32x32x16_bf16 a[160:175], a[224:227], a[240:243], a[160:175]
 ds_read_b128 a[224:227], v2 offset:28672
 v_cos_f32 v66, v67
 v_sin_f32 v67, v67
 v_mul_f32 v66, v66, v55
 v_mul_f32 v67, v67, v55
 v_mfma_f32_32x32x16_bf16 a[176:191], a[228:231], a[240:243], a[176:191]
 ds_read_b128 a[228:231], v2 offset:36864
 s_waitcnt lgkmcnt(2)
 v_fmac_f32 v49, v66, v64
 v_fmac_f32 v50, v66, v65
 v_fma_f32 v49, -v67, v65, v49
 v_fmac_f32 v50, v67, v64
 v_fmac_f32 v164, v43, v163
 v_mfma_f32_32x32x16_bf16 a[96:111], a[232:235], a[244:247], a[96:111]
 ds_read_b128 a[232:235], v2 offset:38912
 buffer_load_dwordx4 v6, s[52:55], s38 offen offset:3072 lds
 v_fmac_f32 v180, v43, v179
 v_fmac_f32 v164, v45, v179
 v_mfma_f32_32x32x16_bf16 a[112:127], a[236:239], a[244:247], a[112:127]
 ds_read_b128 a[236:239], v2 offset:40960
 s_waitcnt lgkmcnt(2)
 v_fmac_f32 v180, v44, v163
 v_fmac_f32 v165, v43, v164
 v_fmac_f32 v181, v43, v180
 v_fmac_f32 v165, v45, v180
 v_fmac_f32 v181, v44, v164
 v_mfma_f32_32x32x16_bf16 a[128:143], a[224:227], a[244:247], a[128:143]
 ds_read_b128 a[224:227], v53 offset:24576
 v_fmac_f32 v166, v43, v165
 v_fmac_f32 v182, v43, v181
 v_fmac_f32 v166, v45, v181
 v_fmac_f32 v182, v44, v165
 v_fmac_f32 v167, v43, v166
 v_fmac_f32 v183, v43, v182
 v_mfma_f32_32x32x16_bf16 a[144:159], a[228:231], a[244:247], a[144:159]
 ds_read_b128 a[228:231], v53 offset:26624
 s_add_u32 m0, s36, 28672
 s_add_u32 s38, s33, 73856
 buffer_load_dwordx4 v3, s[52:55], s38 offen offset:0 lds
 s_waitcnt lgkmcnt(2)
 v_mfma_f32_32x32x16_bf16 a[160:175], a[232:235], a[244:247], a[160:175]
 ds_read_b128 a[232:235], v53 offset:28672
 v_fmac_f32 v167, v45, v182
 v_fmac_f32 v183, v44, v166
 v_fmac_f32 v168, v43, v167
 v_fmac_f32 v184, v43, v183
 v_fmac_f32 v168, v45, v183
 v_mfma_f32_32x32x16_bf16 a[176:191], a[236:239], a[244:247], a[176:191]
 ds_read_b128 a[236:239], v53 offset:36864
 s_waitcnt lgkmcnt(2)
 v_fmac_f32 v184, v44, v167
 v_fmac_f32 v169, v43, v168
 v_fmac_f32 v185, v43, v184
 v_fmac_f32 v169, v45, v184
 v_fmac_f32 v185, v44, v168
 v_mfma_f32_32x32x16_bf16 a[96:111], a[224:227], v[128:131], a[96:111]
 ds_read_b128 a[224:227], v53 offset:38912
 buffer_load_dwordx4 v4, s[52:55], s38 offen offset:1024 lds
 v_fmac_f32 v170, v43, v169
 v_fmac_f32 v186, v43, v185
 v_mfma_f32_32x32x16_bf16 a[112:127], a[228:231], v[128:131], a[112:127]
 ds_read_b128 a[228:231], v53 offset:40960
 s_waitcnt lgkmcnt(2)
 v_fmac_f32 v170, v45, v185
 v_fmac_f32 v186, v44, v169
 v_fmac_f32 v171, v43, v170
 v_fmac_f32 v187, v43, v186
 v_fmac_f32 v171, v45, v186
 v_mfma_f32_32x32x16_bf16 a[128:143], a[232:235], v[128:131], a[128:143]
 ds_read_b128 a[232:235], v54 offset:24576
 v_fmac_f32 v187, v44, v170
 v_fmac_f32 v172, v43, v171
 v_fmac_f32 v188, v43, v187
 v_fmac_f32 v172, v45, v187
 v_fmac_f32 v188, v44, v171
 v_fmac_f32 v173, v43, v172
 v_mfma_f32_32x32x16_bf16 a[144:159], a[236:239], v[128:131], a[144:159]
 ds_read_b128 a[236:239], v54 offset:26624
 s_waitcnt lgkmcnt(2)
 v_fmac_f32 v189, v43, v188
 v_fmac_f32 v173, v45, v188
 v_fmac_f32 v189, v44, v172
 v_fmac_f32 v174, v43, v173
 v_fmac_f32 v190, v43, v189
 v_mfma_f32_32x32x16_bf16 a[160:175], a[224:227], v[128:131], a[160:175]
 ds_read_b128 a[224:227], v54 offset:28672
 v_fmac_f32 v174, v45, v189
 v_fmac_f32 v190, v44, v173
 v_fmac_f32 v175, v43, v174
 v_fmac_f32 v191, v43, v190
 v_fmac_f32 v175, v45, v190
 v_fmac_f32 v191, v44, v174
 v_mfma_f32_32x32x16_bf16 a[176:191], a[228:231], v[128:131], a[176:191]
 ds_read_b128 a[228:231], v54 offset:36864
 s_waitcnt lgkmcnt(2)
 v_cvt_pk_bf16_f32 v160, v160, v161
 v_cvt_pk_bf16_f32 v161, v162, v163
 v_cvt_pk_bf16_f32 v162, v164, v165
 v_cvt_pk_bf16_f32 v163, v166, v167
 v_cvt_pk_bf16_f32 v164, v168, v169
 v_mfma_f32_32x32x16_bf16 a[96:111], a[232:235], v[132:135], a[96:111]
 ds_read_b128 a[232:235], v54 offset:38912
 v_cvt_pk_bf16_f32 v165, v170, v171
 v_cvt_pk_bf16_f32 v166, v172, v173
 v_cvt_pk_bf16_f32 v167, v174, v175
 v_cvt_pk_bf16_f32 v176, -v176, -v177
 v_cvt_pk_bf16_f32 v177, -v178, -v179
 v_cvt_pk_bf16_f32 v178, -v180, -v181
 v_mfma_f32_32x32x16_bf16 a[112:127], a[236:239], v[132:135], a[112:127]
 ds_read_b128 a[236:239], v54 offset:40960
 s_waitcnt lgkmcnt(2)
 v_cvt_pk_bf16_f32 v179, -v182, -v183
 v_cvt_pk_bf16_f32 v180, -v184, -v185
 v_cvt_pk_bf16_f32 v181, -v186, -v187
 v_cvt_pk_bf16_f32 v182, -v188, -v189
 v_cvt_pk_bf16_f32 v183, -v190, -v191
 v_mfma_f32_32x32x16_bf16 a[128:143], a[224:227], v[132:135], a[128:143]
 s_barrier
 v_add_u32 v1, 49152, v1
 v_add_u32 v2, 49152, v2
 v_add_u32 v53, 49152, v53
 v_add_u32 v54, 49152, v54
 ds_read_b128 a[224:227], v1 offset:0
 s_add_u32 s37, s34, 40960
 buffer_load_dwordx4 v[56:59], v41, s[16:19], s37 offen sc1
 buffer_load_dwordx4 v[60:63], v42, s[16:19], s37 offen sc1
 v_mfma_f32_32x32x16_bf16 a[144:159], a[228:231], v[132:135], a[144:159]
 ds_read_b128 a[228:231], v1 offset:2048
 s_add_u32 m0, s36, 49152
 s_add_u32 s38, s33, 221312
 buffer_load_dwordx4 v3, s[12:15], s38 offen offset:0 lds
 s_waitcnt lgkmcnt(2)
 v_mfma_f32_32x32x16_bf16 a[160:175], a[232:235], v[132:135], a[160:175]
 ds_read_b128 a[232:235], v1 offset:4096
 ds_write_b128 v40, v[160:163]
 v_xor_b32 v40, 16, v40
 v_mfma_f32_32x32x16_bf16 a[176:191], a[236:239], v[132:135], a[176:191]
 ds_read_b128 a[236:239], v1 offset:12288
 s_waitcnt lgkmcnt(3)
 ds_write_b128 v40, v[164:167]
 ds_read_b64_tr_b16 v[168:169], v0 offset:0
 ds_read_b64_tr_b16 v[172:173], v0 offset:1024
 v_mfma_f32_32x32x16_bf16 a[192:207], a[224:227], a[248:251], 0
 ds_read_b128 a[224:227], v1 offset:14336
 buffer_load_dwordx4 v4, s[12:15], s38 offen offset:1024 lds
 v_xor_b32 v0, 32, v0
 ds_read_b64_tr_b16 v[170:171], v0 offset:256
 v_mfma_f32_32x32x16_bf16 a[208:223], a[228:231], a[248:251], 0
 ds_read_b128 a[228:231], v1 offset:16384
 s_waitcnt lgkmcnt(6)
 ds_read_b64_tr_b16 v[174:175], v0 offset:1280
 ds_write_b128 v40, v[180:183]
 v_xor_b32 v40, 16, v40
 v_mfma_f32_32x32x16_bf16 v[144:159], a[232:235], a[248:251], 0
 ds_read_b128 a[232:235], v2 offset:0
 ds_write_b128 v40, v[176:179]
 ds_read_b64_tr_b16 v[162:163], v0 offset:256
 ds_read_b64_tr_b16 v[166:167], v0 offset:1280
 v_xor_b32 v0, 32, v0
 v_mfma_f32_32x32x16_bf16 v[80:95], a[236:239], a[248:251], 0
 ds_read_b128 a[236:239], v2 offset:2048
 buffer_load_dwordx4 v5, s[12:15], s38 offen offset:2048 lds
 s_waitcnt lgkmcnt(7)
 ds_read_b64_tr_b16 v[160:161], v0 offset:0
 ds_read_b64_tr_b16 v[164:165], v0 offset:1024
 v_mfma_f32_32x32x16_bf16 v[176:191], a[224:227], a[248:251], 0
 ds_read_b128 a[224:227], v2 offset:4096
 v_exp_f32 v45, v24
 v_fract_f32 v44, v25
 v_cos_f32 v43, v44
 v_mfma_f32_32x32x16_bf16 v[8:23], a[228:231], a[248:251], 0
 ds_read_b128 a[228:231], v2 offset:12288
 s_waitcnt lgkmcnt(4)
 v_sin_f32 v44, v44
 v_mul_f32 v43, v43, v45
 v_mul_f32 v44, v44, v45
 v_mul_f32 v45, v27, v192
 v_mul_f32 v192, v26, v192
 v_mfma_f32_32x32x16_bf16 a[192:207], a[232:235], a[252:255], a[192:207]
 ds_read_b128 a[232:235], v2 offset:14336
 buffer_load_dwordx4 v6, s[12:15], s38 offen offset:3072 lds
 v_fmac_f32 v192, v27, v208
 v_fma_f32 v208, v26, v208, -v45
 v_mfma_f32_32x32x16_bf16 a[208:223], a[236:239], a[252:255], a[208:223]
 ds_read_b128 a[236:239], v2 offset:16384
 s_waitcnt lgkmcnt(2)
 v_mul_f32 v46, v27, v193
 v_mul_f32 v193, v26, v193
 v_fmac_f32 v193, v27, v209
 v_fma_f32 v209, v26, v209, -v46
 v_mul_f32 v45, v27, v194
 v_mfma_f32_32x32x16_bf16 v[144:159], a[224:227], a[252:255], v[144:159]
 ds_read_b128 a[224:227], v53 offset:0
 v_mul_f32 v194, v26, v194
 v_fmac_f32 v194, v27, v210
 v_fma_f32 v210, v26, v210, -v45
 v_mul_f32 v46, v27, v195
 v_mul_f32 v195, v26, v195
 v_fmac_f32 v195, v27, v211
 v_mfma_f32_32x32x16_bf16 v[80:95], a[228:231], a[252:255], v[80:95]
 ds_read_b128 a[228:231], v53 offset:2048
 s_add_u32 m0, s36, 53248
 s_add_u32 s38, s33, 295040
 buffer_load_dwordx4 v3, s[12:15], s38 offen offset:0 lds
 s_waitcnt lgkmcnt(2)
 v_mfma_f32_32x32x16_bf16 v[176:191], a[232:235], a[252:255], v[176:191]
 ds_read_b128 a[232:235], v53 offset:4096
 v_fma_f32 v211, v26, v211, -v46
 v_mul_f32 v45, v27, v196
 v_mul_f32 v196, v26, v196
 v_fmac_f32 v196, v27, v212
 v_fma_f32 v212, v26, v212, -v45
 v_mfma_f32_32x32x16_bf16 v[8:23], a[236:239], a[252:255], v[8:23]
 ds_read_b128 a[236:239], v53 offset:12288
 s_waitcnt lgkmcnt(2)
 v_mul_f32 v46, v27, v197
 v_mul_f32 v197, v26, v197
 v_fmac_f32 v197, v27, v213
 v_fma_f32 v213, v26, v213, -v46
 v_mul_f32 v45, v27, v198
 v_mfma_f32_32x32x16_bf16 a[192:207], a[224:227], v[136:139], a[192:207]
 ds_read_b128 a[224:227], v53 offset:14336
 buffer_load_dwordx4 v4, s[12:15], s38 offen offset:1024 lds
 v_mul_f32 v198, v26, v198
 v_fmac_f32 v198, v27, v214
 v_mfma_f32_32x32x16_bf16 a[208:223], a[228:231], v[136:139], a[208:223]
 ds_read_b128 a[228:231], v53 offset:16384
 s_waitcnt lgkmcnt(2)
 v_fma_f32 v214, v26, v214, -v45
 v_mul_f32 v46, v27, v199
 v_mul_f32 v199, v26, v199
 v_fmac_f32 v199, v27, v215
 v_fma_f32 v215, v26, v215, -v46
 v_mfma_f32_32x32x16_bf16 v[144:159], a[232:235], v[136:139], v[144:159]
 ds_read_b128 a[232:235], v54 offset:0
 v_mul_f32 v45, v27, v200
 v_mul_f32 v200, v26, v200
 v_fmac_f32 v200, v27, v216
 v_fma_f32 v216, v26, v216, -v45
 v_mul_f32 v46, v27, v201
 v_mul_f32 v201, v26, v201
 v_mfma_f32_32x32x16_bf16 v[80:95], a[236:239], v[136:139], v[80:95]
 ds_read_b128 a[236:239], v54 offset:2048
 s_waitcnt lgkmcnt(2)
 v_fmac_f32 v201, v27, v217
 v_fma_f32 v217, v26, v217, -v46
 v_mul_f32 v45, v27, v202
 v_mul_f32 v202, v26, v202
 v_fmac_f32 v202, v27, v218
 v_mfma_f32_32x32x16_bf16 v[176:191], a[224:227], v[136:139], v[176:191]
 ds_read_b128 a[224:227], v54 offset:4096
 v_fma_f32 v218, v26, v218, -v45
 v_mul_f32 v46, v27, v203
 v_mul_f32 v203, v26, v203
 v_fmac_f32 v203, v27, v219
 v_fma_f32 v219, v26, v219, -v46
 v_mul_f32 v45, v27, v204
 v_mfma_f32_32x32x16_bf16 v[8:23], a[228:231], v[136:139], v[8:23]
 ds_read_b128 a[228:231], v54 offset:12288
 s_waitcnt lgkmcnt(2)
 v_mul_f32 v204, v26, v204
 v_fmac_f32 v204, v27, v220
 v_fma_f32 v220, v26, v220, -v45
 v_mul_f32 v46, v27, v205
 v_mul_f32 v205, v26, v205
 v_mfma_f32_32x32x16_bf16 a[192:207], a[232:235], v[140:143], a[192:207]
 ds_read_b128 a[232:235], v54 offset:14336
 v_fmac_f32 v205, v27, v221
 v_fma_f32 v221, v26, v221, -v46
 v_mul_f32 v45, v27, v206
 v_mul_f32 v206, v26, v206
 v_fmac_f32 v206, v27, v222
 v_fma_f32 v222, v26, v222, -v45
 v_mfma_f32_32x32x16_bf16 a[208:223], a[236:239], v[140:143], a[208:223]
 ds_read_b128 a[236:239], v54 offset:16384
 s_waitcnt lgkmcnt(2)
 v_mul_f32 v46, v27, v207
 v_mul_f32 v207, v26, v207
 v_fmac_f32 v207, v27, v223
 v_fma_f32 v223, v26, v223, -v46
 v_sub_f32 v45, 0, v44
 v_mfma_f32_32x32x16_bf16 v[144:159], a[224:227], v[140:143], v[144:159]
 s_waitcnt vmcnt(21)
 s_barrier
 ds_read_b128 a[224:227], v1 offset:24576
 v_mul_f32 v55, 0x43000000, v32
 v_mul_f32 v69, 0x43000000, v33
 v_exp_f32 v55, v55
 v_mfma_f32_32x32x16_bf16 v[80:95], a[228:231], v[140:143], v[80:95]
 ds_read_b128 a[228:231], v1 offset:26624
 s_add_u32 m0, s36, 73728
 s_add_u32 s38, s33, 221312
 buffer_load_dwordx4 v3, s[52:55], s38 offen offset:0 lds
 s_waitcnt lgkmcnt(2)
 v_mfma_f32_32x32x16_bf16 v[176:191], a[232:235], v[140:143], v[176:191]
 ds_read_b128 a[232:235], v1 offset:28672
 v_fract_f32 v69, v69
 v_cos_f32 v68, v69
 v_sin_f32 v69, v69
 v_mfma_f32_32x32x16_bf16 v[8:23], a[236:239], v[140:143], v[8:23]
 ds_read_b128 a[236:239], v1 offset:36864
 s_waitcnt lgkmcnt(2)
 v_mul_f32 v68, v68, v55
 v_mul_f32 v69, v69, v55
 v_mul_f32 v55, v37, v32
 v_mul_f32 v71, v37, v33
 v_mfma_f32_32x32x16_bf16 a[192:207], a[224:227], a[240:243], a[192:207]
 ds_read_b128 a[224:227], v1 offset:38912
 buffer_load_dwordx4 v4, s[52:55], s38 offen offset:1024 lds
 v_exp_f32 v55, v55
 v_fract_f32 v71, v71
 v_mfma_f32_32x32x16_bf16 a[208:223], a[228:231], a[240:243], a[208:223]
 ds_read_b128 a[228:231], v1 offset:40960
 s_waitcnt lgkmcnt(2)
 v_cos_f32 v70, v71
 v_sin_f32 v71, v71
 v_mul_f32 v70, v70, v55
 v_mfma_f32_32x32x16_bf16 v[144:159], a[232:235], a[240:243], v[144:159]
 ds_read_b128 a[232:235], v2 offset:24576
 v_mul_f32 v71, v71, v55
 v_fmac_f32 v192, v43, v47
 v_fmac_f32 v208, v43, v48
 v_fmac_f32 v192, v45, v48
 v_fmac_f32 v208, v44, v47
 v_fmac_f32 v193, v43, v192
 v_mfma_f32_32x32x16_bf16 v[80:95], a[236:239], a[240:243], v[80:95]
 ds_read_b128 a[236:239], v2 offset:26624
 buffer_load_dwordx4 v5, s[52:55], s38 offen offset:2048 lds
 s_waitcnt lgkmcnt(2)
 v_fmac_f32 v209, v43, v208
 v_mfma_f32_32x32x16_bf16 v[176:191], a[224:227], a[240:243], v[176:191]
 ds_read_b128 a[224:227], v2 offset:28672
 v_fmac_f32 v193, v45, v208
 v_fmac_f32 v209, v44, v192
 v_fmac_f32 v194, v43, v193
 v_fmac_f32 v210, v43, v209
 v_fmac_f32 v194, v45, v209
 v_fmac_f32 v210, v44, v193
 v_mfma_f32_32x32x16_bf16 v[8:23], a[228:231], a[240:243], v[8:23]
 ds_read_b128 a[228:231], v2 offset:36864
 s_waitcnt lgkmcnt(2)
 v_fmac_f32 v195, v43, v194
 v_fmac_f32 v211, v43, v210
 v_fmac_f32 v195, v45, v210
 v_fmac_f32 v211, v44, v194
 v_fmac_f32 v196, v43, v195
 v_mfma_f32_32x32x16_bf16 a[192:207], a[232:235], a[244:247], a[192:207]
 ds_read_b128 a[232:235], v2 offset:38912
 buffer_load_dwordx4 v6, s[52:55], s38 offen offset:3072 lds
 v_fmac_f32 v212, v43, v211
 v_fmac_f32 v196, v45, v211
 v_mfma_f32_32x32x16_bf16 a[208:223], a[236:239], a[244:247], a[208:223]
 ds_read_b128 a[236:239], v2 offset:40960
 s_waitcnt lgkmcnt(2)
 v_fmac_f32 v212, v44, v195
 v_fmac_f32 v197, v43, v196
 v_fmac_f32 v213, v43, v212
 v_fmac_f32 v197, v45, v212
 v_fmac_f32 v213, v44, v196
 v_mfma_f32_32x32x16_bf16 v[144:159], a[224:227], a[244:247], v[144:159]
 ds_read_b128 a[224:227], v53 offset:24576
 v_fmac_f32 v198, v43, v197
 v_fmac_f32 v214, v43, v213
 v_fmac_f32 v198, v45, v213
 v_fmac_f32 v214, v44, v197
 v_fmac_f32 v199, v43, v198
 v_fmac_f32 v215, v43, v214
 v_mfma_f32_32x32x16_bf16 v[80:95], a[228:231], a[244:247], v[80:95]
 ds_read_b128 a[228:231], v53 offset:26624
 s_add_u32 m0, s36, 77824
 s_add_u32 s38, s33, 295040
 buffer_load_dwordx4 v3, s[52:55], s38 offen offset:0 lds
 s_waitcnt lgkmcnt(2)
 v_mfma_f32_32x32x16_bf16 v[176:191], a[232:235], a[244:247], v[176:191]
 ds_read_b128 a[232:235], v53 offset:28672
 v_fmac_f32 v199, v45, v214
 v_fmac_f32 v215, v44, v198
 v_fmac_f32 v200, v43, v199
 v_fmac_f32 v216, v43, v215
 v_fmac_f32 v200, v45, v215
 v_mfma_f32_32x32x16_bf16 v[8:23], a[236:239], a[244:247], v[8:23]
 ds_read_b128 a[236:239], v53 offset:36864
 s_waitcnt lgkmcnt(2)
 v_fmac_f32 v216, v44, v199
 v_fmac_f32 v201, v43, v200
 v_fmac_f32 v217, v43, v216
 v_fmac_f32 v201, v45, v216
 v_fmac_f32 v217, v44, v200
 v_mfma_f32_32x32x16_bf16 a[192:207], a[224:227], v[128:131], a[192:207]
 ds_read_b128 a[224:227], v53 offset:38912
 buffer_load_dwordx4 v4, s[52:55], s38 offen offset:1024 lds
 v_mfma_f32_32x32x16_bf16 a[208:223], a[228:231], v[128:131], a[208:223]
 ds_read_b128 a[228:231], v53 offset:40960
 s_waitcnt lgkmcnt(2)
 s_waitcnt vmcnt(13)
 v_cmp_ne_u32 vcc, s45, v58
 s_and_b64 s[40:41], vcc, s[42:43]
 s_waitcnt vmcnt(12)
 v_cmp_ne_u32 vcc, s45, v62
 s_and_b64 vcc, vcc, s[46:47]
 s_or_b64 vcc, vcc, s[40:41]
 s_cbranch_vccnz L_lb5
L_lb5_b:
 v_mfma_f32_32x32x16_bf16 v[144:159], a[232:235], v[128:131], v[144:159]
 ds_read_b128 a[232:235], v54 offset:24576
 v_fma_f32 v72, v68, v56, v60
 v_fma_f32 v73, v68, v57, v61
 v_fma_f32 v72, -v69, v57, v72
 v_fmac_f32 v73, v69, v56
 v_mul_f32 v74, v70, v72
 v_mul_f32 v75, v70, v73
 v_mfma_f32_32x32x16_bf16 v[80:95], a[236:239], v[128:131], v[80:95]
 ds_read_b128 a[236:239], v54 offset:26624
 s_waitcnt lgkmcnt(2)
 v_fma_f32 v74, -v71, v73, v74
 v_fmac_f32 v75, v71, v72
 ds_write_b64 v38, v[74:75] offset:4096
 v_fmac_f32 v202, v43, v201
 v_fmac_f32 v218, v43, v217
 v_mfma_f32_32x32x16_bf16 v[176:191], a[224:227], v[128:131], v[176:191]
 ds_read_b128 a[224:227], v54 offset:28672
 v_fmac_f32 v202, v45, v217
 v_fmac_f32 v218, v44, v201
 v_fmac_f32 v203, v43, v202
 v_fmac_f32 v219, v43, v218
 v_fmac_f32 v203, v45, v218
 v_fmac_f32 v219, v44, v202
 v_mfma_f32_32x32x16_bf16 v[8:23], a[228:231], v[128:131], v[8:23]
 ds_read_b128 a[228:231], v54 offset:36864
 s_waitcnt lgkmcnt(3)
 v_fmac_f32 v204, v43, v203
 v_fmac_f32 v220, v43, v219
 v_fmac_f32 v204, v45, v219
 v_fmac_f32 v220, v44, v203
 v_fmac_f32 v205, v43, v204
 v_mfma_f32_32x32x16_bf16 a[192:207], a[232:235], v[132:135], a[192:207]
 ds_read_b128 a[232:235], v54 offset:38912
 v_fmac_f32 v221, v43, v220
 v_fmac_f32 v205, v45, v220
 v_fmac_f32 v221, v44, v204
 v_fmac_f32 v206, v43, v205
 v_fmac_f32 v222, v43, v221
 v_fmac_f32 v206, v45, v221
 v_mfma_f32_32x32x16_bf16 a[208:223], a[236:239], v[132:135], a[208:223]
 ds_read_b128 a[236:239], v54 offset:40960
 s_waitcnt lgkmcnt(2)
 v_fmac_f32 v222, v44, v205
 v_fmac_f32 v207, v43, v206
 v_fmac_f32 v223, v43, v222
 v_fmac_f32 v207, v45, v222
 v_fmac_f32 v223, v44, v206
 v_mfma_f32_32x32x16_bf16 v[144:159], a[224:227], v[132:135], v[144:159]
 s_barrier
 v_add_u32 v1, -98304, v1
 v_add_u32 v2, -98304, v2
 v_add_u32 v53, -98304, v53
 v_add_u32 v54, -98304, v54
 ds_read_b128 a[224:227], v1 offset:0
 v_mfma_f32_32x32x16_bf16 v[80:95], a[228:231], v[132:135], v[80:95]
 ds_read_b128 a[228:231], v1 offset:2048
 s_add_u32 m0, s36, 98304
 s_add_u32 s38, s33, 256
 buffer_load_dwordx4 v3, s[12:15], s38 offen offset:0 lds
 s_waitcnt lgkmcnt(2)
 v_mfma_f32_32x32x16_bf16 v[176:191], a[232:235], v[132:135], v[176:191]
 ds_read_b128 a[232:235], v1 offset:4096
 ds_read2_b64 v[64:67], v39 offset0:0 offset1:32
 ds_read2_b64 v[68:71], v39 offset0:64 offset1:96
 ds_read2_b64 v[72:75], v39 offset0:128 offset1:160
 ds_read2_b64 v[76:79], v39 offset0:192 offset1:224
 v_cvt_pk_bf16_f32 v192, v192, v193
 v_mfma_f32_32x32x16_bf16 v[8:23], a[236:239], v[132:135], v[8:23]
 ds_read_b128 a[236:239], v1 offset:12288
 s_waitcnt lgkmcnt(6)
 v_cvt_pk_bf16_f32 v193, v194, v195
 v_cvt_pk_bf16_f32 v194, v196, v197
 v_cvt_pk_bf16_f32 v195, v198, v199
 v_cvt_pk_bf16_f32 v196, v200, v201
 v_cvt_pk_bf16_f32 v197, v202, v203
 v_mfma_f32_32x32x16_bf16 a[0:15], a[224:227], v[168:171], a[0:15]
 ds_read_b128 a[224:227], v1 offset:14336
 buffer_load_dwordx4 v4, s[12:15], s38 offen offset:1024 lds
 v_cvt_pk_bf16_f32 v198, v204, v205
 v_cvt_pk_bf16_f32 v199, v206, v207
 v_mfma_f32_32x32x16_bf16 a[16:31], a[228:231], v[168:171], a[16:31]
 ds_read_b128 a[228:231], v1 offset:16384
 s_waitcnt lgkmcnt(2)
 v_add_f32 v64, v64, v66
 v_add_f32 v65, v65, v67
 v_add_f32 v68, v68, v70
 v_add_f32 v69, v69, v71
 v_add_f32 v72, v72, v74
 v_mfma_f32_32x32x16_bf16 a[32:47], a[232:235], v[168:171], a[32:47]
 ds_read_b128 a[232:235], v2 offset:0
 v_add_f32 v73, v73, v75
 v_add_f32 v76, v76, v78
 v_add_f32 v77, v77, v79
 v_add_f32 v64, v64, v68
 v_add_f32 v65, v65, v69
 v_add_f32 v72, v72, v76
 v_mfma_f32_32x32x16_bf16 a[48:63], a[236:239], v[168:171], a[48:63]
 ds_read_b128 a[236:239], v2 offset:2048
 buffer_load_dwordx4 v5, s[12:15], s38 offen offset:2048 lds
 s_waitcnt lgkmcnt(2)
 v_add_f32 v73, v73, v77
 v_mfma_f32_32x32x16_bf16 a[64:79], a[224:227], v[168:171], a[64:79]
 ds_read_b128 a[224:227], v2 offset:4096
 v_add_f32 v64, v64, v72
 v_add_f32 v65, v65, v73
 v_mul_f32 v55, v36, v32
 v_mul_f32 v67, v36, v33
 v_exp_f32 v55, v55
 v_mfma_f32_32x32x16_bf16 a[80:95], a[228:231], v[168:171], a[80:95]
 ds_read_b128 a[228:231], v2 offset:12288
 s_waitcnt lgkmcnt(2)
 v_fract_f32 v67, v67
 v_cos_f32 v66, v67
 v_sin_f32 v67, v67
 v_mfma_f32_32x32x16_bf16 a[0:15], a[232:235], v[172:175], a[0:15]
 ds_read_b128 a[232:235], v2 offset:14336
 buffer_load_dwordx4 v6, s[12:15], s38 offen offset:3072 lds
 v_mul_f32 v66, v66, v55
 v_mul_f32 v67, v67, v55
 v_mfma_f32_32x32x16_bf16 a[16:31], a[236:239], v[172:175], a[16:31]
 ds_read_b128 a[236:239], v2 offset:16384
 s_waitcnt lgkmcnt(2)
 v_fmac_f32 v51, v66, v64
 v_fmac_f32 v52, v66, v65
 v_fma_f32 v51, -v67, v65, v51
 v_fmac_f32 v52, v67, v64
 v_cvt_pk_bf16_f32 v208, -v208, -v209
 v_mfma_f32_32x32x16_bf16 a[32:47], a[224:227], v[172:175], a[32:47]
 ds_read_b128 a[224:227], v53 offset:0
 v_cvt_pk_bf16_f32 v209, -v210, -v211
 v_cvt_pk_bf16_f32 v210, -v212, -v213
 v_cvt_pk_bf16_f32 v211, -v214, -v215
 v_cvt_pk_bf16_f32 v212, -v216, -v217
 v_cvt_pk_bf16_f32 v213, -v218, -v219
 v_cvt_pk_bf16_f32 v214, -v220, -v221
 v_mfma_f32_32x32x16_bf16 a[48:63], a[228:231], v[172:175], a[48:63]
 ds_read_b128 a[228:231], v53 offset:2048
 s_add_u32 m0, s36, 102400
 s_add_u32 s38, s33, 73984
 buffer_load_dwordx4 v3, s[12:15], s38 offen offset:0 lds
 s_waitcnt lgkmcnt(2)
 v_mfma_f32_32x32x16_bf16 a[64:79], a[232:235], v[172:175], a[64:79]
 ds_read_b128 a[232:235], v53 offset:4096
 v_cvt_pk_bf16_f32 v215, -v222, -v223
 ds_write_b128 v40, v[192:195]
 v_xor_b32 v40, 16, v40
 v_mfma_f32_32x32x16_bf16 a[80:95], a[236:239], v[172:175], a[80:95]
 ds_read_b128 a[236:239], v53 offset:12288
 s_waitcnt lgkmcnt(3)
 ds_write_b128 v40, v[196:199]
 ds_read_b64_tr_b16 v[200:201], v0 offset:0
 ds_read_b64_tr_b16 v[204:205], v0 offset:1024
 v_xor_b32 v0, 32, v0
 ds_read_b64_tr_b16 v[202:203], v0 offset:256
 ds_read_b64_tr_b16 v[206:207], v0 offset:1280
 ds_write_b128 v40, v[212:215]
 v_xor_b32 v40, 16, v40
 ds_write_b128 v40, v[208:211]
 ds_read_b64_tr_b16 v[194:195], v0 offset:256
 ds_read_b64_tr_b16 v[198:199], v0 offset:1280
 v_xor_b32 v0, 32, v0
 ds_read_b64_tr_b16 v[192:193], v0 offset:0
 ds_read_b64_tr_b16 v[196:197], v0 offset:1024
 s_waitcnt lgkmcnt(7)
 v_mfma_f32_32x32x16_bf16 a[0:15], a[224:227], v[200:203], a[0:15]
 ds_read_b128 a[224:227], v53 offset:14336
 buffer_load_dwordx4 v4, s[12:15], s38 offen offset:1024 lds
 v_exp_f32 v45, v28
 v_mfma_f32_32x32x16_bf16 a[16:31], a[228:231], v[200:203], a[16:31]
 ds_read_b128 a[228:231], v53 offset:16384
 v_fract_f32 v44, v29
 v_cos_f32 v43, v44
 v_sin_f32 v44, v44
 v_mfma_f32_32x32x16_bf16 a[32:47], a[232:235], v[200:203], a[32:47]
 ds_read_b128 a[232:235], v54 offset:0
 v_mul_f32 v43, v43, v45
 v_mul_f32 v44, v44, v45
 v_mul_f32 v45, v31, v224
 v_mul_f32 v224, v30, v224
 v_fmac_f32 v224, v31, v240
 v_fma_f32 v240, v30, v240, -v45
 v_mfma_f32_32x32x16_bf16 a[48:63], a[236:239], v[200:203], a[48:63]
 ds_read_b128 a[236:239], v54 offset:2048
 s_waitcnt lgkmcnt(2)
 v_mul_f32 v46, v31, v225
 v_mul_f32 v225, v30, v225
 v_fmac_f32 v225, v31, v241
 v_fma_f32 v241, v30, v241, -v46
 v_mul_f32 v45, v31, v226
 v_mfma_f32_32x32x16_bf16 a[64:79], a[224:227], v[200:203], a[64:79]
 ds_read_b128 a[224:227], v54 offset:4096
 v_mul_f32 v226, v30, v226
 v_fmac_f32 v226, v31, v242
 v_fma_f32 v242, v30, v242, -v45
 v_mul_f32 v46, v31, v227
 v_mul_f32 v227, v30, v227
 v_fmac_f32 v227, v31, v243
 v_mfma_f32_32x32x16_bf16 a[80:95], a[228:231], v[200:203], a[80:95]
 ds_read_b128 a[228:231], v54 offset:12288
 s_waitcnt lgkmcnt(2)
 v_fma_f32 v243, v30, v243, -v46
 v_mul_f32 v45, v31, v228
 v_mul_f32 v228, v30, v228
 v_fmac_f32 v228, v31, v244
 v_fma_f32 v244, v30, v244, -v45
 v_mfma_f32_32x32x16_bf16 a[0:15], a[232:235], v[204:207], a[0:15]
 ds_read_b128 a[232:235], v54 offset:14336
 v_mul_f32 v46, v31, v229
 v_mul_f32 v229, v30, v229
 v_fmac_f32 v229, v31, v245
 v_fma_f32 v245, v30, v245, -v46
 v_mul_f32 v45, v31, v230
 v_mul_f32 v230, v30, v230
 v_mfma_f32_32x32x16_bf16 a[16:31], a[236:239], v[204:207], a[16:31]
 ds_read_b128 a[236:239], v54 offset:16384
 s_waitcnt lgkmcnt(2)
 v_fmac_f32 v230, v31, v246
 v_fma_f32 v246, v30, v246, -v45
 v_mul_f32 v46, v31, v231
 v_mul_f32 v231, v30, v231
 v_fmac_f32 v231, v31, v247
 v_mfma_f32_32x32x16_bf16 a[32:47], a[224:227], v[204:207], a[32:47]
 s_barrier
 ds_read_b128 a[224:227], v1 offset:24576
 v_fma_f32 v247, v30, v247, -v46
 v_mul_f32 v45, v31, v232
 v_mul_f32 v232, v30, v232
 v_fmac_f32 v232, v31, v248
 v_mfma_f32_32x32x16_bf16 a[48:63], a[228:231], v[204:207], a[48:63]
 ds_read_b128 a[228:231], v1 offset:26624
 s_add_u32 m0, s36, 122880
 s_add_u32 s38, s33, 256
 buffer_load_dwordx4 v3, s[52:55], s38 offen offset:0 lds
 s_waitcnt lgkmcnt(2)
 v_mfma_f32_32x32x16_bf16 a[64:79], a[232:235], v[204:207], a[64:79]
 ds_read_b128 a[232:235], v1 offset:28672
 v_fma_f32 v248, v30, v248, -v45
 v_mul_f32 v46, v31, v233
 v_mul_f32 v233, v30, v233
 v_fmac_f32 v233, v31, v249
 v_fma_f32 v249, v30, v249, -v46
 v_mfma_f32_32x32x16_bf16 a[80:95], a[236:239], v[204:207], a[80:95]
 ds_read_b128 a[236:239], v1 offset:36864
 s_waitcnt lgkmcnt(2)
 v_mul_f32 v45, v31, v234
 v_mul_f32 v234, v30, v234
 v_fmac_f32 v234, v31, v250
 v_fma_f32 v250, v30, v250, -v45
 v_mul_f32 v46, v31, v235
 v_mfma_f32_32x32x16_bf16 a[0:15], a[224:227], v[160:163], a[0:15]
 ds_read_b128 a[224:227], v1 offset:38912
 buffer_load_dwordx4 v4, s[52:55], s38 offen offset:1024 lds
 v_mul_f32 v235, v30, v235
 v_fmac_f32 v235, v31, v251
 v_mfma_f32_32x32x16_bf16 a[16:31], a[228:231], v[160:163], a[16:31]
 ds_read_b128 a[228:231], v1 offset:40960
 s_waitcnt lgkmcnt(2)
 v_fma_f32 v251, v30, v251, -v46
 v_mul_f32 v45, v31, v236
 v_mul_f32 v236, v30, v236
 v_fmac_f32 v236, v31, v252
 v_fma_f32 v252, v30, v252, -v45
 v_mfma_f32_32x32x16_bf16 a[32:47], a[232:235], v[160:163], a[32:47]
 ds_read_b128 a[232:235], v2 offset:24576
 v_mul_f32 v46, v31, v237
 v_mul_f32 v237, v30, v237
 v_fmac_f32 v237, v31, v253
 v_fma_f32 v253, v30, v253, -v46
 v_mul_f32 v45, v31, v238
 v_mul_f32 v238, v30, v238
 v_mfma_f32_32x32x16_bf16 a[48:63], a[236:239], v[160:163], a[48:63]
 ds_read_b128 a[236:239], v2 offset:26624
 buffer_load_dwordx4 v5, s[52:55], s38 offen offset:2048 lds
 s_waitcnt lgkmcnt(2)
 v_fmac_f32 v238, v31, v254
 v_mfma_f32_32x32x16_bf16 a[64:79], a[224:227], v[160:163], a[64:79]
 ds_read_b128 a[224:227], v2 offset:28672
 v_fma_f32 v254, v30, v254, -v45
 v_mul_f32 v46, v31, v239
 v_mul_f32 v239, v30, v239
 v_fmac_f32 v239, v31, v255
 v_fma_f32 v255, v30, v255, -v46
 v_sub_f32 v45, 0, v44
 v_mfma_f32_32x32x16_bf16 a[80:95], a[228:231], v[160:163], a[80:95]
 ds_read_b128 a[228:231], v2 offset:36864
 s_waitcnt lgkmcnt(2)
 v_fmac_f32 v224, v43, v49
 v_fmac_f32 v240, v43, v50
 v_fmac_f32 v224, v45, v50
 v_fmac_f32 v240, v44, v49
 v_fmac_f32 v225, v43, v224
 v_mfma_f32_32x32x16_bf16 a[0:15], a[232:235], v[164:167], a[0:15]
 ds_read_b128 a[232:235], v2 offset:38912
 buffer_load_dwordx4 v6, s[52:55], s38 offen offset:3072 lds
 v_fmac_f32 v241, v43, v240
 v_fmac_f32 v225, v45, v240
 v_mfma_f32_32x32x16_bf16 a[16:31], a[236:239], v[164:167], a[16:31]
 ds_read_b128 a[236:239], v2 offset:40960
 s_waitcnt lgkmcnt(2)
 v_fmac_f32 v241, v44, v224
 v_fmac_f32 v226, v43, v225
 v_fmac_f32 v242, v43, v241
 v_fmac_f32 v226, v45, v241
 v_fmac_f32 v242, v44, v225
 v_mfma_f32_32x32x16_bf16 a[32:47], a[224:227], v[164:167], a[32:47]
 ds_read_b128 a[224:227], v53 offset:24576
 v_fmac_f32 v227, v43, v226
 v_fmac_f32 v243, v43, v242
 v_fmac_f32 v227, v45, v242
 v_fmac_f32 v243, v44, v226
 v_fmac_f32 v228, v43, v227
 v_fmac_f32 v244, v43, v243
 v_mfma_f32_32x32x16_bf16 a[48:63], a[228:231], v[164:167], a[48:63]
 ds_read_b128 a[228:231], v53 offset:26624
 s_add_u32 m0, s36, 126976
 s_add_u32 s38, s33, 73984
 buffer_load_dwordx4 v3, s[52:55], s38 offen offset:0 lds
 s_waitcnt lgkmcnt(2)
 v_mfma_f32_32x32x16_bf16 a[64:79], a[232:235], v[164:167], a[64:79]
 ds_read_b128 a[232:235], v53 offset:28672
 v_fmac_f32 v228, v45, v243
 v_fmac_f32 v244, v44, v227
 v_fmac_f32 v229, v43, v228
 v_fmac_f32 v245, v43, v244
 v_fmac_f32 v229, v45, v244
 v_mfma_f32_32x32x16_bf16 a[80:95], a[236:239], v[164:167], a[80:95]
 ds_read_b128 a[236:239], v53 offset:36864
 s_waitcnt lgkmcnt(2)
 v_fmac_f32 v245, v44, v228
 v_fmac_f32 v230, v43, v229
 v_fmac_f32 v246, v43, v245
 v_fmac_f32 v230, v45, v245
 v_fmac_f32 v246, v44, v229
 v_mfma_f32_32x32x16_bf16 a[0:15], a[224:227], v[192:195], a[0:15]
 ds_read_b128 a[224:227], v53 offset:38912
 buffer_load_dwordx4 v4, s[52:55], s38 offen offset:1024 lds
 v_fmac_f32 v231, v43, v230
 v_fmac_f32 v247, v43, v246
 v_mfma_f32_32x32x16_bf16 a[16:31], a[228:231], v[192:195], a[16:31]
 ds_read_b128 a[228:231], v53 offset:40960
 s_waitcnt lgkmcnt(2)
 v_fmac_f32 v231, v45, v246
 v_fmac_f32 v247, v44, v230
 v_fmac_f32 v232, v43, v231
 v_fmac_f32 v248, v43, v247
 v_fmac_f32 v232, v45, v247
 v_mfma_f32_32x32x16_bf16 a[32:47], a[232:235], v[192:195], a[32:47]
 ds_read_b128 a[232:235], v54 offset:24576
 v_fmac_f32 v248, v44, v231
 v_fmac_f32 v233, v43, v232
 v_fmac_f32 v249, v43, v248
 v_fmac_f32 v233, v45, v248
 v_fmac_f32 v249, v44, v232
 v_fmac_f32 v234, v43, v233
 v_mfma_f32_32x32x16_bf16 a[48:63], a[236:239], v[192:195], a[48:63]
 ds_read_b128 a[236:239], v54 offset:26624
 s_waitcnt lgkmcnt(2)
 v_fmac_f32 v250, v43, v249
 v_fmac_f32 v234, v45, v249
 v_fmac_f32 v250, v44, v233
 v_fmac_f32 v235, v43, v234
 v_fmac_f32 v251, v43, v250
 v_mfma_f32_32x32x16_bf16 a[64:79], a[224:227], v[192:195], a[64:79]
 ds_read_b128 a[224:227], v54 offset:28672
 v_fmac_f32 v235, v45, v250
 v_fmac_f32 v251, v44, v234
 v_fmac_f32 v236, v43, v235
 v_fmac_f32 v252, v43, v251
 v_fmac_f32 v236, v45, v251
 v_fmac_f32 v252, v44, v235
 v_mfma_f32_32x32x16_bf16 a[80:95], a[228:231], v[192:195], a[80:95]
 ds_read_b128 a[228:231], v54 offset:36864
 s_waitcnt lgkmcnt(2)
 v_fmac_f32 v237, v43, v236
 v_fmac_f32 v253, v43, v252
 v_fmac_f32 v237, v45, v252
 v_fmac_f32 v253, v44, v236
 v_fmac_f32 v238, v43, v237
 v_mfma_f32_32x32x16_bf16 a[0:15], a[232:235], v[196:199], a[0:15]
 ds_read_b128 a[232:235], v54 offset:38912
 v_fmac_f32 v254, v43, v253
 v_fmac_f32 v238, v45, v253
 v_fmac_f32 v254, v44, v237
 v_fmac_f32 v239, v43, v238
 v_fmac_f32 v255, v43, v254
 v_fmac_f32 v239, v45, v254
 v_mfma_f32_32x32x16_bf16 a[16:31], a[236:239], v[196:199], a[16:31]
 ds_read_b128 a[236:239], v54 offset:40960
 s_waitcnt lgkmcnt(2)
 v_fmac_f32 v255, v44, v238
 v_cvt_pk_bf16_f32 v224, v224, v225
 v_cvt_pk_bf16_f32 v225, v226, v227
 v_cvt_pk_bf16_f32 v226, v228, v229
 v_cvt_pk_bf16_f32 v227, v230, v231
 v_mfma_f32_32x32x16_bf16 a[32:47], a[224:227], v[196:199], a[32:47]
 s_waitcnt vmcnt(18)
 s_barrier
 v_add_u32 v1, 49152, v1
 v_add_u32 v2, 49152, v2
 v_add_u32 v53, 49152, v53
 v_add_u32 v54, 49152, v54
 ds_read_b128 a[224:227], v1 offset:0
 v_mfma_f32_32x32x16_bf16 a[48:63], a[228:231], v[196:199], a[48:63]
 ds_read_b128 a[228:231], v1 offset:2048
 s_add_u32 m0, s36, 0
 s_add_u32 s38, s33, 221440
 buffer_load_dwordx4 v3, s[12:15], s38 offen offset:0 lds
 s_waitcnt lgkmcnt(2)
 v_mfma_f32_32x32x16_bf16 a[64:79], a[232:235], v[196:199], a[64:79]
 ds_read_b128 a[232:235], v1 offset:4096
 v_cvt_pk_bf16_f32 v228, v232, v233
 v_cvt_pk_bf16_f32 v229, v234, v235
 v_cvt_pk_bf16_f32 v230, v236, v237
 v_cvt_pk_bf16_f32 v231, v238, v239
 v_cvt_pk_bf16_f32 v240, -v240, -v241
 v_mfma_f32_32x32x16_bf16 a[80:95], a[236:239], v[196:199], a[80:95]
 ds_read_b128 a[236:239], v1 offset:12288
 s_waitcnt lgkmcnt(2)
 v_cvt_pk_bf16_f32 v241, -v242, -v243
 v_cvt_pk_bf16_f32 v242, -v244, -v245
 v_cvt_pk_bf16_f32 v243, -v246, -v247
 v_cvt_pk_bf16_f32 v244, -v248, -v249
 v_cvt_pk_bf16_f32 v245, -v250, -v251
 v_mfma_f32_32x32x16_bf16 a[96:111], a[224:227], v[168:171], a[96:111]
 ds_read_b128 a[224:227], v1 offset:14336
 buffer_load_dwordx4 v4, s[12:15], s38 offen offset:1024 lds
 v_cvt_pk_bf16_f32 v246, -v252, -v253
 v_cvt_pk_bf16_f32 v247, -v254, -v255
 v_mfma_f32_32x32x16_bf16 a[112:127], a[228:231], v[168:171], a[112:127]
 ds_read_b128 a[228:231], v1 offset:16384
 s_waitcnt lgkmcnt(2)
 ds_write_b128 v40, v[224:227]
 v_xor_b32 v40, 16, v40
 v_mfma_f32_32x32x16_bf16 a[128:143], a[232:235], v[168:171], a[128:143]
 ds_read_b128 a[232:235], v2 offset:0
 ds_write_b128 v40, v[228:231]
 ds_read_b64_tr_b16 v[232:233], v0 offset:0
 ds_read_b64_tr_b16 v[236:237], v0 offset:1024
 v_xor_b32 v0, 32, v0
 ds_read_b64_tr_b16 v[234:235], v0 offset:256
 v_mfma_f32_32x32x16_bf16 a[144:159], a[236:239], v[168:171], a[144:159]
 ds_read_b128 a[236:239], v2 offset:2048
 buffer_load_dwordx4 v5, s[12:15], s38 offen offset:2048 lds
 s_waitcnt lgkmcnt(7)
 ds_read_b64_tr_b16 v[238:239], v0 offset:1280
 v_mfma_f32_32x32x16_bf16 a[160:175], a[224:227], v[168:171], a[160:175]
 ds_read_b128 a[224:227], v2 offset:4096
 ds_write_b128 v40, v[244:247]
 v_xor_b32 v40, 16, v40
 v_mfma_f32_32x32x16_bf16 a[176:191], a[228:231], v[168:171], a[176:191]
 ds_read_b128 a[228:231], v2 offset:12288
 s_waitcnt lgkmcnt(4)
 ds_write_b128 v40, v[240:243]
 ds_read_b64_tr_b16 v[226:227], v0 offset:256
 ds_read_b64_tr_b16 v[230:231], v0 offset:1280
 v_xor_b32 v0, 32, v0
 v_mfma_f32_32x32x16_bf16 a[96:111], a[232:235], v[172:175], a[96:111]
 ds_read_b128 a[232:235], v2 offset:14336
 buffer_load_dwordx4 v6, s[12:15], s38 offen offset:3072 lds
 ds_read_b64_tr_b16 v[224:225], v0 offset:0
 ds_read_b64_tr_b16 v[228:229], v0 offset:1024
 v_mfma_f32_32x32x16_bf16 a[112:127], a[236:239], v[172:175], a[112:127]
 ds_read_b128 a[236:239], v2 offset:16384
 s_waitcnt lgkmcnt(7)
 v_exp_f32 v45, v32
 v_fract_f32 v44, v33
 v_cos_f32 v43, v44
 v_mfma_f32_32x32x16_bf16 a[128:143], a[224:227], v[172:175], a[128:143]
 ds_read_b128 a[224:227], v53 offset:0
 v_sin_f32 v44, v44
 v_mul_f32 v43, v43, v45
 v_mul_f32 v44, v44, v45
 v_mul_f32 v45, v35, v96
 v_mul_f32 v96, v34, v96
 v_mfma_f32_32x32x16_bf16 a[144:159], a[228:231], v[172:175], a[144:159]
 ds_read_b128 a[228:231], v53 offset:2048
 s_add_u32 m0, s36, 4096
 s_add_u32 s38, s33, 295168
 buffer_load_dwordx4 v3, s[12:15], s38 offen offset:0 lds
 s_waitcnt lgkmcnt(2)
 v_mfma_f32_32x32x16_bf16 a[160:175], a[232:235], v[172:175], a[160:175]
 ds_read_b128 a[232:235], v53 offset:4096
 v_fmac_f32 v96, v35, v112
 v_fma_f32 v112, v34, v112, -v45
 v_mul_f32 v46, v35, v97
 v_mul_f32 v97, v34, v97
 v_fmac_f32 v97, v35, v113
 v_mfma_f32_32x32x16_bf16 a[176:191], a[236:239], v[172:175], a[176:191]
 ds_read_b128 a[236:239], v53 offset:12288
 s_waitcnt lgkmcnt(2)
 v_fma_f32 v113, v34, v113, -v46
 v_mul_f32 v45, v35, v98
 v_mul_f32 v98, v34, v98
 v_fmac_f32 v98, v35, v114
 v_fma_f32 v114, v34, v114, -v45
 v_mfma_f32_32x32x16_bf16 a[96:111], a[224:227], v[200:203], a[96:111]
 ds_read_b128 a[224:227], v53 offset:14336
 buffer_load_dwordx4 v4, s[12:15], s38 offen offset:1024 lds
 v_mul_f32 v46, v35, v99
 v_mul_f32 v99, v34, v99
 v_mfma_f32_32x32x16_bf16 a[112:127], a[228:231], v[200:203], a[112:127]
 ds_read_b128 a[228:231], v53 offset:16384
 s_waitcnt lgkmcnt(2)
 v_fmac_f32 v99, v35, v115
 v_fma_f32 v115, v34, v115, -v46
 v_mul_f32 v45, v35, v100
 v_mul_f32 v100, v34, v100
 v_fmac_f32 v100, v35, v116
 v_mfma_f32_32x32x16_bf16 a[128:143], a[232:235], v[200:203], a[128:143]
 ds_read_b128 a[232:235], v54 offset:0
 v_fma_f32 v116, v34, v116, -v45
 v_mul_f32 v46, v35, v101
 v_mul_f32 v101, v34, v101
 v_fmac_f32 v101, v35, v117
 v_fma_f32 v117, v34, v117, -v46
 v_mul_f32 v45, v35, v102
 v_mfma_f32_32x32x16_bf16 a[144:159], a[236:239], v[200:203], a[144:159]
 ds_read_b128 a[236:239], v54 offset:2048
 s_waitcnt lgkmcnt(2)
 v_mul_f32 v102, v34, v102
 v_fmac_f32 v102, v35, v118
 v_fma_f32 v118, v34, v118, -v45
 v_mul_f32 v46, v35, v103
 v_mul_f32 v103, v34, v103
 v_mfma_f32_32x32x16_bf16 a[160:175], a[224:227], v[200:203], a[160:175]
 ds_read_b128 a[224:227], v54 offset:4096
 v_fmac_f32 v103, v35, v119
 v_fma_f32 v119, v34, v119, -v46
 v_mul_f32 v45, v35, v104
 v_mul_f32 v104, v34, v104
 v_fmac_f32 v104, v35, v120
 v_fma_f32 v120, v34, v120, -v45
 v_mfma_f32_32x32x16_bf16 a[176:191], a[228:231], v[200:203], a[176:191]
 ds_read_b128 a[228:231], v54 offset:12288
 s_waitcnt lgkmcnt(2)
 v_mul_f32 v46, v35, v105
 v_mul_f32 v105, v34, v105
 v_fmac_f32 v105, v35, v121
 v_fma_f32 v121, v34, v121, -v46
 v_mul_f32 v45, v35, v106
 v_mfma_f32_32x32x16_bf16 a[96:111], a[232:235], v[204:207], a[96:111]
 ds_read_b128 a[232:235], v54 offset:14336
 v_mul_f32 v106, v34, v106
 v_fmac_f32 v106, v35, v122
 v_fma_f32 v122, v34, v122, -v45
 v_mul_f32 v46, v35, v107
 v_mul_f32 v107, v34, v107
 v_fmac_f32 v107, v35, v123
 v_mfma_f32_32x32x16_bf16 a[112:127], a[236:239], v[204:207], a[112:127]
 ds_read_b128 a[236:239], v54 offset:16384
 s_waitcnt lgkmcnt(2)
 v_fma_f32 v123, v34, v123, -v46
 v_mul_f32 v45, v35, v108
 v_mul_f32 v108, v34, v108
 v_fmac_f32 v108, v35, v124
 v_fma_f32 v124, v34, v124, -v45
 v_mfma_f32_32x32x16_bf16 a[128:143], a[224:227], v[204:207], a[128:143]
 s_waitcnt vmcnt(18)
 s_barrier
 ds_read_b128 a[224:227], v1 offset:24576
 v_mul_f32 v46, v35, v109
 v_mul_f32 v109, v34, v109
 v_fmac_f32 v109, v35, v125
 v_fma_f32 v125, v34, v125, -v46
 v_mfma_f32_32x32x16_bf16 a[144:159], a[228:231], v[204:207], a[144:159]
 ds_read_b128 a[228:231], v1 offset:26624
 s_add_u32 m0, s36, 24576
 s_add_u32 s38, s33, 221440
 buffer_load_dwordx4 v3, s[52:55], s38 offen offset:0 lds
 s_waitcnt lgkmcnt(2)
 v_mfma_f32_32x32x16_bf16 a[160:175], a[232:235], v[204:207], a[160:175]
 ds_read_b128 a[232:235], v1 offset:28672
 v_mul_f32 v45, v35, v110
 v_mul_f32 v110, v34, v110
 v_fmac_f32 v110, v35, v126
 v_fma_f32 v126, v34, v126, -v45
 v_mul_f32 v46, v35, v111
 v_mfma_f32_32x32x16_bf16 a[176:191], a[236:239], v[204:207], a[176:191]
 ds_read_b128 a[236:239], v1 offset:36864
 s_waitcnt lgkmcnt(2)
 v_mul_f32 v111, v34, v111
 v_fmac_f32 v111, v35, v127
 v_fma_f32 v127, v34, v127, -v46
 v_sub_f32 v45, 0, v44
 v_fmac_f32 v96, v43, v51
 v_mfma_f32_32x32x16_bf16 a[96:111], a[224:227], v[160:163], a[96:111]
 ds_read_b128 a[224:227], v1 offset:38912
 buffer_load_dwordx4 v4, s[52:55], s38 offen offset:1024 lds
 v_fmac_f32 v112, v43, v52
 v_fmac_f32 v96, v45, v52
 v_mfma_f32_32x32x16_bf16 a[112:127], a[228:231], v[160:163], a[112:127]
 ds_read_b128 a[228:231], v1 offset:40960
 s_waitcnt lgkmcnt(2)
 v_fmac_f32 v112, v44, v51
 v_fmac_f32 v97, v43, v96
 v_fmac_f32 v113, v43, v112
 v_fmac_f32 v97, v45, v112
 v_fmac_f32 v113, v44, v96
 v_mfma_f32_32x32x16_bf16 a[128:143], a[232:235], v[160:163], a[128:143]
 ds_read_b128 a[232:235], v2 offset:24576
 v_fmac_f32 v98, v43, v97
 v_fmac_f32 v114, v43, v113
 v_fmac_f32 v98, v45, v113
 v_fmac_f32 v114, v44, v97
 v_fmac_f32 v99, v43, v98
 v_fmac_f32 v115, v43, v114
 v_mfma_f32_32x32x16_bf16 a[144:159], a[236:239], v[160:163], a[144:159]
 ds_read_b128 a[236:239], v2 offset:26624
 buffer_load_dwordx4 v5, s[52:55], s38 offen offset:2048 lds
 s_waitcnt lgkmcnt(2)
 v_fmac_f32 v99, v45, v114
 v_mfma_f32_32x32x16_bf16 a[160:175], a[224:227], v[160:163], a[160:175]
 ds_read_b128 a[224:227], v2 offset:28672
 v_fmac_f32 v115, v44, v98
 v_fmac_f32 v100, v43, v99
 v_fmac_f32 v116, v43, v115
 v_fmac_f32 v100, v45, v115
 v_fmac_f32 v116, v44, v99
 v_fmac_f32 v101, v43, v100
 v_mfma_f32_32x32x16_bf16 a[176:191], a[228:231], v[160:163], a[176:191]
 ds_read_b128 a[228:231], v2 offset:36864
 s_waitcnt lgkmcnt(2)
 v_fmac_f32 v117, v43, v116
 v_fmac_f32 v101, v45, v116
 v_fmac_f32 v117, v44, v100
 v_fmac_f32 v102, v43, v101
 v_fmac_f32 v118, v43, v117
 v_mfma_f32_32x32x16_bf16 a[96:111], a[232:235], v[164:167], a[96:111]
 ds_read_b128 a[232:235], v2 offset:38912
 buffer_load_dwordx4 v6, s[52:55], s38 offen offset:3072 lds
 v_fmac_f32 v102, v45, v117
 v_fmac_f32 v118, v44, v101
 v_mfma_f32_32x32x16_bf16 a[112:127], a[236:239], v[164:167], a[112:127]
 ds_read_b128 a[236:239], v2 offset:40960
 s_waitcnt lgkmcnt(2)
 v_fmac_f32 v103, v43, v102
 v_fmac_f32 v119, v43, v118
 v_fmac_f32 v103, v45, v118
 v_fmac_f32 v119, v44, v102
 v_fmac_f32 v104, v43, v103
 v_mfma_f32_32x32x16_bf16 a[128:143], a[224:227], v[164:167], a[128:143]
 ds_read_b128 a[224:227], v53 offset:24576
 v_fmac_f32 v120, v43, v119
 v_fmac_f32 v104, v45, v119
 v_fmac_f32 v120, v44, v103
 v_fmac_f32 v105, v43, v104
 v_fmac_f32 v121, v43, v120
 v_fmac_f32 v105, v45, v120
 v_mfma_f32_32x32x16_bf16 a[144:159], a[228:231], v[164:167], a[144:159]
 ds_read_b128 a[228:231], v53 offset:26624
 s_add_u32 m0, s36, 28672
 s_add_u32 s38, s33, 295168
 buffer_load_dwordx4 v3, s[52:55], s38 offen offset:0 lds
 s_waitcnt lgkmcnt(2)
 v_mfma_f32_32x32x16_bf16 a[160:175], a[232:235], v[164:167], a[160:175]
 ds_read_b128 a[232:235], v53 offset:28672
 v_fmac_f32 v121, v44, v104
 v_fmac_f32 v106, v43, v105
 v_fmac_f32 v122, v43, v121
 v_fmac_f32 v106, v45, v121
 v_fmac_f32 v122, v44, v105
 v_mfma_f32_32x32x16_bf16 a[176:191], a[236:239], v[164:167], a[176:191]
 ds_read_b128 a[236:239], v53 offset:36864
 s_waitcnt lgkmcnt(2)
 v_fmac_f32 v107, v43, v106
 v_fmac_f32 v123, v43, v122
 v_fmac_f32 v107, v45, v122
 v_fmac_f32 v123, v44, v106
 v_fmac_f32 v108, v43, v107
 v_mfma_f32_32x32x16_bf16 a[96:111], a[224:227], v[192:195], a[96:111]
 ds_read_b128 a[224:227], v53 offset:38912
 buffer_load_dwordx4 v4, s[52:55], s38 offen offset:1024 lds
 v_fmac_f32 v124, v43, v123
 v_fmac_f32 v108, v45, v123
 v_mfma_f32_32x32x16_bf16 a[112:127], a[228:231], v[192:195], a[112:127]
 ds_read_b128 a[228:231], v53 offset:40960
 s_waitcnt lgkmcnt(2)
 v_fmac_f32 v124, v44, v107
 v_fmac_f32 v109, v43, v108
 v_fmac_f32 v125, v43, v124
 v_fmac_f32 v109, v45, v124
 v_fmac_f32 v125, v44, v108
 v_mfma_f32_32x32x16_bf16 a[128:143], a[232:235], v[192:195], a[128:143]
 ds_read_b128 a[232:235], v54 offset:24576
 v_fmac_f32 v110, v43, v109
 v_fmac_f32 v126, v43, v125
 v_fmac_f32 v110, v45, v125
 v_fmac_f32 v126, v44, v109
 v_fmac_f32 v111, v43, v110
 v_fmac_f32 v127, v43, v126
 v_mfma_f32_32x32x16_bf16 a[144:159], a[236:239], v[192:195], a[144:159]
 ds_read_b128 a[236:239], v54 offset:26624
 s_waitcnt lgkmcnt(2)
 v_fmac_f32 v111, v45, v126
 v_fmac_f32 v127, v44, v110
 v_cvt_pk_bf16_f32 v96, v96, v97
 v_cvt_pk_bf16_f32 v97, v98, v99
 v_cvt_pk_bf16_f32 v98, v100, v101
 v_mfma_f32_32x32x16_bf16 a[160:175], a[224:227], v[192:195], a[160:175]
 ds_read_b128 a[224:227], v54 offset:28672
 v_cvt_pk_bf16_f32 v99, v102, v103
 v_cvt_pk_bf16_f32 v100, v104, v105
 v_cvt_pk_bf16_f32 v101, v106, v107
 v_cvt_pk_bf16_f32 v102, v108, v109
 v_cvt_pk_bf16_f32 v103, v110, v111
 v_cvt_pk_bf16_f32 v112, -v112, -v113
 v_mfma_f32_32x32x16_bf16 a[176:191], a[228:231], v[192:195], a[176:191]
 ds_read_b128 a[228:231], v54 offset:36864
 s_waitcnt lgkmcnt(2)
 v_cvt_pk_bf16_f32 v113, -v114, -v115
 v_cvt_pk_bf16_f32 v114, -v116, -v117
 v_cvt_pk_bf16_f32 v115, -v118, -v119
 v_cvt_pk_bf16_f32 v116, -v120, -v121
 v_cvt_pk_bf16_f32 v117, -v122, -v123
 v_mfma_f32_32x32x16_bf16 a[96:111], a[232:235], v[196:199], a[96:111]
 ds_read_b128 a[232:235], v54 offset:38912
 v_cvt_pk_bf16_f32 v118, -v124, -v125
 v_cvt_pk_bf16_f32 v119, -v126, -v127
 ds_write_b128 v40, v[96:99]
 v_xor_b32 v40, 16, v40
 v_mfma_f32_32x32x16_bf16 a[112:127], a[236:239], v[196:199], a[112:127]
 ds_read_b128 a[236:239], v54 offset:40960
 s_waitcnt lgkmcnt(3)
 ds_write_b128 v40, v[100:103]
 ds_read_b64_tr_b16 v[104:105], v0 offset:0
 ds_read_b64_tr_b16 v[108:109], v0 offset:1024
 v_mfma_f32_32x32x16_bf16 a[128:143], a[224:227], v[196:199], a[128:143]
 s_waitcnt vmcnt(18)
 s_barrier
 v_add_u32 v1, 49152, v1
 v_add_u32 v2, 49152, v2
 v_add_u32 v53, 49152, v53
 v_add_u32 v54, 49152, v54
 ds_read_b128 a[224:227], v1 offset:0
 v_mfma_f32_32x32x16_bf16 a[144:159], a[228:231], v[196:199], a[144:159]
 ds_read_b128 a[228:231], v2 offset:0
 s_add_u32 m0, s36, 49152
 s_add_u32 s38, s33, 442496
 buffer_load_dwordx4 v3, s[12:15], s38 offen offset:0 lds
 s_waitcnt lgkmcnt(5)
 v_mfma_f32_32x32x16_bf16 a[160:175], a[232:235], v[196:199], a[160:175]
 ds_read_b128 a[232:235], v53 offset:0
 v_xor_b32 v0, 32, v0
 ds_read_b64_tr_b16 v[106:107], v0 offset:256
 ds_read_b64_tr_b16 v[110:111], v0 offset:1280
 v_mfma_f32_32x32x16_bf16 a[176:191], a[236:239], v[196:199], a[176:191]
 ds_read_b128 a[236:239], v54 offset:0
 s_waitcnt lgkmcnt(4)
 ds_write_b128 v40, v[116:119]
 v_xor_b32 v40, 16, v40
 v_mfma_f32_32x32x16_bf16 a[0:15], a[224:227], v[232:235], a[0:15]
 s_waitcnt vmcnt(13)
 s_barrier
 ds_read_b128 a[224:227], v1 offset:24576
 buffer_load_dwordx4 v4, s[12:15], s38 offen offset:1024 lds
 v_mfma_f32_32x32x16_bf16 a[0:15], a[228:231], v[236:239], a[0:15]
 ds_read_b128 a[228:231], v2 offset:24576
 s_waitcnt lgkmcnt(3)
 ds_write_b128 v40, v[112:115]
 ds_read_b64_tr_b16 v[98:99], v0 offset:256
 ds_read_b64_tr_b16 v[102:103], v0 offset:1280
 v_xor_b32 v0, 32, v0
 ds_read_b64_tr_b16 v[96:97], v0 offset:0
 ds_read_b64_tr_b16 v[100:101], v0 offset:1024
 v_mfma_f32_32x32x16_bf16 a[0:15], a[232:235], v[104:107], a[0:15]
 ds_read_b128 a[232:235], v53 offset:24576
 v_mfma_f32_32x32x16_bf16 a[0:15], a[236:239], v[108:111], a[0:15]
 ds_read_b128 a[236:239], v54 offset:24576
 buffer_load_dwordx4 v5, s[12:15], s38 offen offset:2048 lds
 s_waitcnt lgkmcnt(7)
 v_mfma_f32_32x32x16_bf16 a[0:15], a[224:227], v[224:227], a[0:15]
 ds_read_b128 a[224:227], v1 offset:2048
 v_mfma_f32_32x32x16_bf16 a[0:15], a[228:231], v[228:231], a[0:15]
 ds_read_b128 a[228:231], v2 offset:2048
 s_waitcnt lgkmcnt(2)
 v_mfma_f32_32x32x16_bf16 a[0:15], a[232:235], v[96:99], a[0:15]
 ds_read_b128 a[232:235], v53 offset:2048
 buffer_load_dwordx4 v6, s[12:15], s38 offen offset:3072 lds
 v_mfma_f32_32x32x16_bf16 a[0:15], a[236:239], v[100:103], a[0:15]
 ds_read_b128 a[236:239], v54 offset:2048
 s_waitcnt lgkmcnt(2)
 v_mov_b32 v67, s45
 v_mov_b32 v71, s45
 v_mov_b32 v75, s45
 v_mov_b32 v79, s45
 v_mov_b32 v59, s45
 v_mfma_f32_32x32x16_bf16 a[16:31], a[224:227], v[232:235], a[16:31]
 ds_read_b128 a[224:227], v1 offset:26624
 v_mov_b32 v63, s45
 s_mul_i32 s39, s30, 4348
 s_sub_u32 s39, 12812, s39
 v_add_u32 v36, s39, v7
 v_lshl_or_b32 v36, v7, 24, v36
 v_add_u32 v41, 1, v67
 v_mfma_f32_32x32x16_bf16 a[16:31], a[228:231], v[236:239], a[16:31]
 ds_read_b128 a[228:231], v2 offset:26624
 s_add_u32 m0, s36, 53248
 s_add_u32 s38, s33, 516224
 buffer_load_dwordx4 v3, s[12:15], s38 offen offset:0 lds
 s_waitcnt lgkmcnt(2)
 v_mfma_f32_32x32x16_bf16 a[16:31], a[232:235], v[104:107], a[16:31]
 ds_read_b128 a[232:235], v53 offset:26624
 v_add_u32 v42, 2, v67
 v_accvgpr_read_b32 v43, a0
 v_accvgpr_read_b32 v44, a1
 v_cvt_pk_bf16_f32 v64, v43, v44
 v_accvgpr_read_b32 v45, a2
 v_mfma_f32_32x32x16_bf16 a[16:31], a[236:239], v[108:111], a[16:31]
 ds_read_b128 a[236:239], v54 offset:26624
 s_waitcnt lgkmcnt(2)
 v_accvgpr_read_b32 v46, a3
 v_cvt_pk_bf16_f32 v65, v45, v46
 v_accvgpr_read_b32 v43, a8
 v_accvgpr_read_b32 v44, a9
 v_cvt_pk_bf16_f32 v66, v43, v44
 v_mfma_f32_32x32x16_bf16 a[16:31], a[224:227], v[224:227], a[16:31]
 ds_read_b128 a[224:227], v1 offset:4096
 buffer_load_dwordx4 v4, s[12:15], s38 offen offset:1024 lds
 v_mfma_f32_32x32x16_bf16 a[16:31], a[228:231], v[228:231], a[16:31]
 ds_read_b128 a[228:231], v2 offset:4096
 s_add_u32 m0, s36, 73728
 s_add_u32 s38, s33, 442496
 buffer_load_dwordx4 v3, s[52:55], s38 offen offset:0 lds
 s_waitcnt lgkmcnt(2)
 v_mfma_f32_32x32x16_bf16 a[16:31], a[232:235], v[96:99], a[16:31]
 ds_read_b128 a[232:235], v53 offset:4096
 buffer_load_dwordx4 v4, s[52:55], s38 offen offset:1024 lds
 v_mfma_f32_32x32x16_bf16 a[16:31], a[236:239], v[100:103], a[16:31]
 ds_read_b128 a[236:239], v54 offset:4096
 buffer_load_dwordx4 v5, s[52:55], s38 offen offset:2048 lds
 s_waitcnt lgkmcnt(2)
 v_mfma_f32_32x32x16_bf16 a[32:47], a[224:227], v[232:235], a[32:47]
 ds_read_b128 a[224:227], v1 offset:28672
 buffer_load_dwordx4 v6, s[52:55], s38 offen offset:3072 lds
 buffer_store_dwordx4 v[64:67], v7, s[16:19], s48 offen offset:0 sc1
 v_mfma_f32_32x32x16_bf16 a[32:47], a[228:231], v[236:239], a[32:47]
 ds_read_b128 a[228:231], v2 offset:28672
 s_add_u32 m0, s36, 77824
 s_add_u32 s38, s33, 516224
 buffer_load_dwordx4 v3, s[52:55], s38 offen offset:0 lds
 s_waitcnt lgkmcnt(2)
 v_mfma_f32_32x32x16_bf16 a[32:47], a[232:235], v[104:107], a[32:47]
 ds_read_b128 a[232:235], v53 offset:28672
 buffer_load_dwordx4 v4, s[52:55], s38 offen offset:1024 lds
 v_accvgpr_read_b32 v45, a4
 v_mfma_f32_32x32x16_bf16 a[32:47], a[236:239], v[108:111], a[32:47]
 ds_read_b128 a[236:239], v54 offset:28672
 s_waitcnt lgkmcnt(2)
 v_accvgpr_read_b32 v46, a5
 v_cvt_pk_bf16_f32 v68, v45, v46
 v_accvgpr_read_b32 v43, a6
 v_accvgpr_read_b32 v44, a7
 v_cvt_pk_bf16_f32 v69, v43, v44
 v_mfma_f32_32x32x16_bf16 a[32:47], a[224:227], v[224:227], a[32:47]
 ds_read_b128 a[224:227], v1 offset:12288
 v_accvgpr_read_b32 v45, a10
 v_accvgpr_read_b32 v46, a11
 v_cvt_pk_bf16_f32 v70, v45, v46
 buffer_store_dwordx4 v[68:71], v7, s[16:19], s48 offen offset:256 sc1
 v_mfma_f32_32x32x16_bf16 a[32:47], a[228:231], v[228:231], a[32:47]
 ds_read_b128 a[228:231], v2 offset:12288
 s_waitcnt lgkmcnt(2)
 v_accvgpr_read_b32 v43, a12
 v_accvgpr_read_b32 v44, a13
 v_cvt_pk_bf16_f32 v72, v43, v44
 v_accvgpr_read_b32 v45, a14
 v_accvgpr_read_b32 v46, a15
 v_mfma_f32_32x32x16_bf16 a[32:47], a[232:235], v[96:99], a[32:47]
 ds_read_b128 a[232:235], v53 offset:12288
 v_cvt_pk_bf16_f32 v73, v45, v46
 v_accvgpr_read_b32 v43, a20
 v_accvgpr_read_b32 v44, a21
 v_cvt_pk_bf16_f32 v74, v43, v44
 v_mfma_f32_32x32x16_bf16 a[32:47], a[236:239], v[100:103], a[32:47]
 ds_read_b128 a[236:239], v54 offset:12288
 s_waitcnt lgkmcnt(2)
 buffer_store_dwordx4 v[72:75], v7, s[16:19], s48 offen offset:512 sc1
 v_accvgpr_read_b32 v45, a16
 v_accvgpr_read_b32 v46, a17
 v_cvt_pk_bf16_f32 v76, v45, v46
 v_mfma_f32_32x32x16_bf16 a[48:63], a[224:227], v[232:235], a[48:63]
 ds_read_b128 a[224:227], v1 offset:36864
 v_accvgpr_read_b32 v43, a18
 v_accvgpr_read_b32 v44, a19
 v_cvt_pk_bf16_f32 v77, v43, v44
 v_accvgpr_read_b32 v45, a22
 v_accvgpr_read_b32 v46, a23
 v_cvt_pk_bf16_f32 v78, v45, v46
 v_mfma_f32_32x32x16_bf16 a[48:63], a[228:231], v[236:239], a[48:63]
 ds_read_b128 a[228:231], v2 offset:36864
 s_waitcnt lgkmcnt(2)
 buffer_store_dwordx4 v[76:79], v7, s[16:19], s48 offen offset:768 sc1
 v_accvgpr_read_b32 v43, a24
 v_accvgpr_read_b32 v44, a25
 v_mfma_f32_32x32x16_bf16 a[48:63], a[232:235], v[104:107], a[48:63]
 ds_read_b128 a[232:235], v53 offset:36864
 v_cvt_pk_bf16_f32 v56, v43, v44
 v_accvgpr_read_b32 v45, a26
 v_accvgpr_read_b32 v46, a27
 v_cvt_pk_bf16_f32 v57, v45, v46
 v_accvgpr_read_b32 v43, a32
 v_accvgpr_read_b32 v44, a33
 v_mfma_f32_32x32x16_bf16 a[48:63], a[236:239], v[108:111], a[48:63]
 ds_read_b128 a[236:239], v54 offset:36864
 s_waitcnt lgkmcnt(2)
 v_cvt_pk_bf16_f32 v58, v43, v44
 buffer_store_dwordx4 v[56:59], v7, s[16:19], s48 offen offset:1024 sc1
 v_accvgpr_read_b32 v45, a28
 v_mfma_f32_32x32x16_bf16 a[48:63], a[224:227], v[224:227], a[48:63]
 ds_read_b128 a[224:227], v1 offset:14336
 v_accvgpr_read_b32 v46, a29
 v_cvt_pk_bf16_f32 v60, v45, v46
 v_accvgpr_read_b32 v43, a30
 v_accvgpr_read_b32 v44, a31
 v_cvt_pk_bf16_f32 v61, v43, v44
 v_accvgpr_read_b32 v45, a34
 v_mfma_f32_32x32x16_bf16 a[48:63], a[228:231], v[228:231], a[48:63]
 ds_read_b128 a[228:231], v2 offset:14336
 s_waitcnt lgkmcnt(2)
 v_accvgpr_read_b32 v46, a35
 v_cvt_pk_bf16_f32 v62, v45, v46
 buffer_store_dwordx4 v[60:63], v7, s[16:19], s48 offen offset:1280 sc1
 v_mfma_f32_32x32x16_bf16 a[48:63], a[232:235], v[96:99], a[48:63]
 ds_read_b128 a[232:235], v53 offset:14336
 v_accvgpr_read_b32 v43, a36
 v_accvgpr_read_b32 v44, a37
 v_cvt_pk_bf16_f32 v64, v43, v44
 v_accvgpr_read_b32 v45, a38
 v_accvgpr_read_b32 v46, a39
 v_cvt_pk_bf16_f32 v65, v45, v46
 v_mfma_f32_32x32x16_bf16 a[48:63], a[236:239], v[100:103], a[48:63]
 ds_read_b128 a[236:239], v54 offset:14336
 s_waitcnt lgkmcnt(2)
 v_accvgpr_read_b32 v43, a44
 v_accvgpr_read_b32 v44, a45
 v_cvt_pk_bf16_f32 v66, v43, v44
 v_mfma_f32_32x32x16_bf16 a[64:79], a[224:227], v[232:235], a[64:79]
 ds_read_b128 a[224:227], v1 offset:38912
 buffer_store_dwordx4 v[64:67], v7, s[16:19], s48 offen offset:1536 sc1
 v_accvgpr_read_b32 v45, a40
 v_accvgpr_read_b32 v46, a41
 v_cvt_pk_bf16_f32 v68, v45, v46
 v_accvgpr_read_b32 v43, a42
 v_mfma_f32_32x32x16_bf16 a[64:79], a[228:231], v[236:239], a[64:79]
 ds_read_b128 a[228:231], v2 offset:38912
 s_waitcnt lgkmcnt(2)
 v_accvgpr_read_b32 v44, a43
 v_cvt_pk_bf16_f32 v69, v43, v44
 v_accvgpr_read_b32 v45, a46
 v_accvgpr_read_b32 v46, a47
 v_cvt_pk_bf16_f32 v70, v45, v46
 v_mfma_f32_32x32x16_bf16 a[64:79], a[232:235], v[104:107], a[64:79]
 ds_read_b128 a[232:235], v53 offset:38912
 v_mfma_f32_32x32x16_bf16 a[64:79], a[236:239], v[108:111], a[64:79]
 ds_read_b128 a[236:239], v54 offset:38912
 s_waitcnt lgkmcnt(2)
 buffer_store_dwordx4 v[68:71], v7, s[16:19], s48 offen offset:1792 sc1
 v_mfma_f32_32x32x16_bf16 a[64:79], a[224:227], v[224:227], a[64:79]
 ds_read_b128 a[224:227], v1 offset:16384
 buffer_store_dword v41, v36, s[16:19], s48 offen sc1
 v_accvgpr_read_b32 v43, a48
 v_accvgpr_read_b32 v44, a49
 v_cvt_pk_bf16_f32 v72, v43, v44
 v_accvgpr_read_b32 v45, a50
 v_mfma_f32_32x32x16_bf16 a[64:79], a[228:231], v[228:231], a[64:79]
 ds_read_b128 a[228:231], v2 offset:16384
 s_waitcnt lgkmcnt(2)
 v_accvgpr_read_b32 v46, a51
 v_cvt_pk_bf16_f32 v73, v45, v46
 v_accvgpr_read_b32 v43, a56
 v_accvgpr_read_b32 v44, a57
 v_cvt_pk_bf16_f32 v74, v43, v44
 v_mfma_f32_32x32x16_bf16 a[64:79], a[232:235], v[96:99], a[64:79]
 ds_read_b128 a[232:235], v53 offset:16384
 v_mfma_f32_32x32x16_bf16 a[64:79], a[236:239], v[100:103], a[64:79]
 ds_read_b128 a[236:239], v54 offset:16384
 s_waitcnt lgkmcnt(2)
 buffer_store_dwordx4 v[72:75], v7, s[16:19], s48 offen offset:2048 sc1
 v_accvgpr_read_b32 v45, a52
 v_accvgpr_read_b32 v46, a53
 v_mfma_f32_32x32x16_bf16 a[80:95], a[224:227], v[232:235], a[80:95]
 ds_read_b128 a[224:227], v1 offset:40960
 v_cvt_pk_bf16_f32 v76, v45, v46
 v_accvgpr_read_b32 v43, a54
 v_accvgpr_read_b32 v44, a55
 v_cvt_pk_bf16_f32 v77, v43, v44
 v_accvgpr_read_b32 v45, a58
 v_accvgpr_read_b32 v46, a59
 v_mfma_f32_32x32x16_bf16 a[80:95], a[228:231], v[236:239], a[80:95]
 ds_read_b128 a[228:231], v2 offset:40960
 s_waitcnt lgkmcnt(2)
 v_cvt_pk_bf16_f32 v78, v45, v46
 v_mfma_f32_32x32x16_bf16 a[80:95], a[232:235], v[104:107], a[80:95]
 ds_read_b128 a[232:235], v53 offset:40960
 v_mfma_f32_32x32x16_bf16 a[80:95], a[236:239], v[108:111], a[80:95]
 ds_read_b128 a[236:239], v54 offset:40960
 s_waitcnt lgkmcnt(2)
 buffer_store_dwordx4 v[76:79], v7, s[16:19], s48 offen offset:2304 sc1
 v_accvgpr_read_b32 v43, a60
 v_accvgpr_read_b32 v44, a61
 v_mfma_f32_32x32x16_bf16 a[80:95], a[224:227], v[224:227], a[80:95]
 s_waitcnt vmcnt(29)
 s_barrier
 v_add_u32 v1, -98304, v1
 v_add_u32 v2, -98304, v2
 v_add_u32 v53, -98304, v53
 v_add_u32 v54, -98304, v54
 ds_read_b128 a[224:227], v1 offset:0
 v_mfma_f32_32x32x16_bf16 a[80:95], a[228:231], v[228:231], a[80:95]
 ds_read_b128 a[228:231], v2 offset:0
 s_waitcnt lgkmcnt(2)
 v_cvt_pk_bf16_f32 v56, v43, v44
 v_accvgpr_read_b32 v45, a62
 v_accvgpr_read_b32 v46, a63
 v_cvt_pk_bf16_f32 v57, v45, v46
 v_accvgpr_read_b32 v43, a68
 v_mfma_f32_32x32x16_bf16 a[80:95], a[232:235], v[96:99], a[80:95]
 ds_read_b128 a[232:235], v53 offset:0
 v_accvgpr_read_b32 v44, a69
 v_cvt_pk_bf16_f32 v58, v43, v44
 v_mfma_f32_32x32x16_bf16 a[80:95], a[236:239], v[100:103], a[80:95]
 ds_read_b128 a[236:239], v54 offset:0
 s_waitcnt lgkmcnt(2)
 buffer_store_dwordx4 v[56:59], v7, s[16:19], s48 offen offset:2560 sc1
 v_accvgpr_read_b32 v45, a64
 v_accvgpr_read_b32 v46, a65
 v_mfma_f32_32x32x16_bf16 a[96:111], a[224:227], v[232:235], a[96:111]
 s_waitcnt vmcnt(24)
 s_barrier
 ds_read_b128 a[224:227], v1 offset:24576
 v_cvt_pk_bf16_f32 v60, v45, v46
 v_accvgpr_read_b32 v43, a66
 v_accvgpr_read_b32 v44, a67
 v_cvt_pk_bf16_f32 v61, v43, v44
 v_mfma_f32_32x32x16_bf16 a[96:111], a[228:231], v[236:239], a[96:111]
 ds_read_b128 a[228:231], v2 offset:24576
 s_add_u32 m0, s36, 98304
 s_add_u32 s38, s33, 442624
 buffer_load_dwordx4 v3, s[12:15], s38 offen offset:0 lds
 s_waitcnt lgkmcnt(2)
 v_mfma_f32_32x32x16_bf16 a[96:111], a[232:235], v[104:107], a[96:111]
 ds_read_b128 a[232:235], v53 offset:24576
 v_accvgpr_read_b32 v45, a70
 v_accvgpr_read_b32 v46, a71
 v_cvt_pk_bf16_f32 v62, v45, v46
 v_mfma_f32_32x32x16_bf16 a[96:111], a[236:239], v[108:111], a[96:111]
 ds_read_b128 a[236:239], v54 offset:24576
 s_waitcnt lgkmcnt(2)
 buffer_store_dwordx4 v[60:63], v7, s[16:19], s48 offen offset:2816 sc1
 v_accvgpr_read_b32 v43, a72
 v_accvgpr_read_b32 v44, a73
 v_cvt_pk_bf16_f32 v64, v43, v44
 v_mfma_f32_32x32x16_bf16 a[96:111], a[224:227], v[224:227], a[96:111]
 ds_read_b128 a[224:227], v1 offset:2048
 buffer_load_dwordx4 v4, s[12:15], s38 offen offset:1024 lds
 v_accvgpr_read_b32 v45, a74
 v_accvgpr_read_b32 v46, a75
 v_mfma_f32_32x32x16_bf16 a[96:111], a[228:231], v[228:231], a[96:111]
 ds_read_b128 a[228:231], v2 offset:2048
 s_waitcnt lgkmcnt(2)
 v_cvt_pk_bf16_f32 v65, v45, v46
 v_accvgpr_read_b32 v43, a80
 v_accvgpr_read_b32 v44, a81
 v_cvt_pk_bf16_f32 v66, v43, v44
 v_mfma_f32_32x32x16_bf16 a[96:111], a[232:235], v[96:99], a[96:111]
 ds_read_b128 a[232:235], v53 offset:2048
 buffer_store_dwordx4 v[64:67], v7, s[16:19], s48 offen offset:3072 sc1
 v_accvgpr_read_b32 v45, a76
 v_accvgpr_read_b32 v46, a77
 v_cvt_pk_bf16_f32 v68, v45, v46
 v_mfma_f32_32x32x16_bf16 a[96:111], a[236:239], v[100:103], a[96:111]
 ds_read_b128 a[236:239], v54 offset:2048
 buffer_load_dwordx4 v5, s[12:15], s38 offen offset:2048 lds
 s_waitcnt lgkmcnt(2)
 v_accvgpr_read_b32 v43, a78
 v_mfma_f32_32x32x16_bf16 a[112:127], a[224:227], v[232:235], a[112:127]
 ds_read_b128 a[224:227], v1 offset:26624
 v_accvgpr_read_b32 v44, a79
 v_cvt_pk_bf16_f32 v69, v43, v44
 v_accvgpr_read_b32 v45, a82
 v_accvgpr_read_b32 v46, a83
 v_cvt_pk_bf16_f32 v70, v45, v46
 v_mfma_f32_32x32x16_bf16 a[112:127], a[228:231], v[236:239], a[112:127]
 ds_read_b128 a[228:231], v2 offset:26624
 s_waitcnt lgkmcnt(2)
 v_mfma_f32_32x32x16_bf16 a[112:127], a[232:235], v[104:107], a[112:127]
 ds_read_b128 a[232:235], v53 offset:26624
 buffer_load_dwordx4 v6, s[12:15], s38 offen offset:3072 lds
 v_mfma_f32_32x32x16_bf16 a[112:127], a[236:239], v[108:111], a[112:127]
 ds_read_b128 a[236:239], v54 offset:26624
 s_waitcnt lgkmcnt(2)
 buffer_store_dwordx4 v[68:71], v7, s[16:19], s48 offen offset:3328 sc1
 v_accvgpr_read_b32 v43, a84
 v_accvgpr_read_b32 v44, a85
 v_cvt_pk_bf16_f32 v72, v43, v44
 v_mfma_f32_32x32x16_bf16 a[112:127], a[224:227], v[224:227], a[112:127]
 ds_read_b128 a[224:227], v1 offset:4096
 v_accvgpr_read_b32 v45, a86
 v_accvgpr_read_b32 v46, a87
 v_cvt_pk_bf16_f32 v73, v45, v46
 v_accvgpr_read_b32 v43, a92
 v_accvgpr_read_b32 v44, a93
 v_cvt_pk_bf16_f32 v74, v43, v44
 v_mfma_f32_32x32x16_bf16 a[112:127], a[228:231], v[228:231], a[112:127]
 ds_read_b128 a[228:231], v2 offset:4096
 s_add_u32 m0, s36, 102400
 s_add_u32 s38, s33, 516352
 buffer_load_dwordx4 v3, s[12:15], s38 offen offset:0 lds
 s_waitcnt lgkmcnt(2)
 v_mfma_f32_32x32x16_bf16 a[112:127], a[232:235], v[96:99], a[112:127]
 ds_read_b128 a[232:235], v53 offset:4096
 buffer_store_dwordx4 v[72:75], v7, s[16:19], s48 offen offset:3584 sc1
 v_accvgpr_read_b32 v45, a88
 v_accvgpr_read_b32 v46, a89
 v_cvt_pk_bf16_f32 v76, v45, v46
 v_mfma_f32_32x32x16_bf16 a[112:127], a[236:239], v[100:103], a[112:127]
 ds_read_b128 a[236:239], v54 offset:4096
 s_waitcnt lgkmcnt(2)
 v_accvgpr_read_b32 v43, a90
 v_accvgpr_read_b32 v44, a91
 v_cvt_pk_bf16_f32 v77, v43, v44
 v_accvgpr_read_b32 v45, a94
 v_accvgpr_read_b32 v46, a95
 v_mfma_f32_32x32x16_bf16 a[128:143], a[224:227], v[232:235], a[128:143]
 ds_read_b128 a[224:227], v1 offset:28672
 buffer_load_dwordx4 v4, s[12:15], s38 offen offset:1024 lds
 v_cvt_pk_bf16_f32 v78, v45, v46
 v_mfma_f32_32x32x16_bf16 a[128:143], a[228:231], v[236:239], a[128:143]
 ds_read_b128 a[228:231], v2 offset:28672
 s_add_u32 m0, s36, 122880
 s_add_u32 s38, s33, 442624
 buffer_load_dwordx4 v3, s[52:55], s38 offen offset:0 lds
 s_waitcnt lgkmcnt(2)
 v_mfma_f32_32x32x16_bf16 a[128:143], a[232:235], v[104:107], a[128:143]
 ds_read_b128 a[232:235], v53 offset:28672
 buffer_load_dwordx4 v4, s[52:55], s38 offen offset:1024 lds
 v_mfma_f32_32x32x16_bf16 a[128:143], a[236:239], v[108:111], a[128:143]
 ds_read_b128 a[236:239], v54 offset:28672
 buffer_load_dwordx4 v5, s[52:55], s38 offen offset:2048 lds
 s_waitcnt lgkmcnt(2)
 v_mfma_f32_32x32x16_bf16 a[128:143], a[224:227], v[224:227], a[128:143]
 ds_read_b128 a[224:227], v1 offset:12288
 buffer_store_dwordx4 v[76:79], v7, s[16:19], s48 offen offset:3840 sc1
 buffer_store_dword v42, v36, s[16:19], s48 offen sc1
 s_add_u32 s48, s48, 418816
 v_mfma_f32_32x32x16_bf16 a[128:143], a[228:231], v[228:231], a[128:143]
 ds_read_b128 a[228:231], v2 offset:12288
 s_waitcnt lgkmcnt(2)
 v_accvgpr_read_b32 v43, a96
 v_accvgpr_read_b32 v44, a97
 v_cvt_pk_bf16_f32 v56, v43, v44
 v_accvgpr_read_b32 v45, a98
 v_accvgpr_read_b32 v46, a99
 v_mfma_f32_32x32x16_bf16 a[128:143], a[232:235], v[96:99], a[128:143]
 ds_read_b128 a[232:235], v53 offset:12288
 buffer_load_dwordx4 v6, s[52:55], s38 offen offset:3072 lds
 v_cvt_pk_bf16_f32 v57, v45, v46
 v_accvgpr_read_b32 v43, a104
 v_mfma_f32_32x32x16_bf16 a[128:143], a[236:239], v[100:103], a[128:143]
 ds_read_b128 a[236:239], v54 offset:12288
 s_waitcnt lgkmcnt(2)
 v_accvgpr_read_b32 v44, a105
 v_cvt_pk_bf16_f32 v58, v43, v44
 buffer_store_dwordx4 v[56:59], v7, s[16:19], s48 offen offset:0 sc1
 v_mfma_f32_32x32x16_bf16 a[144:159], a[224:227], v[232:235], a[144:159]
 ds_read_b128 a[224:227], v1 offset:36864
 v_accvgpr_read_b32 v45, a100
 v_accvgpr_read_b32 v46, a101
 v_cvt_pk_bf16_f32 v60, v45, v46
 v_accvgpr_read_b32 v43, a102
 v_accvgpr_read_b32 v44, a103
 v_cvt_pk_bf16_f32 v61, v43, v44
 v_mfma_f32_32x32x16_bf16 a[144:159], a[228:231], v[236:239], a[144:159]
 ds_read_b128 a[228:231], v2 offset:36864
 s_add_u32 m0, s36, 126976
 s_add_u32 s38, s33, 516352
 buffer_load_dwordx4 v3, s[52:55], s38 offen offset:0 lds
 s_waitcnt lgkmcnt(2)
 v_mfma_f32_32x32x16_bf16 a[144:159], a[232:235], v[104:107], a[144:159]
 ds_read_b128 a[232:235], v53 offset:36864
 v_accvgpr_read_b32 v45, a106
 v_accvgpr_read_b32 v46, a107
 v_cvt_pk_bf16_f32 v62, v45, v46
 v_mfma_f32_32x32x16_bf16 a[144:159], a[236:239], v[108:111], a[144:159]
 ds_read_b128 a[236:239], v54 offset:36864
 s_waitcnt lgkmcnt(2)
 buffer_store_dwordx4 v[60:63], v7, s[16:19], s48 offen offset:256 sc1
 v_accvgpr_read_b32 v43, a108
 v_accvgpr_read_b32 v44, a109
 v_cvt_pk_bf16_f32 v64, v43, v44
 v_mfma_f32_32x32x16_bf16 a[144:159], a[224:227], v[224:227], a[144:159]
 ds_read_b128 a[224:227], v1 offset:14336
 buffer_load_dwordx4 v4, s[52:55], s38 offen offset:1024 lds
 v_accvgpr_read_b32 v45, a110
 v_accvgpr_read_b32 v46, a111
 v_mfma_f32_32x32x16_bf16 a[144:159], a[228:231], v[228:231], a[144:159]
 ds_read_b128 a[228:231], v2 offset:14336
 s_waitcnt lgkmcnt(2)
 v_cvt_pk_bf16_f32 v65, v45, v46
 v_accvgpr_read_b32 v43, a116
 v_accvgpr_read_b32 v44, a117
 v_cvt_pk_bf16_f32 v66, v43, v44
 v_mfma_f32_32x32x16_bf16 a[144:159], a[232:235], v[96:99], a[144:159]
 ds_read_b128 a[232:235], v53 offset:14336
 buffer_store_dwordx4 v[64:67], v7, s[16:19], s48 offen offset:512 sc1
 v_accvgpr_read_b32 v45, a112
 v_accvgpr_read_b32 v46, a113
 v_cvt_pk_bf16_f32 v68, v45, v46
 v_accvgpr_read_b32 v43, a114
 v_mfma_f32_32x32x16_bf16 a[144:159], a[236:239], v[100:103], a[144:159]
 ds_read_b128 a[236:239], v54 offset:14336
 s_waitcnt lgkmcnt(2)
 v_accvgpr_read_b32 v44, a115
 v_cvt_pk_bf16_f32 v69, v43, v44
 v_accvgpr_read_b32 v45, a118
 v_accvgpr_read_b32 v46, a119
 v_cvt_pk_bf16_f32 v70, v45, v46
 v_mfma_f32_32x32x16_bf16 a[160:175], a[224:227], v[232:235], a[160:175]
 ds_read_b128 a[224:227], v1 offset:38912
 v_mfma_f32_32x32x16_bf16 a[160:175], a[228:231], v[236:239], a[160:175]
 ds_read_b128 a[228:231], v2 offset:38912
 s_waitcnt lgkmcnt(2)
 buffer_store_dwordx4 v[68:71], v7, s[16:19], s48 offen offset:768 sc1
 v_accvgpr_read_b32 v43, a120
 v_accvgpr_read_b32 v44, a121
 v_mfma_f32_32x32x16_bf16 a[160:175], a[232:235], v[104:107], a[160:175]
 ds_read_b128 a[232:235], v53 offset:38912
 v_cvt_pk_bf16_f32 v72, v43, v44
 v_accvgpr_read_b32 v45, a122
 v_accvgpr_read_b32 v46, a123
 v_cvt_pk_bf16_f32 v73, v45, v46
 v_accvgpr_read_b32 v43, a128
 v_accvgpr_read_b32 v44, a129
 v_mfma_f32_32x32x16_bf16 a[160:175], a[236:239], v[108:111], a[160:175]
 ds_read_b128 a[236:239], v54 offset:38912
 s_waitcnt lgkmcnt(2)
 v_cvt_pk_bf16_f32 v74, v43, v44
 v_mfma_f32_32x32x16_bf16 a[160:175], a[224:227], v[224:227], a[160:175]
 ds_read_b128 a[224:227], v1 offset:16384
 v_mfma_f32_32x32x16_bf16 a[160:175], a[228:231], v[228:231], a[160:175]
 ds_read_b128 a[228:231], v2 offset:16384
 s_waitcnt lgkmcnt(2)
 buffer_store_dwordx4 v[72:75], v7, s[16:19], s48 offen offset:1024 sc1
 v_accvgpr_read_b32 v45, a124
 v_accvgpr_read_b32 v46, a125
 v_mfma_f32_32x32x16_bf16 a[160:175], a[232:235], v[96:99], a[160:175]
 ds_read_b128 a[232:235], v53 offset:16384
 v_cvt_pk_bf16_f32 v76, v45, v46
 v_accvgpr_read_b32 v43, a126
 v_accvgpr_read_b32 v44, a127
 v_cvt_pk_bf16_f32 v77, v43, v44
 v_accvgpr_read_b32 v45, a130
 v_accvgpr_read_b32 v46, a131
 v_mfma_f32_32x32x16_bf16 a[160:175], a[236:239], v[100:103], a[160:175]
 ds_read_b128 a[236:239], v54 offset:16384
 s_waitcnt lgkmcnt(2)
 v_cvt_pk_bf16_f32 v78, v45, v46
 v_mfma_f32_32x32x16_bf16 a[176:191], a[224:227], v[232:235], a[176:191]
 ds_read_b128 a[224:227], v1 offset:40960
 buffer_store_dwordx4 v[76:79], v7, s[16:19], s48 offen offset:1280 sc1
 v_accvgpr_read_b32 v43, a132
 v_accvgpr_read_b32 v44, a133
 v_cvt_pk_bf16_f32 v56, v43, v44
 v_mfma_f32_32x32x16_bf16 a[176:191], a[228:231], v[236:239], a[176:191]
 ds_read_b128 a[228:231], v2 offset:40960
 s_waitcnt lgkmcnt(2)
 v_accvgpr_read_b32 v45, a134
 v_accvgpr_read_b32 v46, a135
 v_cvt_pk_bf16_f32 v57, v45, v46
 v_accvgpr_read_b32 v43, a140
 v_accvgpr_read_b32 v44, a141
 v_mfma_f32_32x32x16_bf16 a[176:191], a[232:235], v[104:107], a[176:191]
 ds_read_b128 a[232:235], v53 offset:40960
 v_cvt_pk_bf16_f32 v58, v43, v44
 v_mfma_f32_32x32x16_bf16 a[176:191], a[236:239], v[108:111], a[176:191]
 ds_read_b128 a[236:239], v54 offset:40960
 s_waitcnt lgkmcnt(2)
 v_mfma_f32_32x32x16_bf16 a[176:191], a[224:227], v[224:227], a[176:191]
 s_waitcnt vmcnt(42)
 s_barrier
 v_add_u32 v1, 49152, v1
 v_add_u32 v2, 49152, v2
 v_add_u32 v53, 49152, v53
 v_add_u32 v54, 49152, v54
 ds_read_b128 a[224:227], v1 offset:0
 v_mfma_f32_32x32x16_bf16 a[176:191], a[228:231], v[228:231], a[176:191]
 ds_read_b128 a[228:231], v2 offset:0
 s_waitcnt lgkmcnt(2)
 buffer_store_dwordx4 v[56:59], v7, s[16:19], s48 offen offset:1536 sc1
 v_accvgpr_read_b32 v45, a136
 v_accvgpr_read_b32 v46, a137
 v_mfma_f32_32x32x16_bf16 a[176:191], a[232:235], v[96:99], a[176:191]
 ds_read_b128 a[232:235], v53 offset:0
 v_cvt_pk_bf16_f32 v60, v45, v46
 v_accvgpr_read_b32 v43, a138
 v_accvgpr_read_b32 v44, a139
 v_cvt_pk_bf16_f32 v61, v43, v44
 v_accvgpr_read_b32 v45, a142
 v_accvgpr_read_b32 v46, a143
 v_mfma_f32_32x32x16_bf16 a[176:191], a[236:239], v[100:103], a[176:191]
 ds_read_b128 a[236:239], v54 offset:0
 s_waitcnt lgkmcnt(2)
 v_cvt_pk_bf16_f32 v62, v45, v46
 v_mfma_f32_32x32x16_bf16 a[192:207], a[224:227], v[168:171], a[192:207]
 s_waitcnt vmcnt(36)
 s_barrier
 v_add_u32 v24, 49152, v1
 v_add_u32 v25, 49152, v2
 v_add_u32 v26, 49152, v53
 v_add_u32 v27, 49152, v54
 ds_read_b128 a[224:227], v1 offset:24576
 v_mfma_f32_32x32x16_bf16 a[192:207], a[228:231], v[172:175], a[192:207]
 ds_read_b128 a[228:231], v2 offset:24576
 s_waitcnt lgkmcnt(2)
 buffer_store_dwordx4 v[60:63], v7, s[16:19], s48 offen offset:1792 sc1
 v_mfma_f32_32x32x16_bf16 a[192:207], a[232:235], v[200:203], a[192:207]
 ds_read_b128 a[232:235], v53 offset:24576
 buffer_store_dword v41, v36, s[16:19], s48 offen sc1
 v_accvgpr_read_b32 v43, a144
 v_accvgpr_read_b32 v44, a145
 v_cvt_pk_bf16_f32 v64, v43, v44
 v_accvgpr_read_b32 v45, a146
 v_mfma_f32_32x32x16_bf16 a[192:207], a[236:239], v[204:207], a[192:207]
 ds_read_b128 a[236:239], v54 offset:24576
 s_waitcnt lgkmcnt(2)
 v_accvgpr_read_b32 v46, a147
 v_cvt_pk_bf16_f32 v65, v45, v46
 v_accvgpr_read_b32 v43, a152
 v_accvgpr_read_b32 v44, a153
 v_cvt_pk_bf16_f32 v66, v43, v44
 v_mfma_f32_32x32x16_bf16 a[192:207], a[224:227], v[160:163], a[192:207]
 s_waitcnt vmcnt(17)
 s_barrier
 ds_read_b128 a[224:227], v24 offset:0
 buffer_store_dwordx4 v[64:67], v7, s[16:19], s48 offen offset:2048 sc1
 v_accvgpr_read_b32 v45, a148
 v_mfma_f32_32x32x16_bf16 a[192:207], a[228:231], v[164:167], a[192:207]
 ds_read_b128 a[228:231], v25 offset:0
 s_waitcnt lgkmcnt(2)
 v_accvgpr_read_b32 v46, a149
 v_cvt_pk_bf16_f32 v68, v45, v46
 v_accvgpr_read_b32 v43, a150
 v_accvgpr_read_b32 v44, a151
 v_cvt_pk_bf16_f32 v69, v43, v44
 v_mfma_f32_32x32x16_bf16 a[192:207], a[232:235], v[192:195], a[192:207]
 ds_read_b128 a[232:235], v26 offset:0
 v_accvgpr_read_b32 v45, a154
 v_accvgpr_read_b32 v46, a155
 v_cvt_pk_bf16_f32 v70, v45, v46
 v_mfma_f32_32x32x16_bf16 a[192:207], a[236:239], v[196:199], a[192:207]
 ds_read_b128 a[236:239], v27 offset:0
 s_waitcnt lgkmcnt(2)
 v_mfma_f32_32x32x16_bf16 a[192:207], a[224:227], v[232:235], a[192:207]
 s_waitcnt vmcnt(8)
 s_barrier
 ds_read_b128 a[224:227], v24 offset:24576
 buffer_store_dwordx4 v[68:71], v7, s[16:19], s48 offen offset:2304 sc1
 v_accvgpr_read_b32 v43, a156
 v_mfma_f32_32x32x16_bf16 a[192:207], a[228:231], v[236:239], a[192:207]
 ds_read_b128 a[228:231], v25 offset:24576
 s_waitcnt lgkmcnt(2)
 v_accvgpr_read_b32 v44, a157
 v_cvt_pk_bf16_f32 v72, v43, v44
 v_accvgpr_read_b32 v45, a158
 v_accvgpr_read_b32 v46, a159
 v_cvt_pk_bf16_f32 v73, v45, v46
 v_mfma_f32_32x32x16_bf16 a[192:207], a[232:235], v[104:107], a[192:207]
 ds_read_b128 a[232:235], v26 offset:24576
 v_accvgpr_read_b32 v43, a164
 v_accvgpr_read_b32 v44, a165
 v_cvt_pk_bf16_f32 v74, v43, v44
 v_mfma_f32_32x32x16_bf16 a[192:207], a[236:239], v[108:111], a[192:207]
 ds_read_b128 a[236:239], v27 offset:24576
 s_waitcnt lgkmcnt(2)
 buffer_store_dwordx4 v[72:75], v7, s[16:19], s48 offen offset:2560 sc1
 v_accvgpr_read_b32 v45, a160
 v_accvgpr_read_b32 v46, a161
 v_mfma_f32_32x32x16_bf16 a[192:207], a[224:227], v[224:227], a[192:207]
 ds_read_b128 a[224:227], v1 offset:2048
 v_cvt_pk_bf16_f32 v76, v45, v46
 v_accvgpr_read_b32 v43, a162
 v_accvgpr_read_b32 v44, a163
 v_cvt_pk_bf16_f32 v77, v43, v44
 v_accvgpr_read_b32 v45, a166
 v_accvgpr_read_b32 v46, a167
 v_mfma_f32_32x32x16_bf16 a[192:207], a[228:231], v[228:231], a[192:207]
 ds_read_b128 a[228:231], v2 offset:2048
 s_waitcnt lgkmcnt(2)
 v_cvt_pk_bf16_f32 v78, v45, v46
 v_mfma_f32_32x32x16_bf16 a[192:207], a[232:235], v[96:99], a[192:207]
 ds_read_b128 a[232:235], v53 offset:2048
 v_mfma_f32_32x32x16_bf16 a[192:207], a[236:239], v[100:103], a[192:207]
 ds_read_b128 a[236:239], v54 offset:2048
 s_waitcnt lgkmcnt(2)
 buffer_store_dwordx4 v[76:79], v7, s[16:19], s48 offen offset:2816 sc1
 v_accvgpr_read_b32 v43, a168
 v_accvgpr_read_b32 v44, a169
 v_mfma_f32_32x32x16_bf16 a[208:223], a[224:227], v[168:171], a[208:223]
 ds_read_b128 a[224:227], v1 offset:26624
 v_cvt_pk_bf16_f32 v56, v43, v44
 v_accvgpr_read_b32 v45, a170
 v_accvgpr_read_b32 v46, a171
 v_cvt_pk_bf16_f32 v57, v45, v46
 v_accvgpr_read_b32 v43, a176
 v_accvgpr_read_b32 v44, a177
 v_mfma_f32_32x32x16_bf16 a[208:223], a[228:231], v[172:175], a[208:223]
 ds_read_b128 a[228:231], v2 offset:26624
 s_waitcnt lgkmcnt(2)
 v_cvt_pk_bf16_f32 v58, v43, v44
 v_mfma_f32_32x32x16_bf16 a[208:223], a[232:235], v[200:203], a[208:223]
 ds_read_b128 a[232:235], v53 offset:26624
 v_mfma_f32_32x32x16_bf16 a[208:223], a[236:239], v[204:207], a[208:223]
 ds_read_b128 a[236:239], v54 offset:26624
 s_waitcnt lgkmcnt(2)
 buffer_store_dwordx4 v[56:59], v7, s[16:19], s48 offen offset:3072 sc1
 v_accvgpr_read_b32 v45, a172
 v_accvgpr_read_b32 v46, a173
 v_mfma_f32_32x32x16_bf16 a[208:223], a[224:227], v[160:163], a[208:223]
 ds_read_b128 a[224:227], v24 offset:2048
 v_cvt_pk_bf16_f32 v60, v45, v46
 v_accvgpr_read_b32 v43, a174
 v_accvgpr_read_b32 v44, a175
 v_cvt_pk_bf16_f32 v61, v43, v44
 v_accvgpr_read_b32 v45, a178
 v_accvgpr_read_b32 v46, a179
 v_mfma_f32_32x32x16_bf16 a[208:223], a[228:231], v[164:167], a[208:223]
 ds_read_b128 a[228:231], v25 offset:2048
 s_waitcnt lgkmcnt(2)
 v_cvt_pk_bf16_f32 v62, v45, v46
 v_mfma_f32_32x32x16_bf16 a[208:223], a[232:235], v[192:195], a[208:223]
 ds_read_b128 a[232:235], v26 offset:2048
 v_mfma_f32_32x32x16_bf16 a[208:223], a[236:239], v[196:199], a[208:223]
 ds_read_b128 a[236:239], v27 offset:2048
 s_waitcnt lgkmcnt(2)
 buffer_store_dwordx4 v[60:63], v7, s[16:19], s48 offen offset:3328 sc1
 v_accvgpr_read_b32 v43, a180
 v_accvgpr_read_b32 v44, a181
 v_mfma_f32_32x32x16_bf16 a[208:223], a[224:227], v[232:235], a[208:223]
 ds_read_b128 a[224:227], v24 offset:26624
 v_cvt_pk_bf16_f32 v64, v43, v44
 v_accvgpr_read_b32 v45, a182
 v_accvgpr_read_b32 v46, a183
 v_cvt_pk_bf16_f32 v65, v45, v46
 v_accvgpr_read_b32 v43, a188
 v_accvgpr_read_b32 v44, a189
 v_mfma_f32_32x32x16_bf16 a[208:223], a[228:231], v[236:239], a[208:223]
 ds_read_b128 a[228:231], v25 offset:26624
 s_waitcnt lgkmcnt(2)
 v_cvt_pk_bf16_f32 v66, v43, v44
 v_mfma_f32_32x32x16_bf16 a[208:223], a[232:235], v[104:107], a[208:223]
 ds_read_b128 a[232:235], v26 offset:26624
 v_mfma_f32_32x32x16_bf16 a[208:223], a[236:239], v[108:111], a[208:223]
 ds_read_b128 a[236:239], v27 offset:26624
 s_waitcnt lgkmcnt(2)
 buffer_store_dwordx4 v[64:67], v7, s[16:19], s48 offen offset:3584 sc1
 v_accvgpr_read_b32 v45, a184
 v_accvgpr_read_b32 v46, a185
 v_mfma_f32_32x32x16_bf16 a[208:223], a[224:227], v[224:227], a[208:223]
 ds_read_b128 a[224:227], v1 offset:4096
 v_cvt_pk_bf16_f32 v68, v45, v46
 v_accvgpr_read_b32 v43, a186
 v_accvgpr_read_b32 v44, a187
 v_cvt_pk_bf16_f32 v69, v43, v44
 v_accvgpr_read_b32 v45, a190
 v_accvgpr_read_b32 v46, a191
 v_mfma_f32_32x32x16_bf16 a[208:223], a[228:231], v[228:231], a[208:223]
 ds_read_b128 a[228:231], v2 offset:4096
 s_waitcnt lgkmcnt(2)
 v_cvt_pk_bf16_f32 v70, v45, v46
 v_mfma_f32_32x32x16_bf16 a[208:223], a[232:235], v[96:99], a[208:223]
 ds_read_b128 a[232:235], v53 offset:4096
 buffer_store_dwordx4 v[68:71], v7, s[16:19], s48 offen offset:3840 sc1
 buffer_store_dword v42, v36, s[16:19], s48 offen sc1
 v_mfma_f32_32x32x16_bf16 a[208:223], a[236:239], v[100:103], a[208:223]
 ds_read_b128 a[236:239], v54 offset:4096
 s_waitcnt lgkmcnt(2)
 s_add_u32 s48, s48, 418816
 v_accvgpr_read_b32 v43, a192
 v_accvgpr_read_b32 v44, a193
 v_cvt_pk_bf16_f32 v72, v43, v44
 v_accvgpr_read_b32 v45, a194
 v_mfma_f32_32x32x16_bf16 v[144:159], a[224:227], v[168:171], v[144:159]
 ds_read_b128 a[224:227], v1 offset:28672
 v_accvgpr_read_b32 v46, a195
 v_cvt_pk_bf16_f32 v73, v45, v46
 v_accvgpr_read_b32 v43, a200
 v_accvgpr_read_b32 v44, a201
 v_cvt_pk_bf16_f32 v74, v43, v44
 v_mfma_f32_32x32x16_bf16 v[144:159], a[228:231], v[172:175], v[144:159]
 ds_read_b128 a[228:231], v2 offset:28672
 s_waitcnt lgkmcnt(2)
 v_mfma_f32_32x32x16_bf16 v[144:159], a[232:235], v[200:203], v[144:159]
 ds_read_b128 a[232:235], v53 offset:28672
 buffer_store_dwordx4 v[72:75], v7, s[16:19], s48 offen offset:0 sc1
 v_accvgpr_read_b32 v45, a196
 v_accvgpr_read_b32 v46, a197
 v_cvt_pk_bf16_f32 v76, v45, v46
 v_mfma_f32_32x32x16_bf16 v[144:159], a[236:239], v[204:207], v[144:159]
 ds_read_b128 a[236:239], v54 offset:28672
 s_waitcnt lgkmcnt(2)
 v_accvgpr_read_b32 v43, a198
 v_accvgpr_read_b32 v44, a199
 v_cvt_pk_bf16_f32 v77, v43, v44
 v_accvgpr_read_b32 v45, a202
 v_accvgpr_read_b32 v46, a203
 v_mfma_f32_32x32x16_bf16 v[144:159], a[224:227], v[160:163], v[144:159]
 ds_read_b128 a[224:227], v24 offset:4096
 v_cvt_pk_bf16_f32 v78, v45, v46
 v_mfma_f32_32x32x16_bf16 v[144:159], a[228:231], v[164:167], v[144:159]
 ds_read_b128 a[228:231], v25 offset:4096
 s_waitcnt lgkmcnt(2)
 v_mfma_f32_32x32x16_bf16 v[144:159], a[232:235], v[192:195], v[144:159]
 ds_read_b128 a[232:235], v26 offset:4096
 buffer_store_dwordx4 v[76:79], v7, s[16:19], s48 offen offset:256 sc1
 v_accvgpr_read_b32 v43, a204
 v_accvgpr_read_b32 v44, a205
 v_cvt_pk_bf16_f32 v56, v43, v44
 v_mfma_f32_32x32x16_bf16 v[144:159], a[236:239], v[196:199], v[144:159]
 ds_read_b128 a[236:239], v27 offset:4096
 s_waitcnt lgkmcnt(2)
 v_accvgpr_read_b32 v45, a206
 v_accvgpr_read_b32 v46, a207
 v_cvt_pk_bf16_f32 v57, v45, v46
 v_accvgpr_read_b32 v43, a212
 v_accvgpr_read_b32 v44, a213
 v_mfma_f32_32x32x16_bf16 v[144:159], a[224:227], v[232:235], v[144:159]
 ds_read_b128 a[224:227], v24 offset:28672
 v_cvt_pk_bf16_f32 v58, v43, v44
 v_mfma_f32_32x32x16_bf16 v[144:159], a[228:231], v[236:239], v[144:159]
 ds_read_b128 a[228:231], v25 offset:28672
 s_waitcnt lgkmcnt(2)
 v_mfma_f32_32x32x16_bf16 v[144:159], a[232:235], v[104:107], v[144:159]
 ds_read_b128 a[232:235], v26 offset:28672
 buffer_store_dwordx4 v[56:59], v7, s[16:19], s48 offen offset:512 sc1
 v_accvgpr_read_b32 v45, a208
 v_accvgpr_read_b32 v46, a209
 v_cvt_pk_bf16_f32 v60, v45, v46
 v_mfma_f32_32x32x16_bf16 v[144:159], a[236:239], v[108:111], v[144:159]
 ds_read_b128 a[236:239], v27 offset:28672
 s_waitcnt lgkmcnt(2)
 v_accvgpr_read_b32 v43, a210
 v_accvgpr_read_b32 v44, a211
 v_cvt_pk_bf16_f32 v61, v43, v44
 v_accvgpr_read_b32 v45, a214
 v_accvgpr_read_b32 v46, a215
 v_mfma_f32_32x32x16_bf16 v[144:159], a[224:227], v[224:227], v[144:159]
 ds_read_b128 a[224:227], v1 offset:12288
 v_cvt_pk_bf16_f32 v62, v45, v46
 v_mfma_f32_32x32x16_bf16 v[144:159], a[228:231], v[228:231], v[144:159]
 ds_read_b128 a[228:231], v2 offset:12288
 s_waitcnt lgkmcnt(2)
 v_mfma_f32_32x32x16_bf16 v[144:159], a[232:235], v[96:99], v[144:159]
 ds_read_b128 a[232:235], v53 offset:12288
 buffer_store_dwordx4 v[60:63], v7, s[16:19], s48 offen offset:768 sc1
 v_accvgpr_read_b32 v43, a216
 v_accvgpr_read_b32 v44, a217
 v_cvt_pk_bf16_f32 v64, v43, v44
 v_mfma_f32_32x32x16_bf16 v[144:159], a[236:239], v[100:103], v[144:159]
 ds_read_b128 a[236:239], v54 offset:12288
 s_waitcnt lgkmcnt(2)
 v_accvgpr_read_b32 v45, a218
 v_accvgpr_read_b32 v46, a219
 v_cvt_pk_bf16_f32 v65, v45, v46
 v_mfma_f32_32x32x16_bf16 v[80:95], a[224:227], v[168:171], v[80:95]
 ds_read_b128 a[224:227], v1 offset:36864
 v_mfma_f32_32x32x16_bf16 v[80:95], a[228:231], v[172:175], v[80:95]
 ds_read_b128 a[228:231], v2 offset:36864
 s_waitcnt lgkmcnt(2)
 s_nop 1
 v_cvt_pk_bf16_f32 v66, v144, v145
 buffer_store_dwordx4 v[64:67], v7, s[16:19], s48 offen offset:1024 sc1
 v_accvgpr_read_b32 v43, a220
 v_mfma_f32_32x32x16_bf16 v[80:95], a[232:235], v[200:203], v[80:95]
 ds_read_b128 a[232:235], v53 offset:36864
 v_accvgpr_read_b32 v44, a221
 v_cvt_pk_bf16_f32 v68, v43, v44
 v_accvgpr_read_b32 v45, a222
 v_accvgpr_read_b32 v46, a223
 v_cvt_pk_bf16_f32 v69, v45, v46
 v_cvt_pk_bf16_f32 v70, v146, v147
 v_mfma_f32_32x32x16_bf16 v[80:95], a[236:239], v[204:207], v[80:95]
 ds_read_b128 a[236:239], v54 offset:36864
 s_waitcnt lgkmcnt(2)
 v_mfma_f32_32x32x16_bf16 v[80:95], a[224:227], v[160:163], v[80:95]
 ds_read_b128 a[224:227], v24 offset:12288
 v_mfma_f32_32x32x16_bf16 v[80:95], a[228:231], v[164:167], v[80:95]
 ds_read_b128 a[228:231], v25 offset:12288
 s_waitcnt lgkmcnt(2)
 buffer_store_dwordx4 v[68:71], v7, s[16:19], s48 offen offset:1280 sc1
 v_cvt_pk_bf16_f32 v72, v148, v149
 v_cvt_pk_bf16_f32 v73, v150, v151
 v_mfma_f32_32x32x16_bf16 v[80:95], a[232:235], v[192:195], v[80:95]
 ds_read_b128 a[232:235], v26 offset:12288
 v_cvt_pk_bf16_f32 v74, v156, v157
 v_mfma_f32_32x32x16_bf16 v[80:95], a[236:239], v[196:199], v[80:95]
 ds_read_b128 a[236:239], v27 offset:12288
 s_waitcnt lgkmcnt(2)
 v_mfma_f32_32x32x16_bf16 v[80:95], a[224:227], v[232:235], v[80:95]
 ds_read_b128 a[224:227], v24 offset:36864
 v_mfma_f32_32x32x16_bf16 v[80:95], a[228:231], v[236:239], v[80:95]
 ds_read_b128 a[228:231], v25 offset:36864
 s_waitcnt lgkmcnt(2)
 buffer_store_dwordx4 v[72:75], v7, s[16:19], s48 offen offset:1536 sc1
 v_cvt_pk_bf16_f32 v76, v152, v153
 v_cvt_pk_bf16_f32 v77, v154, v155
 v_mfma_f32_32x32x16_bf16 v[80:95], a[232:235], v[104:107], v[80:95]
 ds_read_b128 a[232:235], v26 offset:36864
 v_cvt_pk_bf16_f32 v78, v158, v159
 v_mfma_f32_32x32x16_bf16 v[80:95], a[236:239], v[108:111], v[80:95]
 ds_read_b128 a[236:239], v27 offset:36864
 s_waitcnt lgkmcnt(2)
 v_mfma_f32_32x32x16_bf16 v[80:95], a[224:227], v[224:227], v[80:95]
 ds_read_b128 a[224:227], v1 offset:14336
 v_mfma_f32_32x32x16_bf16 v[80:95], a[228:231], v[228:231], v[80:95]
 ds_read_b128 a[228:231], v2 offset:14336
 s_waitcnt lgkmcnt(2)
 buffer_store_dwordx4 v[76:79], v7, s[16:19], s48 offen offset:1792 sc1
 v_mfma_f32_32x32x16_bf16 v[80:95], a[232:235], v[96:99], v[80:95]
 ds_read_b128 a[232:235], v53 offset:14336
 buffer_store_dword v41, v36, s[16:19], s48 offen sc1
 v_mfma_f32_32x32x16_bf16 v[80:95], a[236:239], v[100:103], v[80:95]
 ds_read_b128 a[236:239], v54 offset:14336
 s_waitcnt lgkmcnt(2)
 v_mfma_f32_32x32x16_bf16 v[176:191], a[224:227], v[168:171], v[176:191]
 ds_read_b128 a[224:227], v1 offset:38912
 v_mfma_f32_32x32x16_bf16 v[176:191], a[228:231], v[172:175], v[176:191]
 ds_read_b128 a[228:231], v2 offset:38912
 s_waitcnt lgkmcnt(2)
 s_nop 4
 v_cvt_pk_bf16_f32 v56, v80, v81
 v_cvt_pk_bf16_f32 v57, v82, v83
 v_cvt_pk_bf16_f32 v58, v88, v89
 v_mfma_f32_32x32x16_bf16 v[176:191], a[232:235], v[200:203], v[176:191]
 ds_read_b128 a[232:235], v53 offset:38912
 buffer_store_dwordx4 v[56:59], v7, s[16:19], s48 offen offset:2048 sc1
 v_cvt_pk_bf16_f32 v60, v84, v85
 v_cvt_pk_bf16_f32 v61, v86, v87
 v_cvt_pk_bf16_f32 v62, v90, v91
 v_mfma_f32_32x32x16_bf16 v[176:191], a[236:239], v[204:207], v[176:191]
 ds_read_b128 a[236:239], v54 offset:38912
 s_waitcnt lgkmcnt(2)
 v_mfma_f32_32x32x16_bf16 v[176:191], a[224:227], v[160:163], v[176:191]
 ds_read_b128 a[224:227], v24 offset:14336
 buffer_store_dwordx4 v[60:63], v7, s[16:19], s48 offen offset:2304 sc1
 v_cvt_pk_bf16_f32 v64, v92, v93
 v_cvt_pk_bf16_f32 v65, v94, v95
 v_mfma_f32_32x32x16_bf16 v[176:191], a[228:231], v[164:167], v[176:191]
 ds_read_b128 a[228:231], v25 offset:14336
 s_waitcnt lgkmcnt(2)
 v_mfma_f32_32x32x16_bf16 v[176:191], a[232:235], v[192:195], v[176:191]
 ds_read_b128 a[232:235], v26 offset:14336
 v_mfma_f32_32x32x16_bf16 v[176:191], a[236:239], v[196:199], v[176:191]
 ds_read_b128 a[236:239], v27 offset:14336
 s_waitcnt lgkmcnt(2)
 v_mfma_f32_32x32x16_bf16 v[176:191], a[224:227], v[232:235], v[176:191]
 ds_read_b128 a[224:227], v24 offset:38912
 v_mfma_f32_32x32x16_bf16 v[176:191], a[228:231], v[236:239], v[176:191]
 ds_read_b128 a[228:231], v25 offset:38912
 s_waitcnt lgkmcnt(2)
 v_mfma_f32_32x32x16_bf16 v[176:191], a[232:235], v[104:107], v[176:191]
 ds_read_b128 a[232:235], v26 offset:38912
 v_mfma_f32_32x32x16_bf16 v[176:191], a[236:239], v[108:111], v[176:191]
 ds_read_b128 a[236:239], v27 offset:38912
 s_waitcnt lgkmcnt(2)
 v_mfma_f32_32x32x16_bf16 v[176:191], a[224:227], v[224:227], v[176:191]
 ds_read_b128 a[224:227], v1 offset:16384
 v_mfma_f32_32x32x16_bf16 v[176:191], a[228:231], v[228:231], v[176:191]
 ds_read_b128 a[228:231], v2 offset:16384
 s_waitcnt lgkmcnt(2)
 v_mfma_f32_32x32x16_bf16 v[176:191], a[232:235], v[96:99], v[176:191]
 ds_read_b128 a[232:235], v53 offset:16384
 v_mfma_f32_32x32x16_bf16 v[176:191], a[236:239], v[100:103], v[176:191]
 ds_read_b128 a[236:239], v54 offset:16384
 s_waitcnt lgkmcnt(2)
 v_mfma_f32_32x32x16_bf16 v[8:23], a[224:227], v[168:171], v[8:23]
 ds_read_b128 a[224:227], v1 offset:40960
 v_mfma_f32_32x32x16_bf16 v[8:23], a[228:231], v[172:175], v[8:23]
 ds_read_b128 a[228:231], v2 offset:40960
 s_waitcnt lgkmcnt(2)
 s_nop 4
 v_cvt_pk_bf16_f32 v66, v180, v181
 buffer_store_dwordx4 v[64:67], v7, s[16:19], s48 offen offset:2560 sc1
 v_cvt_pk_bf16_f32 v68, v176, v177
 v_mfma_f32_32x32x16_bf16 v[8:23], a[232:235], v[200:203], v[8:23]
 ds_read_b128 a[232:235], v53 offset:40960
 v_cvt_pk_bf16_f32 v69, v178, v179
 v_cvt_pk_bf16_f32 v70, v182, v183
 buffer_store_dwordx4 v[68:71], v7, s[16:19], s48 offen offset:2816 sc1
 v_cvt_pk_bf16_f32 v72, v184, v185
 v_mfma_f32_32x32x16_bf16 v[8:23], a[236:239], v[204:207], v[8:23]
 ds_read_b128 a[236:239], v54 offset:40960
 s_waitcnt lgkmcnt(2)
 v_cvt_pk_bf16_f32 v73, v186, v187
 v_mfma_f32_32x32x16_bf16 v[8:23], a[224:227], v[160:163], v[8:23]
 ds_read_b128 a[224:227], v24 offset:16384
 v_mfma_f32_32x32x16_bf16 v[8:23], a[228:231], v[164:167], v[8:23]
 ds_read_b128 a[228:231], v25 offset:16384
 s_waitcnt lgkmcnt(2)
 v_mfma_f32_32x32x16_bf16 v[8:23], a[232:235], v[192:195], v[8:23]
 ds_read_b128 a[232:235], v26 offset:16384
 v_mfma_f32_32x32x16_bf16 v[8:23], a[236:239], v[196:199], v[8:23]
 ds_read_b128 a[236:239], v27 offset:16384
 s_waitcnt lgkmcnt(2)
 v_mfma_f32_32x32x16_bf16 v[8:23], a[224:227], v[232:235], v[8:23]
 ds_read_b128 a[224:227], v24 offset:40960
 v_mfma_f32_32x32x16_bf16 v[8:23], a[228:231], v[236:239], v[8:23]
 ds_read_b128 a[228:231], v25 offset:40960
 s_waitcnt lgkmcnt(2)
 v_mfma_f32_32x32x16_bf16 v[8:23], a[232:235], v[104:107], v[8:23]
 ds_read_b128 a[232:235], v26 offset:40960
 v_mfma_f32_32x32x16_bf16 v[8:23], a[236:239], v[108:111], v[8:23]
 ds_read_b128 a[236:239], v27 offset:40960
 s_waitcnt lgkmcnt(2)
 v_mfma_f32_32x32x16_bf16 v[8:23], a[224:227], v[224:227], v[8:23]
 v_mfma_f32_32x32x16_bf16 v[8:23], a[228:231], v[228:231], v[8:23]
 s_waitcnt lgkmcnt(0)
 v_mfma_f32_32x32x16_bf16 v[8:23], a[232:235], v[96:99], v[8:23]
 v_mfma_f32_32x32x16_bf16 v[8:23], a[236:239], v[100:103], v[8:23]
 s_nop 11
 v_cvt_pk_bf16_f32 v74, v8, v9
 buffer_store_dwordx4 v[72:75], v7, s[16:19], s48 offen offset:3072 sc1
 v_cvt_pk_bf16_f32 v76, v188, v189
 v_cvt_pk_bf16_f32 v77, v190, v191
 v_cvt_pk_bf16_f32 v78, v10, v11
 buffer_store_dwordx4 v[76:79], v7, s[16:19], s48 offen offset:3328 sc1
 v_cvt_pk_bf16_f32 v56, v12, v13
 v_cvt_pk_bf16_f32 v57, v14, v15
 v_cvt_pk_bf16_f32 v58, v20, v21
 buffer_store_dwordx4 v[56:59], v7, s[16:19], s48 offen offset:3584 sc1
 v_cvt_pk_bf16_f32 v60, v16, v17
 v_cvt_pk_bf16_f32 v61, v18, v19
 v_cvt_pk_bf16_f32 v62, v22, v23
 buffer_store_dwordx4 v[60:63], v7, s[16:19], s48 offen offset:3840 sc1
 buffer_store_dword v42, v36, s[16:19], s48 offen sc1
 s_endpgm
L_ssm_end:
L_sn:
 s_mov_b32 s49, 100000
L_sn_l:
 s_sleep 1
 buffer_load_dword v56, off, s[24:27], 0 sc1
 s_waitcnt vmcnt(0)
 v_cmp_eq_u32 vcc, 0, v56
 s_nop 1
 s_nop 3
 s_cbranch_vccz L_sn_b
 s_sub_u32 s49, s49, 1
 s_cmp_lg_u32 s49, 0
 s_cbranch_scc1 L_sn_l
 s_branch L_sn_b
L_sx0:
 s_mov_b32 s49, 100000
L_sx0_l:
 s_sleep 1
 buffer_load_dwordx4 a[152:155], v23, s[16:19], s35 offen sc1
 s_waitcnt vmcnt(0)
 v_accvgpr_read_b32 v63, a155
 s_nop 1
 v_cmp_ne_u32 vcc, s90, v63
 s_nop 1
 s_nop 3
 s_cbranch_vccz L_sx0_b
 s_sub_u32 s49, s49, 1
 s_cmp_lg_u32 s49, 0
 s_cbranch_scc1 L_sx0_l
 s_branch L_sx0_b
L_sx1:
 s_mov_b32 s49, 100000
L_sx1_l:
 s_sleep 1
 buffer_load_dwordx4 a[152:155], v23, s[16:19], s35 offen sc1
 s_waitcnt vmcnt(0)
 v_accvgpr_read_b32 v63, a155
 s_nop 1
 v_cmp_ne_u32 vcc, s90, v63
 s_nop 1
 s_nop 3
 s_cbranch_vccz L_sx1_b
 s_sub_u32 s49, s49, 1
 s_cmp_lg_u32 s49, 0
 s_cbranch_scc1 L_sx1_l
 s_branch L_sx1_b
L_lb0:
 s_mov_b32 s49, 100000
L_lb0_l:
 s_sleep 1
 s_add_u32 s37, s34, 0
 buffer_load_dwordx4 v[56:59], v41, s[16:19], s37 offen sc1
 buffer_load_dwordx4 v[60:63], v42, s[16:19], s37 offen sc1
 s_waitcnt vmcnt(0)
 v_cmp_ne_u32 vcc, s45, v58
 s_nop 1
 s_and_b64 s[40:41], vcc, s[42:43]
 s_nop 1
 v_cmp_ne_u32 vcc, s45, v62
 s_nop 1
 s_and_b64 vcc, vcc, s[46:47]
 s_nop 1
 s_or_b64 vcc, vcc, s[40:41]
 s_nop 1
 s_nop 3
 s_cbranch_vccz L_lb0_b
 s_sub_u32 s49, s49, 1
 s_cmp_lg_u32 s49, 0
 s_cbranch_scc1 L_lb0_l
 s_branch L_lb0_b
L_sx2:
 s_mov_b32 s49, 100000
L_sx2_l:
 s_sleep 1
 buffer_load_dwordx4 a[152:155], v23, s[16:19], s35 offen sc1
 s_waitcnt vmcnt(0)
 v_accvgpr_read_b32 v63, a155
 s_nop 1
 v_cmp_ne_u32 vcc, s90, v63
 s_nop 1
 s_nop 3
 s_cbranch_vccz L_sx2_b
 s_sub_u32 s49, s49, 1
 s_cmp_lg_u32 s49, 0
 s_cbranch_scc1 L_sx2_l
 s_branch L_sx2_b
L_lb1:
 s_mov_b32 s49, 100000
L_lb1_l:
 s_sleep 1
 s_add_u32 s37, s34, 8192
 buffer_load_dwordx4 v[56:59], v41, s[16:19], s37 offen sc1
 buffer_load_dwordx4 v[60:63], v42, s[16:19], s37 offen sc1
 s_waitcnt vmcnt(0)
 v_cmp_ne_u32 vcc, s45, v58
 s_nop 1
 s_and_b64 s[40:41], vcc, s[42:43]
 s_nop 1
 v_cmp_ne_u32 vcc, s45, v62
 s_nop 1
 s_and_b64 vcc, vcc, s[46:47]
 s_nop 1
 s_or_b64 vcc, vcc, s[40:41]
 s_nop 1
 s_nop 3
 s_cbranch_vccz L_lb1_b
 s_sub_u32 s49, s49, 1
 s_cmp_lg_u32 s49, 0
 s_cbranch_scc1 L_lb1_l
 s_branch L_lb1_b
L_sx3:
 s_mov_b32 s49, 100000
L_sx3_l:
 s_sleep 1
 buffer_load_dwordx4 a[152:155], v23, s[16:19], s35 offen sc1
 s_waitcnt vmcnt(0)
 v_accvgpr_read_b32 v63, a155
 s_nop 1
 v_cmp_ne_u32 vcc, s90, v63
 s_nop 1
 s_nop 3
 s_cbranch_vccz L_sx3_b
 s_sub_u32 s49, s49, 1
 s_cmp_lg_u32 s49, 0
 s_cbranch_scc1 L_sx3_l
 s_branch L_sx3_b
L_lb2:
 s_mov_b32 s49, 100000
L_lb2_l:
 s_sleep 1
 s_add_u32 s37, s34, 16384
 buffer_load_dwordx4 v[56:59], v41, s[16:19], s37 offen sc1
 buffer_load_dwordx4 v[60:63], v42, s[16:19], s37 offen sc1
 s_waitcnt vmcnt(0)
 v_cmp_ne_u32 vcc, s45, v58
 s_nop 1
 s_and_b64 s[40:41], vcc, s[42:43]
 s_nop 1
 v_cmp_ne_u32 vcc, s45, v62
 s_nop 1
 s_and_b64 vcc, vcc, s[46:47]
 s_nop 1
 s_or_b64 vcc, vcc, s[40:41]
 s_nop 1
 s_nop 3
 s_cbranch_vccz L_lb2_b
 s_sub_u32 s49, s49, 1
 s_cmp_lg_u32 s49, 0
 s_cbranch_scc1 L_lb2_l
 s_branch L_lb2_b
L_sx4:
 s_mov_b32 s49, 100000
L_sx4_l:
 s_sleep 1
 buffer_load_dwordx4 a[152:155], v23, s[16:19], s35 offen sc1
 s_waitcnt vmcnt(0)
 v_accvgpr_read_b32 v63, a155
 s_nop 1
 v_cmp_ne_u32 vcc, s90, v63
 s_nop 1
 s_nop 3
 s_cbranch_vccz L_sx4_b
 s_sub_u32 s49, s49, 1
 s_cmp_lg_u32 s49, 0
 s_cbranch_scc1 L_sx4_l
 s_branch L_sx4_b
L_lb3:
 s_mov_b32 s49, 100000
L_lb3_l:
 s_sleep 1
 s_add_u32 s37, s34, 24576
 buffer_load_dwordx4 v[56:59], v41, s[16:19], s37 offen sc1
 buffer_load_dwordx4 v[60:63], v42, s[16:19], s37 offen sc1
 s_waitcnt vmcnt(0)
 v_cmp_ne_u32 vcc, s45, v58
 s_nop 1
 s_and_b64 s[40:41], vcc, s[42:43]
 s_nop 1
 v_cmp_ne_u32 vcc, s45, v62
 s_nop 1
 s_and_b64 vcc, vcc, s[46:47]
 s_nop 1
 s_or_b64 vcc, vcc, s[40:41]
 s_nop 1
 s_nop 3
 s_cbranch_vccz L_lb3_b
 s_sub_u32 s49, s49, 1
 s_cmp_lg_u32 s49, 0
 s_cbranch_scc1 L_lb3_l
 s_branch L_lb3_b
L_sx5:
 s_mov_b32 s49, 100000
L_sx5_l:
 s_sleep 1
 buffer_load_dwordx4 a[152:155], v23, s[16:19], s35 offen sc1
 s_waitcnt vmcnt(0)
 v_accvgpr_read_b32 v63, a155
 s_nop 1
 v_cmp_ne_u32 vcc, s90, v63
 s_nop 1
 s_nop 3
 s_cbranch_vccz L_sx5_b
 s_sub_u32 s49, s49, 1
 s_cmp_lg_u32 s49, 0
 s_cbranch_scc1 L_sx5_l
 s_branch L_sx5_b
L_lb4:
 s_mov_b32 s49, 100000
L_lb4_l:
 s_sleep 1
 s_add_u32 s37, s34, 32768
 buffer_load_dwordx4 v[56:59], v41, s[16:19], s37 offen sc1
 buffer_load_dwordx4 v[60:63], v42, s[16:19], s37 offen sc1
 s_waitcnt vmcnt(0)
 v_cmp_ne_u32 vcc, s45, v58
 s_nop 1
 s_and_b64 s[40:41], vcc, s[42:43]
 s_nop 1
 v_cmp_ne_u32 vcc, s45, v62
 s_nop 1
 s_and_b64 vcc, vcc, s[46:47]
 s_nop 1
 s_or_b64 vcc, vcc, s[40:41]
 s_nop 1
 s_nop 3
 s_cbranch_vccz L_lb4_b
 s_sub_u32 s49, s49, 1
 s_cmp_lg_u32 s49, 0
 s_cbranch_scc1 L_lb4_l
 s_branch L_lb4_b
L_lb5:
 s_mov_b32 s49, 100000
L_lb5_l:
 s_sleep 1
 s_add_u32 s37, s34, 40960
 buffer_load_dwordx4 v[56:59], v41, s[16:19], s37 offen sc1
 buffer_load_dwordx4 v[60:63], v42, s[16:19], s37 offen sc1
 s_waitcnt vmcnt(0)
 v_cmp_ne_u32 vcc, s45, v58
 s_nop 1
 s_and_b64 s[40:41], vcc, s[42:43]
 s_nop 1
 v_cmp_ne_u32 vcc, s45, v62
 s_nop 1
 s_and_b64 vcc, vcc, s[46:47]
 s_nop 1
 s_or_b64 vcc, vcc, s[40:41]
 s_nop 1
 s_nop 3
 s_cbranch_vccz L_lb5_b
 s_sub_u32 s49, s49, 1
 s_cmp_lg_u32 s49, 0
 s_cbranch_scc1 L_lb5_l
 s_branch L_lb5_b
L_help0:
L_help:
 v_and_b32 v0, 63, v0
 s_lshr_b32 s39, s2, 3
 s_and_b32 s39, s39, 1
 s_and_b32 s38, s2, 1
 s_lshl_b32 s38, s38, 1
 s_add_u32 s30, s38, s39
 s_bfe_u32 s29, s2, 0x20001
 s_memrealtime s[70:71]
 v_lshrrev_b32 v1, 3, v0
 v_and_b32 v2, 7, v0
 v_mov_b32 v5, 0
 s_cmp_eq_u32 s30, 3
 s_cbranch_scc1 L_help_s
 v_mul_u32_u24 v232, 9216, v1
 v_lshl_add_u32 v232, v2, 4, v232
 v_add_u32 v233, 73728, v232
 v_add_u32 v234, 147456, v232
 v_add_u32 v235, 221184, v232
 v_add_u32 v236, 294912, v232
 v_add_u32 v237, 368640, v232
 s_mul_i32 s51, s29, 3
 s_add_u32 s51, s51, s30
 s_mul_i32 s37, s51, 768
 s_mul_i32 s39, s31, 442368
 s_add_u32 s32, s37, s39
 s_mul_i32 s38, s30, 1769472
 s_add_u32 s60, s32, s38
 s_mov_b32 s40, 1769472
 s_cmp_eq_u32 s30, 2
 s_cselect_b32 s38, -3538944, s40
 s_add_u32 s61, s60, s38
 s_cmp_eq_u32 s30, 1
 s_cselect_b32 s38, -3538944, s40
 s_add_u32 s62, s61, s38
 s_waitcnt lgkmcnt(0)
 s_and_b32 s25, s25, 0xffff
 s_mov_b32 s26, 0x100
 s_mov_b32 s27, 0x20000
 s_lshl_b32 s70, s70, 3
 s_or_b32 s70, s70, 0x80000000
 v_mov_b32 v4, s70
 s_cmp_eq_u32 s31, 0
 s_cselect_b64 s[40:41], 1, 0
 v_mov_b32 v3, 4096
 v_cndmask_b32 v3, v3, v5, s[40:41]
 buffer_atomic_cmpswap v[4:5], v3, s[24:27], 0 offen sc0 sc1
 s_and_b32 s17, s17, 0xffff
 s_mov_b32 s18, 0x2700000
 s_mov_b32 s19, 0x20000
 s_and_b32 s9, s9, 0xffff
 s_mov_b32 s10, 0x510000
 s_mov_b32 s11, 0x20000
 s_and_b32 s21, s21, 0xffff
 s_mov_b32 s22, 0x2400
 s_mov_b32 s23, 0x20000
 v_lshlrev_b32 v9, 1, v0
 buffer_load_ushort v8, v9, s[20:23], s37 offen
 buffer_load_dwordx4 v[16:19], v232, s[8:11], s60 offen
 buffer_load_dwordx4 v[20:23], v233, s[8:11], s60 offen
 buffer_load_dwordx4 v[24:27], v234, s[8:11], s60 offen
 buffer_load_dwordx4 v[28:31], v235, s[8:11], s60 offen
 buffer_load_dwordx4 v[32:35], v236, s[8:11], s60 offen
 buffer_load_dwordx4 v[36:39], v237, s[8:11], s60 offen
 buffer_load_dwordx4 v[40:43], v232, s[8:11], s61 offen
 buffer_load_dwordx4 v[44:47], v233, s[8:11], s61 offen
 buffer_load_dwordx4 v[48:51], v234, s[8:11], s61 offen
 buffer_load_dwordx4 v[52:55], v235, s[8:11], s61 offen
 buffer_load_dwordx4 v[56:59], v236, s[8:11], s61 offen
 buffer_load_dwordx4 v[60:63], v237, s[8:11], s61 offen
 buffer_load_dwordx4 v[64:67], v232, s[8:11], s62 offen
 buffer_load_dwordx4 v[68:71], v233, s[8:11], s62 offen
 buffer_load_dwordx4 v[72:75], v234, s[8:11], s62 offen
 buffer_load_dwordx4 v[76:79], v235, s[8:11], s62 offen
 buffer_load_dwordx4 v[80:83], v236, s[8:11], s62 offen
 buffer_load_dwordx4 v[84:87], v237, s[8:11], s62 offen
 v_mov_b32 v238, 0x3f80
 v_mov_b32 v239, 0x3f800000
 v_lshl_add_u32 v6, v2, 3, v1
 s_lshl_b32 s38, s31, 8
 v_lshl_add_u32 v6, v6, 2, s38
 v_lshlrev_b32 v7, 2, v0
 v_lshlrev_b32 v14, 4, v0
 v_mov_b32 v15, 0
 s_mul_i32 s51, s51, 6144
 s_add_u32 s51, s51, 0x60000
 v_and_b32 v3, 8, v0
 v_cmp_ne_u32 vcc, 0, v3
 s_waitcnt vmcnt(19)
 v_readfirstlane_b32 s71, v4
 s_cmp_eq_u32 s71, 0
 s_cselect_b32 s71, s70, s71
 s_and_b32 s71, s71, 0xbfffbfff
 v_mov_b32 v4, s71
 s_lshl_b32 s38, s31, 2
 v_mov_b32 v3, s38
 ds_write_b32 v3, v4 offset:8192
 s_lshl_b32 s38, s31, 4
 s_lshl_b64 s[66:67], 0xffff, s38
 s_mov_b32 s63, 0
L_hm:
 s_cmp_eq_u32 s63, 5
 s_cselect_b32 s10, 0, s10
 s_add_u32 s60, s60, 128
 s_add_u32 s61, s61, 128
 s_add_u32 s62, s62, 128
 s_add_u32 s37, s37, 128
 s_waitcnt vmcnt(17)
 v_dot2_f32_bf16 v240, v16, v238, 0
 v_dot2_f32_bf16 v241, v16, v239, 0
 v_dot2_f32_bf16 v242, v17, v238, 0
 v_dot2_f32_bf16 v243, v17, v239, 0
 v_dot2_f32_bf16 v244, v18, v238, 0
 v_dot2_f32_bf16 v245, v18, v239, 0
 v_dot2_f32_bf16 v246, v19, v238, 0
 v_dot2_f32_bf16 v247, v19, v239, 0
 buffer_load_dwordx4 v[16:19], v232, s[8:11], s60 offen
 s_waitcnt vmcnt(17)
 v_dot2_f32_bf16 v240, v20, v238, v240
 v_dot2_f32_bf16 v241, v20, v239, v241
 v_dot2_f32_bf16 v242, v21, v238, v242
 v_dot2_f32_bf16 v243, v21, v239, v243
 v_dot2_f32_bf16 v244, v22, v238, v244
 v_dot2_f32_bf16 v245, v22, v239, v245
 v_dot2_f32_bf16 v246, v23, v238, v246
 v_dot2_f32_bf16 v247, v23, v239, v247
 buffer_load_dwordx4 v[20:23], v233, s[8:11], s60 offen
 s_waitcnt vmcnt(17)
 v_dot2_f32_bf16 v240, v24, v238, v240
 v_dot2_f32_bf16 v241, v24, v239, v241
 v_dot2_f32_bf16 v242, v25, v238, v242
 v_dot2_f32_bf16 v243, v25, v239, v243
 v_dot2_f32_bf16 v244, v26, v238, v244
 v_dot2_f32_bf16 v245, v26, v239, v245
 v_dot2_f32_bf16 v246, v27, v238, v246
 v_dot2_f32_bf16 v247, v27, v239, v247
 buffer_load_dwordx4 v[24:27], v234, s[8:11], s60 offen
 s_waitcnt vmcnt(17)
 v_dot2_f32_bf16 v240, v28, v238, v240
 v_dot2_f32_bf16 v241, v28, v239, v241
 v_dot2_f32_bf16 v242, v29, v238, v242
 v_dot2_f32_bf16 v243, v29, v239, v243
 v_dot2_f32_bf16 v244, v30, v238, v244
 v_dot2_f32_bf16 v245, v30, v239, v245
 v_dot2_f32_bf16 v246, v31, v238, v246
 v_dot2_f32_bf16 v247, v31, v239, v247
 buffer_load_dwordx4 v[28:31], v235, s[8:11], s60 offen
 s_waitcnt vmcnt(17)
 v_dot2_f32_bf16 v240, v32, v238, v240
 v_dot2_f32_bf16 v241, v32, v239, v241
 v_dot2_f32_bf16 v242, v33, v238, v242
 v_dot2_f32_bf16 v243, v33, v239, v243
 v_dot2_f32_bf16 v244, v34, v238, v244
 v_dot2_f32_bf16 v245, v34, v239, v245
 v_dot2_f32_bf16 v246, v35, v238, v246
 v_dot2_f32_bf16 v247, v35, v239, v247
 buffer_load_dwordx4 v[32:35], v236, s[8:11], s60 offen
 s_waitcnt vmcnt(17)
 v_dot2_f32_bf16 v240, v36, v238, v240
 v_dot2_f32_bf16 v241, v36, v239, v241
 v_dot2_f32_bf16 v242, v37, v238, v242
 v_dot2_f32_bf16 v243, v37, v239, v243
 v_dot2_f32_bf16 v244, v38, v238, v244
 v_dot2_f32_bf16 v245, v38, v239, v245
 v_dot2_f32_bf16 v246, v39, v238, v246
 v_dot2_f32_bf16 v247, v39, v239, v247
 buffer_load_dwordx4 v[36:39], v237, s[8:11], s60 offen
 s_waitcnt vmcnt(17)
 v_dot2_f32_bf16 v240, v40, v238, v240
 v_dot2_f32_bf16 v241, v40, v239, v241
 v_dot2_f32_bf16 v242, v41, v238, v242
 v_dot2_f32_bf16 v243, v41, v239, v243
 v_dot2_f32_bf16 v244, v42, v238, v244
 v_dot2_f32_bf16 v245, v42, v239, v245
 v_dot2_f32_bf16 v246, v43, v238, v246
 v_dot2_f32_bf16 v247, v43, v239, v247
 buffer_load_dwordx4 v[40:43], v232, s[8:11], s61 offen
 s_waitcnt vmcnt(17)
 v_dot2_f32_bf16 v240, v44, v238, v240
 v_dot2_f32_bf16 v241, v44, v239, v241
 v_dot2_f32_bf16 v242, v45, v238, v242
 v_dot2_f32_bf16 v243, v45, v239, v243
 v_dot2_f32_bf16 v244, v46, v238, v244
 v_dot2_f32_bf16 v245, v46, v239, v245
 v_dot2_f32_bf16 v246, v47, v238, v246
 v_dot2_f32_bf16 v247, v47, v239, v247
 buffer_load_dwordx4 v[44:47], v233, s[8:11], s61 offen
 s_waitcnt vmcnt(17)
 v_dot2_f32_bf16 v240, v48, v238, v240
 v_dot2_f32_bf16 v241, v48, v239, v241
 v_dot2_f32_bf16 v242, v49, v238, v242
 v_dot2_f32_bf16 v243, v49, v239, v243
 v_dot2_f32_bf16 v244, v50, v238, v244
 v_dot2_f32_bf16 v245, v50, v239, v245
 v_dot2_f32_bf16 v246, v51, v238, v246
 v_dot2_f32_bf16 v247, v51, v239, v247
 buffer_load_dwordx4 v[48:51], v234, s[8:11], s61 offen
 s_waitcnt vmcnt(17)
 v_dot2_f32_bf16 v240, v52, v238, v240
 v_dot2_f32_bf16 v241, v52, v239, v241
 v_dot2_f32_bf16 v242, v53, v238, v242
 v_dot2_f32_bf16 v243, v53, v239, v243
 v_dot2_f32_bf16 v244, v54, v238, v244
 v_dot2_f32_bf16 v245, v54, v239, v245
 v_dot2_f32_bf16 v246, v55, v238, v246
 v_dot2_f32_bf16 v247, v55, v239, v247
 buffer_load_dwordx4 v[52:55], v235, s[8:11], s61 offen
 s_waitcnt vmcnt(17)
 v_dot2_f32_bf16 v240, v56, v238, v240
 v_dot2_f32_bf16 v241, v56, v239, v241
 v_dot2_f32_bf16 v242, v57, v238, v242
 v_dot2_f32_bf16 v243, v57, v239, v243
 v_dot2_f32_bf16 v244, v58, v238, v244
 v_dot2_f32_bf16 v245, v58, v239, v245
 v_dot2_f32_bf16 v246, v59, v238, v246
 v_dot2_f32_bf16 v247, v59, v239, v247
 buffer_load_dwordx4 v[56:59], v236, s[8:11], s61 offen
 s_waitcnt vmcnt(17)
 v_dot2_f32_bf16 v240, v60, v238, v240
 v_dot2_f32_bf16 v241, v60, v239, v241
 v_dot2_f32_bf16 v242, v61, v238, v242
 v_dot2_f32_bf16 v243, v61, v239, v243
 v_dot2_f32_bf16 v244, v62, v238, v244
 v_dot2_f32_bf16 v245, v62, v239, v245
 v_dot2_f32_bf16 v246, v63, v238, v246
 v_dot2_f32_bf16 v247, v63, v239, v247
 buffer_load_dwordx4 v[60:63], v237, s[8:11], s61 offen
 s_waitcnt vmcnt(17)
 v_dot2_f32_bf16 v240, v64, v238, v240
 v_dot2_f32_bf16 v241, v64, v239, v241
 v_dot2_f32_bf16 v242, v65, v238, v242
 v_dot2_f32_bf16 v243, v65, v239, v243
 v_dot2_f32_bf16 v244, v66, v238, v244
 v_dot2_f32_bf16 v245, v66, v239, v245
 v_dot2_f32_bf16 v246, v67, v238, v246
 v_dot2_f32_bf16 v247, v67, v239, v247
 s_waitcnt vmcnt(16)
 v_dot2_f32_bf16 v240, v68, v238, v240
 v_dot2_f32_bf16 v241, v68, v239, v241
 v_dot2_f32_bf16 v242, v69, v238, v242
 v_dot2_f32_bf16 v243, v69, v239, v243
 v_dot2_f32_bf16 v244, v70, v238, v244
 v_dot2_f32_bf16 v245, v70, v239, v245
 v_dot2_f32_bf16 v246, v71, v238, v246
 v_dot2_f32_bf16 v247, v71, v239, v247
 s_waitcnt vmcnt(15)
 v_dot2_f32_bf16 v240, v72, v238, v240
 v_dot2_f32_bf16 v241, v72, v239, v241
 v_dot2_f32_bf16 v242, v73, v238, v242
 v_dot2_f32_bf16 v243, v73, v239, v243
 v_dot2_f32_bf16 v244, v74, v238, v244
 v_dot2_f32_bf16 v245, v74, v239, v245
 v_dot2_f32_bf16 v246, v75, v238, v246
 v_dot2_f32_bf16 v247, v75, v239, v247
 s_waitcnt vmcnt(14)
 v_dot2_f32_bf16 v240, v76, v238, v240
 v_dot2_f32_bf16 v241, v76, v239, v241
 v_dot2_f32_bf16 v242, v77, v238, v242
 v_dot2_f32_bf16 v243, v77, v239, v243
 v_dot2_f32_bf16 v244, v78, v238, v244
 v_dot2_f32_bf16 v245, v78, v239, v245
 v_dot2_f32_bf16 v246, v79, v238, v246
 v_dot2_f32_bf16 v247, v79, v239, v247
 s_waitcnt vmcnt(13)
 v_dot2_f32_bf16 v240, v80, v238, v240
 v_dot2_f32_bf16 v241, v80, v239, v241
 v_dot2_f32_bf16 v242, v81, v238, v242
 v_dot2_f32_bf16 v243, v81, v239, v243
 v_dot2_f32_bf16 v244, v82, v238, v244
 v_dot2_f32_bf16 v245, v82, v239, v245
 v_dot2_f32_bf16 v246, v83, v238, v246
 v_dot2_f32_bf16 v247, v83, v239, v247
 s_waitcnt vmcnt(12)
 v_dot2_f32_bf16 v240, v84, v238, v240
 v_dot2_f32_bf16 v241, v84, v239, v241
 v_dot2_f32_bf16 v242, v85, v238, v242
 v_dot2_f32_bf16 v243, v85, v239, v243
 v_dot2_f32_bf16 v244, v86, v238, v244
 v_dot2_f32_bf16 v245, v86, v239, v245
 v_dot2_f32_bf16 v246, v87, v238, v246
 v_dot2_f32_bf16 v247, v87, v239, v247
 v_permlane32_swap_b32 v240, v244
 v_permlane32_swap_b32 v241, v245
 v_permlane32_swap_b32 v242, v246
 v_permlane32_swap_b32 v243, v247
 v_add_f32 v240, v240, v244
 v_add_f32 v241, v241, v245
 v_add_f32 v242, v242, v246
 v_add_f32 v243, v243, v247
 s_nop 0
 v_permlane16_swap_b32 v240, v242
 v_permlane16_swap_b32 v241, v243
 v_add_f32 v240, v240, v242
 v_add_f32 v241, v241, v243
 s_nop 0
 v_add_f32_dpp v240, v240, v240 row_ror:8 row_mask:0xf bank_mask:0xf
 v_add_f32_dpp v241, v241, v241 row_ror:8 row_mask:0xf bank_mask:0xf
 v_cndmask_b32 v240, v240, v241, vcc
 ds_write_b32 v6, v240
 s_waitcnt lgkmcnt(0)
 s_barrier
 ds_read_b32 v251, v15 offset:8192
 ds_read2st64_b32 v[240:241], v7 offset0:0 offset1:1
 ds_read2st64_b32 v[242:243], v7 offset0:2 offset1:3
 v_add_u32 v6, 1024, v6
 v_add_u32 v7, 1024, v7
 s_waitcnt lgkmcnt(1)
 v_add_f32 v240, v240, v241
 s_waitcnt lgkmcnt(0)
 v_add_f32 v242, v242, v243
 v_add_f32 v240, v240, v242
 v_cvt_pk_bf16_f32 v249, v240, v240
 v_lshlrev_b32 v248, 16, v249
 v_sub_f32 v248, v240, v248
 v_cvt_pk_bf16_f32 v248, v240, v248
 v_and_b32 v249, 0xffff, v249
 v_lshl_or_b32 v249, v8, 16, v249
 v_mov_b32 v250, v8
 s_mov_b64 exec, s[66:67]
 buffer_store_dwordx4 v[248:251], v14, s[16:19], s51 offen sc1
 s_mov_b64 exec, -1
 buffer_load_ushort v8, v9, s[20:23], s37 offen
 buffer_load_dwordx4 v[64:67], v232, s[8:11], s62 offen
 buffer_load_dwordx4 v[68:71], v233, s[8:11], s62 offen
 buffer_load_dwordx4 v[72:75], v234, s[8:11], s62 offen
 buffer_load_dwordx4 v[76:79], v235, s[8:11], s62 offen
 buffer_load_dwordx4 v[80:83], v236, s[8:11], s62 offen
 buffer_load_dwordx4 v[84:87], v237, s[8:11], s62 offen
 s_add_u32 s51, s51, 1024
 s_add_u32 s63, s63, 1
 s_cmp_lt_u32 s63, 6
 s_cbranch_scc1 L_hm
 s_waitcnt vmcnt(0)
 s_endpgm
L_help_s:
 v_mul_u32_u24 v232, 1152, v1
 v_lshl_add_u32 v232, v2, 4, v232
 v_add_u32 v233, 9216, v232
 s_and_b32 s38, s29, 1
 s_lshl_b32 s38, s38, 4
 s_mul_i32 s39, s31, 192
 s_add_u32 s38, s38, s39
 s_mul_i32 s60, s38, 1152
 s_cmp_lt_u32 s29, 2
 s_waitcnt lgkmcnt(0)
 s_cselect_b32 s8, s92, s94
 s_cselect_b32 s9, s93, s95
 s_cmp_eq_u32 s31, 3
 s_cbranch_scc1 L_help_t
 s_and_b32 s25, s25, 0xffff
 s_mov_b32 s26, 0x100
 s_mov_b32 s27, 0x20000
 s_lshl_b32 s70, s70, 3
 s_or_b32 s70, s70, 0x80000000
 v_mov_b32 v4, s70
 s_cmp_eq_u32 s31, 0
 s_cselect_b64 s[40:41], 1, 0
 v_mov_b32 v3, 4096
 v_cndmask_b32 v3, v3, v5, s[40:41]
 buffer_atomic_cmpswap v[4:5], v3, s[24:27], 0 offen sc0 sc1
 s_and_b32 s17, s17, 0xffff
 s_mov_b32 s18, 0x2700000
 s_mov_b32 s19, 0x20000
 s_and_b32 s9, s9, 0xffff
 s_mov_b32 s10, 0xa2000
 s_mov_b32 s11, 0x20000
 buffer_load_dwordx4 v[16:19], v232, s[8:11], s60 offen offset:0
 buffer_load_dwordx4 v[20:23], v232, s[8:11], s60 offen offset:128
 buffer_load_dwordx4 v[24:27], v232, s[8:11], s60 offen offset:256
 buffer_load_dwordx4 v[28:31], v232, s[8:11], s60 offen offset:384
 buffer_load_dwordx4 v[32:35], v232, s[8:11], s60 offen offset:512
 buffer_load_dwordx4 v[36:39], v232, s[8:11], s60 offen offset:640
 buffer_load_dwordx4 v[40:43], v232, s[8:11], s60 offen offset:768
 buffer_load_dwordx4 v[44:47], v232, s[8:11], s60 offen offset:896
 buffer_load_dwordx4 v[48:51], v232, s[8:11], s60 offen offset:1024
 buffer_load_dwordx4 v[52:55], v233, s[8:11], s60 offen offset:0
 buffer_load_dwordx4 v[56:59], v233, s[8:11], s60 offen offset:128
 buffer_load_dwordx4 v[60:63], v233, s[8:11], s60 offen offset:256
 buffer_load_dwordx4 v[64:67], v233, s[8:11], s60 offen offset:384
 buffer_load_dwordx4 v[68:71], v233, s[8:11], s60 offen offset:512
 buffer_load_dwordx4 v[72:75], v233, s[8:11], s60 offen offset:640
 buffer_load_dwordx4 v[76:79], v233, s[8:11], s60 offen offset:768
 buffer_load_dwordx4 v[80:83], v233, s[8:11], s60 offen offset:896
 buffer_load_dwordx4 v[84:87], v233, s[8:11], s60 offen offset:1024
 v_mov_b32 v238, 0x3f803f80
 v_mov_b32 v15, 0
 v_mov_b32 v250, 0
 v_lshl_add_u32 v14, v2, 3, v1
 v_lshlrev_b32 v14, 4, v14
 v_and_b32 v3, 6, v0
 v_lshl_or_b32 v14, v3, 28, v14
 s_mul_i32 s51, s31, 6144
 s_lshl_b32 s38, s29, 8
 s_add_u32 s51, s51, s38
 s_add_u32 s51, s51, 0x72000
 v_and_b32 v3, 1, v0
 v_cmp_ne_u32 vcc, 0, v3
 s_waitcnt vmcnt(18)
 v_readfirstlane_b32 s71, v4
 s_cmp_eq_u32 s71, 0
 s_cselect_b32 s71, s70, s71
 s_and_b32 s71, s71, 0xbfffbfff
 v_mov_b32 v4, s71
 s_lshl_b32 s38, s31, 2
 v_mov_b32 v3, s38
 ds_write_b32 v3, v4 offset:8192
 s_waitcnt lgkmcnt(0)
 s_barrier
 ds_read_b32 v251, v15 offset:8192
 s_mov_b32 s63, 0
L_hs:
 s_cmp_eq_u32 s63, 5
 s_cselect_b32 s10, 0, s10
 s_add_u32 s60, s60, 36864
 s_waitcnt vmcnt(17)
 v_dot2_f32_bf16 v240, v16, v238, 0
 v_dot2_f32_bf16 v242, v17, v238, 0
 v_dot2_f32_bf16 v240, v18, v238, v240
 v_dot2_f32_bf16 v242, v19, v238, v242
 buffer_load_dwordx4 v[16:19], v232, s[8:11], s60 offen offset:0
 s_waitcnt vmcnt(17)
 v_dot2_f32_bf16 v240, v20, v238, v240
 v_dot2_f32_bf16 v242, v21, v238, v242
 v_dot2_f32_bf16 v240, v22, v238, v240
 v_dot2_f32_bf16 v242, v23, v238, v242
 buffer_load_dwordx4 v[20:23], v232, s[8:11], s60 offen offset:128
 s_waitcnt vmcnt(17)
 v_dot2_f32_bf16 v240, v24, v238, v240
 v_dot2_f32_bf16 v242, v25, v238, v242
 v_dot2_f32_bf16 v240, v26, v238, v240
 v_dot2_f32_bf16 v242, v27, v238, v242
 buffer_load_dwordx4 v[24:27], v232, s[8:11], s60 offen offset:256
 s_waitcnt vmcnt(17)
 v_dot2_f32_bf16 v240, v28, v238, v240
 v_dot2_f32_bf16 v242, v29, v238, v242
 v_dot2_f32_bf16 v240, v30, v238, v240
 v_dot2_f32_bf16 v242, v31, v238, v242
 buffer_load_dwordx4 v[28:31], v232, s[8:11], s60 offen offset:384
 s_waitcnt vmcnt(17)
 v_dot2_f32_bf16 v240, v32, v238, v240
 v_dot2_f32_bf16 v242, v33, v238, v242
 v_dot2_f32_bf16 v240, v34, v238, v240
 v_dot2_f32_bf16 v242, v35, v238, v242
 buffer_load_dwordx4 v[32:35], v232, s[8:11], s60 offen offset:512
 s_waitcnt vmcnt(17)
 v_dot2_f32_bf16 v240, v36, v238, v240
 v_dot2_f32_bf16 v242, v37, v238, v242
 v_dot2_f32_bf16 v240, v38, v238, v240
 v_dot2_f32_bf16 v242, v39, v238, v242
 buffer_load_dwordx4 v[36:39], v232, s[8:11], s60 offen offset:640
 s_waitcnt vmcnt(17)
 v_dot2_f32_bf16 v240, v40, v238, v240
 v_dot2_f32_bf16 v242, v41, v238, v242
 v_dot2_f32_bf16 v240, v42, v238, v240
 v_dot2_f32_bf16 v242, v43, v238, v242
 buffer_load_dwordx4 v[40:43], v232, s[8:11], s60 offen offset:768
 s_waitcnt vmcnt(17)
 v_dot2_f32_bf16 v240, v44, v238, v240
 v_dot2_f32_bf16 v242, v45, v238, v242
 v_dot2_f32_bf16 v240, v46, v238, v240
 v_dot2_f32_bf16 v242, v47, v238, v242
 buffer_load_dwordx4 v[44:47], v232, s[8:11], s60 offen offset:896
 s_waitcnt vmcnt(17)
 v_dot2_f32_bf16 v240, v48, v238, v240
 v_dot2_f32_bf16 v242, v49, v238, v242
 v_dot2_f32_bf16 v240, v50, v238, v240
 v_dot2_f32_bf16 v242, v51, v238, v242
 buffer_load_dwordx4 v[48:51], v232, s[8:11], s60 offen offset:1024
 s_waitcnt vmcnt(17)
 v_dot2_f32_bf16 v241, v52, v238, 0
 v_dot2_f32_bf16 v243, v53, v238, 0
 v_dot2_f32_bf16 v241, v54, v238, v241
 v_dot2_f32_bf16 v243, v55, v238, v243
 buffer_load_dwordx4 v[52:55], v233, s[8:11], s60 offen offset:0
 s_waitcnt vmcnt(17)
 v_dot2_f32_bf16 v241, v56, v238, v241
 v_dot2_f32_bf16 v243, v57, v238, v243
 v_dot2_f32_bf16 v241, v58, v238, v241
 v_dot2_f32_bf16 v243, v59, v238, v243
 buffer_load_dwordx4 v[56:59], v233, s[8:11], s60 offen offset:128
 s_waitcnt vmcnt(17)
 v_dot2_f32_bf16 v241, v60, v238, v241
 v_dot2_f32_bf16 v243, v61, v238, v243
 v_dot2_f32_bf16 v241, v62, v238, v241
 v_dot2_f32_bf16 v243, v63, v238, v243
 buffer_load_dwordx4 v[60:63], v233, s[8:11], s60 offen offset:256
 s_waitcnt vmcnt(17)
 v_dot2_f32_bf16 v241, v64, v238, v241
 v_dot2_f32_bf16 v243, v65, v238, v243
 v_dot2_f32_bf16 v241, v66, v238, v241
 v_dot2_f32_bf16 v243, v67, v238, v243
 s_waitcnt vmcnt(16)
 v_dot2_f32_bf16 v241, v68, v238, v241
 v_dot2_f32_bf16 v243, v69, v238, v243
 v_dot2_f32_bf16 v241, v70, v238, v241
 v_dot2_f32_bf16 v243, v71, v238, v243
 s_waitcnt vmcnt(15)
 v_dot2_f32_bf16 v241, v72, v238, v241
 v_dot2_f32_bf16 v243, v73, v238, v243
 v_dot2_f32_bf16 v241, v74, v238, v241
 v_dot2_f32_bf16 v243, v75, v238, v243
 s_waitcnt vmcnt(14)
 v_dot2_f32_bf16 v241, v76, v238, v241
 v_dot2_f32_bf16 v243, v77, v238, v243
 v_dot2_f32_bf16 v241, v78, v238, v241
 v_dot2_f32_bf16 v243, v79, v238, v243
 s_waitcnt vmcnt(13)
 v_dot2_f32_bf16 v241, v80, v238, v241
 v_dot2_f32_bf16 v243, v81, v238, v243
 v_dot2_f32_bf16 v241, v82, v238, v241
 v_dot2_f32_bf16 v243, v83, v238, v243
 s_waitcnt vmcnt(12)
 v_dot2_f32_bf16 v241, v84, v238, v241
 v_dot2_f32_bf16 v243, v85, v238, v243
 v_dot2_f32_bf16 v241, v86, v238, v241
 v_dot2_f32_bf16 v243, v87, v238, v243
 v_add_f32 v240, v240, v242
 s_nop 1
 v_add_f32 v241, v241, v243
 v_add_f32_dpp v240, v240, v240 quad_perm:[1,0,3,2] row_mask:0xf bank_mask:0xf
 s_nop 0
 v_add_f32_dpp v241, v241, v241 quad_perm:[1,0,3,2] row_mask:0xf bank_mask:0xf
 v_add_f32_dpp v240, v240, v240 quad_perm:[2,3,0,1] row_mask:0xf bank_mask:0xf
 s_nop 0
 v_add_f32_dpp v241, v241, v241 quad_perm:[2,3,0,1] row_mask:0xf bank_mask:0xf
 v_add_f32_dpp v240, v240, v240 row_half_mirror row_mask:0xf bank_mask:0xf
 s_nop 0
 v_add_f32_dpp v241, v241, v241 row_half_mirror row_mask:0xf bank_mask:0xf
 v_cndmask_b32 v240, v240, v241, vcc
 v_cvt_pk_bf16_f32 v249, v240, v240
 v_lshlrev_b32 v248, 16, v249
 v_sub_f32 v248, v240, v248
 v_cvt_pk_bf16_f32 v248, v240, v248
 v_and_b32 v249, 0xffff, v249
 s_waitcnt lgkmcnt(0)
 buffer_store_dwordx4 v[248:251], v14, s[16:19], s51 offen sc1
 buffer_load_dwordx4 v[64:67], v233, s[8:11], s60 offen offset:384
 buffer_load_dwordx4 v[68:71], v233, s[8:11], s60 offen offset:512
 buffer_load_dwordx4 v[72:75], v233, s[8:11], s60 offen offset:640
 buffer_load_dwordx4 v[76:79], v233, s[8:11], s60 offen offset:768
 buffer_load_dwordx4 v[80:83], v233, s[8:11], s60 offen offset:896
 buffer_load_dwordx4 v[84:87], v233, s[8:11], s60 offen offset:1024
 s_add_u32 s51, s51, 1024
 s_add_u32 s63, s63, 1
 s_cmp_lt_u32 s63, 6
 s_cbranch_scc1 L_hs
 s_waitcnt vmcnt(0)
 s_endpgm
L_help_t:
 s_barrier
 s_and_b32 s13, s13, 0xffff
 s_mov_b32 s14, 0x510000
 s_mov_b32 s15, 0x20000
 v_mul_u32_u24 v3, 1152, v0
 s_mul_i32 s38, s29, 1327104
 buffer_load_dword v16, v3, s[12:15], s38 offen offset:0
 buffer_load_dword v17, v3, s[12:15], s38 offen offset:128
 buffer_load_dword v18, v3, s[12:15], s38 offen offset:256
 s_add_u32 s38, s38, 442368
 buffer_load_dword v19, v3, s[12:15], s38 offen offset:384
 buffer_load_dword v20, v3, s[12:15], s38 offen offset:512
 buffer_load_dword v21, v3, s[12:15], s38 offen offset:640
 s_add_u32 s38, s38, 442368
 buffer_load_dword v22, v3, s[12:15], s38 offen offset:768
 buffer_load_dword v23, v3, s[12:15], s38 offen offset:896
 buffer_load_dword v24, v3, s[12:15], s38 offen offset:1024
 s_add_u32 s38, s38, 442368
 s_waitcnt vmcnt(0)
 s_endpgm
L_code_end:
.section .rodata,"a"
.p2align 6
.amdhsa_kernel recurrent_scan__ssm_conv_s5__mixer_channel_mlp__prompt_kernel
  .amdhsa_next_free_vgpr 512
  .amdhsa_next_free_sgpr 102
  .amdhsa_accum_offset 256
  .amdhsa_group_segment_fixed_size 0
  .amdhsa_kernarg_size 136
  .amdhsa_user_sgpr_count 2
  .amdhsa_user_sgpr_kernarg_segment_ptr 1
  .amdhsa_system_sgpr_workgroup_id_x 1
  .amdhsa_float_denorm_mode_32 3
.end_amdhsa_kernel
```
